```python
import torch

def _softmax(x, axis=-1):
    return torch.softmax(x, dim=axis)

def _gelu(x):
    return torch.nn.functional.gelu(x, approximate='tanh')

def _silu(x):
    return torch.nn.functional.silu(x)

def _sigmoid(x):
    return torch.sigmoid(x)

def _layernorm(x, axis=-1, eps=1e-05):
    m = x.mean(dim=axis, keepdim=True)
    v = x.var(dim=axis, keepdim=True, unbiased=False)
    return (x - m) / torch.sqrt(v + eps)

def _scatter_add(tgt, idx, src, axis=0):
    return tgt.clone().index_add_(axis, idx, src)

def _segment_sum(src, seg, n):
    out = torch.zeros((n,) + src.shape[1:], dtype=src.dtype)
    return out.index_add_(0, seg, src)

def _pad(x, pw):
    flat = tuple((v for pair in reversed(pw) for v in pair))
    return torch.nn.functional.pad(x, flat)
kernel_name = 'adaLN_cond__ssm_conv_s4d__mixer_s_mlp__prompt'

def setup_inputs():

    _w = lambda a: (lambda t: t.to(torch.bfloat16) if t.is_floating_point() else t)(torch.as_tensor(a))

    def _A_setup():
        Bsz, L, D, N = (1, 2048, 576, 128)
        return {'u': _w((lambda *s: torch.randn(*s, dtype=torch.bfloat16) * 0.05)(Bsz, L, D)), 'log_A_real': _w((lambda *s: torch.randn(*s, dtype=torch.bfloat16) * 3.2)(D, N) * 0.5), 'A_imag': _w((lambda *s: torch.randn(*s, dtype=torch.bfloat16) * 0.1)(D, N) * 3.14), 'C_real': _w((lambda *s: torch.randn(*s, dtype=torch.bfloat16) * 0.4)(D, N) / N ** 0.5), 'C_imag': _w((lambda *s: torch.randn(*s, dtype=torch.bfloat16) * 0.4)(D, N) / N ** 0.5), 'log_dt': _w((lambda *s: torch.randn(*s, dtype=torch.bfloat16) * 0.1)(D) * 0.5 - 4.0), 'D_skip': _w((lambda *s: torch.randn(*s, dtype=torch.bfloat16) * 0.1)(D))}
    _A_in = _A_setup()

    def _B_setup():
        B, S, D, F = (1, 2048, 576, 4608)
        return {'x': _w((lambda *s: torch.randn(*s, dtype=torch.bfloat16) * 0.05)(B, S, D)), 'w1': _w((lambda *s: torch.randn(*s, dtype=torch.bfloat16) * 3.2)(D, D) * D ** (-0.5)), 'w2': _w((lambda *s: torch.randn(*s, dtype=torch.bfloat16) * 3.2)(D, D) * D ** (-0.5)), 'w3': _w((lambda *s: torch.randn(*s, dtype=torch.bfloat16) * 3.2)(D, F) * D ** (-0.5)), 'w4': _w((lambda *s: torch.randn(*s, dtype=torch.bfloat16) * 3.2)(F, D) * F ** (-0.5))}
    _B_in = _B_setup()
    return {'A_u': _A_in['u'], 'A_log_A_real': _A_in['log_A_real'], 'A_A_imag': _A_in['A_imag'], 'A_C_real': _A_in['C_real'], 'A_C_imag': _A_in['C_imag'], 'A_log_dt': _A_in['log_dt'], 'A_D_skip': _A_in['D_skip'], 'B_x': _B_in['x'], 'B_w1': _B_in['w1'], 'B_w2': _B_in['w2'], 'B_w3': _B_in['w3'], 'B_w4': _B_in['w4'], 'c': _w((lambda *s: torch.randn(*s, dtype=torch.bfloat16) * 0.2)(1, 576) * 8.0), 'w_mod': _w((lambda *s: torch.randn(*s, dtype=torch.bfloat16) * 0.2)(576, 6 * 576) * 576 ** (-0.5) * 8.0)}

def reference(A_u, A_log_A_real, A_A_imag, A_C_real, A_C_imag, A_log_dt, A_D_skip, B_x, B_w1, B_w2, B_w3, B_w4, c, w_mod):

    def _A_ref(u, log_A_real, A_imag, C_real, C_imag, log_dt, D_skip):
        L = u.shape[1]
        dt = torch.exp(log_dt)
        A = -torch.exp(log_A_real) + 1j * A_imag
        C = (C_real + 1j * C_imag) * dt[:, None]
        pos = (lambda x, dt: x.to(dt))(torch.arange(L), log_dt.dtype)
        P = torch.exp((A * dt[:, None])[:, :, None] * pos[None, None, :])
        K = 2.0 * torch.einsum('dn,dnl->dl', C, P).real
        L2 = 2 * L
        u_t = (lambda x, *d: x.permute(*d))(u, 0, 2, 1)
        Kf = (lambda x, *a, **k: torch.fft.rfft(x.float(), *a, **k))(K, L2)
        Uf = (lambda x, *a, **k: torch.fft.rfft(x.float(), *a, **k))(u_t, L2)
        y = (lambda x, *a, **k: torch.fft.irfft(x, *a, **k).to(torch.bfloat16))(Uf * Kf[None, :, :], L2)[:, :, :L]
        y = (lambda x, *d: x.permute(*d))(y, 0, 2, 1)
        return y + u * D_skip[None, None, :]

    def _B_ref(x, w1, w2, w3, w4):
        B, S, D = x.shape
        h = _gelu(_layernorm(x, axis=-1) @ w1)
        c = D // 4
        g0 = _pad(h[:, :, 0 * c:1 * c], ((0, 0), (1, 0), (0, 0)))[:, :S, :]
        g1 = _pad(h[:, :, 1 * c:2 * c], ((0, 0), (0, 1), (0, 0)))[:, 1:, :]
        g2 = _pad(h[:, :, 2 * c:3 * c], ((0, 0), (2, 0), (0, 0)))[:, :S, :]
        g3 = _pad(h[:, :, 3 * c:], ((0, 0), (0, 2), (0, 0)))[:, 2:, :]
        hs = torch.concatenate([g0, g1, g2, g3], axis=-1) @ w2
        x1 = x + hs
        h2 = _gelu(_layernorm(x1, axis=-1) @ w3) @ w4
        return x1 + h2
    x = A_u
    mod = (_silu(c) @ w_mod).reshape(c.shape[0], 6, 1, -1)
    sa, ca, ga, sb, cb, gb = (mod[:, 0].clone(), mod[:, 1].clone(), mod[:, 2].clone(), mod[:, 3].clone(), mod[:, 4].clone(), mod[:, 5].clone())
    h = _layernorm(x, axis=-1) * (1 + ca) + sa
    x = x + ga * _A_ref(h, A_log_A_real, A_A_imag, A_C_real, A_C_imag, A_log_dt, A_D_skip)
    h = _layernorm(x, axis=-1) * (1 + cb) + sb
    x = x + gb * _B_ref(h, B_w1, B_w2, B_w3, B_w4)
    return x
```

```asm
; @launch grid=(256,1,1) block=(256,1,1) lds=162816
.amdgcn_target "amdgcn-amd-amdhsa--gfx950"
.text
.globl adaLN_cond__ssm_conv_s4d__mixer_s_mlp__prompt_kernel
.p2align 8
.type adaLN_cond__ssm_conv_s4d__mixer_s_mlp__prompt_kernel,@function
adaLN_cond__ssm_conv_s4d__mixer_s_mlp__prompt_kernel:
    s_cmp_ge_u32 s2, 256
    s_cbranch_scc1 km_exit
    s_load_dwordx16 s[8:23], s[0:1], 0
    s_load_dwordx2 s[28:29], s[0:1], 128
    s_load_dwordx2 s[96:97], s[0:1], 120
    v_lshrrev_b32 v1, 6, v0
    v_and_b32 v2, 63, v0
    s_add_u32 s57, s2, 144
    v_readfirstlane_b32 s3, v1
    s_and_b32 s57, s57, 255
    s_cmp_ge_u32 s57, 144
    s_cbranch_scc1 km_side
code_begin:
    s_cmp_ge_u32 s57, 8
    s_cselect_b32 s4, 0, 1
    s_getpc_b64 s[6:7]
here_1:
    s_mul_i32 s39, s4, 24448
    s_lshl_b32 s4, s3, 13
    v_lshl_add_u32 v3, v2, 7, s4
    v_min_u32 v3, s39, v3
    v_mov_b32 v5, s7
    v_add_co_u32 v4, vcc, s6, v3
    s_nop 1
    v_addc_co_u32 v5, vcc, 0, v5, vcc
    global_load_dword a20, v[4:5], off
    s_and_b32 s4, s57, 7
    s_lshr_b32 s5, s57, 3
    s_lshl_b32 s59, s4, 4
    s_lshl_b32 s4, s4, 1
    s_add_u32 s4, s4, 112
    s_cmp_lt_u32 s5, 16
    s_cselect_b32 s59, s59, s4
    s_add_u32 s59, s59, s5
    s_lshl_b32 s5, s59, 2
    s_add_u32 s5, s5, s3
    s_lshl_b32 s7, s5, 8
    v_lshl_add_u32 v4, v2, 2, s7
    s_lshl_b32 s6, s5, 1
    v_mov_b32 v6, s6
    s_waitcnt lgkmcnt(0)
    global_load_ushort v10, v6, s[18:19]
    global_load_dword v11, v4, s[10:11] nt
    global_load_dword v12, v4, s[12:13] nt
    global_load_dword v14, v4, s[14:15] nt
    global_load_dword v15, v4, s[16:17] nt
    global_load_ushort v18, v6, s[20:21]
    s_mov_b32 s30, 53477376
    s_mov_b32 s31, 0x20000
    s_mov_b32 s98, 256
    s_mov_b32 s99, 0x20000
    v_lshlrev_b32 v250, 4, v2
    v_mov_b32 v244, 1
    v_mov_b32 v245, 0
    v_mov_b32 v247, 0
    v_mov_b32 v249, 0
    s_and_b32 s58, s2, 1
    s_bfe_u32 s61, s2, 131075
    s_lshl_b32 s58, s58, 2
    s_add_u32 s58, s58, s61
    s_bfe_u32 s61, s2, 131073
    s_lshl_b32 s61, s61, 3
    s_lshr_b32 s60, s2, 5
    s_add_u32 s61, s61, s60
    s_lshl_b32 s61, s61, 3
    s_add_u32 s60, s58, s61
    s_lshl_b32 s60, s60, 7
    s_add_u32 s60, s60, 163840
    s_mov_b32 s61, 0
    s_mov_b64 s[32:33], s[8:9]
    s_mov_b32 s34, 2359296
    s_mov_b32 s19, 0x20000
    v_mul_u32_u24 v8, 9216, v2
    s_mul_i32 s4, s3, 589824
    s_lshl_b32 s6, s59, 3
    s_add_u32 s4, s4, s6
    s_add_u32 s38, s4, 4608
    v_mov_b32 v233, v8
    v_mul_u32_u24 v8, 1152, v2
    s_lshr_b32 s6, s57, 3
    s_and_b32 s39, s59, 15
    s_lshr_b32 s42, s59, 4
    s_cmp_lt_u32 s3, 2
    s_cselect_b32 s6, s39, s6
    s_cselect_b32 s42, s42, 8
    s_lshl_b32 s6, s6, 1
    s_and_b32 s39, s3, 1
    s_add_u32 s6, s6, s39
    s_mul_i32 s6, s6, 73728
    s_lshl_b32 s42, s42, 7
    s_add_u32 s6, s6, s42
    s_mov_b32 s56, s6
    v_mov_b32 v232, v8
    s_mov_b64 s[16:17], s[32:33]
    s_mov_b32 s18, s34
    s_mul_i32 s34, s3, 28672
    v_lshlrev_b32 v7, 3, v2
    v_add_u32 v7, s34, v7
    s_load_dwordx2 s[40:41], s[0:1], 104
    s_mov_b32 s42, 3981312
    s_mov_b32 s43, 0x20000
    v_xor_b32 v64, 0, v7
    v_xor_b32 v65, 16, v7
    v_xor_b32 v66, 32, v7
    v_xor_b32 v67, 48, v7
    v_xor_b32 v68, 64, v7
    v_xor_b32 v69, 80, v7
    v_xor_b32 v70, 96, v7
    v_xor_b32 v71, 112, v7
    v_xor_b32 v72, 128, v7
    v_xor_b32 v73, 144, v7
    v_xor_b32 v74, 160, v7
    v_xor_b32 v75, 176, v7
    v_xor_b32 v76, 192, v7
    v_xor_b32 v77, 208, v7
    v_xor_b32 v78, 224, v7
    v_xor_b32 v79, 240, v7
    s_mov_b32 s36, 0x3fb8aa3b
    s_mov_b32 s37, 0x3e22f983
    s_waitcnt vmcnt(5)
    v_lshlrev_b32 v10, 16, v10
    v_mul_f32 v10, s36, v10
    v_exp_f32 v10, v10
    s_waitcnt vmcnt(4)
    v_and_b32 v121, 0xffff0000, v11
    v_lshlrev_b32 v11, 16, v11
    s_waitcnt vmcnt(3)
    v_and_b32 v122, 0xffff0000, v12
    v_lshlrev_b32 v12, 16, v12
    s_waitcnt vmcnt(2)
    v_and_b32 v124, 0xffff0000, v14
    v_lshlrev_b32 v14, 16, v14
    s_waitcnt vmcnt(1)
    v_and_b32 v125, 0xffff0000, v15
    v_lshlrev_b32 v15, 16, v15
    v_mul_f32 v11, s36, v11
    v_mul_f32 v121, s36, v121
    v_exp_f32 v11, v11
    v_exp_f32 v121, v121
    v_cvt_pk_bf16_f32 v10, v10, v10
    v_and_b32 v10, 0xffff0000, v10
    v_cvt_pk_bf16_f32 v11, v11, v121
    v_and_b32 v121, 0xffff0000, v11
    v_lshlrev_b32 v11, 16, v11
    v_mul_f32 v11, v11, v10
    v_mul_f32 v12, v12, v10
    v_mul_f32 v121, v121, v10
    v_mul_f32 v122, v122, v10
    v_mul_f32 v11, s36, v11
    v_mul_f32 v12, s37, v12
    v_mul_f32 v121, s36, v121
    v_mul_f32 v122, s37, v122
    v_mul_f32 v30, 0xbf800000, v11
    v_mul_f32 v34, 0x3f800000, v12
    v_mul_f32 v140, 0xbf800000, v121
    v_mul_f32 v144, 0x3f800000, v122
    v_mul_f32 v31, 0xc1000000, v11
    v_mul_f32 v35, 0x41000000, v12
    v_mul_f32 v141, 0xc1000000, v121
    v_mul_f32 v145, 0x41000000, v122
    v_mul_f32 v32, 0xc2800000, v11
    v_mul_f32 v36, 0x42800000, v12
    v_mul_f32 v142, 0xc2800000, v121
    v_mul_f32 v146, 0x42800000, v122
    v_mul_f32 v33, 0xc3800000, v11
    v_mul_f32 v37, 0x43800000, v12
    v_mul_f32 v143, 0xc3800000, v121
    v_mul_f32 v147, 0x43800000, v122
    v_max3_f32 v16, |v14|, |v15|, |v124|
    v_max_f32 v16, |v16|, |v125|
    v_exp_f32 v30, v30
    v_fract_f32 v34, v34
    v_exp_f32 v140, v140
    v_fract_f32 v144, v144
    v_max_f32_dpp v16, v16, v16 row_ror:8 row_mask:0xf bank_mask:0xf bound_ctrl:1
    v_exp_f32 v31, v31
    v_fract_f32 v35, v35
    v_exp_f32 v141, v141
    v_fract_f32 v145, v145
    v_max_f32_dpp v16, v16, v16 row_ror:4 row_mask:0xf bank_mask:0xf bound_ctrl:1
    v_exp_f32 v32, v32
    v_fract_f32 v36, v36
    v_exp_f32 v142, v142
    v_fract_f32 v146, v146
    v_max_f32_dpp v16, v16, v16 row_ror:2 row_mask:0xf bank_mask:0xf bound_ctrl:1
    v_exp_f32 v33, v33
    v_fract_f32 v37, v37
    v_exp_f32 v143, v143
    v_fract_f32 v147, v147
    v_max_f32_dpp v16, v16, v16 row_ror:1 row_mask:0xf bank_mask:0xf bound_ctrl:1
    v_cos_f32 v20, v34
    v_sin_f32 v21, v34
    v_cos_f32 v130, v144
    v_sin_f32 v131, v144
    v_cos_f32 v22, v35
    v_sin_f32 v23, v35
    v_cos_f32 v132, v145
    v_sin_f32 v133, v145
    v_cos_f32 v24, v36
    v_sin_f32 v25, v36
    v_cos_f32 v134, v146
    v_sin_f32 v135, v146
    v_cos_f32 v26, v37
    v_sin_f32 v27, v37
    v_cos_f32 v136, v147
    v_sin_f32 v137, v147
    v_mov_b32 v17, v16
    s_nop 1
    v_permlane16_swap_b32 v16, v17
    v_max_f32 v16, v16, v17
    v_mov_b32 v17, v16
    s_nop 1
    v_permlane32_swap_b32 v16, v17
    v_max_f32 v16, v16, v17
    v_mul_f32 v20, v20, v30
    v_mul_f32 v21, v21, v30
    v_mul_f32 v130, v130, v140
    v_mul_f32 v131, v131, v140
    v_mul_f32 v22, v22, v31
    v_mul_f32 v23, v23, v31
    v_mul_f32 v132, v132, v141
    v_mul_f32 v133, v133, v141
    v_mul_f32 v24, v24, v32
    v_mul_f32 v25, v25, v32
    v_mul_f32 v134, v134, v142
    v_mul_f32 v135, v135, v142
    v_mul_f32 v26, v26, v33
    v_mul_f32 v27, v27, v33
    v_mul_f32 v136, v136, v143
    v_mul_f32 v137, v137, v143
    v_frexp_exp_i32_f32 v16, v16
    v_sub_u32 v17, 0, v16
    v_add_u32 v16, 1, v16
    v_ldexp_f32 v14, v14, v17
    v_ldexp_f32 v15, v15, v17
    v_ldexp_f32 v124, v124, v17
    v_ldexp_f32 v125, v125, v17
    v_ldexp_f32 v17, v10, v16
    v_mov_b32 v56, 0x3c00
    v_mov_b32 v57, 0x3c00
    ds_write_b64 v64, v[56:57]
    v_cvt_pk_f16_f32 v58, v22, v23
    v_cvt_pk_f16_f32 v59, v132, v133
    ds_write_b64 v65, v[58:59] offset:512
    v_cvt_pk_f16_f32 v60, v14, -v15
    v_cvt_pk_f16_f32 v61, v124, -v125
    ds_write_b64 v64, v[60:61] offset:16384
    v_cvt_pk_f16_f32 v62, v24, v25
    v_cvt_pk_f16_f32 v63, v134, v135
    ds_write_b64 v72, v[62:63] offset:4096
    v_pk_mul_f32 v[84:85], v[22:23], v[22:23] op_sel:[0,0] op_sel_hi:[0,1]
    v_pk_mul_f32 v[194:195], v[132:133], v[132:133] op_sel:[0,0] op_sel_hi:[0,1]
    v_pk_fma_f32 v[84:85], v[22:23], v[22:23], v[84:85] op_sel:[1,1,0] op_sel_hi:[1,0,1] neg_lo:[1,0,0]
    v_pk_fma_f32 v[194:195], v[132:133], v[132:133], v[194:195] op_sel:[1,1,0] op_sel_hi:[1,0,1] neg_lo:[1,0,0]
    v_pk_mul_f32 v[104:105], v[14:15], v[20:21] op_sel:[0,0] op_sel_hi:[0,1]
    v_pk_mul_f32 v[214:215], v[124:125], v[130:131] op_sel:[0,0] op_sel_hi:[0,1]
    v_pk_fma_f32 v[104:105], v[14:15], v[20:21], v[104:105] op_sel:[1,1,0] op_sel_hi:[1,0,1] neg_lo:[1,0,0]
    v_pk_fma_f32 v[214:215], v[124:125], v[130:131], v[214:215] op_sel:[1,1,0] op_sel_hi:[1,0,1] neg_lo:[1,0,0]
    v_cvt_pk_f16_f32 v56, v84, v85
    v_cvt_pk_f16_f32 v57, v194, v195
    ds_write_b64 v66, v[56:57] offset:1024
    v_cvt_pk_f16_f32 v58, v104, -v105
    v_cvt_pk_f16_f32 v59, v214, -v215
    ds_write_b64 v65, v[58:59] offset:16896
    v_pk_mul_f32 v[86:87], v[84:85], v[22:23] op_sel:[0,0] op_sel_hi:[0,1]
    v_pk_mul_f32 v[196:197], v[194:195], v[132:133] op_sel:[0,0] op_sel_hi:[0,1]
    v_pk_fma_f32 v[86:87], v[84:85], v[22:23], v[86:87] op_sel:[1,1,0] op_sel_hi:[1,0,1] neg_lo:[1,0,0]
    v_pk_fma_f32 v[196:197], v[194:195], v[132:133], v[196:197] op_sel:[1,1,0] op_sel_hi:[1,0,1] neg_lo:[1,0,0]
    v_pk_mul_f32 v[106:107], v[104:105], v[20:21] op_sel:[0,0] op_sel_hi:[0,1]
    v_pk_mul_f32 v[216:217], v[214:215], v[130:131] op_sel:[0,0] op_sel_hi:[0,1]
    v_pk_fma_f32 v[106:107], v[104:105], v[20:21], v[106:107] op_sel:[1,1,0] op_sel_hi:[1,0,1] neg_lo:[1,0,0]
    v_pk_fma_f32 v[216:217], v[214:215], v[130:131], v[216:217] op_sel:[1,1,0] op_sel_hi:[1,0,1] neg_lo:[1,0,0]
    v_cvt_pk_f16_f32 v60, v86, v87
    v_cvt_pk_f16_f32 v61, v196, v197
    ds_write_b64 v67, v[60:61] offset:1536
    v_cvt_pk_f16_f32 v62, v106, -v107
    v_cvt_pk_f16_f32 v63, v216, -v217
    ds_write_b64 v66, v[62:63] offset:17408
    v_pk_mul_f32 v[88:89], v[84:85], v[84:85] op_sel:[0,0] op_sel_hi:[0,1]
    v_pk_mul_f32 v[198:199], v[194:195], v[194:195] op_sel:[0,0] op_sel_hi:[0,1]
    v_pk_fma_f32 v[88:89], v[84:85], v[84:85], v[88:89] op_sel:[1,1,0] op_sel_hi:[1,0,1] neg_lo:[1,0,0]
    v_pk_fma_f32 v[198:199], v[194:195], v[194:195], v[198:199] op_sel:[1,1,0] op_sel_hi:[1,0,1] neg_lo:[1,0,0]
    v_pk_mul_f32 v[108:109], v[106:107], v[20:21] op_sel:[0,0] op_sel_hi:[0,1]
    v_pk_mul_f32 v[218:219], v[216:217], v[130:131] op_sel:[0,0] op_sel_hi:[0,1]
    v_pk_fma_f32 v[108:109], v[106:107], v[20:21], v[108:109] op_sel:[1,1,0] op_sel_hi:[1,0,1] neg_lo:[1,0,0]
    v_pk_fma_f32 v[218:219], v[216:217], v[130:131], v[218:219] op_sel:[1,1,0] op_sel_hi:[1,0,1] neg_lo:[1,0,0]
    v_cvt_pk_f16_f32 v56, v88, v89
    v_cvt_pk_f16_f32 v57, v198, v199
    ds_write_b64 v68, v[56:57] offset:2048
    v_cvt_pk_f16_f32 v58, v108, -v109
    v_cvt_pk_f16_f32 v59, v218, -v219
    ds_write_b64 v67, v[58:59] offset:17920
    v_pk_mul_f32 v[90:91], v[88:89], v[22:23] op_sel:[0,0] op_sel_hi:[0,1]
    v_pk_mul_f32 v[200:201], v[198:199], v[132:133] op_sel:[0,0] op_sel_hi:[0,1]
    v_pk_fma_f32 v[90:91], v[88:89], v[22:23], v[90:91] op_sel:[1,1,0] op_sel_hi:[1,0,1] neg_lo:[1,0,0]
    v_pk_fma_f32 v[200:201], v[198:199], v[132:133], v[200:201] op_sel:[1,1,0] op_sel_hi:[1,0,1] neg_lo:[1,0,0]
    v_pk_mul_f32 v[110:111], v[108:109], v[20:21] op_sel:[0,0] op_sel_hi:[0,1]
    v_pk_mul_f32 v[220:221], v[218:219], v[130:131] op_sel:[0,0] op_sel_hi:[0,1]
    v_pk_fma_f32 v[110:111], v[108:109], v[20:21], v[110:111] op_sel:[1,1,0] op_sel_hi:[1,0,1] neg_lo:[1,0,0]
    v_pk_fma_f32 v[220:221], v[218:219], v[130:131], v[220:221] op_sel:[1,1,0] op_sel_hi:[1,0,1] neg_lo:[1,0,0]
    v_cvt_pk_f16_f32 v60, v90, v91
    v_cvt_pk_f16_f32 v61, v200, v201
    ds_write_b64 v69, v[60:61] offset:2560
    v_cvt_pk_f16_f32 v62, v110, -v111
    v_cvt_pk_f16_f32 v63, v220, -v221
    ds_write_b64 v68, v[62:63] offset:18432
    v_pk_mul_f32 v[92:93], v[90:91], v[22:23] op_sel:[0,0] op_sel_hi:[0,1]
    v_pk_mul_f32 v[202:203], v[200:201], v[132:133] op_sel:[0,0] op_sel_hi:[0,1]
    v_pk_fma_f32 v[92:93], v[90:91], v[22:23], v[92:93] op_sel:[1,1,0] op_sel_hi:[1,0,1] neg_lo:[1,0,0]
    v_pk_fma_f32 v[202:203], v[200:201], v[132:133], v[202:203] op_sel:[1,1,0] op_sel_hi:[1,0,1] neg_lo:[1,0,0]
    v_pk_mul_f32 v[112:113], v[110:111], v[20:21] op_sel:[0,0] op_sel_hi:[0,1]
    v_pk_mul_f32 v[222:223], v[220:221], v[130:131] op_sel:[0,0] op_sel_hi:[0,1]
    v_pk_fma_f32 v[112:113], v[110:111], v[20:21], v[112:113] op_sel:[1,1,0] op_sel_hi:[1,0,1] neg_lo:[1,0,0]
    v_pk_fma_f32 v[222:223], v[220:221], v[130:131], v[222:223] op_sel:[1,1,0] op_sel_hi:[1,0,1] neg_lo:[1,0,0]
    v_cvt_pk_f16_f32 v56, v92, v93
    v_cvt_pk_f16_f32 v57, v202, v203
    ds_write_b64 v70, v[56:57] offset:3072
    v_cvt_pk_f16_f32 v58, v112, -v113
    v_cvt_pk_f16_f32 v59, v222, -v223
    ds_write_b64 v69, v[58:59] offset:18944
    v_pk_mul_f32 v[94:95], v[92:93], v[22:23] op_sel:[0,0] op_sel_hi:[0,1]
    v_pk_mul_f32 v[204:205], v[202:203], v[132:133] op_sel:[0,0] op_sel_hi:[0,1]
    v_pk_fma_f32 v[94:95], v[92:93], v[22:23], v[94:95] op_sel:[1,1,0] op_sel_hi:[1,0,1] neg_lo:[1,0,0]
    v_pk_fma_f32 v[204:205], v[202:203], v[132:133], v[204:205] op_sel:[1,1,0] op_sel_hi:[1,0,1] neg_lo:[1,0,0]
    v_pk_mul_f32 v[114:115], v[112:113], v[20:21] op_sel:[0,0] op_sel_hi:[0,1]
    v_pk_mul_f32 v[224:225], v[222:223], v[130:131] op_sel:[0,0] op_sel_hi:[0,1]
    v_pk_fma_f32 v[114:115], v[112:113], v[20:21], v[114:115] op_sel:[1,1,0] op_sel_hi:[1,0,1] neg_lo:[1,0,0]
    v_pk_fma_f32 v[224:225], v[222:223], v[130:131], v[224:225] op_sel:[1,1,0] op_sel_hi:[1,0,1] neg_lo:[1,0,0]
    v_cvt_pk_f16_f32 v60, v94, v95
    v_cvt_pk_f16_f32 v61, v204, v205
    ds_write_b64 v71, v[60:61] offset:3584
    buffer_load_dwordx2 a[0:1], v233, s[16:19], s4 offen offset:0
    v_cvt_pk_f16_f32 v62, v114, -v115
    v_cvt_pk_f16_f32 v63, v224, -v225
    ds_write_b64 v70, v[62:63] offset:19456
    v_pk_mul_f32 v[116:117], v[114:115], v[20:21] op_sel:[0,0] op_sel_hi:[0,1]
    v_pk_mul_f32 v[226:227], v[224:225], v[130:131] op_sel:[0,0] op_sel_hi:[0,1]
    v_pk_fma_f32 v[116:117], v[114:115], v[20:21], v[116:117] op_sel:[1,1,0] op_sel_hi:[1,0,1] neg_lo:[1,0,0]
    v_pk_fma_f32 v[226:227], v[224:225], v[130:131], v[226:227] op_sel:[1,1,0] op_sel_hi:[1,0,1] neg_lo:[1,0,0]
    v_pk_mul_f32 v[96:97], v[24:25], v[24:25] op_sel:[0,0] op_sel_hi:[0,1]
    v_pk_mul_f32 v[206:207], v[134:135], v[134:135] op_sel:[0,0] op_sel_hi:[0,1]
    v_pk_fma_f32 v[96:97], v[24:25], v[24:25], v[96:97] op_sel:[1,1,0] op_sel_hi:[1,0,1] neg_lo:[1,0,0]
    v_pk_fma_f32 v[206:207], v[134:135], v[134:135], v[206:207] op_sel:[1,1,0] op_sel_hi:[1,0,1] neg_lo:[1,0,0]
    v_cvt_pk_f16_f32 v56, v116, -v117
    v_cvt_pk_f16_f32 v57, v226, -v227
    ds_write_b64 v71, v[56:57] offset:19968
    v_pk_mul_f32 v[98:99], v[96:97], v[24:25] op_sel:[0,0] op_sel_hi:[0,1]
    v_pk_mul_f32 v[208:209], v[206:207], v[134:135] op_sel:[0,0] op_sel_hi:[0,1]
    v_pk_fma_f32 v[98:99], v[96:97], v[24:25], v[98:99] op_sel:[1,1,0] op_sel_hi:[1,0,1] neg_lo:[1,0,0]
    v_pk_fma_f32 v[208:209], v[206:207], v[134:135], v[208:209] op_sel:[1,1,0] op_sel_hi:[1,0,1] neg_lo:[1,0,0]
    v_cvt_pk_f16_f32 v58, v96, v97
    v_cvt_pk_f16_f32 v59, v206, v207
    ds_write_b64 v64, v[58:59] offset:8192
    v_cvt_pk_f16_f32 v60, v98, v99
    v_cvt_pk_f16_f32 v61, v208, v209
    ds_write_b64 v72, v[60:61] offset:12288
    v_pk_mul_f32 v[40:41], v[22:23], v[24:25] op_sel:[0,0] op_sel_hi:[0,1]
    v_pk_mul_f32 v[150:151], v[132:133], v[134:135] op_sel:[0,0] op_sel_hi:[0,1]
    v_pk_fma_f32 v[40:41], v[22:23], v[24:25], v[40:41] op_sel:[1,1,0] op_sel_hi:[1,0,1] neg_lo:[1,0,0]
    v_pk_fma_f32 v[150:151], v[132:133], v[134:135], v[150:151] op_sel:[1,1,0] op_sel_hi:[1,0,1] neg_lo:[1,0,0]
    v_pk_mul_f32 v[118:119], v[14:15], v[26:27] op_sel:[0,0] op_sel_hi:[0,1]
    v_pk_mul_f32 v[228:229], v[124:125], v[136:137] op_sel:[0,0] op_sel_hi:[0,1]
    v_pk_fma_f32 v[118:119], v[14:15], v[26:27], v[118:119] op_sel:[1,1,0] op_sel_hi:[1,0,1] neg_lo:[1,0,0]
    v_pk_fma_f32 v[228:229], v[124:125], v[136:137], v[228:229] op_sel:[1,1,0] op_sel_hi:[1,0,1] neg_lo:[1,0,0]
    v_cvt_pk_f16_f32 v62, v40, v41
    v_cvt_pk_f16_f32 v63, v150, v151
    ds_write_b64 v73, v[62:63] offset:4608
    buffer_load_dwordx2 a[2:3], v233, s[16:19], s4 offen offset:1152
    v_cvt_pk_f16_f32 v56, v118, -v119
    v_cvt_pk_f16_f32 v57, v228, -v229
    ds_write_b64 v72, v[56:57] offset:20480
    v_pk_mul_f32 v[42:43], v[84:85], v[24:25] op_sel:[0,0] op_sel_hi:[0,1]
    v_pk_mul_f32 v[152:153], v[194:195], v[134:135] op_sel:[0,0] op_sel_hi:[0,1]
    v_pk_fma_f32 v[42:43], v[84:85], v[24:25], v[42:43] op_sel:[1,1,0] op_sel_hi:[1,0,1] neg_lo:[1,0,0]
    v_pk_fma_f32 v[152:153], v[194:195], v[134:135], v[152:153] op_sel:[1,1,0] op_sel_hi:[1,0,1] neg_lo:[1,0,0]
    v_pk_mul_f32 v[120:121], v[118:119], v[26:27] op_sel:[0,0] op_sel_hi:[0,1]
    v_pk_mul_f32 v[230:231], v[228:229], v[136:137] op_sel:[0,0] op_sel_hi:[0,1]
    v_pk_fma_f32 v[120:121], v[118:119], v[26:27], v[120:121] op_sel:[1,1,0] op_sel_hi:[1,0,1] neg_lo:[1,0,0]
    v_pk_fma_f32 v[230:231], v[228:229], v[136:137], v[230:231] op_sel:[1,1,0] op_sel_hi:[1,0,1] neg_lo:[1,0,0]
    v_cvt_pk_f16_f32 v58, v42, v43
    v_cvt_pk_f16_f32 v59, v152, v153
    ds_write_b64 v74, v[58:59] offset:5120
    v_cvt_pk_f16_f32 v60, v120, -v121
    v_cvt_pk_f16_f32 v61, v230, -v231
    ds_write_b64 v76, v[60:61] offset:22528
    v_pk_mul_f32 v[44:45], v[86:87], v[24:25] op_sel:[0,0] op_sel_hi:[0,1]
    v_pk_mul_f32 v[154:155], v[196:197], v[134:135] op_sel:[0,0] op_sel_hi:[0,1]
    v_pk_fma_f32 v[44:45], v[86:87], v[24:25], v[44:45] op_sel:[1,1,0] op_sel_hi:[1,0,1] neg_lo:[1,0,0]
    v_pk_fma_f32 v[154:155], v[196:197], v[134:135], v[154:155] op_sel:[1,1,0] op_sel_hi:[1,0,1] neg_lo:[1,0,0]
    v_pk_mul_f32 v[118:119], v[120:121], v[26:27] op_sel:[0,0] op_sel_hi:[0,1]
    v_pk_mul_f32 v[228:229], v[230:231], v[136:137] op_sel:[0,0] op_sel_hi:[0,1]
    v_pk_fma_f32 v[118:119], v[120:121], v[26:27], v[118:119] op_sel:[1,1,0] op_sel_hi:[1,0,1] neg_lo:[1,0,0]
    v_pk_fma_f32 v[228:229], v[230:231], v[136:137], v[228:229] op_sel:[1,1,0] op_sel_hi:[1,0,1] neg_lo:[1,0,0]
    v_cvt_pk_f16_f32 v62, v44, v45
    v_cvt_pk_f16_f32 v63, v154, v155
    ds_write_b64 v75, v[62:63] offset:5632
    v_cvt_pk_f16_f32 v56, v118, -v119
    v_cvt_pk_f16_f32 v57, v228, -v229
    ds_write_b64 v78, v[56:57] offset:23552
    buffer_load_dwordx2 a[4:5], v233, s[16:19], s4 offen offset:2304
    v_pk_mul_f32 v[46:47], v[88:89], v[24:25] op_sel:[0,0] op_sel_hi:[0,1]
    v_pk_mul_f32 v[156:157], v[198:199], v[134:135] op_sel:[0,0] op_sel_hi:[0,1]
    v_pk_fma_f32 v[46:47], v[88:89], v[24:25], v[46:47] op_sel:[1,1,0] op_sel_hi:[1,0,1] neg_lo:[1,0,0]
    v_pk_fma_f32 v[156:157], v[198:199], v[134:135], v[156:157] op_sel:[1,1,0] op_sel_hi:[1,0,1] neg_lo:[1,0,0]
    v_pk_mul_f32 v[120:121], v[118:119], v[26:27] op_sel:[0,0] op_sel_hi:[0,1]
    v_pk_mul_f32 v[230:231], v[228:229], v[136:137] op_sel:[0,0] op_sel_hi:[0,1]
    v_pk_fma_f32 v[120:121], v[118:119], v[26:27], v[120:121] op_sel:[1,1,0] op_sel_hi:[1,0,1] neg_lo:[1,0,0]
    v_pk_fma_f32 v[230:231], v[228:229], v[136:137], v[230:231] op_sel:[1,1,0] op_sel_hi:[1,0,1] neg_lo:[1,0,0]
    v_cvt_pk_f16_f32 v58, v46, v47
    v_cvt_pk_f16_f32 v59, v156, v157
    ds_write_b64 v76, v[58:59] offset:6144
    v_cvt_pk_f16_f32 v60, v120, -v121
    v_cvt_pk_f16_f32 v61, v230, -v231
    ds_write_b64 v64, v[60:61] offset:24576
    v_pk_mul_f32 v[40:41], v[90:91], v[24:25] op_sel:[0,0] op_sel_hi:[0,1]
    v_pk_mul_f32 v[150:151], v[200:201], v[134:135] op_sel:[0,0] op_sel_hi:[0,1]
    v_pk_fma_f32 v[40:41], v[90:91], v[24:25], v[40:41] op_sel:[1,1,0] op_sel_hi:[1,0,1] neg_lo:[1,0,0]
    v_pk_fma_f32 v[150:151], v[200:201], v[134:135], v[150:151] op_sel:[1,1,0] op_sel_hi:[1,0,1] neg_lo:[1,0,0]
    v_pk_mul_f32 v[118:119], v[120:121], v[26:27] op_sel:[0,0] op_sel_hi:[0,1]
    v_pk_mul_f32 v[228:229], v[230:231], v[136:137] op_sel:[0,0] op_sel_hi:[0,1]
    v_pk_fma_f32 v[118:119], v[120:121], v[26:27], v[118:119] op_sel:[1,1,0] op_sel_hi:[1,0,1] neg_lo:[1,0,0]
    v_pk_fma_f32 v[228:229], v[230:231], v[136:137], v[228:229] op_sel:[1,1,0] op_sel_hi:[1,0,1] neg_lo:[1,0,0]
    v_cvt_pk_f16_f32 v62, v40, v41
    v_cvt_pk_f16_f32 v63, v150, v151
    ds_write_b64 v77, v[62:63] offset:6656
    v_cvt_pk_f16_f32 v56, v118, -v119
    v_cvt_pk_f16_f32 v57, v228, -v229
    ds_write_b64 v65, v[56:57] offset:25088
    v_pk_mul_f32 v[42:43], v[92:93], v[24:25] op_sel:[0,0] op_sel_hi:[0,1]
    v_pk_mul_f32 v[152:153], v[202:203], v[134:135] op_sel:[0,0] op_sel_hi:[0,1]
    v_pk_fma_f32 v[42:43], v[92:93], v[24:25], v[42:43] op_sel:[1,1,0] op_sel_hi:[1,0,1] neg_lo:[1,0,0]
    v_pk_fma_f32 v[152:153], v[202:203], v[134:135], v[152:153] op_sel:[1,1,0] op_sel_hi:[1,0,1] neg_lo:[1,0,0]
    v_pk_mul_f32 v[120:121], v[118:119], v[26:27] op_sel:[0,0] op_sel_hi:[0,1]
    v_pk_mul_f32 v[230:231], v[228:229], v[136:137] op_sel:[0,0] op_sel_hi:[0,1]
    v_pk_fma_f32 v[120:121], v[118:119], v[26:27], v[120:121] op_sel:[1,1,0] op_sel_hi:[1,0,1] neg_lo:[1,0,0]
    v_pk_fma_f32 v[230:231], v[228:229], v[136:137], v[230:231] op_sel:[1,1,0] op_sel_hi:[1,0,1] neg_lo:[1,0,0]
    v_cvt_pk_f16_f32 v58, v42, v43
    v_cvt_pk_f16_f32 v59, v152, v153
    ds_write_b64 v78, v[58:59] offset:7168
    buffer_load_dwordx2 a[6:7], v233, s[16:19], s4 offen offset:3456
    v_cvt_pk_f16_f32 v60, v120, -v121
    v_cvt_pk_f16_f32 v61, v230, -v231
    ds_write_b64 v66, v[60:61] offset:25600
    v_pk_mul_f32 v[44:45], v[94:95], v[24:25] op_sel:[0,0] op_sel_hi:[0,1]
    v_pk_mul_f32 v[154:155], v[204:205], v[134:135] op_sel:[0,0] op_sel_hi:[0,1]
    v_pk_fma_f32 v[44:45], v[94:95], v[24:25], v[44:45] op_sel:[1,1,0] op_sel_hi:[1,0,1] neg_lo:[1,0,0]
    v_pk_fma_f32 v[154:155], v[204:205], v[134:135], v[154:155] op_sel:[1,1,0] op_sel_hi:[1,0,1] neg_lo:[1,0,0]
    v_pk_mul_f32 v[118:119], v[120:121], v[26:27] op_sel:[0,0] op_sel_hi:[0,1]
    v_pk_mul_f32 v[228:229], v[230:231], v[136:137] op_sel:[0,0] op_sel_hi:[0,1]
    v_pk_fma_f32 v[118:119], v[120:121], v[26:27], v[118:119] op_sel:[1,1,0] op_sel_hi:[1,0,1] neg_lo:[1,0,0]
    v_pk_fma_f32 v[228:229], v[230:231], v[136:137], v[228:229] op_sel:[1,1,0] op_sel_hi:[1,0,1] neg_lo:[1,0,0]
    v_cvt_pk_f16_f32 v62, v44, v45
    v_cvt_pk_f16_f32 v63, v154, v155
    ds_write_b64 v79, v[62:63] offset:7680
    v_cvt_pk_f16_f32 v56, v118, -v119
    v_cvt_pk_f16_f32 v57, v228, -v229
    ds_write_b64 v67, v[56:57] offset:26112
    v_pk_mul_f32 v[46:47], v[22:23], v[96:97] op_sel:[0,0] op_sel_hi:[0,1]
    v_pk_mul_f32 v[156:157], v[132:133], v[206:207] op_sel:[0,0] op_sel_hi:[0,1]
    v_pk_fma_f32 v[46:47], v[22:23], v[96:97], v[46:47] op_sel:[1,1,0] op_sel_hi:[1,0,1] neg_lo:[1,0,0]
    v_pk_fma_f32 v[156:157], v[132:133], v[206:207], v[156:157] op_sel:[1,1,0] op_sel_hi:[1,0,1] neg_lo:[1,0,0]
    v_pk_mul_f32 v[120:121], v[118:119], v[26:27] op_sel:[0,0] op_sel_hi:[0,1]
    v_pk_mul_f32 v[230:231], v[228:229], v[136:137] op_sel:[0,0] op_sel_hi:[0,1]
    v_pk_fma_f32 v[120:121], v[118:119], v[26:27], v[120:121] op_sel:[1,1,0] op_sel_hi:[1,0,1] neg_lo:[1,0,0]
    v_pk_fma_f32 v[230:231], v[228:229], v[136:137], v[230:231] op_sel:[1,1,0] op_sel_hi:[1,0,1] neg_lo:[1,0,0]
    v_cvt_pk_f16_f32 v58, v46, v47
    v_cvt_pk_f16_f32 v59, v156, v157
    ds_write_b64 v65, v[58:59] offset:8704
    v_cvt_pk_f16_f32 v60, v120, -v121
    v_cvt_pk_f16_f32 v61, v230, -v231
    ds_write_b64 v68, v[60:61] offset:26624
    buffer_load_dwordx2 a[8:9], v233, s[16:19], s38 offen offset:0
    v_pk_mul_f32 v[40:41], v[84:85], v[96:97] op_sel:[0,0] op_sel_hi:[0,1]
    v_pk_mul_f32 v[150:151], v[194:195], v[206:207] op_sel:[0,0] op_sel_hi:[0,1]
    v_pk_fma_f32 v[40:41], v[84:85], v[96:97], v[40:41] op_sel:[1,1,0] op_sel_hi:[1,0,1] neg_lo:[1,0,0]
    v_pk_fma_f32 v[150:151], v[194:195], v[206:207], v[150:151] op_sel:[1,1,0] op_sel_hi:[1,0,1] neg_lo:[1,0,0]
    v_pk_mul_f32 v[50:51], v[110:111], v[26:27] op_sel:[0,0] op_sel_hi:[0,1]
    v_pk_mul_f32 v[160:161], v[220:221], v[136:137] op_sel:[0,0] op_sel_hi:[0,1]
    v_pk_fma_f32 v[50:51], v[110:111], v[26:27], v[50:51] op_sel:[1,1,0] op_sel_hi:[1,0,1] neg_lo:[1,0,0]
    v_pk_fma_f32 v[160:161], v[220:221], v[136:137], v[160:161] op_sel:[1,1,0] op_sel_hi:[1,0,1] neg_lo:[1,0,0]
    v_cvt_pk_f16_f32 v62, v40, v41
    v_cvt_pk_f16_f32 v63, v150, v151
    ds_write_b64 v66, v[62:63] offset:9216
    v_cvt_pk_f16_f32 v56, v50, -v51
    v_cvt_pk_f16_f32 v57, v160, -v161
    ds_write_b64 v74, v[56:57] offset:21504
    v_pk_mul_f32 v[42:43], v[86:87], v[96:97] op_sel:[0,0] op_sel_hi:[0,1]
    v_pk_mul_f32 v[152:153], v[196:197], v[206:207] op_sel:[0,0] op_sel_hi:[0,1]
    v_pk_fma_f32 v[42:43], v[86:87], v[96:97], v[42:43] op_sel:[1,1,0] op_sel_hi:[1,0,1] neg_lo:[1,0,0]
    v_pk_fma_f32 v[152:153], v[196:197], v[206:207], v[152:153] op_sel:[1,1,0] op_sel_hi:[1,0,1] neg_lo:[1,0,0]
    v_pk_mul_f32 v[52:53], v[50:51], v[26:27] op_sel:[0,0] op_sel_hi:[0,1]
    v_pk_mul_f32 v[162:163], v[160:161], v[136:137] op_sel:[0,0] op_sel_hi:[0,1]
    v_pk_fma_f32 v[52:53], v[50:51], v[26:27], v[52:53] op_sel:[1,1,0] op_sel_hi:[1,0,1] neg_lo:[1,0,0]
    v_pk_fma_f32 v[162:163], v[160:161], v[136:137], v[162:163] op_sel:[1,1,0] op_sel_hi:[1,0,1] neg_lo:[1,0,0]
    v_cvt_pk_f16_f32 v58, v42, v43
    v_cvt_pk_f16_f32 v59, v152, v153
    ds_write_b64 v67, v[58:59] offset:9728
    v_cvt_pk_f16_f32 v60, v52, -v53
    v_cvt_pk_f16_f32 v61, v162, -v163
    ds_write_b64 v77, v[60:61] offset:23040
    v_pk_mul_f32 v[44:45], v[88:89], v[96:97] op_sel:[0,0] op_sel_hi:[0,1]
    v_pk_mul_f32 v[154:155], v[198:199], v[206:207] op_sel:[0,0] op_sel_hi:[0,1]
    v_pk_fma_f32 v[44:45], v[88:89], v[96:97], v[44:45] op_sel:[1,1,0] op_sel_hi:[1,0,1] neg_lo:[1,0,0]
    v_pk_fma_f32 v[154:155], v[198:199], v[206:207], v[154:155] op_sel:[1,1,0] op_sel_hi:[1,0,1] neg_lo:[1,0,0]
    v_pk_mul_f32 v[50:51], v[52:53], v[26:27] op_sel:[0,0] op_sel_hi:[0,1]
    v_pk_mul_f32 v[160:161], v[162:163], v[136:137] op_sel:[0,0] op_sel_hi:[0,1]
    v_pk_fma_f32 v[50:51], v[52:53], v[26:27], v[50:51] op_sel:[1,1,0] op_sel_hi:[1,0,1] neg_lo:[1,0,0]
    v_pk_fma_f32 v[160:161], v[162:163], v[136:137], v[160:161] op_sel:[1,1,0] op_sel_hi:[1,0,1] neg_lo:[1,0,0]
    v_cvt_pk_f16_f32 v62, v44, v45
    v_cvt_pk_f16_f32 v63, v154, v155
    ds_write_b64 v68, v[62:63] offset:10240
    buffer_load_dwordx2 a[10:11], v233, s[16:19], s38 offen offset:1152
    v_cvt_pk_f16_f32 v56, v50, -v51
    v_cvt_pk_f16_f32 v57, v160, -v161
    ds_write_b64 v79, v[56:57] offset:24064
    v_pk_mul_f32 v[46:47], v[90:91], v[96:97] op_sel:[0,0] op_sel_hi:[0,1]
    v_pk_mul_f32 v[156:157], v[200:201], v[206:207] op_sel:[0,0] op_sel_hi:[0,1]
    v_pk_fma_f32 v[46:47], v[90:91], v[96:97], v[46:47] op_sel:[1,1,0] op_sel_hi:[1,0,1] neg_lo:[1,0,0]
    v_pk_fma_f32 v[156:157], v[200:201], v[206:207], v[156:157] op_sel:[1,1,0] op_sel_hi:[1,0,1] neg_lo:[1,0,0]
    v_pk_mul_f32 v[48:49], v[106:107], v[26:27] op_sel:[0,0] op_sel_hi:[0,1]
    v_pk_mul_f32 v[158:159], v[216:217], v[136:137] op_sel:[0,0] op_sel_hi:[0,1]
    v_pk_fma_f32 v[48:49], v[106:107], v[26:27], v[48:49] op_sel:[1,1,0] op_sel_hi:[1,0,1] neg_lo:[1,0,0]
    v_pk_fma_f32 v[158:159], v[216:217], v[136:137], v[158:159] op_sel:[1,1,0] op_sel_hi:[1,0,1] neg_lo:[1,0,0]
    v_cvt_pk_f16_f32 v58, v46, v47
    v_cvt_pk_f16_f32 v59, v156, v157
    ds_write_b64 v69, v[58:59] offset:10752
    v_cvt_pk_f16_f32 v60, v48, -v49
    v_cvt_pk_f16_f32 v61, v158, -v159
    ds_write_b64 v73, v[60:61] offset:20992
    v_pk_mul_f32 v[40:41], v[92:93], v[96:97] op_sel:[0,0] op_sel_hi:[0,1]
    v_pk_mul_f32 v[150:151], v[202:203], v[206:207] op_sel:[0,0] op_sel_hi:[0,1]
    v_pk_fma_f32 v[40:41], v[92:93], v[96:97], v[40:41] op_sel:[1,1,0] op_sel_hi:[1,0,1] neg_lo:[1,0,0]
    v_pk_fma_f32 v[150:151], v[202:203], v[206:207], v[150:151] op_sel:[1,1,0] op_sel_hi:[1,0,1] neg_lo:[1,0,0]
    v_pk_mul_f32 v[48:49], v[114:115], v[26:27] op_sel:[0,0] op_sel_hi:[0,1]
    v_pk_mul_f32 v[158:159], v[224:225], v[136:137] op_sel:[0,0] op_sel_hi:[0,1]
    v_pk_fma_f32 v[48:49], v[114:115], v[26:27], v[48:49] op_sel:[1,1,0] op_sel_hi:[1,0,1] neg_lo:[1,0,0]
    v_pk_fma_f32 v[158:159], v[224:225], v[136:137], v[158:159] op_sel:[1,1,0] op_sel_hi:[1,0,1] neg_lo:[1,0,0]
    v_cvt_pk_f16_f32 v62, v40, v41
    v_cvt_pk_f16_f32 v63, v150, v151
    ds_write_b64 v70, v[62:63] offset:11264
    v_cvt_pk_f16_f32 v56, v48, -v49
    v_cvt_pk_f16_f32 v57, v158, -v159
    ds_write_b64 v75, v[56:57] offset:22016
    buffer_load_dwordx2 a[12:13], v233, s[16:19], s38 offen offset:2304
    v_pk_mul_f32 v[42:43], v[94:95], v[96:97] op_sel:[0,0] op_sel_hi:[0,1]
    v_pk_mul_f32 v[152:153], v[204:205], v[206:207] op_sel:[0,0] op_sel_hi:[0,1]
    v_pk_fma_f32 v[42:43], v[94:95], v[96:97], v[42:43] op_sel:[1,1,0] op_sel_hi:[1,0,1] neg_lo:[1,0,0]
    v_pk_fma_f32 v[152:153], v[204:205], v[206:207], v[152:153] op_sel:[1,1,0] op_sel_hi:[1,0,1] neg_lo:[1,0,0]
    v_cvt_pk_f16_f32 v58, v42, v43
    v_cvt_pk_f16_f32 v59, v152, v153
    ds_write_b64 v71, v[58:59] offset:11776
    v_pk_mul_f32 v[44:45], v[22:23], v[98:99] op_sel:[0,0] op_sel_hi:[0,1]
    v_pk_mul_f32 v[154:155], v[132:133], v[208:209] op_sel:[0,0] op_sel_hi:[0,1]
    v_pk_fma_f32 v[44:45], v[22:23], v[98:99], v[44:45] op_sel:[1,1,0] op_sel_hi:[1,0,1] neg_lo:[1,0,0]
    v_pk_fma_f32 v[154:155], v[132:133], v[208:209], v[154:155] op_sel:[1,1,0] op_sel_hi:[1,0,1] neg_lo:[1,0,0]
    v_cvt_pk_f16_f32 v60, v44, v45
    v_cvt_pk_f16_f32 v61, v154, v155
    ds_write_b64 v73, v[60:61] offset:12800
    v_pk_mul_f32 v[46:47], v[84:85], v[98:99] op_sel:[0,0] op_sel_hi:[0,1]
    v_pk_mul_f32 v[156:157], v[194:195], v[208:209] op_sel:[0,0] op_sel_hi:[0,1]
    v_pk_fma_f32 v[46:47], v[84:85], v[98:99], v[46:47] op_sel:[1,1,0] op_sel_hi:[1,0,1] neg_lo:[1,0,0]
    v_pk_fma_f32 v[156:157], v[194:195], v[208:209], v[156:157] op_sel:[1,1,0] op_sel_hi:[1,0,1] neg_lo:[1,0,0]
    v_cvt_pk_f16_f32 v62, v46, v47
    v_cvt_pk_f16_f32 v63, v156, v157
    ds_write_b64 v74, v[62:63] offset:13312
    v_pk_mul_f32 v[40:41], v[86:87], v[98:99] op_sel:[0,0] op_sel_hi:[0,1]
    v_pk_mul_f32 v[150:151], v[196:197], v[208:209] op_sel:[0,0] op_sel_hi:[0,1]
    v_pk_fma_f32 v[40:41], v[86:87], v[98:99], v[40:41] op_sel:[1,1,0] op_sel_hi:[1,0,1] neg_lo:[1,0,0]
    v_pk_fma_f32 v[150:151], v[196:197], v[208:209], v[150:151] op_sel:[1,1,0] op_sel_hi:[1,0,1] neg_lo:[1,0,0]
    v_cvt_pk_f16_f32 v56, v40, v41
    v_cvt_pk_f16_f32 v57, v150, v151
    ds_write_b64 v75, v[56:57] offset:13824
    v_pk_mul_f32 v[42:43], v[88:89], v[98:99] op_sel:[0,0] op_sel_hi:[0,1]
    v_pk_mul_f32 v[152:153], v[198:199], v[208:209] op_sel:[0,0] op_sel_hi:[0,1]
    v_pk_fma_f32 v[42:43], v[88:89], v[98:99], v[42:43] op_sel:[1,1,0] op_sel_hi:[1,0,1] neg_lo:[1,0,0]
    v_pk_fma_f32 v[152:153], v[198:199], v[208:209], v[152:153] op_sel:[1,1,0] op_sel_hi:[1,0,1] neg_lo:[1,0,0]
    v_cvt_pk_f16_f32 v58, v42, v43
    v_cvt_pk_f16_f32 v59, v152, v153
    ds_write_b64 v76, v[58:59] offset:14336
    buffer_load_dwordx2 a[14:15], v233, s[16:19], s38 offen offset:3456
    v_pk_mul_f32 v[44:45], v[90:91], v[98:99] op_sel:[0,0] op_sel_hi:[0,1]
    v_pk_mul_f32 v[154:155], v[200:201], v[208:209] op_sel:[0,0] op_sel_hi:[0,1]
    v_pk_fma_f32 v[44:45], v[90:91], v[98:99], v[44:45] op_sel:[1,1,0] op_sel_hi:[1,0,1] neg_lo:[1,0,0]
    v_pk_fma_f32 v[154:155], v[200:201], v[208:209], v[154:155] op_sel:[1,1,0] op_sel_hi:[1,0,1] neg_lo:[1,0,0]
    v_cvt_pk_f16_f32 v60, v44, v45
    v_cvt_pk_f16_f32 v61, v154, v155
    ds_write_b64 v77, v[60:61] offset:14848
    v_pk_mul_f32 v[46:47], v[92:93], v[98:99] op_sel:[0,0] op_sel_hi:[0,1]
    v_pk_mul_f32 v[156:157], v[202:203], v[208:209] op_sel:[0,0] op_sel_hi:[0,1]
    v_pk_fma_f32 v[46:47], v[92:93], v[98:99], v[46:47] op_sel:[1,1,0] op_sel_hi:[1,0,1] neg_lo:[1,0,0]
    v_pk_fma_f32 v[156:157], v[202:203], v[208:209], v[156:157] op_sel:[1,1,0] op_sel_hi:[1,0,1] neg_lo:[1,0,0]
    v_cvt_pk_f16_f32 v62, v46, v47
    v_cvt_pk_f16_f32 v63, v156, v157
    ds_write_b64 v78, v[62:63] offset:15360
    v_pk_mul_f32 v[40:41], v[94:95], v[98:99] op_sel:[0,0] op_sel_hi:[0,1]
    v_pk_mul_f32 v[150:151], v[204:205], v[208:209] op_sel:[0,0] op_sel_hi:[0,1]
    v_pk_fma_f32 v[40:41], v[94:95], v[98:99], v[40:41] op_sel:[1,1,0] op_sel_hi:[1,0,1] neg_lo:[1,0,0]
    v_pk_fma_f32 v[150:151], v[204:205], v[208:209], v[150:151] op_sel:[1,1,0] op_sel_hi:[1,0,1] neg_lo:[1,0,0]
    v_cvt_pk_f16_f32 v56, v40, v41
    v_cvt_pk_f16_f32 v57, v150, v151
    ds_write_b64 v79, v[56:57] offset:15872
    v_and_b32 v13, 15, v2
    v_lshrrev_b32 v5, 4, v2
    v_xor_b32 v4, v5, v13
    v_lshlrev_b32 v4, 4, v4
    v_min_u32 v3, 4, v13
    v_xor_b32 v6, v5, v3
    v_lshlrev_b32 v6, 4, v6
    v_lshl_add_u32 v4, v13, 9, v4
    v_lshl_add_u32 v6, v3, 9, v6
    v_add_u32 v4, s34, v4
    v_add_u32 v6, s34, v6
    v_xor_b32 v41, 64, v4
    v_xor_b32 v45, 64, v6
    v_xor_b32 v42, 128, v4
    v_xor_b32 v46, 128, v6
    v_xor_b32 v43, 192, v4
    v_xor_b32 v47, 192, v6
    ds_read_b128 v[84:87], v4 offset:0
    ds_read_b128 v[92:95], v4 offset:16384
    ds_read_b128 v[88:91], v4 offset:8192
    ds_read_b128 v[96:99], v6 offset:24576
    ds_read_b128 v[100:103], v41 offset:0
    ds_read_b128 v[108:111], v41 offset:16384
    ds_read_b128 v[104:107], v41 offset:8192
    ds_read_b128 v[112:115], v45 offset:24576
    ds_read_b128 v[116:119], v42 offset:0
    ds_read_b128 v[124:127], v42 offset:16384
    ds_read_b128 v[120:123], v42 offset:8192
    ds_read_b128 v[128:131], v46 offset:24576
    ds_read_b128 v[132:135], v43 offset:0
    ds_read_b128 v[140:143], v43 offset:16384
    ds_read_b128 v[136:139], v43 offset:8192
    ds_read_b128 v[144:147], v47 offset:24576
    ds_read_b128 v[148:151], v4 offset:256
    ds_read_b128 v[156:159], v4 offset:16640
    ds_read_b128 v[152:155], v4 offset:8448
    ds_read_b128 v[160:163], v6 offset:24832
    ds_read_b128 v[164:167], v41 offset:256
    ds_read_b128 v[172:175], v41 offset:16640
    ds_read_b128 v[168:171], v41 offset:8448
    ds_read_b128 v[176:179], v45 offset:24832
    ds_read_b128 v[180:183], v42 offset:256
    ds_read_b128 v[188:191], v42 offset:16640
    ds_read_b128 v[184:187], v42 offset:8448
    ds_read_b128 v[192:195], v46 offset:24832
    ds_read_b128 v[196:199], v43 offset:256
    ds_read_b128 v[204:207], v43 offset:16640
    ds_read_b128 v[200:203], v43 offset:8448
    ds_read_b128 v[208:211], v47 offset:24832
    s_add_u32 s38, s34, 27136
    s_waitcnt lgkmcnt(0)
    v_mfma_f32_16x16x32_f16 v[20:23], v[92:95], v[84:87], 0
    v_lshlrev_b32 v8, 4, v13
    v_mfma_f32_16x16x32_f16 v[24:27], v[92:95], v[88:91], 0
    v_lshl_add_u32 v8, v5, 3, v8
    v_mfma_f32_16x16x32_f16 v[28:31], v[96:99], v[84:87], 0
    v_mov_b32 v10, 256
    v_mfma_f32_16x16x32_f16 v[32:35], v[96:99], v[88:91], 0
    v_lshlrev_b32 v9, 3, v13
    v_mfma_f32_16x16x32_f16 v[20:23], v[108:111], v[100:103], v[20:23]
    v_add_u32 v9, 512, v9
    v_cmp_eq_u32 vcc, 2, v5
    v_mfma_f32_16x16x32_f16 v[24:27], v[108:111], v[104:107], v[24:27]
    s_nop 0
    v_cndmask_b32 v8, v8, v9, vcc
    v_mfma_f32_16x16x32_f16 v[28:31], v[112:115], v[100:103], v[28:31]
    v_mov_b32 v9, 128
    v_mfma_f32_16x16x32_f16 v[32:35], v[112:115], v[104:107], v[32:35]
    v_cndmask_b32 v10, v10, v9, vcc
    v_mfma_f32_16x16x32_f16 v[20:23], v[124:127], v[116:119], v[20:23]
    v_lshlrev_b32 v9, 2, v13
    v_mfma_f32_16x16x32_f16 v[24:27], v[124:127], v[120:123], v[24:27]
    v_add_u32 v9, 768, v9
    v_mfma_f32_16x16x32_f16 v[28:31], v[128:131], v[116:119], v[28:31]
    v_cmp_eq_u32 vcc, 3, v5
    v_mfma_f32_16x16x32_f16 v[32:35], v[128:131], v[120:123], v[32:35]
    s_nop 0
    v_cndmask_b32 v8, v8, v9, vcc
    v_mfma_f32_16x16x32_f16 v[20:23], v[140:143], v[132:135], v[20:23]
    v_cndmask_b32 v10, v10, 64, vcc
    v_mfma_f32_16x16x32_f16 v[24:27], v[140:143], v[136:139], v[24:27]
    v_add_u32 v8, s38, v8
    v_mfma_f32_16x16x32_f16 v[28:31], v[144:147], v[132:135], v[28:31]
    v_add_u32 v9, 4, v8
    v_add_u32 v11, 128, v8
    v_mfma_f32_16x16x32_f16 v[32:35], v[144:147], v[136:139], v[32:35]
    v_cndmask_b32 v9, v9, v11, vcc
    v_mfma_f32_16x16x32_f16 v[20:23], v[156:159], v[148:151], v[20:23]
    v_add_u32 v14, v8, v10
    v_mfma_f32_16x16x32_f16 v[24:27], v[156:159], v[152:155], v[24:27]
    v_add_u32 v15, v9, v10
    v_mfma_f32_16x16x32_f16 v[28:31], v[160:163], v[148:151], v[28:31]
    v_lshlrev_b32 v11, 1, v13
    v_mfma_f32_16x16x32_f16 v[32:35], v[160:163], v[152:155], v[32:35]
    v_add_u32 v11, 1024, v11
    v_mfma_f32_16x16x32_f16 v[20:23], v[172:175], v[164:167], v[20:23]
    v_mov_b32 v12, 1296
    v_mfma_f32_16x16x32_f16 v[24:27], v[172:175], v[168:171], v[24:27]
    v_cmp_eq_u32 vcc, 0, v5
    v_mfma_f32_16x16x32_f16 v[28:31], v[176:179], v[164:167], v[28:31]
    s_nop 0
    v_cndmask_b32 v11, v12, v11, vcc
    v_mfma_f32_16x16x32_f16 v[32:35], v[176:179], v[168:171], v[32:35]
    v_mov_b32 v12, 1280
    v_mfma_f32_16x16x32_f16 v[20:23], v[188:191], v[180:183], v[20:23]
    v_cmp_eq_u32 vcc, 16, v2
    s_nop 1
    v_cndmask_b32 v12, v11, v12, vcc
    v_mfma_f32_16x16x32_f16 v[24:27], v[188:191], v[184:187], v[24:27]
    v_add_u32 v11, s38, v11
    v_mfma_f32_16x16x32_f16 v[28:31], v[192:195], v[180:183], v[28:31]
    v_add_u32 v12, s38, v12
    v_mfma_f32_16x16x32_f16 v[32:35], v[192:195], v[184:187], v[32:35]
    v_lshl_add_u32 v3, v2, 3, s38
    v_mfma_f32_16x16x32_f16 v[20:23], v[204:207], v[196:199], v[20:23]
    v_lshl_add_u32 v4, v2, 2, s38
    v_mfma_f32_16x16x32_f16 v[24:27], v[204:207], v[200:203], v[24:27]
    v_add_u32 v4, 512, v4
    v_mfma_f32_16x16x32_f16 v[28:31], v[208:211], v[196:199], v[28:31]
    v_mfma_f32_16x16x32_f16 v[32:35], v[208:211], v[200:203], v[32:35]
    s_nop 2
    v_cvt_pk_f16_f32 v40, v20, v21
    v_cvt_pk_f16_f32 v41, v22, v23
    v_cvt_pk_f16_f32 v42, v24, v25
    v_cvt_pk_f16_f32 v43, v26, v27
    v_cvt_pk_f16_f32 v44, v28, v29
    v_cvt_pk_f16_f32 v45, v30, v31
    v_cvt_pk_f16_f32 v46, v32, v33
    v_cvt_pk_f16_f32 v47, v34, v35
    ds_write_b32 v8, v40
    ds_write_b32 v9, v41
    ds_write_b32 v14, v42
    ds_write_b32 v15, v43
    ds_write_b16 v12, v44
    ds_write_b16_d16_hi v11, v44 offset:64
    ds_write_b16 v11, v45 offset:128
    ds_write_b16_d16_hi v11, v45 offset:192
    s_mov_b64 exec, 0xffff
    ds_write_b16 v11, v46 offset:32
    ds_write_b16_d16_hi v11, v46 offset:96
    ds_write_b16 v11, v47 offset:160
    ds_write_b16_d16_hi v11, v47 offset:224
    s_mov_b64 exec, -1
    ds_read_b64 v[20:21], v3
    ds_read_b64 v[22:23], v3 offset:8
    ds_read2_b32 v[24:25], v4 offset0:0 offset1:1
    ds_read2_b32 v[26:27], v4 offset0:64 offset1:65
    ds_read2_b32 v[28:29], v4 offset0:128 offset1:129
    s_mul_i32 s37, s3, 28704
    v_lshrrev_b32 v8, 3, v2
    v_and_b32 v9, 7, v2
    v_lshl_add_u32 v48, v2, 3, s37
    v_lshl_add_u32 v49, v2, 4, s37
    v_lshl_add_u32 v50, v2, 5, s37
    v_mul_u32_u24 v51, 1280, v5
    v_lshl_add_u32 v51, v13, 4, v51
    v_add_u32 v51, s37, v51
    v_mov_b32 v52, 0
    v_mov_b32 v53, 0
    v_mov_b32 v54, 0
    v_mov_b32 v55, 0
    v_bfe_u32 v60, v2, 3, 2
    v_cmp_eq_u32 vcc, 1, v60
    v_mov_b32 v61, 4352
    s_nop 0
    v_cndmask_b32 v61, 0, v61, vcc
    v_cmp_eq_u32 vcc, 2, v60
    v_mov_b32 v62, 8528
    s_nop 0
    v_cndmask_b32 v61, v61, v62, vcc
    v_cmp_eq_u32 vcc, 3, v60
    v_mov_b32 v62, 12704
    s_nop 0
    v_cndmask_b32 v61, v61, v62, vcc
    v_lshl_add_u32 v61, v9, 3, v61
    v_add_u32 v61, s37, v61
    v_cmp_eq_u32 vcc, 63, v2
    v_mov_b32 v62, 0x03020100
    v_mov_b32 v63, 0x01000100
    v_cndmask_b32 v62, v62, v63, vcc
    v_mov_b32 v63, 0x07060504
    v_mov_b32 v64, 0x03020302
    v_cndmask_b32 v63, v63, v64, vcc
    s_mov_b32 s40, 0x01000100
    s_mov_b32 s41, 0x03020302
    ds_write_b128 v51, v[52:55] offset:16864
    s_waitcnt lgkmcnt(5)
    v_readfirstlane_b32 s44, v20
    v_readfirstlane_b32 s45, v21
    s_lshl_b32 s46, s44, 16
    s_lshr_b32 s47, s44, 16
    s_lshl_b32 s45, s45, 16
    s_or_b32 s47, s47, s45
    v_writelane_b32 v53, s46, 15
    v_writelane_b32 v53, s44, 23
    v_writelane_b32 v52, s46, 31
    v_writelane_b32 v53, s47, 31
    s_mov_b32 exec_hi, 0
    ds_write_b64 v61, v[52:53]
    s_mov_b32 exec_hi, -1
    s_waitcnt lgkmcnt(5)
    v_perm_b32 v23, v23, v22, v63
    v_perm_b32 v22, v22, v22, v62
    ds_write_b64 v48, v[20:21] offset:64
    v_alignbit_b32 v68, v21, v20, 16
    v_alignbit_b32 v69, v22, v21, 16
    ds_write_b64 v48, v[68:69] offset:4416
    v_mov_b32 v70, v21
    v_mov_b32 v71, v22
    ds_write_b64 v48, v[70:71] offset:8592
    v_mov_b32 v72, v69
    v_alignbit_b32 v73, v23, v22, 16
    ds_write_b64 v48, v[72:73] offset:12768
    buffer_load_dword v19, v245, s[96:99], 0 offen sc1
    s_waitcnt lgkmcnt(8)
    v_perm_b32 v68, v24, v24, s40
    v_alignbit_b32 v69, v25, v24, 16
    ds_write_b64 v48, v[68:69] offset:576
    v_mov_b32 v72, v24
    v_perm_b32 v73, v25, v25, s40
    ds_write_b64 v48, v[72:73] offset:4928
    v_alignbit_b32 v76, v25, v24, 16
    v_perm_b32 v77, v25, v25, s40
    ds_write_b64 v48, v[76:77] offset:9104
    v_perm_b32 v80, v25, v25, s40
    v_perm_b32 v81, v25, v25, v62
    ds_write_b64 v48, v[80:81] offset:13280
    s_waitcnt lgkmcnt(11)
    v_perm_b32 v84, v26, v26, s40
    v_mov_b32 v85, v26
    v_perm_b32 v86, v26, v26, s41
    v_perm_b32 v87, v27, v27, s40
    ds_write_b128 v49, v[84:87] offset:1088
    v_perm_b32 v88, v26, v26, s40
    v_perm_b32 v89, v26, v26, s41
    v_alignbit_b32 v90, v27, v26, 16
    v_perm_b32 v91, v27, v27, s40
    ds_write_b128 v49, v[88:91] offset:5440
    v_mov_b32 v68, v26
    v_perm_b32 v69, v26, v26, s41
    v_perm_b32 v70, v27, v27, s40
    v_perm_b32 v71, v27, v27, s40
    ds_write_b128 v49, v[68:71] offset:9616
    v_perm_b32 v72, v26, v26, s41
    v_alignbit_b32 v73, v27, v26, 16
    v_perm_b32 v74, v27, v27, s40
    v_perm_b32 v75, v27, v27, s40
    ds_write_b128 v49, v[72:75] offset:13792
    s_waitcnt lgkmcnt(14)
    v_perm_b32 v76, v28, v28, s40
    v_perm_b32 v77, v28, v28, s40
    v_mov_b32 v78, v28
    v_perm_b32 v79, v28, v28, s41
    ds_write_b128 v50, v[76:79] offset:2112
    v_perm_b32 v80, v28, v28, s41
    v_perm_b32 v81, v28, v28, s41
    v_perm_b32 v82, v29, v29, s40
    v_perm_b32 v83, v29, v29, s40
    ds_write_b128 v50, v[80:83] offset:2128
    v_perm_b32 v84, v28, v28, s40
    v_perm_b32 v85, v28, v28, s40
    v_perm_b32 v86, v28, v28, s41
    v_perm_b32 v87, v28, v28, s41
    ds_write_b128 v50, v[84:87] offset:6464
    v_perm_b32 v88, v28, v28, s41
    v_alignbit_b32 v89, v29, v28, 16
    v_perm_b32 v90, v29, v29, s40
    v_perm_b32 v91, v29, v29, s40
    ds_write_b128 v50, v[88:91] offset:6480
    v_perm_b32 v68, v28, v28, s40
    v_mov_b32 v69, v28
    v_perm_b32 v70, v28, v28, s41
    v_perm_b32 v71, v28, v28, s41
    ds_write_b128 v50, v[68:71] offset:10640
    v_perm_b32 v72, v28, v28, s41
    v_perm_b32 v73, v29, v29, s40
    v_perm_b32 v74, v29, v29, s40
    v_perm_b32 v75, v29, v29, s40
    ds_write_b128 v50, v[72:75] offset:10656
    v_perm_b32 v76, v28, v28, s40
    v_perm_b32 v77, v28, v28, s41
    v_perm_b32 v78, v28, v28, s41
    v_perm_b32 v79, v28, v28, s41
    ds_write_b128 v50, v[76:79] offset:14816
    v_alignbit_b32 v80, v29, v28, 16
    v_perm_b32 v81, v29, v29, s40
    v_perm_b32 v82, v29, v29, s40
    v_perm_b32 v83, v29, v29, s40
    ds_write_b128 v50, v[80:83] offset:14832
    v_bfe_u32 v4, v2, 2, 2
    v_min_u32 v3, 2, v5
    v_mul_u32_u24 v3, 2304, v3
    v_lshl_add_u32 v3, v4, 2, v3
    s_lshl_b32 s6, s59, 4
    s_add_u32 s6, s6, 65536
    v_lshlrev_b32 v10, 6, v2
    s_lshl_b32 s32, s3, 12
    s_add_u32 s32, s32, 245760
    v_and_b32 v56, 3, v2
    v_lshrrev_b32 v58, 2, v2
    v_lshlrev_b32 v58, 4, v58
    s_lshl_b32 s38, s3, 8
    v_add_u32 v58, s38, v58
    v_mul_u32_u24 v57, 1280, v56
    v_add_u32 v57, v57, v58
    v_add_u32 v59, 57408, v57
    v_lshl_add_u32 v15, v56, 10, v58
    v_add_u32 v15, 132352, v15
    v_lshlrev_b32 v14, 10, v5
    v_lshl_add_u32 v14, v13, 4, v14
    s_mul_i32 s38, s3, 4128
    s_add_u32 s38, s38, 132352
    v_add_u32 v14, s38, v14
    v_lshlrev_b32 v56, 4, v56
    v_add_u32 v58, 64, v56
    s_mov_b32 s40, 0x05040100
    s_mov_b32 s41, 0x07060302
    v_and_b32 v11, 3, v13
    v_add_u32 v11, 1, v11
    v_lshrrev_b32 v4, 2, v11
    v_and_b32 v11, 3, v11
    v_cmp_eq_u32 vcc, 1, v11
    v_mov_b32 v6, 4352
    s_nop 0
    v_cndmask_b32 v6, 0, v6, vcc
    v_cmp_eq_u32 vcc, 2, v11
    v_mov_b32 v7, 8528
    s_nop 0
    v_cndmask_b32 v6, v6, v7, vcc
    v_cmp_eq_u32 vcc, 3, v11
    v_mov_b32 v7, 12704
    s_nop 0
    v_cndmask_b32 v6, v6, v7, vcc
    v_lshrrev_b32 v7, 2, v13
    v_add_u32 v7, v7, v5
    v_lshl_add_u32 v7, v7, 1, v4
    v_lshl_add_u32 v6, v7, 3, v6
    v_add_u32 v6, s37, v6
    v_sub_u32 v7, 3, v5
    v_mul_u32_u24 v7, 1280, v7
    v_lshl_add_u32 v7, v13, 4, v7
    v_add_u32 v7, s37, v7
    s_waitcnt vmcnt(9)
    v_lshlrev_b32 v18, 16, v18
    s_waitcnt vmcnt(8)
    v_accvgpr_read_b32 v96, a0
    v_accvgpr_read_b32 v97, a1
    s_waitcnt vmcnt(7)
    v_accvgpr_read_b32 v98, a2
    v_accvgpr_read_b32 v99, a3
    s_waitcnt vmcnt(6)
    v_accvgpr_read_b32 v100, a4
    v_accvgpr_read_b32 v101, a5
    s_waitcnt vmcnt(5)
    v_accvgpr_read_b32 v102, a6
    v_accvgpr_read_b32 v103, a7
    s_waitcnt vmcnt(4)
    v_accvgpr_read_b32 v104, a8
    v_accvgpr_read_b32 v105, a9
    s_waitcnt vmcnt(3)
    v_accvgpr_read_b32 v106, a10
    v_accvgpr_read_b32 v107, a11
    s_waitcnt vmcnt(2)
    v_accvgpr_read_b32 v108, a12
    v_accvgpr_read_b32 v109, a13
    s_waitcnt vmcnt(1)
    v_accvgpr_read_b32 v110, a14
    v_accvgpr_read_b32 v111, a15
    v_perm_b32 v68, v98, v96, s40
    v_perm_b32 v69, v102, v100, s40
    v_perm_b32 v70, v106, v104, s40
    v_perm_b32 v71, v110, v108, s40
    ds_write_b128 v15, v[68:71] offset:0
    v_perm_b32 v72, v98, v96, s41
    v_perm_b32 v73, v102, v100, s41
    v_perm_b32 v74, v106, v104, s41
    v_perm_b32 v75, v110, v108, s41
    ds_write_b128 v15, v[72:75] offset:4128
    v_perm_b32 v76, v99, v97, s40
    v_perm_b32 v77, v103, v101, s40
    v_perm_b32 v78, v107, v105, s40
    v_perm_b32 v79, v111, v109, s40
    ds_write_b128 v15, v[76:79] offset:8256
    v_perm_b32 v80, v99, v97, s41
    v_perm_b32 v81, v103, v101, s41
    v_perm_b32 v82, v107, v105, s41
    v_perm_b32 v83, v111, v109, s41
    ds_write_b128 v15, v[80:83] offset:12384
    v_lshlrev_b32 v112, 16, v96
    v_and_b32 v113, 0xffff0000, v96
    v_lshlrev_b32 v114, 16, v97
    v_and_b32 v115, 0xffff0000, v97
    v_lshlrev_b32 v116, 16, v98
    v_and_b32 v117, 0xffff0000, v98
    v_lshlrev_b32 v118, 16, v99
    v_and_b32 v119, 0xffff0000, v99
    v_lshlrev_b32 v120, 16, v100
    v_and_b32 v121, 0xffff0000, v100
    v_lshlrev_b32 v122, 16, v101
    v_and_b32 v123, 0xffff0000, v101
    v_lshlrev_b32 v124, 16, v102
    v_and_b32 v125, 0xffff0000, v102
    v_lshlrev_b32 v126, 16, v103
    v_and_b32 v127, 0xffff0000, v103
    v_lshlrev_b32 v128, 16, v104
    v_and_b32 v129, 0xffff0000, v104
    v_lshlrev_b32 v130, 16, v105
    v_and_b32 v131, 0xffff0000, v105
    v_lshlrev_b32 v132, 16, v106
    v_and_b32 v133, 0xffff0000, v106
    v_lshlrev_b32 v134, 16, v107
    v_and_b32 v135, 0xffff0000, v107
    v_lshlrev_b32 v136, 16, v108
    v_and_b32 v137, 0xffff0000, v108
    v_lshlrev_b32 v138, 16, v109
    v_and_b32 v139, 0xffff0000, v109
    v_lshlrev_b32 v140, 16, v110
    v_and_b32 v141, 0xffff0000, v110
    v_lshlrev_b32 v142, 16, v111
    v_and_b32 v143, 0xffff0000, v111
    s_waitcnt vmcnt(0) lgkmcnt(0)
    s_cmp_lg_u32 s3, 3
    s_cbranch_scc1 conv_go_2
    v_readfirstlane_b32 s39, v19
    s_nop 0
    s_cmp_ge_u32 s39, 24
    s_cbranch_scc1 conv_go_2_c
    v_mov_b32 v247, 0
    s_mov_b64 exec, 1
    s_mov_b32 s58, 0
poll_3:
    buffer_load_dword v246, v247, s[96:99], 0 offen sc1
    s_add_u32 s58, s58, 1
    s_waitcnt vmcnt(0)
    v_cmp_gt_u32 vcc, 24, v246
    s_cmp_gt_u32 s58, 0x40000
    s_cbranch_scc1 poll_3_done
    s_nop 3
    s_cbranch_vccnz poll_3
poll_3_done:
    s_mov_b64 exec, -1
    s_branch conv_go_2_w
conv_go_2_c:
conv_go_2_w:
    s_lshr_b32 s39, s57, 3
    s_lshl_b32 s39, s39, 9
    s_add_u32 s39, s39, 196608
    v_lshrrev_b32 v247, 1, v250
    s_mov_b32 s100, 0xffffffff
    s_mov_b32 s101, 0x3fff
    s_mov_b64 exec, s[100:101]
    s_mov_b32 s58, 0
poll_4:
    buffer_load_dwordx2 v[236:237], v247, s[28:31], s39 offen sc1
    s_add_u32 s58, s58, 1
    s_waitcnt vmcnt(0)
    v_min_u32 v246, v236, v237
    v_cmp_gt_u32 vcc, 1, v246
    s_cmp_gt_u32 s58, 0x40000
    s_cbranch_scc1 poll_4_done
    s_nop 3
    s_cbranch_vccnz poll_4
poll_4_done:
    s_mov_b64 exec, -1
    s_cmp_lg_u32 s57, 0
    s_cbranch_scc1 conv_go_2
    v_lshlrev_b32 v246, 3, v250
    s_mov_b32 s58, 163840
    buffer_store_dword v244, v246, s[28:31], s58 offen offset:124 sc1
    s_add_u32 s58, s58, 8192
    buffer_store_dword v244, v246, s[28:31], s58 offen offset:124 sc1
    s_add_u32 s58, s58, 8192
    buffer_store_dword v244, v246, s[28:31], s58 offen offset:124 sc1
    s_add_u32 s58, s58, 8192
    buffer_store_dword v244, v246, s[28:31], s58 offen offset:124 sc1
    s_add_u32 s58, s58, 8192
conv_go_2:
    s_barrier
    buffer_load_dword v16, v3, s[28:31], s6 offen sc1
    buffer_load_dwordx4 v[32:35], v10, s[28:31], s32 offen offset:0 sc1
    buffer_load_dwordx4 v[36:39], v10, s[28:31], s32 offen offset:16 sc1
    buffer_load_dwordx4 v[40:43], v10, s[28:31], s32 offen offset:32 sc1
    buffer_load_dwordx4 v[44:47], v10, s[28:31], s32 offen offset:48 sc1
    s_lshl_b32 s39, s3, 2
    s_add_u32 s39, s39, 32
    s_mov_b32 s48, 0x41c00000
    s_waitcnt vmcnt(4)
    ds_bpermute_b32 v65, v56, v16
    ds_bpermute_b32 v66, v58, v16
    v_readlane_b32 s43, v16, s39
    s_nop 1
    v_mul_f32 v17, s43, v17
    v_mul_f32 v18, s43, v18
    s_waitcnt vmcnt(3)
    v_pk_fma_f32 v[112:113], v[112:113], v[32:33], v[32:33] op_sel:[0,0,1] op_sel_hi:[1,0,1]
    v_pk_fma_f32 v[114:115], v[114:115], v[32:33], v[32:33] op_sel:[0,0,1] op_sel_hi:[1,0,1]
    v_pk_fma_f32 v[116:117], v[116:117], v[34:35], v[34:35] op_sel:[0,0,1] op_sel_hi:[1,0,1]
    v_pk_fma_f32 v[118:119], v[118:119], v[34:35], v[34:35] op_sel:[0,0,1] op_sel_hi:[1,0,1]
    s_waitcnt vmcnt(2)
    v_pk_fma_f32 v[120:121], v[120:121], v[36:37], v[36:37] op_sel:[0,0,1] op_sel_hi:[1,0,1]
    v_pk_fma_f32 v[122:123], v[122:123], v[36:37], v[36:37] op_sel:[0,0,1] op_sel_hi:[1,0,1]
    v_pk_fma_f32 v[124:125], v[124:125], v[38:39], v[38:39] op_sel:[0,0,1] op_sel_hi:[1,0,1]
    v_pk_fma_f32 v[126:127], v[126:127], v[38:39], v[38:39] op_sel:[0,0,1] op_sel_hi:[1,0,1]
    s_waitcnt vmcnt(1)
    v_pk_fma_f32 v[128:129], v[128:129], v[40:41], v[40:41] op_sel:[0,0,1] op_sel_hi:[1,0,1]
    v_pk_fma_f32 v[130:131], v[130:131], v[40:41], v[40:41] op_sel:[0,0,1] op_sel_hi:[1,0,1]
    v_pk_fma_f32 v[132:133], v[132:133], v[42:43], v[42:43] op_sel:[0,0,1] op_sel_hi:[1,0,1]
    v_pk_fma_f32 v[134:135], v[134:135], v[42:43], v[42:43] op_sel:[0,0,1] op_sel_hi:[1,0,1]
    s_waitcnt vmcnt(0)
    v_pk_fma_f32 v[136:137], v[136:137], v[44:45], v[44:45] op_sel:[0,0,1] op_sel_hi:[1,0,1]
    v_pk_fma_f32 v[138:139], v[138:139], v[44:45], v[44:45] op_sel:[0,0,1] op_sel_hi:[1,0,1]
    v_pk_fma_f32 v[140:141], v[140:141], v[46:47], v[46:47] op_sel:[0,0,1] op_sel_hi:[1,0,1]
    v_pk_fma_f32 v[142:143], v[142:143], v[46:47], v[46:47] op_sel:[0,0,1] op_sel_hi:[1,0,1]
    s_waitcnt lgkmcnt(0)
    v_fma_f32 v67, |v66|, s48, |v65|
    v_frexp_exp_i32_f32 v67, v67
    v_sub_u32 v67, 14, v67
    v_ldexp_f32 v65, v65, v67
    v_ldexp_f32 v66, v66, v67
    v_readlane_b32 s49, v67, s3
    v_readlane_b32 s40, v66, 0
    v_readlane_b32 s44, v65, 0
    v_readlane_b32 s41, v66, 1
    v_readlane_b32 s45, v65, 1
    v_readlane_b32 s42, v66, 2
    v_readlane_b32 s46, v65, 2
    v_readlane_b32 s43, v66, 3
    v_readlane_b32 s47, v65, 3
    v_mov_b32 v60, s44
    v_mov_b32 v61, s45
    v_mov_b32 v62, s46
    v_mov_b32 v63, s47
    v_pk_fma_f32 v[112:113], v[112:113], s[40:41], v[60:61]
    v_pk_fma_f32 v[116:117], v[116:117], s[40:41], v[60:61]
    v_pk_fma_f32 v[120:121], v[120:121], s[40:41], v[60:61]
    v_pk_fma_f32 v[124:125], v[124:125], s[40:41], v[60:61]
    v_pk_fma_f32 v[128:129], v[128:129], s[40:41], v[60:61]
    v_pk_fma_f32 v[132:133], v[132:133], s[40:41], v[60:61]
    v_pk_fma_f32 v[136:137], v[136:137], s[40:41], v[60:61]
    v_pk_fma_f32 v[140:141], v[140:141], s[40:41], v[60:61]
    v_cvt_pk_f16_f32 v68, v140, v136
    v_cvt_pk_f16_f32 v69, v132, v128
    v_cvt_pk_f16_f32 v70, v124, v120
    v_cvt_pk_f16_f32 v71, v116, v112
    ds_write_b128 v57, v[68:71] offset:17120
    v_cvt_pk_f16_f32 v72, v141, v137
    v_cvt_pk_f16_f32 v73, v133, v129
    v_cvt_pk_f16_f32 v74, v125, v121
    v_cvt_pk_f16_f32 v75, v117, v113
    ds_write_b128 v57, v[72:75] offset:45824
    v_pk_fma_f32 v[114:115], v[114:115], s[42:43], v[62:63]
    v_pk_fma_f32 v[118:119], v[118:119], s[42:43], v[62:63]
    v_pk_fma_f32 v[122:123], v[122:123], s[42:43], v[62:63]
    v_pk_fma_f32 v[126:127], v[126:127], s[42:43], v[62:63]
    v_pk_fma_f32 v[130:131], v[130:131], s[42:43], v[62:63]
    v_pk_fma_f32 v[134:135], v[134:135], s[42:43], v[62:63]
    v_pk_fma_f32 v[138:139], v[138:139], s[42:43], v[62:63]
    v_pk_fma_f32 v[142:143], v[142:143], s[42:43], v[62:63]
    v_cvt_pk_f16_f32 v76, v142, v138
    v_cvt_pk_f16_f32 v77, v134, v130
    v_cvt_pk_f16_f32 v78, v126, v122
    v_cvt_pk_f16_f32 v79, v118, v114
    ds_write_b128 v59, v[76:79] offset:17120
    v_cvt_pk_f16_f32 v80, v143, v139
    v_cvt_pk_f16_f32 v81, v135, v131
    v_cvt_pk_f16_f32 v82, v127, v123
    v_cvt_pk_f16_f32 v83, v119, v115
    ds_write_b128 v59, v[80:83] offset:45824
    s_sub_u32 s49, 0, s49
    v_ldexp_f32 v17, v17, s49
    v_ldexp_f32 v18, v18, s49
    v_mul_u32_u24 v3, 36992, v5
    v_lshl_add_u32 v3, v13, 4, v3
    s_mul_i32 s6, s3, 591872
    s_lshl_b32 s38, s59, 8
    s_add_u32 s6, s6, s38
    v_mul_u32_u24 v4, 272, v13
    v_lshl_add_u32 v4, v5, 4, v4
    s_lshl_b32 s38, s3, 6
    s_add_u32 s38, s38, 114816
    v_add_u32 v4, s38, v4
    v_mul_u32_u24 v12, 272, v5
    v_lshl_add_u32 v12, v13, 4, v12
    s_mul_i32 s38, s3, 4352
    s_add_u32 s38, s38, 114816
    v_add_u32 v12, s38, v12
    s_add_u32 s6, s6, 6029312
    s_waitcnt lgkmcnt(0)
    s_barrier
    ds_read_b128 v[168:171], v7 offset:17120
    ds_read_b64 v[144:145], v6 offset:0
    ds_read_b64 v[146:147], v6 offset:8
    ds_read_b64 v[148:149], v6 offset:16
    ds_read_b128 v[172:175], v7 offset:17376
    ds_read_b128 v[176:179], v7 offset:17632
    ds_read_b128 v[180:183], v7 offset:17888
    ds_read_b64 v[150:151], v6 offset:1024
    ds_read_b64 v[152:153], v6 offset:1032
    ds_read_b64 v[154:155], v6 offset:1040
    ds_read_b64 v[156:157], v6 offset:2048
    ds_read_b64 v[158:159], v6 offset:2056
    ds_read_b64 v[160:161], v6 offset:2064
    ds_read_b64 v[162:163], v6 offset:3072
    ds_read_b64 v[164:165], v6 offset:3080
    ds_read_b64 v[166:167], v6 offset:3088
    s_waitcnt lgkmcnt(13)
    v_mfma_f32_16x16x32_f16 v[112:115], v[144:147], v[168:171], 0
    s_waitcnt lgkmcnt(12)
    ds_read_b128 v[208:211], v7 offset:17104
    v_mfma_f32_16x16x32_f16 v[116:119], v[146:149], v[168:171], 0
    s_waitcnt lgkmcnt(12)
    ds_read_b64 v[184:185], v6 offset:64
    v_mfma_f32_16x16x32_f16 v[120:123], v[144:147], v[172:175], 0
    ds_read_b64 v[186:187], v6 offset:72
    v_mfma_f32_16x16x32_f16 v[124:127], v[146:149], v[172:175], 0
    s_waitcnt lgkmcnt(13)
    ds_read_b64 v[188:189], v6 offset:80
    v_mfma_f32_16x16x32_f16 v[128:131], v[144:147], v[176:179], 0
    ds_read_b128 v[212:215], v7 offset:17360
    v_mfma_f32_16x16x32_f16 v[132:135], v[146:149], v[176:179], 0
    s_waitcnt lgkmcnt(14)
    ds_read_b128 v[216:219], v7 offset:17616
    v_mfma_f32_16x16x32_f16 v[136:139], v[144:147], v[180:183], 0
    ds_read_b128 v[220:223], v7 offset:17872
    v_mfma_f32_16x16x32_f16 v[140:143], v[146:149], v[180:183], 0
    s_waitcnt lgkmcnt(14)
    ds_read_b64 v[190:191], v6 offset:1088
    v_mfma_f32_16x16x32_f16 v[120:123], v[150:153], v[168:171], v[120:123]
    s_waitcnt lgkmcnt(14)
    ds_read_b64 v[192:193], v6 offset:1096
    v_mfma_f32_16x16x32_f16 v[124:127], v[152:155], v[168:171], v[124:127]
    ds_read_b64 v[194:195], v6 offset:1104
    v_mfma_f32_16x16x32_f16 v[128:131], v[150:153], v[172:175], v[128:131]
    ds_read_b64 v[196:197], v6 offset:2112
    v_mfma_f32_16x16x32_f16 v[132:135], v[152:155], v[172:175], v[132:135]
    ds_read_b64 v[198:199], v6 offset:2120
    v_mfma_f32_16x16x32_f16 v[136:139], v[150:153], v[176:179], v[136:139]
    ds_read_b64 v[200:201], v6 offset:2128
    v_mfma_f32_16x16x32_f16 v[140:143], v[152:155], v[176:179], v[140:143]
    s_waitcnt lgkmcnt(15)
    ds_read_b64 v[202:203], v6 offset:3136
    v_mfma_f32_16x16x32_f16 v[128:131], v[156:159], v[168:171], v[128:131]
    ds_read_b64 v[204:205], v6 offset:3144
    v_mfma_f32_16x16x32_f16 v[132:135], v[158:161], v[168:171], v[132:135]
    ds_read_b64 v[206:207], v6 offset:3152
    v_mfma_f32_16x16x32_f16 v[136:139], v[156:159], v[172:175], v[136:139]
    v_mfma_f32_16x16x32_f16 v[140:143], v[158:161], v[172:175], v[140:143]
    s_waitcnt lgkmcnt(15)
    v_mfma_f32_16x16x32_f16 v[136:139], v[162:165], v[168:171], v[136:139]
    v_mfma_f32_16x16x32_f16 v[140:143], v[164:167], v[168:171], v[140:143]
    s_waitcnt lgkmcnt(13)
    v_mfma_f32_16x16x32_f16 v[112:115], v[184:187], v[208:211], v[112:115]
    s_waitcnt lgkmcnt(12)
    ds_read_b128 v[168:171], v7 offset:17088
    v_mfma_f32_16x16x32_f16 v[116:119], v[186:189], v[208:211], v[116:119]
    s_waitcnt lgkmcnt(12)
    ds_read_b64 v[144:145], v6 offset:128
    v_mfma_f32_16x16x32_f16 v[120:123], v[184:187], v[212:215], v[120:123]
    ds_read_b64 v[146:147], v6 offset:136
    v_mfma_f32_16x16x32_f16 v[124:127], v[186:189], v[212:215], v[124:127]
    s_waitcnt lgkmcnt(13)
    ds_read_b64 v[148:149], v6 offset:144
    v_mfma_f32_16x16x32_f16 v[128:131], v[184:187], v[216:219], v[128:131]
    ds_read_b128 v[172:175], v7 offset:17344
    v_mfma_f32_16x16x32_f16 v[132:135], v[186:189], v[216:219], v[132:135]
    s_waitcnt lgkmcnt(14)
    ds_read_b128 v[176:179], v7 offset:17600
    v_mfma_f32_16x16x32_f16 v[136:139], v[184:187], v[220:223], v[136:139]
    ds_read_b128 v[180:183], v7 offset:17856
    v_mfma_f32_16x16x32_f16 v[140:143], v[186:189], v[220:223], v[140:143]
    s_waitcnt lgkmcnt(14)
    ds_read_b64 v[150:151], v6 offset:1152
    v_mfma_f32_16x16x32_f16 v[120:123], v[190:193], v[208:211], v[120:123]
    s_waitcnt lgkmcnt(14)
    ds_read_b64 v[152:153], v6 offset:1160
    v_mfma_f32_16x16x32_f16 v[124:127], v[192:195], v[208:211], v[124:127]
    ds_read_b64 v[154:155], v6 offset:1168
    v_mfma_f32_16x16x32_f16 v[128:131], v[190:193], v[212:215], v[128:131]
    ds_read_b64 v[156:157], v6 offset:2176
    v_mfma_f32_16x16x32_f16 v[132:135], v[192:195], v[212:215], v[132:135]
    ds_read_b64 v[158:159], v6 offset:2184
    v_mfma_f32_16x16x32_f16 v[136:139], v[190:193], v[216:219], v[136:139]
    ds_read_b64 v[160:161], v6 offset:2192
    v_mfma_f32_16x16x32_f16 v[140:143], v[192:195], v[216:219], v[140:143]
    s_waitcnt lgkmcnt(15)
    ds_read_b64 v[162:163], v6 offset:3200
    v_mfma_f32_16x16x32_f16 v[128:131], v[196:199], v[208:211], v[128:131]
    ds_read_b64 v[164:165], v6 offset:3208
    v_mfma_f32_16x16x32_f16 v[132:135], v[198:201], v[208:211], v[132:135]
    ds_read_b64 v[166:167], v6 offset:3216
    v_mfma_f32_16x16x32_f16 v[136:139], v[196:199], v[212:215], v[136:139]
    v_mfma_f32_16x16x32_f16 v[140:143], v[198:201], v[212:215], v[140:143]
    s_waitcnt lgkmcnt(15)
    v_mfma_f32_16x16x32_f16 v[136:139], v[202:205], v[208:211], v[136:139]
    v_mfma_f32_16x16x32_f16 v[140:143], v[204:207], v[208:211], v[140:143]
    s_waitcnt lgkmcnt(13)
    v_mfma_f32_16x16x32_f16 v[112:115], v[144:147], v[168:171], v[112:115]
    s_waitcnt lgkmcnt(12)
    ds_read_b128 v[208:211], v7 offset:17072
    v_mfma_f32_16x16x32_f16 v[116:119], v[146:149], v[168:171], v[116:119]
    s_waitcnt lgkmcnt(12)
    ds_read_b64 v[184:185], v6 offset:192
    v_mfma_f32_16x16x32_f16 v[120:123], v[144:147], v[172:175], v[120:123]
    ds_read_b64 v[186:187], v6 offset:200
    v_mfma_f32_16x16x32_f16 v[124:127], v[146:149], v[172:175], v[124:127]
    s_waitcnt lgkmcnt(13)
    ds_read_b64 v[188:189], v6 offset:208
    v_mfma_f32_16x16x32_f16 v[128:131], v[144:147], v[176:179], v[128:131]
    ds_read_b128 v[212:215], v7 offset:17328
    v_mfma_f32_16x16x32_f16 v[132:135], v[146:149], v[176:179], v[132:135]
    s_waitcnt lgkmcnt(14)
    ds_read_b128 v[216:219], v7 offset:17584
    v_mfma_f32_16x16x32_f16 v[136:139], v[144:147], v[180:183], v[136:139]
    ds_read_b128 v[220:223], v7 offset:17840
    v_mfma_f32_16x16x32_f16 v[140:143], v[146:149], v[180:183], v[140:143]
    s_waitcnt lgkmcnt(14)
    ds_read_b64 v[190:191], v6 offset:1216
    v_mfma_f32_16x16x32_f16 v[120:123], v[150:153], v[168:171], v[120:123]
    s_waitcnt lgkmcnt(14)
    ds_read_b64 v[192:193], v6 offset:1224
    v_mfma_f32_16x16x32_f16 v[124:127], v[152:155], v[168:171], v[124:127]
    ds_read_b64 v[194:195], v6 offset:1232
    v_mfma_f32_16x16x32_f16 v[128:131], v[150:153], v[172:175], v[128:131]
    ds_read_b64 v[196:197], v6 offset:2240
    v_mfma_f32_16x16x32_f16 v[132:135], v[152:155], v[172:175], v[132:135]
    ds_read_b64 v[198:199], v6 offset:2248
    v_mfma_f32_16x16x32_f16 v[136:139], v[150:153], v[176:179], v[136:139]
    ds_read_b64 v[200:201], v6 offset:2256
    v_mfma_f32_16x16x32_f16 v[140:143], v[152:155], v[176:179], v[140:143]
    s_waitcnt lgkmcnt(15)
    ds_read_b64 v[202:203], v6 offset:3264
    v_mfma_f32_16x16x32_f16 v[128:131], v[156:159], v[168:171], v[128:131]
    ds_read_b64 v[204:205], v6 offset:3272
    v_mfma_f32_16x16x32_f16 v[132:135], v[158:161], v[168:171], v[132:135]
    ds_read_b64 v[206:207], v6 offset:3280
    v_mfma_f32_16x16x32_f16 v[136:139], v[156:159], v[172:175], v[136:139]
    v_mfma_f32_16x16x32_f16 v[140:143], v[158:161], v[172:175], v[140:143]
    s_waitcnt lgkmcnt(15)
    v_mfma_f32_16x16x32_f16 v[136:139], v[162:165], v[168:171], v[136:139]
    v_mfma_f32_16x16x32_f16 v[140:143], v[164:167], v[168:171], v[140:143]
    s_waitcnt lgkmcnt(13)
    v_mfma_f32_16x16x32_f16 v[112:115], v[184:187], v[208:211], v[112:115]
    s_waitcnt lgkmcnt(12)
    ds_read_b128 v[168:171], v7 offset:17056
    v_mfma_f32_16x16x32_f16 v[116:119], v[186:189], v[208:211], v[116:119]
    s_waitcnt lgkmcnt(12)
    ds_read_b64 v[144:145], v6 offset:256
    v_mfma_f32_16x16x32_f16 v[120:123], v[184:187], v[212:215], v[120:123]
    ds_read_b64 v[146:147], v6 offset:264
    v_mfma_f32_16x16x32_f16 v[124:127], v[186:189], v[212:215], v[124:127]
    s_waitcnt lgkmcnt(13)
    ds_read_b64 v[148:149], v6 offset:272
    v_mfma_f32_16x16x32_f16 v[128:131], v[184:187], v[216:219], v[128:131]
    ds_read_b128 v[172:175], v7 offset:17312
    v_mfma_f32_16x16x32_f16 v[132:135], v[186:189], v[216:219], v[132:135]
    s_waitcnt lgkmcnt(14)
    ds_read_b128 v[176:179], v7 offset:17568
    v_mfma_f32_16x16x32_f16 v[136:139], v[184:187], v[220:223], v[136:139]
    ds_read_b128 v[180:183], v7 offset:17824
    v_mfma_f32_16x16x32_f16 v[140:143], v[186:189], v[220:223], v[140:143]
    s_waitcnt lgkmcnt(14)
    ds_read_b64 v[150:151], v6 offset:1280
    v_mfma_f32_16x16x32_f16 v[120:123], v[190:193], v[208:211], v[120:123]
    s_waitcnt lgkmcnt(14)
    ds_read_b64 v[152:153], v6 offset:1288
    v_mfma_f32_16x16x32_f16 v[124:127], v[192:195], v[208:211], v[124:127]
    ds_read_b64 v[154:155], v6 offset:1296
    v_mfma_f32_16x16x32_f16 v[128:131], v[190:193], v[212:215], v[128:131]
    ds_read_b64 v[156:157], v6 offset:2304
    v_mfma_f32_16x16x32_f16 v[132:135], v[192:195], v[212:215], v[132:135]
    ds_read_b64 v[158:159], v6 offset:2312
    v_mfma_f32_16x16x32_f16 v[136:139], v[190:193], v[216:219], v[136:139]
    ds_read_b64 v[160:161], v6 offset:2320
    v_mfma_f32_16x16x32_f16 v[140:143], v[192:195], v[216:219], v[140:143]
    s_waitcnt lgkmcnt(15)
    ds_read_b64 v[162:163], v6 offset:3328
    v_mfma_f32_16x16x32_f16 v[128:131], v[196:199], v[208:211], v[128:131]
    ds_read_b64 v[164:165], v6 offset:3336
    v_mfma_f32_16x16x32_f16 v[132:135], v[198:201], v[208:211], v[132:135]
    ds_read_b64 v[166:167], v6 offset:3344
    v_mfma_f32_16x16x32_f16 v[136:139], v[196:199], v[212:215], v[136:139]
    v_mfma_f32_16x16x32_f16 v[140:143], v[198:201], v[212:215], v[140:143]
    s_waitcnt lgkmcnt(15)
    v_mfma_f32_16x16x32_f16 v[136:139], v[202:205], v[208:211], v[136:139]
    v_mfma_f32_16x16x32_f16 v[140:143], v[204:207], v[208:211], v[140:143]
    s_waitcnt lgkmcnt(13)
    v_mfma_f32_16x16x32_f16 v[112:115], v[144:147], v[168:171], v[112:115]
    s_waitcnt lgkmcnt(12)
    ds_read_b128 v[208:211], v7 offset:17040
    v_mfma_f32_16x16x32_f16 v[116:119], v[146:149], v[168:171], v[116:119]
    s_waitcnt lgkmcnt(12)
    ds_read_b64 v[184:185], v6 offset:320
    v_mfma_f32_16x16x32_f16 v[120:123], v[144:147], v[172:175], v[120:123]
    ds_read_b64 v[186:187], v6 offset:328
    v_mfma_f32_16x16x32_f16 v[124:127], v[146:149], v[172:175], v[124:127]
    s_waitcnt lgkmcnt(13)
    ds_read_b64 v[188:189], v6 offset:336
    v_mfma_f32_16x16x32_f16 v[128:131], v[144:147], v[176:179], v[128:131]
    ds_read_b128 v[212:215], v7 offset:17296
    v_mfma_f32_16x16x32_f16 v[132:135], v[146:149], v[176:179], v[132:135]
    s_waitcnt lgkmcnt(14)
    ds_read_b128 v[216:219], v7 offset:17552
    v_mfma_f32_16x16x32_f16 v[136:139], v[144:147], v[180:183], v[136:139]
    ds_read_b128 v[220:223], v7 offset:17808
    v_mfma_f32_16x16x32_f16 v[140:143], v[146:149], v[180:183], v[140:143]
    s_waitcnt lgkmcnt(14)
    ds_read_b64 v[190:191], v6 offset:1344
    v_mfma_f32_16x16x32_f16 v[120:123], v[150:153], v[168:171], v[120:123]
    s_waitcnt lgkmcnt(14)
    ds_read_b64 v[192:193], v6 offset:1352
    v_mfma_f32_16x16x32_f16 v[124:127], v[152:155], v[168:171], v[124:127]
    ds_read_b64 v[194:195], v6 offset:1360
    v_mfma_f32_16x16x32_f16 v[128:131], v[150:153], v[172:175], v[128:131]
    ds_read_b64 v[196:197], v6 offset:2368
    v_mfma_f32_16x16x32_f16 v[132:135], v[152:155], v[172:175], v[132:135]
    ds_read_b64 v[198:199], v6 offset:2376
    v_mfma_f32_16x16x32_f16 v[136:139], v[150:153], v[176:179], v[136:139]
    ds_read_b64 v[200:201], v6 offset:2384
    v_mfma_f32_16x16x32_f16 v[140:143], v[152:155], v[176:179], v[140:143]
    s_waitcnt lgkmcnt(15)
    ds_read_b64 v[202:203], v6 offset:3392
    v_mfma_f32_16x16x32_f16 v[128:131], v[156:159], v[168:171], v[128:131]
    ds_read_b64 v[204:205], v6 offset:3400
    v_mfma_f32_16x16x32_f16 v[132:135], v[158:161], v[168:171], v[132:135]
    ds_read_b64 v[206:207], v6 offset:3408
    v_mfma_f32_16x16x32_f16 v[136:139], v[156:159], v[172:175], v[136:139]
    v_mfma_f32_16x16x32_f16 v[140:143], v[158:161], v[172:175], v[140:143]
    s_waitcnt lgkmcnt(15)
    v_mfma_f32_16x16x32_f16 v[136:139], v[162:165], v[168:171], v[136:139]
    v_mfma_f32_16x16x32_f16 v[140:143], v[164:167], v[168:171], v[140:143]
    s_waitcnt lgkmcnt(13)
    v_mfma_f32_16x16x32_f16 v[112:115], v[184:187], v[208:211], v[112:115]
    s_waitcnt lgkmcnt(12)
    ds_read_b128 v[168:171], v7 offset:17024
    v_mfma_f32_16x16x32_f16 v[116:119], v[186:189], v[208:211], v[116:119]
    s_waitcnt lgkmcnt(12)
    ds_read_b64 v[144:145], v6 offset:384
    v_mfma_f32_16x16x32_f16 v[120:123], v[184:187], v[212:215], v[120:123]
    ds_read_b64 v[146:147], v6 offset:392
    v_mfma_f32_16x16x32_f16 v[124:127], v[186:189], v[212:215], v[124:127]
    s_waitcnt lgkmcnt(13)
    ds_read_b64 v[148:149], v6 offset:400
    v_mfma_f32_16x16x32_f16 v[128:131], v[184:187], v[216:219], v[128:131]
    ds_read_b128 v[172:175], v7 offset:17280
    v_mfma_f32_16x16x32_f16 v[132:135], v[186:189], v[216:219], v[132:135]
    s_waitcnt lgkmcnt(14)
    ds_read_b128 v[176:179], v7 offset:17536
    v_mfma_f32_16x16x32_f16 v[136:139], v[184:187], v[220:223], v[136:139]
    ds_read_b128 v[180:183], v7 offset:17792
    v_mfma_f32_16x16x32_f16 v[140:143], v[186:189], v[220:223], v[140:143]
    s_waitcnt lgkmcnt(14)
    ds_read_b64 v[150:151], v6 offset:1408
    v_mfma_f32_16x16x32_f16 v[120:123], v[190:193], v[208:211], v[120:123]
    s_waitcnt lgkmcnt(14)
    ds_read_b64 v[152:153], v6 offset:1416
    v_mfma_f32_16x16x32_f16 v[124:127], v[192:195], v[208:211], v[124:127]
    ds_read_b64 v[154:155], v6 offset:1424
    v_mfma_f32_16x16x32_f16 v[128:131], v[190:193], v[212:215], v[128:131]
    ds_read_b64 v[156:157], v6 offset:2432
    v_mfma_f32_16x16x32_f16 v[132:135], v[192:195], v[212:215], v[132:135]
    ds_read_b64 v[158:159], v6 offset:2440
    v_mfma_f32_16x16x32_f16 v[136:139], v[190:193], v[216:219], v[136:139]
    ds_read_b64 v[160:161], v6 offset:2448
    v_mfma_f32_16x16x32_f16 v[140:143], v[192:195], v[216:219], v[140:143]
    s_waitcnt lgkmcnt(15)
    ds_read_b64 v[162:163], v6 offset:3456
    v_mfma_f32_16x16x32_f16 v[128:131], v[196:199], v[208:211], v[128:131]
    ds_read_b64 v[164:165], v6 offset:3464
    v_mfma_f32_16x16x32_f16 v[132:135], v[198:201], v[208:211], v[132:135]
    ds_read_b64 v[166:167], v6 offset:3472
    v_mfma_f32_16x16x32_f16 v[136:139], v[196:199], v[212:215], v[136:139]
    v_mfma_f32_16x16x32_f16 v[140:143], v[198:201], v[212:215], v[140:143]
    s_waitcnt lgkmcnt(15)
    v_mfma_f32_16x16x32_f16 v[136:139], v[202:205], v[208:211], v[136:139]
    v_mfma_f32_16x16x32_f16 v[140:143], v[204:207], v[208:211], v[140:143]
    s_waitcnt lgkmcnt(13)
    v_mfma_f32_16x16x32_f16 v[112:115], v[144:147], v[168:171], v[112:115]
    s_waitcnt lgkmcnt(12)
    ds_read_b128 v[208:211], v7 offset:17008
    v_mfma_f32_16x16x32_f16 v[116:119], v[146:149], v[168:171], v[116:119]
    s_waitcnt lgkmcnt(12)
    ds_read_b64 v[184:185], v6 offset:448
    v_mfma_f32_16x16x32_f16 v[120:123], v[144:147], v[172:175], v[120:123]
    ds_read_b64 v[186:187], v6 offset:456
    v_mfma_f32_16x16x32_f16 v[124:127], v[146:149], v[172:175], v[124:127]
    s_waitcnt lgkmcnt(13)
    ds_read_b64 v[188:189], v6 offset:464
    v_mfma_f32_16x16x32_f16 v[128:131], v[144:147], v[176:179], v[128:131]
    ds_read_b128 v[212:215], v7 offset:17264
    v_mfma_f32_16x16x32_f16 v[132:135], v[146:149], v[176:179], v[132:135]
    s_waitcnt lgkmcnt(14)
    ds_read_b128 v[216:219], v7 offset:17520
    v_mfma_f32_16x16x32_f16 v[136:139], v[144:147], v[180:183], v[136:139]
    ds_read_b128 v[220:223], v7 offset:17776
    v_mfma_f32_16x16x32_f16 v[140:143], v[146:149], v[180:183], v[140:143]
    s_waitcnt lgkmcnt(14)
    ds_read_b64 v[190:191], v6 offset:1472
    v_mfma_f32_16x16x32_f16 v[120:123], v[150:153], v[168:171], v[120:123]
    s_waitcnt lgkmcnt(14)
    ds_read_b64 v[192:193], v6 offset:1480
    v_mfma_f32_16x16x32_f16 v[124:127], v[152:155], v[168:171], v[124:127]
    ds_read_b64 v[194:195], v6 offset:1488
    v_mfma_f32_16x16x32_f16 v[128:131], v[150:153], v[172:175], v[128:131]
    ds_read_b64 v[196:197], v6 offset:2496
    v_mfma_f32_16x16x32_f16 v[132:135], v[152:155], v[172:175], v[132:135]
    ds_read_b64 v[198:199], v6 offset:2504
    v_mfma_f32_16x16x32_f16 v[136:139], v[150:153], v[176:179], v[136:139]
    ds_read_b64 v[200:201], v6 offset:2512
    v_mfma_f32_16x16x32_f16 v[140:143], v[152:155], v[176:179], v[140:143]
    s_waitcnt lgkmcnt(15)
    ds_read_b64 v[202:203], v6 offset:3520
    v_mfma_f32_16x16x32_f16 v[128:131], v[156:159], v[168:171], v[128:131]
    ds_read_b64 v[204:205], v6 offset:3528
    v_mfma_f32_16x16x32_f16 v[132:135], v[158:161], v[168:171], v[132:135]
    ds_read_b64 v[206:207], v6 offset:3536
    v_mfma_f32_16x16x32_f16 v[136:139], v[156:159], v[172:175], v[136:139]
    v_mfma_f32_16x16x32_f16 v[140:143], v[158:161], v[172:175], v[140:143]
    s_waitcnt lgkmcnt(15)
    v_mfma_f32_16x16x32_f16 v[136:139], v[162:165], v[168:171], v[136:139]
    v_mfma_f32_16x16x32_f16 v[140:143], v[164:167], v[168:171], v[140:143]
    s_waitcnt lgkmcnt(13)
    v_mfma_f32_16x16x32_f16 v[112:115], v[184:187], v[208:211], v[112:115]
    s_waitcnt lgkmcnt(12)
    ds_read_b128 v[168:171], v7 offset:16992
    v_mfma_f32_16x16x32_f16 v[116:119], v[186:189], v[208:211], v[116:119]
    s_waitcnt lgkmcnt(12)
    ds_read_b64 v[144:145], v6 offset:512
    v_mfma_f32_16x16x32_f16 v[120:123], v[184:187], v[212:215], v[120:123]
    ds_read_b64 v[146:147], v6 offset:520
    v_mfma_f32_16x16x32_f16 v[124:127], v[186:189], v[212:215], v[124:127]
    s_waitcnt lgkmcnt(13)
    ds_read_b64 v[148:149], v6 offset:528
    v_mfma_f32_16x16x32_f16 v[128:131], v[184:187], v[216:219], v[128:131]
    ds_read_b128 v[172:175], v7 offset:17248
    v_mfma_f32_16x16x32_f16 v[132:135], v[186:189], v[216:219], v[132:135]
    s_waitcnt lgkmcnt(14)
    ds_read_b128 v[176:179], v7 offset:17504
    v_mfma_f32_16x16x32_f16 v[136:139], v[184:187], v[220:223], v[136:139]
    ds_read_b128 v[180:183], v7 offset:17760
    v_mfma_f32_16x16x32_f16 v[140:143], v[186:189], v[220:223], v[140:143]
    s_waitcnt lgkmcnt(14)
    ds_read_b64 v[150:151], v6 offset:1536
    v_mfma_f32_16x16x32_f16 v[120:123], v[190:193], v[208:211], v[120:123]
    s_waitcnt lgkmcnt(14)
    ds_read_b64 v[152:153], v6 offset:1544
    v_mfma_f32_16x16x32_f16 v[124:127], v[192:195], v[208:211], v[124:127]
    ds_read_b64 v[154:155], v6 offset:1552
    v_mfma_f32_16x16x32_f16 v[128:131], v[190:193], v[212:215], v[128:131]
    ds_read_b64 v[156:157], v6 offset:2560
    v_mfma_f32_16x16x32_f16 v[132:135], v[192:195], v[212:215], v[132:135]
    ds_read_b64 v[158:159], v6 offset:2568
    v_mfma_f32_16x16x32_f16 v[136:139], v[190:193], v[216:219], v[136:139]
    ds_read_b64 v[160:161], v6 offset:2576
    v_mfma_f32_16x16x32_f16 v[140:143], v[192:195], v[216:219], v[140:143]
    s_waitcnt lgkmcnt(15)
    ds_read_b64 v[162:163], v6 offset:3584
    v_mfma_f32_16x16x32_f16 v[128:131], v[196:199], v[208:211], v[128:131]
    ds_read_b64 v[164:165], v6 offset:3592
    v_mfma_f32_16x16x32_f16 v[132:135], v[198:201], v[208:211], v[132:135]
    ds_read_b64 v[166:167], v6 offset:3600
    v_mfma_f32_16x16x32_f16 v[136:139], v[196:199], v[212:215], v[136:139]
    ds_read_b128 v[96:99], v14 offset:0
    v_mfma_f32_16x16x32_f16 v[140:143], v[198:201], v[212:215], v[140:143]
    s_waitcnt lgkmcnt(15)
    ds_read_b128 v[100:103], v14 offset:256
    v_mfma_f32_16x16x32_f16 v[136:139], v[202:205], v[208:211], v[136:139]
    ds_read_b128 v[104:107], v14 offset:512
    v_mfma_f32_16x16x32_f16 v[140:143], v[204:207], v[208:211], v[140:143]
    s_waitcnt lgkmcnt(15)
    ds_read_b128 v[108:111], v14 offset:768
    v_mfma_f32_16x16x32_f16 v[112:115], v[144:147], v[168:171], v[112:115]
    ds_read_b128 v[208:211], v7 offset:16976
    v_mfma_f32_16x16x32_f16 v[116:119], v[146:149], v[168:171], v[116:119]
    s_waitcnt lgkmcnt(15)
    ds_read_b64 v[184:185], v6 offset:576
    v_mfma_f32_16x16x32_f16 v[120:123], v[144:147], v[172:175], v[120:123]
    ds_read_b64 v[186:187], v6 offset:584
    v_mfma_f32_16x16x32_f16 v[124:127], v[146:149], v[172:175], v[124:127]
    ds_read_b64 v[188:189], v6 offset:592
    v_mfma_f32_16x16x32_f16 v[128:131], v[144:147], v[176:179], v[128:131]
    ds_read_b128 v[212:215], v7 offset:17232
    v_mfma_f32_16x16x32_f16 v[132:135], v[146:149], v[176:179], v[132:135]
    s_waitcnt lgkmcnt(15)
    ds_read_b128 v[216:219], v7 offset:17488
    v_mfma_f32_16x16x32_f16 v[136:139], v[144:147], v[180:183], v[136:139]
    ds_read_b128 v[220:223], v7 offset:17744
    v_mfma_f32_16x16x32_f16 v[140:143], v[146:149], v[180:183], v[140:143]
    ds_read_b64 v[190:191], v6 offset:1600
    v_mfma_f32_16x16x32_f16 v[120:123], v[150:153], v[168:171], v[120:123]
    ds_read_b64 v[192:193], v6 offset:1608
    v_mfma_f32_16x16x32_f16 v[124:127], v[152:155], v[168:171], v[124:127]
    ds_read_b64 v[194:195], v6 offset:1616
    v_mfma_f32_16x16x32_f16 v[128:131], v[150:153], v[172:175], v[128:131]
    ds_read_b64 v[196:197], v6 offset:2624
    v_mfma_f32_16x16x32_f16 v[132:135], v[152:155], v[172:175], v[132:135]
    ds_read_b64 v[198:199], v6 offset:2632
    v_mfma_f32_16x16x32_f16 v[136:139], v[150:153], v[176:179], v[136:139]
    ds_read_b64 v[200:201], v6 offset:2640
    v_mfma_f32_16x16x32_f16 v[140:143], v[152:155], v[176:179], v[140:143]
    s_waitcnt lgkmcnt(15)
    ds_read_b64 v[202:203], v6 offset:3648
    v_mfma_f32_16x16x32_f16 v[128:131], v[156:159], v[168:171], v[128:131]
    ds_read_b64 v[204:205], v6 offset:3656
    v_mfma_f32_16x16x32_f16 v[132:135], v[158:161], v[168:171], v[132:135]
    ds_read_b64 v[206:207], v6 offset:3664
    v_mfma_f32_16x16x32_f16 v[136:139], v[156:159], v[172:175], v[136:139]
    ds_read_b128 v[32:35], v51 offset:17120
    v_mfma_f32_16x16x32_f16 v[140:143], v[158:161], v[172:175], v[140:143]
    ds_read_b128 v[36:39], v51 offset:17376
    v_mfma_f32_16x16x32_f16 v[136:139], v[162:165], v[168:171], v[136:139]
    ds_read_b128 v[40:43], v51 offset:17632
    v_mfma_f32_16x16x32_f16 v[140:143], v[164:167], v[168:171], v[140:143]
    s_waitcnt lgkmcnt(15)
    ds_read_b128 v[44:47], v51 offset:17888
    v_mfma_f32_16x16x32_f16 v[112:115], v[184:187], v[208:211], v[112:115]
    ds_read_b128 v[168:171], v7 offset:16960
    v_mfma_f32_16x16x32_f16 v[116:119], v[186:189], v[208:211], v[116:119]
    s_waitcnt lgkmcnt(15)
    ds_read_b64 v[144:145], v6 offset:640
    v_mfma_f32_16x16x32_f16 v[120:123], v[184:187], v[212:215], v[120:123]
    ds_read_b64 v[146:147], v6 offset:648
    v_mfma_f32_16x16x32_f16 v[124:127], v[186:189], v[212:215], v[124:127]
    ds_read_b64 v[148:149], v6 offset:656
    v_mfma_f32_16x16x32_f16 v[128:131], v[184:187], v[216:219], v[128:131]
    ds_read_b128 v[172:175], v7 offset:17216
    v_mfma_f32_16x16x32_f16 v[132:135], v[186:189], v[216:219], v[132:135]
    s_waitcnt lgkmcnt(15)
    ds_read_b128 v[176:179], v7 offset:17472
    v_mfma_f32_16x16x32_f16 v[136:139], v[184:187], v[220:223], v[136:139]
    ds_read_b128 v[180:183], v7 offset:17728
    v_mfma_f32_16x16x32_f16 v[140:143], v[186:189], v[220:223], v[140:143]
    ds_read_b64 v[150:151], v6 offset:1664
    v_mfma_f32_16x16x32_f16 v[120:123], v[190:193], v[208:211], v[120:123]
    ds_read_b64 v[152:153], v6 offset:1672
    v_mfma_f32_16x16x32_f16 v[124:127], v[192:195], v[208:211], v[124:127]
    ds_read_b64 v[154:155], v6 offset:1680
    v_mfma_f32_16x16x32_f16 v[128:131], v[190:193], v[212:215], v[128:131]
    ds_read_b64 v[156:157], v6 offset:2688
    v_mfma_f32_16x16x32_f16 v[132:135], v[192:195], v[212:215], v[132:135]
    ds_read_b64 v[158:159], v6 offset:2696
    v_mfma_f32_16x16x32_f16 v[136:139], v[190:193], v[216:219], v[136:139]
    ds_read_b64 v[160:161], v6 offset:2704
    v_mfma_f32_16x16x32_f16 v[140:143], v[192:195], v[216:219], v[140:143]
    s_waitcnt lgkmcnt(15)
    ds_read_b64 v[162:163], v6 offset:3712
    v_mfma_f32_16x16x32_f16 v[128:131], v[196:199], v[208:211], v[128:131]
    ds_read_b64 v[164:165], v6 offset:3720
    v_mfma_f32_16x16x32_f16 v[132:135], v[198:201], v[208:211], v[132:135]
    ds_read_b64 v[166:167], v6 offset:3728
    v_mfma_f32_16x16x32_f16 v[136:139], v[196:199], v[212:215], v[136:139]
    v_mfma_f32_16x16x32_f16 v[140:143], v[198:201], v[212:215], v[140:143]
    v_mfma_f32_16x16x32_f16 v[136:139], v[202:205], v[208:211], v[136:139]
    v_mfma_f32_16x16x32_f16 v[140:143], v[204:207], v[208:211], v[140:143]
    s_waitcnt lgkmcnt(13)
    v_mfma_f32_16x16x32_f16 v[112:115], v[144:147], v[168:171], v[112:115]
    s_waitcnt lgkmcnt(12)
    ds_read_b128 v[208:211], v7 offset:16944
    v_lshlrev_b32 v64, 16, v96
    v_mfma_f32_16x16x32_f16 v[116:119], v[146:149], v[168:171], v[116:119]
    s_waitcnt lgkmcnt(12)
    ds_read_b64 v[184:185], v6 offset:704
    v_and_b32 v65, 0xffff0000, v96
    v_mfma_f32_16x16x32_f16 v[120:123], v[144:147], v[172:175], v[120:123]
    ds_read_b64 v[186:187], v6 offset:712
    v_lshlrev_b32 v66, 16, v97
    v_mfma_f32_16x16x32_f16 v[124:127], v[146:149], v[172:175], v[124:127]
    s_waitcnt lgkmcnt(13)
    ds_read_b64 v[188:189], v6 offset:720
    v_and_b32 v67, 0xffff0000, v97
    v_mfma_f32_16x16x32_f16 v[128:131], v[144:147], v[176:179], v[128:131]
    ds_read_b128 v[212:215], v7 offset:17200
    v_lshlrev_b32 v68, 16, v98
    v_mfma_f32_16x16x32_f16 v[132:135], v[146:149], v[176:179], v[132:135]
    s_waitcnt lgkmcnt(14)
    ds_read_b128 v[216:219], v7 offset:17456
    v_and_b32 v69, 0xffff0000, v98
    v_mfma_f32_16x16x32_f16 v[136:139], v[144:147], v[180:183], v[136:139]
    ds_read_b128 v[220:223], v7 offset:17712
    v_lshlrev_b32 v70, 16, v99
    v_mfma_f32_16x16x32_f16 v[140:143], v[146:149], v[180:183], v[140:143]
    s_waitcnt lgkmcnt(14)
    ds_read_b64 v[190:191], v6 offset:1728
    v_and_b32 v71, 0xffff0000, v99
    v_mfma_f32_16x16x32_f16 v[120:123], v[150:153], v[168:171], v[120:123]
    s_waitcnt lgkmcnt(14)
    ds_read_b64 v[192:193], v6 offset:1736
    v_fma_mix_f32 v64, v35, v18, v64 op_sel:[1,0,0] op_sel_hi:[1,0,0]
    v_mfma_f32_16x16x32_f16 v[124:127], v[152:155], v[168:171], v[124:127]
    ds_read_b64 v[194:195], v6 offset:1744
    v_fma_mix_f32 v65, v35, v18, v65 op_sel:[0,0,0] op_sel_hi:[1,0,0]
    v_mfma_f32_16x16x32_f16 v[128:131], v[150:153], v[172:175], v[128:131]
    ds_read_b64 v[196:197], v6 offset:2752
    v_fma_mix_f32 v66, v34, v18, v66 op_sel:[1,0,0] op_sel_hi:[1,0,0]
    v_mfma_f32_16x16x32_f16 v[132:135], v[152:155], v[172:175], v[132:135]
    ds_read_b64 v[198:199], v6 offset:2760
    v_fma_mix_f32 v67, v34, v18, v67 op_sel:[0,0,0] op_sel_hi:[1,0,0]
    v_mfma_f32_16x16x32_f16 v[136:139], v[150:153], v[176:179], v[136:139]
    ds_read_b64 v[200:201], v6 offset:2768
    v_fma_mix_f32 v68, v33, v18, v68 op_sel:[1,0,0] op_sel_hi:[1,0,0]
    v_mfma_f32_16x16x32_f16 v[140:143], v[152:155], v[176:179], v[140:143]
    s_waitcnt lgkmcnt(15)
    ds_read_b64 v[202:203], v6 offset:3776
    v_fma_mix_f32 v69, v33, v18, v69 op_sel:[0,0,0] op_sel_hi:[1,0,0]
    v_mfma_f32_16x16x32_f16 v[128:131], v[156:159], v[168:171], v[128:131]
    ds_read_b64 v[204:205], v6 offset:3784
    v_fma_mix_f32 v70, v32, v18, v70 op_sel:[1,0,0] op_sel_hi:[1,0,0]
    v_mfma_f32_16x16x32_f16 v[132:135], v[158:161], v[168:171], v[132:135]
    ds_read_b64 v[206:207], v6 offset:3792
    v_fma_mix_f32 v71, v32, v18, v71 op_sel:[0,0,0] op_sel_hi:[1,0,0]
    v_mfma_f32_16x16x32_f16 v[136:139], v[156:159], v[172:175], v[136:139]
    v_mfma_f32_16x16x32_f16 v[140:143], v[158:161], v[172:175], v[140:143]
    s_waitcnt lgkmcnt(15)
    v_mfma_f32_16x16x32_f16 v[136:139], v[162:165], v[168:171], v[136:139]
    v_mfma_f32_16x16x32_f16 v[140:143], v[164:167], v[168:171], v[140:143]
    s_waitcnt lgkmcnt(13)
    v_mfma_f32_16x16x32_f16 v[112:115], v[184:187], v[208:211], v[112:115]
    s_waitcnt lgkmcnt(12)
    ds_read_b128 v[168:171], v7 offset:16928
    v_lshlrev_b32 v72, 16, v100
    v_mfma_f32_16x16x32_f16 v[116:119], v[186:189], v[208:211], v[116:119]
    s_waitcnt lgkmcnt(12)
    ds_read_b64 v[144:145], v6 offset:768
    v_and_b32 v73, 0xffff0000, v100
    v_mfma_f32_16x16x32_f16 v[120:123], v[184:187], v[212:215], v[120:123]
    ds_read_b64 v[146:147], v6 offset:776
    v_lshlrev_b32 v74, 16, v101
    v_mfma_f32_16x16x32_f16 v[124:127], v[186:189], v[212:215], v[124:127]
    s_waitcnt lgkmcnt(13)
    ds_read_b64 v[148:149], v6 offset:784
    v_and_b32 v75, 0xffff0000, v101
    v_mfma_f32_16x16x32_f16 v[128:131], v[184:187], v[216:219], v[128:131]
    ds_read_b128 v[172:175], v7 offset:17184
    v_lshlrev_b32 v76, 16, v102
    v_mfma_f32_16x16x32_f16 v[132:135], v[186:189], v[216:219], v[132:135]
    s_waitcnt lgkmcnt(14)
    ds_read_b128 v[176:179], v7 offset:17440
    v_and_b32 v77, 0xffff0000, v102
    v_mfma_f32_16x16x32_f16 v[136:139], v[184:187], v[220:223], v[136:139]
    ds_read_b128 v[180:183], v7 offset:17696
    v_lshlrev_b32 v78, 16, v103
    v_mfma_f32_16x16x32_f16 v[140:143], v[186:189], v[220:223], v[140:143]
    s_waitcnt lgkmcnt(14)
    ds_read_b64 v[150:151], v6 offset:1792
    v_and_b32 v79, 0xffff0000, v103
    v_mfma_f32_16x16x32_f16 v[120:123], v[190:193], v[208:211], v[120:123]
    s_waitcnt lgkmcnt(14)
    ds_read_b64 v[152:153], v6 offset:1800
    v_fma_mix_f32 v72, v39, v18, v72 op_sel:[1,0,0] op_sel_hi:[1,0,0]
    v_mfma_f32_16x16x32_f16 v[124:127], v[192:195], v[208:211], v[124:127]
    ds_read_b64 v[154:155], v6 offset:1808
    v_fma_mix_f32 v73, v39, v18, v73 op_sel:[0,0,0] op_sel_hi:[1,0,0]
    v_mfma_f32_16x16x32_f16 v[128:131], v[190:193], v[212:215], v[128:131]
    ds_read_b64 v[156:157], v6 offset:2816
    v_fma_mix_f32 v74, v38, v18, v74 op_sel:[1,0,0] op_sel_hi:[1,0,0]
    v_mfma_f32_16x16x32_f16 v[132:135], v[192:195], v[212:215], v[132:135]
    ds_read_b64 v[158:159], v6 offset:2824
    v_fma_mix_f32 v75, v38, v18, v75 op_sel:[0,0,0] op_sel_hi:[1,0,0]
    v_mfma_f32_16x16x32_f16 v[136:139], v[190:193], v[216:219], v[136:139]
    ds_read_b64 v[160:161], v6 offset:2832
    v_fma_mix_f32 v76, v37, v18, v76 op_sel:[1,0,0] op_sel_hi:[1,0,0]
    v_mfma_f32_16x16x32_f16 v[140:143], v[192:195], v[216:219], v[140:143]
    s_waitcnt lgkmcnt(15)
    ds_read_b64 v[162:163], v6 offset:3840
    v_fma_mix_f32 v77, v37, v18, v77 op_sel:[0,0,0] op_sel_hi:[1,0,0]
    v_mfma_f32_16x16x32_f16 v[128:131], v[196:199], v[208:211], v[128:131]
    ds_read_b64 v[164:165], v6 offset:3848
    v_fma_mix_f32 v78, v36, v18, v78 op_sel:[1,0,0] op_sel_hi:[1,0,0]
    v_mfma_f32_16x16x32_f16 v[132:135], v[198:201], v[208:211], v[132:135]
    ds_read_b64 v[166:167], v6 offset:3856
    v_fma_mix_f32 v79, v36, v18, v79 op_sel:[0,0,0] op_sel_hi:[1,0,0]
    v_mfma_f32_16x16x32_f16 v[136:139], v[196:199], v[212:215], v[136:139]
    v_mfma_f32_16x16x32_f16 v[140:143], v[198:201], v[212:215], v[140:143]
    s_waitcnt lgkmcnt(15)
    v_mfma_f32_16x16x32_f16 v[136:139], v[202:205], v[208:211], v[136:139]
    v_mfma_f32_16x16x32_f16 v[140:143], v[204:207], v[208:211], v[140:143]
    s_waitcnt lgkmcnt(13)
    v_mfma_f32_16x16x32_f16 v[112:115], v[144:147], v[168:171], v[112:115]
    s_waitcnt lgkmcnt(12)
    ds_read_b128 v[208:211], v7 offset:16912
    v_lshlrev_b32 v80, 16, v104
    v_mfma_f32_16x16x32_f16 v[116:119], v[146:149], v[168:171], v[116:119]
    s_waitcnt lgkmcnt(12)
    ds_read_b64 v[184:185], v6 offset:832
    v_and_b32 v81, 0xffff0000, v104
    v_mfma_f32_16x16x32_f16 v[120:123], v[144:147], v[172:175], v[120:123]
    ds_read_b64 v[186:187], v6 offset:840
    v_lshlrev_b32 v82, 16, v105
    v_mfma_f32_16x16x32_f16 v[124:127], v[146:149], v[172:175], v[124:127]
    s_waitcnt lgkmcnt(13)
    ds_read_b64 v[188:189], v6 offset:848
    v_and_b32 v83, 0xffff0000, v105
    v_mfma_f32_16x16x32_f16 v[128:131], v[144:147], v[176:179], v[128:131]
    ds_read_b128 v[212:215], v7 offset:17168
    v_lshlrev_b32 v84, 16, v106
    v_mfma_f32_16x16x32_f16 v[132:135], v[146:149], v[176:179], v[132:135]
    s_waitcnt lgkmcnt(14)
    ds_read_b128 v[216:219], v7 offset:17424
    v_and_b32 v85, 0xffff0000, v106
    v_mfma_f32_16x16x32_f16 v[136:139], v[144:147], v[180:183], v[136:139]
    ds_read_b128 v[220:223], v7 offset:17680
    v_lshlrev_b32 v86, 16, v107
    v_mfma_f32_16x16x32_f16 v[140:143], v[146:149], v[180:183], v[140:143]
    s_waitcnt lgkmcnt(14)
    ds_read_b64 v[190:191], v6 offset:1856
    v_and_b32 v87, 0xffff0000, v107
    v_mfma_f32_16x16x32_f16 v[120:123], v[150:153], v[168:171], v[120:123]
    s_waitcnt lgkmcnt(14)
    ds_read_b64 v[192:193], v6 offset:1864
    v_fma_mix_f32 v80, v43, v18, v80 op_sel:[1,0,0] op_sel_hi:[1,0,0]
    v_mfma_f32_16x16x32_f16 v[124:127], v[152:155], v[168:171], v[124:127]
    ds_read_b64 v[194:195], v6 offset:1872
    v_fma_mix_f32 v81, v43, v18, v81 op_sel:[0,0,0] op_sel_hi:[1,0,0]
    v_mfma_f32_16x16x32_f16 v[128:131], v[150:153], v[172:175], v[128:131]
    ds_read_b64 v[196:197], v6 offset:2880
    v_fma_mix_f32 v82, v42, v18, v82 op_sel:[1,0,0] op_sel_hi:[1,0,0]
    v_mfma_f32_16x16x32_f16 v[132:135], v[152:155], v[172:175], v[132:135]
    ds_read_b64 v[198:199], v6 offset:2888
    v_fma_mix_f32 v83, v42, v18, v83 op_sel:[0,0,0] op_sel_hi:[1,0,0]
    v_mfma_f32_16x16x32_f16 v[136:139], v[150:153], v[176:179], v[136:139]
    ds_read_b64 v[200:201], v6 offset:2896
    v_fma_mix_f32 v84, v41, v18, v84 op_sel:[1,0,0] op_sel_hi:[1,0,0]
    v_mfma_f32_16x16x32_f16 v[140:143], v[152:155], v[176:179], v[140:143]
    s_waitcnt lgkmcnt(15)
    ds_read_b64 v[202:203], v6 offset:3904
    v_fma_mix_f32 v85, v41, v18, v85 op_sel:[0,0,0] op_sel_hi:[1,0,0]
    v_mfma_f32_16x16x32_f16 v[128:131], v[156:159], v[168:171], v[128:131]
    ds_read_b64 v[204:205], v6 offset:3912
    v_fma_mix_f32 v86, v40, v18, v86 op_sel:[1,0,0] op_sel_hi:[1,0,0]
    v_mfma_f32_16x16x32_f16 v[132:135], v[158:161], v[168:171], v[132:135]
    ds_read_b64 v[206:207], v6 offset:3920
    v_fma_mix_f32 v87, v40, v18, v87 op_sel:[0,0,0] op_sel_hi:[1,0,0]
    v_mfma_f32_16x16x32_f16 v[136:139], v[156:159], v[172:175], v[136:139]
    v_mfma_f32_16x16x32_f16 v[140:143], v[158:161], v[172:175], v[140:143]
    s_waitcnt lgkmcnt(15)
    v_mfma_f32_16x16x32_f16 v[136:139], v[162:165], v[168:171], v[136:139]
    v_mfma_f32_16x16x32_f16 v[140:143], v[164:167], v[168:171], v[140:143]
    s_waitcnt lgkmcnt(13)
    v_mfma_f32_16x16x32_f16 v[112:115], v[184:187], v[208:211], v[112:115]
    s_waitcnt lgkmcnt(12)
    ds_read_b128 v[168:171], v7 offset:16896
    v_lshlrev_b32 v88, 16, v108
    v_mfma_f32_16x16x32_f16 v[116:119], v[186:189], v[208:211], v[116:119]
    s_waitcnt lgkmcnt(12)
    ds_read_b64 v[144:145], v6 offset:896
    v_and_b32 v89, 0xffff0000, v108
    v_mfma_f32_16x16x32_f16 v[120:123], v[184:187], v[212:215], v[120:123]
    ds_read_b64 v[146:147], v6 offset:904
    v_lshlrev_b32 v90, 16, v109
    v_mfma_f32_16x16x32_f16 v[124:127], v[186:189], v[212:215], v[124:127]
    s_waitcnt lgkmcnt(13)
    ds_read_b64 v[148:149], v6 offset:912
    v_and_b32 v91, 0xffff0000, v109
    v_mfma_f32_16x16x32_f16 v[128:131], v[184:187], v[216:219], v[128:131]
    ds_read_b128 v[172:175], v7 offset:17152
    v_lshlrev_b32 v92, 16, v110
    v_mfma_f32_16x16x32_f16 v[132:135], v[186:189], v[216:219], v[132:135]
    s_waitcnt lgkmcnt(14)
    ds_read_b128 v[176:179], v7 offset:17408
    v_and_b32 v93, 0xffff0000, v110
    v_mfma_f32_16x16x32_f16 v[136:139], v[184:187], v[220:223], v[136:139]
    ds_read_b128 v[180:183], v7 offset:17664
    v_lshlrev_b32 v94, 16, v111
    v_mfma_f32_16x16x32_f16 v[140:143], v[186:189], v[220:223], v[140:143]
    s_waitcnt lgkmcnt(14)
    ds_read_b64 v[150:151], v6 offset:1920
    v_and_b32 v95, 0xffff0000, v111
    v_mfma_f32_16x16x32_f16 v[120:123], v[190:193], v[208:211], v[120:123]
    s_waitcnt lgkmcnt(14)
    ds_read_b64 v[152:153], v6 offset:1928
    v_fma_mix_f32 v88, v47, v18, v88 op_sel:[1,0,0] op_sel_hi:[1,0,0]
    v_mfma_f32_16x16x32_f16 v[124:127], v[192:195], v[208:211], v[124:127]
    ds_read_b64 v[154:155], v6 offset:1936
    v_fma_mix_f32 v89, v47, v18, v89 op_sel:[0,0,0] op_sel_hi:[1,0,0]
    v_mfma_f32_16x16x32_f16 v[128:131], v[190:193], v[212:215], v[128:131]
    ds_read_b64 v[156:157], v6 offset:2944
    v_fma_mix_f32 v90, v46, v18, v90 op_sel:[1,0,0] op_sel_hi:[1,0,0]
    v_mfma_f32_16x16x32_f16 v[132:135], v[192:195], v[212:215], v[132:135]
    ds_read_b64 v[158:159], v6 offset:2952
    v_fma_mix_f32 v91, v46, v18, v91 op_sel:[0,0,0] op_sel_hi:[1,0,0]
    v_mfma_f32_16x16x32_f16 v[136:139], v[190:193], v[216:219], v[136:139]
    ds_read_b64 v[160:161], v6 offset:2960
    v_fma_mix_f32 v92, v45, v18, v92 op_sel:[1,0,0] op_sel_hi:[1,0,0]
    v_mfma_f32_16x16x32_f16 v[140:143], v[192:195], v[216:219], v[140:143]
    s_waitcnt lgkmcnt(15)
    ds_read_b64 v[162:163], v6 offset:3968
    v_fma_mix_f32 v93, v45, v18, v93 op_sel:[0,0,0] op_sel_hi:[1,0,0]
    v_mfma_f32_16x16x32_f16 v[128:131], v[196:199], v[208:211], v[128:131]
    ds_read_b64 v[164:165], v6 offset:3976
    v_fma_mix_f32 v94, v44, v18, v94 op_sel:[1,0,0] op_sel_hi:[1,0,0]
    v_mfma_f32_16x16x32_f16 v[132:135], v[198:201], v[208:211], v[132:135]
    ds_read_b64 v[166:167], v6 offset:3984
    v_fma_mix_f32 v95, v44, v18, v95 op_sel:[0,0,0] op_sel_hi:[1,0,0]
    v_mfma_f32_16x16x32_f16 v[136:139], v[196:199], v[212:215], v[136:139]
    v_mfma_f32_16x16x32_f16 v[140:143], v[198:201], v[212:215], v[140:143]
    s_waitcnt lgkmcnt(15)
    v_mfma_f32_16x16x32_f16 v[136:139], v[202:205], v[208:211], v[136:139]
    v_mfma_f32_16x16x32_f16 v[140:143], v[204:207], v[208:211], v[140:143]
    s_waitcnt lgkmcnt(13)
    v_mfma_f32_16x16x32_f16 v[112:115], v[144:147], v[168:171], v[112:115]
    s_waitcnt lgkmcnt(12)
    ds_read_b128 v[208:211], v7 offset:16880
    v_mfma_f32_16x16x32_f16 v[116:119], v[146:149], v[168:171], v[116:119]
    s_waitcnt lgkmcnt(12)
    ds_read_b64 v[184:185], v6 offset:960
    v_mfma_f32_16x16x32_f16 v[120:123], v[144:147], v[172:175], v[120:123]
    ds_read_b64 v[186:187], v6 offset:968
    v_mfma_f32_16x16x32_f16 v[124:127], v[146:149], v[172:175], v[124:127]
    s_waitcnt lgkmcnt(13)
    ds_read_b64 v[188:189], v6 offset:976
    v_mfma_f32_16x16x32_f16 v[128:131], v[144:147], v[176:179], v[128:131]
    ds_read_b128 v[212:215], v7 offset:17136
    v_mfma_f32_16x16x32_f16 v[132:135], v[146:149], v[176:179], v[132:135]
    s_waitcnt lgkmcnt(14)
    ds_read_b128 v[216:219], v7 offset:17392
    v_mfma_f32_16x16x32_f16 v[136:139], v[144:147], v[180:183], v[136:139]
    ds_read_b128 v[220:223], v7 offset:17648
    v_mfma_f32_16x16x32_f16 v[140:143], v[146:149], v[180:183], v[140:143]
    s_waitcnt lgkmcnt(14)
    ds_read_b64 v[190:191], v6 offset:1984
    v_mfma_f32_16x16x32_f16 v[120:123], v[150:153], v[168:171], v[120:123]
    s_waitcnt lgkmcnt(14)
    ds_read_b64 v[192:193], v6 offset:1992
    v_mfma_f32_16x16x32_f16 v[124:127], v[152:155], v[168:171], v[124:127]
    ds_read_b64 v[194:195], v6 offset:2000
    v_mfma_f32_16x16x32_f16 v[128:131], v[150:153], v[172:175], v[128:131]
    ds_read_b64 v[196:197], v6 offset:3008
    v_mfma_f32_16x16x32_f16 v[132:135], v[152:155], v[172:175], v[132:135]
    ds_read_b64 v[198:199], v6 offset:3016
    v_mfma_f32_16x16x32_f16 v[136:139], v[150:153], v[176:179], v[136:139]
    ds_read_b64 v[200:201], v6 offset:3024
    v_mfma_f32_16x16x32_f16 v[140:143], v[152:155], v[176:179], v[140:143]
    s_waitcnt lgkmcnt(15)
    ds_read_b64 v[202:203], v6 offset:4032
    v_mfma_f32_16x16x32_f16 v[128:131], v[156:159], v[168:171], v[128:131]
    ds_read_b64 v[204:205], v6 offset:4040
    v_mfma_f32_16x16x32_f16 v[132:135], v[158:161], v[168:171], v[132:135]
    ds_read_b64 v[206:207], v6 offset:4048
    v_mfma_f32_16x16x32_f16 v[136:139], v[156:159], v[172:175], v[136:139]
    v_mfma_f32_16x16x32_f16 v[140:143], v[158:161], v[172:175], v[140:143]
    s_waitcnt lgkmcnt(15)
    v_mfma_f32_16x16x32_f16 v[136:139], v[162:165], v[168:171], v[136:139]
    v_mfma_f32_16x16x32_f16 v[140:143], v[164:167], v[168:171], v[140:143]
    s_waitcnt lgkmcnt(13)
    v_mfma_f32_16x16x32_f16 v[112:115], v[184:187], v[208:211], v[112:115]
    s_waitcnt lgkmcnt(12)
    v_mfma_f32_16x16x32_f16 v[116:119], v[186:189], v[208:211], v[116:119]
    s_waitcnt lgkmcnt(11)
    v_mfma_f32_16x16x32_f16 v[120:123], v[184:187], v[212:215], v[120:123]
    v_mfma_f32_16x16x32_f16 v[124:127], v[186:189], v[212:215], v[124:127]
    s_waitcnt lgkmcnt(10)
    v_mfma_f32_16x16x32_f16 v[128:131], v[184:187], v[216:219], v[128:131]
    v_mfma_f32_16x16x32_f16 v[132:135], v[186:189], v[216:219], v[132:135]
    s_waitcnt lgkmcnt(9)
    v_mfma_f32_16x16x32_f16 v[136:139], v[184:187], v[220:223], v[136:139]
    v_mfma_f32_16x16x32_f16 v[140:143], v[186:189], v[220:223], v[140:143]
    s_waitcnt lgkmcnt(7)
    v_mfma_f32_16x16x32_f16 v[120:123], v[190:193], v[208:211], v[120:123]
    s_waitcnt lgkmcnt(6)
    v_mfma_f32_16x16x32_f16 v[124:127], v[192:195], v[208:211], v[124:127]
    v_mfma_f32_16x16x32_f16 v[128:131], v[190:193], v[212:215], v[128:131]
    v_mfma_f32_16x16x32_f16 v[132:135], v[192:195], v[212:215], v[132:135]
    v_mfma_f32_16x16x32_f16 v[136:139], v[190:193], v[216:219], v[136:139]
    v_mfma_f32_16x16x32_f16 v[140:143], v[192:195], v[216:219], v[140:143]
    s_waitcnt lgkmcnt(4)
    v_mfma_f32_16x16x32_f16 v[128:131], v[196:199], v[208:211], v[128:131]
    s_waitcnt lgkmcnt(3)
    v_mfma_f32_16x16x32_f16 v[132:135], v[198:201], v[208:211], v[132:135]
    v_mfma_f32_16x16x32_f16 v[136:139], v[196:199], v[212:215], v[136:139]
    v_mfma_f32_16x16x32_f16 v[140:143], v[198:201], v[212:215], v[140:143]
    s_waitcnt lgkmcnt(1)
    v_mfma_f32_16x16x32_f16 v[136:139], v[202:205], v[208:211], v[136:139]
    s_waitcnt lgkmcnt(0)
    v_mfma_f32_16x16x32_f16 v[140:143], v[204:207], v[208:211], v[140:143]
    v_fmac_f32 v64, v112, v17
    v_fmac_f32 v65, v113, v17
    v_fmac_f32 v66, v114, v17
    v_fmac_f32 v67, v115, v17
    v_fmac_f32 v68, v116, v17
    v_fmac_f32 v69, v117, v17
    v_fmac_f32 v70, v118, v17
    v_fmac_f32 v71, v119, v17
    v_cvt_pk_bf16_f32 v56, v64, v65
    v_cvt_pk_bf16_f32 v57, v66, v67
    v_cvt_pk_bf16_f32 v58, v68, v69
    v_cvt_pk_bf16_f32 v59, v70, v71
    ds_write_b128 v4, v[56:59] offset:0
    v_fmac_f32 v72, v120, v17
    v_fmac_f32 v73, v121, v17
    v_fmac_f32 v74, v122, v17
    v_fmac_f32 v75, v123, v17
    v_fmac_f32 v76, v124, v17
    v_fmac_f32 v77, v125, v17
    v_fmac_f32 v78, v126, v17
    v_fmac_f32 v79, v127, v17
    v_cvt_pk_bf16_f32 v60, v72, v73
    v_cvt_pk_bf16_f32 v61, v74, v75
    v_cvt_pk_bf16_f32 v62, v76, v77
    v_cvt_pk_bf16_f32 v63, v78, v79
    ds_write_b128 v4, v[60:63] offset:4352
    v_fmac_f32 v80, v128, v17
    v_fmac_f32 v81, v129, v17
    v_fmac_f32 v82, v130, v17
    v_fmac_f32 v83, v131, v17
    v_fmac_f32 v84, v132, v17
    v_fmac_f32 v85, v133, v17
    v_fmac_f32 v86, v134, v17
    v_fmac_f32 v87, v135, v17
    v_cvt_pk_bf16_f32 v56, v80, v81
    v_cvt_pk_bf16_f32 v57, v82, v83
    v_cvt_pk_bf16_f32 v58, v84, v85
    v_cvt_pk_bf16_f32 v59, v86, v87
    ds_write_b128 v4, v[56:59] offset:8704
    v_fmac_f32 v88, v136, v17
    v_fmac_f32 v89, v137, v17
    v_fmac_f32 v90, v138, v17
    v_fmac_f32 v91, v139, v17
    v_fmac_f32 v92, v140, v17
    v_fmac_f32 v93, v141, v17
    v_fmac_f32 v94, v142, v17
    v_fmac_f32 v95, v143, v17
    v_cvt_pk_bf16_f32 v60, v88, v89
    v_cvt_pk_bf16_f32 v61, v90, v91
    v_cvt_pk_bf16_f32 v62, v92, v93
    v_cvt_pk_bf16_f32 v63, v94, v95
    ds_write_b128 v4, v[60:63] offset:13056
    s_waitcnt lgkmcnt(0)
    s_barrier
    ds_read_b128 v[32:35], v12 offset:0
    ds_read_b128 v[36:39], v12 offset:1088
    ds_read_b128 v[40:43], v12 offset:2176
    ds_read_b128 v[44:47], v12 offset:3264
    s_waitcnt lgkmcnt(3)
    buffer_store_dwordx4 v[32:35], v3, s[28:31], s6 offen sc1
    s_add_u32 s6, s6, 147968
    s_waitcnt lgkmcnt(2)
    buffer_store_dwordx4 v[36:39], v3, s[28:31], s6 offen sc1
    s_add_u32 s6, s6, 147968
    s_waitcnt lgkmcnt(1)
    buffer_store_dwordx4 v[40:43], v3, s[28:31], s6 offen sc1
    s_add_u32 s6, s6, 147968
    s_waitcnt lgkmcnt(0)
    buffer_store_dwordx4 v[44:47], v3, s[28:31], s6 offen sc1
    s_branch km_join
km_side:
    s_sub_u32 s4, s57, 144
    s_cmp_ge_u32 s4, 91
    s_cbranch_scc1 side_free_6
    s_cmp_ge_u32 s4, 64
    s_cbranch_scc1 side_mod_5
    v_lshrrev_b32 v1, 4, v2
    v_and_b32 v7, 15, v2
    s_lshl_b32 s5, s4, 2
    s_add_u32 s5, s5, s3
    s_mul_i32 s5, s5, 9216
    v_mul_u32_u24 v3, 1152, v1
    v_lshl_add_u32 v4, v7, 3, v3
    v_lshl_add_u32 v3, v7, 4, v3
    s_add_u32 s6, s5, 4608
    s_waitcnt lgkmcnt(0)
    s_mov_b32 s10, 2359296
    s_mov_b32 s11, 0x20000
    buffer_load_dwordx4 v[8:11], v3, s[8:11], s5 offen offset:0
    buffer_load_dwordx4 v[12:15], v3, s[8:11], s5 offen offset:256
    buffer_load_dwordx4 v[16:19], v3, s[8:11], s5 offen offset:512
    buffer_load_dwordx4 v[20:23], v3, s[8:11], s5 offen offset:768
    buffer_load_dwordx2 v[24:25], v4, s[8:11], s5 offen offset:1024
    buffer_load_dwordx4 v[28:31], v3, s[8:11], s6 offen offset:0
    buffer_load_dwordx4 v[32:35], v3, s[8:11], s6 offen offset:256
    buffer_load_dwordx4 v[36:39], v3, s[8:11], s6 offen offset:512
    buffer_load_dwordx4 v[40:43], v3, s[8:11], s6 offen offset:768
    buffer_load_dwordx2 v[44:45], v4, s[8:11], s6 offen offset:1024
    s_mov_b32 s30, 53477376
    s_mov_b32 s31, 0x20000
    s_mov_b32 s98, 256
    s_mov_b32 s99, 0x20000
    v_lshlrev_b32 v250, 4, v2
    v_mov_b32 v244, 1
    v_mov_b32 v245, 0
    v_mov_b32 v247, 0
    v_mov_b32 v249, 0
    s_and_b32 s58, s2, 1
    s_bfe_u32 s61, s2, 131075
    s_lshl_b32 s58, s58, 2
    s_add_u32 s58, s58, s61
    s_bfe_u32 s61, s2, 131073
    s_lshl_b32 s61, s61, 3
    s_lshr_b32 s60, s2, 5
    s_add_u32 s61, s61, s60
    s_lshl_b32 s61, s61, 3
    s_add_u32 s60, s58, s61
    s_lshl_b32 s60, s60, 7
    s_add_u32 s60, s60, 163840
    s_mov_b32 s61, 0
    s_lshl_b32 s7, s3, 6
    v_lshl_add_u32 v5, v1, 3, s7
    v_lshlrev_b32 v6, 3, v2
    s_lshl_b32 s5, s4, 8
    s_add_u32 s5, s5, 245760
    s_mov_b32 s6, 0x3f803f80
    v_mov_b32 v52, 0
    v_mov_b32 v53, 0
    v_mov_b32 v54, 0
    v_mov_b32 v55, 0
    v_mov_b32 v56, 0
    v_mov_b32 v57, 0
    v_mov_b32 v58, 0
    v_mov_b32 v59, 0
    s_waitcnt vmcnt(9)
    v_dot2c_f32_bf16 v53, s6, v8
    v_dot2c_f32_bf16 v52, v8, v8
    v_dot2c_f32_bf16 v55, s6, v9
    v_dot2c_f32_bf16 v54, v9, v9
    v_dot2c_f32_bf16 v53, s6, v10
    v_dot2c_f32_bf16 v52, v10, v10
    v_dot2c_f32_bf16 v55, s6, v11
    v_dot2c_f32_bf16 v54, v11, v11
    s_waitcnt vmcnt(8)
    v_dot2c_f32_bf16 v53, s6, v12
    v_dot2c_f32_bf16 v52, v12, v12
    v_dot2c_f32_bf16 v55, s6, v13
    v_dot2c_f32_bf16 v54, v13, v13
    v_dot2c_f32_bf16 v53, s6, v14
    v_dot2c_f32_bf16 v52, v14, v14
    v_dot2c_f32_bf16 v55, s6, v15
    v_dot2c_f32_bf16 v54, v15, v15
    s_waitcnt vmcnt(7)
    v_dot2c_f32_bf16 v53, s6, v16
    v_dot2c_f32_bf16 v52, v16, v16
    v_dot2c_f32_bf16 v55, s6, v17
    v_dot2c_f32_bf16 v54, v17, v17
    v_dot2c_f32_bf16 v53, s6, v18
    v_dot2c_f32_bf16 v52, v18, v18
    v_dot2c_f32_bf16 v55, s6, v19
    v_dot2c_f32_bf16 v54, v19, v19
    s_waitcnt vmcnt(6)
    v_dot2c_f32_bf16 v53, s6, v20
    v_dot2c_f32_bf16 v52, v20, v20
    v_dot2c_f32_bf16 v55, s6, v21
    v_dot2c_f32_bf16 v54, v21, v21
    v_dot2c_f32_bf16 v53, s6, v22
    v_dot2c_f32_bf16 v52, v22, v22
    v_dot2c_f32_bf16 v55, s6, v23
    v_dot2c_f32_bf16 v54, v23, v23
    s_waitcnt vmcnt(5)
    v_dot2c_f32_bf16 v53, s6, v24
    v_dot2c_f32_bf16 v52, v24, v24
    v_dot2c_f32_bf16 v55, s6, v25
    v_dot2c_f32_bf16 v54, v25, v25
    s_waitcnt vmcnt(4)
    v_dot2c_f32_bf16 v57, s6, v28
    v_dot2c_f32_bf16 v56, v28, v28
    v_dot2c_f32_bf16 v59, s6, v29
    v_dot2c_f32_bf16 v58, v29, v29
    v_dot2c_f32_bf16 v57, s6, v30
    v_dot2c_f32_bf16 v56, v30, v30
    v_dot2c_f32_bf16 v59, s6, v31
    v_dot2c_f32_bf16 v58, v31, v31
    s_waitcnt vmcnt(3)
    v_dot2c_f32_bf16 v57, s6, v32
    v_dot2c_f32_bf16 v56, v32, v32
    v_dot2c_f32_bf16 v59, s6, v33
    v_dot2c_f32_bf16 v58, v33, v33
    v_dot2c_f32_bf16 v57, s6, v34
    v_dot2c_f32_bf16 v56, v34, v34
    v_dot2c_f32_bf16 v59, s6, v35
    v_dot2c_f32_bf16 v58, v35, v35
    s_waitcnt vmcnt(2)
    v_dot2c_f32_bf16 v57, s6, v36
    v_dot2c_f32_bf16 v56, v36, v36
    v_dot2c_f32_bf16 v59, s6, v37
    v_dot2c_f32_bf16 v58, v37, v37
    v_dot2c_f32_bf16 v57, s6, v38
    v_dot2c_f32_bf16 v56, v38, v38
    v_dot2c_f32_bf16 v59, s6, v39
    v_dot2c_f32_bf16 v58, v39, v39
    s_waitcnt vmcnt(1)
    v_dot2c_f32_bf16 v57, s6, v40
    v_dot2c_f32_bf16 v56, v40, v40
    v_dot2c_f32_bf16 v59, s6, v41
    v_dot2c_f32_bf16 v58, v41, v41
    v_dot2c_f32_bf16 v57, s6, v42
    v_dot2c_f32_bf16 v56, v42, v42
    v_dot2c_f32_bf16 v59, s6, v43
    v_dot2c_f32_bf16 v58, v43, v43
    s_waitcnt vmcnt(0)
    v_dot2c_f32_bf16 v57, s6, v44
    v_dot2c_f32_bf16 v56, v44, v44
    v_dot2c_f32_bf16 v59, s6, v45
    v_dot2c_f32_bf16 v58, v45, v45
    v_add_f32 v52, v52, v54
    v_add_f32 v53, v53, v55
    s_nop 0
    v_add_f32 v56, v56, v58
    v_add_f32 v57, v57, v59
    v_add_f32_dpp v52, v52, v52 row_ror:8 row_mask:0xf bank_mask:0xf bound_ctrl:1
    v_add_f32_dpp v53, v53, v53 row_ror:8 row_mask:0xf bank_mask:0xf bound_ctrl:1
    v_add_f32_dpp v56, v56, v56 row_ror:8 row_mask:0xf bank_mask:0xf bound_ctrl:1
    v_add_f32_dpp v57, v57, v57 row_ror:8 row_mask:0xf bank_mask:0xf bound_ctrl:1
    v_add_f32_dpp v52, v52, v52 row_ror:4 row_mask:0xf bank_mask:0xf bound_ctrl:1
    v_add_f32_dpp v53, v53, v53 row_ror:4 row_mask:0xf bank_mask:0xf bound_ctrl:1
    v_add_f32_dpp v56, v56, v56 row_ror:4 row_mask:0xf bank_mask:0xf bound_ctrl:1
    v_add_f32_dpp v57, v57, v57 row_ror:4 row_mask:0xf bank_mask:0xf bound_ctrl:1
    v_add_f32_dpp v52, v52, v52 row_ror:2 row_mask:0xf bank_mask:0xf bound_ctrl:1
    v_add_f32_dpp v53, v53, v53 row_ror:2 row_mask:0xf bank_mask:0xf bound_ctrl:1
    v_add_f32_dpp v56, v56, v56 row_ror:2 row_mask:0xf bank_mask:0xf bound_ctrl:1
    v_add_f32_dpp v57, v57, v57 row_ror:2 row_mask:0xf bank_mask:0xf bound_ctrl:1
    v_add_f32_dpp v52, v52, v52 row_ror:1 row_mask:0xf bank_mask:0xf bound_ctrl:1
    v_add_f32_dpp v53, v53, v53 row_ror:1 row_mask:0xf bank_mask:0xf bound_ctrl:1
    v_add_f32_dpp v56, v56, v56 row_ror:1 row_mask:0xf bank_mask:0xf bound_ctrl:1
    v_add_f32_dpp v57, v57, v57 row_ror:1 row_mask:0xf bank_mask:0xf bound_ctrl:1
    v_mul_f32 v53, 0x3ae38e39, v53
    v_mul_f32 v52, 0x3ae38e39, v52
    v_fma_f32 v52, -v53, v53, v52
    v_max_f32 v52, 0, v52
    v_add_f32 v52, 0x3727c5ac, v52
    v_sqrt_f32 v52, v52
    v_rcp_f32 v52, v52
    v_mul_f32 v57, 0x3ae38e39, v57
    v_mul_f32 v56, 0x3ae38e39, v56
    v_fma_f32 v56, -v57, v57, v56
    v_max_f32 v56, 0, v56
    v_add_f32 v56, 0x3727c5ac, v56
    v_sqrt_f32 v56, v56
    v_rcp_f32 v56, v56
    v_mul_f32 v53, -v53, v52
    ds_write_b64 v5, v[52:53] offset:0
    v_mul_f32 v57, -v57, v56
    ds_write_b64 v5, v[56:57] offset:32
    s_waitcnt lgkmcnt(0)
    s_barrier
    s_cmp_lg_u32 s3, 3
    s_cbranch_scc1 ln_sig_11
    ds_read_b64 v[8:9], v6
    s_waitcnt lgkmcnt(0)
    s_mov_b32 exec_hi, 0
    buffer_store_dwordx2 v[8:9], v6, s[28:31], s5 offen sc1
    s_mov_b32 exec_hi, -1
    v_mov_b32 v247, 0
    s_mov_b64 exec, 1
    s_mov_b32 s58, 0
poll_12:
    buffer_load_dword v246, v247, s[96:99], 0 offen sc1
    s_add_u32 s58, s58, 1
    s_waitcnt vmcnt(0)
    v_cmp_gt_u32 vcc, 24, v246
    s_cmp_gt_u32 s58, 0x40000
    s_cbranch_scc1 poll_12_done
    s_nop 3
    s_cbranch_vccnz poll_12
poll_12_done:
    s_mov_b64 exec, -1
    v_lshrrev_b32 v246, 4, v250
    v_mul_u32_u24 v246, 512, v246
    s_lshl_b32 s58, s4, 2
    s_add_u32 s58, s58, 196608
    s_mov_b32 exec_lo, 0x3ffff
    s_mov_b32 exec_hi, 0
    buffer_store_dword v244, v246, s[28:31], s58 offen sc1
    s_mov_b64 exec, -1
ln_sig_11:
    s_barrier
    s_mul_i32 s4, s4, 3
    s_add_u32 s4, s4, s3
    s_add_u32 s4, s4, 35
    s_cmp_ge_u32 s3, 1
    s_cselect_b32 s4, s4, 1000
    s_branch side_strip_8
side_mod_5:
    s_load_dwordx2 s[40:41], s[0:1], 104
    s_load_dwordx2 s[44:45], s[0:1], 96
    s_mov_b32 s42, 3981312
    s_mov_b32 s43, 0x20000
    s_mov_b32 s46, 1152
    s_mov_b32 s47, 0x20000
    s_sub_u32 s4, s4, 64
    v_lshrrev_b32 v1, 3, v2
    v_and_b32 v3, 7, v2
    v_mul_u32_u24 v4, 6912, v1
    v_lshl_add_u32 v4, v3, 4, v4
    s_lshl_b32 s35, s4, 7
    s_mul_i32 s7, s3, 221184
    s_add_u32 s35, s35, s7
    s_mul_i32 s36, s3, 20480
    v_lshlrev_b32 v5, 2, v0
    s_waitcnt lgkmcnt(0)
    buffer_load_dword v80, v5, s[44:47], 0 offen
    buffer_load_dword v81, v5, s[44:47], 0 offen offset:1024
    s_mov_b32 m0, s36
    s_add_u32 s6, s35, 0
    buffer_load_dwordx4 v4, s[40:43], s6 offen nt lds
    s_add_u32 m0, m0, 1024
    s_add_u32 s6, s6, 55296
    buffer_load_dwordx4 v4, s[40:43], s6 offen nt lds
    s_add_u32 m0, m0, 1024
    s_add_u32 s6, s6, 55296
    buffer_load_dwordx4 v4, s[40:43], s6 offen nt lds
    s_add_u32 m0, m0, 1024
    s_add_u32 s6, s6, 55296
    buffer_load_dwordx4 v4, s[40:43], s6 offen nt lds
    s_add_u32 m0, m0, 1024
    s_add_u32 s6, s6, 718848
    buffer_load_dwordx4 v4, s[40:43], s6 offen nt lds
    s_add_u32 m0, m0, 1024
    s_add_u32 s6, s6, 55296
    buffer_load_dwordx4 v4, s[40:43], s6 offen nt lds
    s_add_u32 m0, m0, 1024
    s_add_u32 s6, s6, 55296
    buffer_load_dwordx4 v4, s[40:43], s6 offen nt lds
    s_add_u32 m0, m0, 1024
    s_add_u32 s6, s6, 55296
    buffer_load_dwordx4 v4, s[40:43], s6 offen nt lds
    s_add_u32 m0, m0, 1024
    s_add_u32 s6, s6, 718848
    buffer_load_dwordx4 v4, s[40:43], s6 offen nt lds
    s_add_u32 m0, m0, 1024
    s_add_u32 s6, s6, 55296
    buffer_load_dwordx4 v4, s[40:43], s6 offen nt lds
    s_add_u32 m0, m0, 1024
    s_add_u32 s6, s6, 55296
    buffer_load_dwordx4 v4, s[40:43], s6 offen nt lds
    s_add_u32 m0, m0, 1024
    s_add_u32 s6, s6, 55296
    buffer_load_dwordx4 v4, s[40:43], s6 offen nt lds
    s_add_u32 m0, m0, 1024
    s_add_u32 s6, s6, 718848
    buffer_load_dwordx4 v4, s[40:43], s6 offen nt lds
    s_add_u32 m0, m0, 1024
    s_add_u32 s6, s6, 55296
    buffer_load_dwordx4 v4, s[40:43], s6 offen nt lds
    s_add_u32 m0, m0, 1024
    s_add_u32 s6, s6, 55296
    buffer_load_dwordx4 v4, s[40:43], s6 offen nt lds
    s_add_u32 m0, m0, 1024
    s_add_u32 s6, s6, 55296
    buffer_load_dwordx4 v4, s[40:43], s6 offen nt lds
    s_add_u32 m0, m0, 1024
    s_add_u32 s6, s6, 718848
    buffer_load_dwordx4 v4, s[40:43], s6 offen nt lds
    s_add_u32 m0, m0, 1024
    s_add_u32 s6, s6, 55296
    buffer_load_dwordx4 v4, s[40:43], s6 offen nt lds
    s_add_u32 m0, m0, 1024
    s_add_u32 s6, s6, 55296
    buffer_load_dwordx4 v4, s[40:43], s6 offen nt lds
    s_add_u32 m0, m0, 1024
    s_add_u32 s6, s6, 55296
    buffer_load_dwordx4 v4, s[40:43], s6 offen nt lds
    s_add_u32 m0, m0, 1024
    s_add_u32 s6, s6, 718848
    s_mov_b32 s30, 53477376
    s_mov_b32 s31, 0x20000
    s_mov_b32 s98, 256
    s_mov_b32 s99, 0x20000
    v_lshlrev_b32 v250, 4, v2
    v_mov_b32 v244, 1
    v_mov_b32 v245, 0
    v_mov_b32 v247, 0
    v_mov_b32 v249, 0
    s_and_b32 s58, s2, 1
    s_bfe_u32 s61, s2, 131075
    s_lshl_b32 s58, s58, 2
    s_add_u32 s58, s58, s61
    s_bfe_u32 s61, s2, 131073
    s_lshl_b32 s61, s61, 3
    s_lshr_b32 s60, s2, 5
    s_add_u32 s61, s61, s60
    s_lshl_b32 s61, s61, 3
    s_add_u32 s60, s58, s61
    s_lshl_b32 s60, s60, 7
    s_add_u32 s60, s60, 163840
    s_mov_b32 s61, 0
    s_mov_b32 s33, 0xbfb8aa3b
    v_add_u32 v5, 147456, v5
    s_waitcnt vmcnt(21)
    v_and_b32 v83, 0xffff0000, v80
    v_lshlrev_b32 v82, 16, v80
    s_waitcnt vmcnt(20)
    v_and_b32 v85, 0xffff0000, v81
    v_lshlrev_b32 v84, 16, v81
    v_mul_f32 v86, s33, v82
    v_exp_f32 v86, v86
    v_mul_f32 v87, s33, v83
    v_exp_f32 v87, v87
    v_mul_f32 v88, s33, v84
    v_exp_f32 v88, v88
    v_mul_f32 v89, s33, v85
    v_exp_f32 v89, v89
    v_add_f32 v86, 1.0, v86
    v_rcp_f32 v86, v86
    v_add_f32 v87, 1.0, v87
    v_rcp_f32 v87, v87
    v_add_f32 v88, 1.0, v88
    v_rcp_f32 v88, v88
    v_add_f32 v89, 1.0, v89
    v_rcp_f32 v89, v89
    v_mul_f32 v82, v82, v86
    v_mul_f32 v83, v83, v87
    v_mul_f32 v84, v84, v88
    v_mul_f32 v85, v85, v89
    v_cvt_pk_bf16_f32 v80, v82, v83
    v_cvt_pk_bf16_f32 v81, v84, v85
    ds_write_b32 v5, v80
    ds_write_b32 v5, v81 offset:1024
    v_lshrrev_b32 v5, 4, v2
    v_bfe_u32 v6, v2, 2, 2
    v_lshl_add_u32 v6, v5, 3, v6
    v_lshlrev_b32 v6, 7, v6
    v_and_b32 v7, 3, v2
    v_lshl_add_u32 v6, v7, 3, v6
    v_add_u32 v6, s36, v6
    v_lshlrev_b32 v7, 4, v5
    s_lshl_b32 s7, s3, 6
    s_add_u32 s7, s7, 147456
    v_add_u32 v8, s7, v7
    s_lshl_b32 s7, s3, 8
    s_add_u32 s7, s7, 149504
    v_add_u32 v7, s7, v7
    v_lshlrev_b32 v11, 2, v2
    v_add_u32 v10, 149504, v11
    s_lshl_b32 s5, s4, 8
    s_add_u32 s5, s5, 65536
    s_sub_u32 s7, s4, 9
    s_cmp_lt_u32 s7, 9
    s_cselect_b32 s7, 1.0, 0
    s_waitcnt lgkmcnt(0)
    s_barrier
    ds_read_b128 v[100:103], v8 offset:0
    ds_read_b128 v[104:107], v8 offset:256
    ds_read_b128 v[108:111], v8 offset:512
    ds_read_b128 v[112:115], v8 offset:768
    ds_read_b128 v[116:119], v8 offset:1024
    s_waitcnt vmcnt(16)
    ds_read_b64_tr_b16 v[12:13], v6 offset:0
    ds_read_b64_tr_b16 v[14:15], v6 offset:512
    ds_read_b64_tr_b16 v[16:17], v6 offset:32
    ds_read_b64_tr_b16 v[18:19], v6 offset:544
    ds_read_b64_tr_b16 v[20:21], v6 offset:64
    ds_read_b64_tr_b16 v[22:23], v6 offset:576
    ds_read_b64_tr_b16 v[24:25], v6 offset:96
    ds_read_b64_tr_b16 v[26:27], v6 offset:608
    s_waitcnt lgkmcnt(6)
    v_mfma_f32_16x16x32_bf16 v[48:51], v[12:15], v[100:103], 0
    s_waitcnt lgkmcnt(4)
    v_mfma_f32_16x16x32_bf16 v[52:55], v[16:19], v[100:103], 0
    s_waitcnt lgkmcnt(2)
    v_mfma_f32_16x16x32_bf16 v[56:59], v[20:23], v[100:103], 0
    s_waitcnt lgkmcnt(0)
    v_mfma_f32_16x16x32_bf16 v[60:63], v[24:27], v[100:103], 0
    s_waitcnt vmcnt(12)
    ds_read_b64_tr_b16 v[28:29], v6 offset:4096
    ds_read_b64_tr_b16 v[30:31], v6 offset:4608
    ds_read_b64_tr_b16 v[32:33], v6 offset:4128
    ds_read_b64_tr_b16 v[34:35], v6 offset:4640
    ds_read_b64_tr_b16 v[36:37], v6 offset:4160
    ds_read_b64_tr_b16 v[38:39], v6 offset:4672
    ds_read_b64_tr_b16 v[40:41], v6 offset:4192
    ds_read_b64_tr_b16 v[42:43], v6 offset:4704
    s_waitcnt lgkmcnt(6)
    v_mfma_f32_16x16x32_bf16 v[48:51], v[28:31], v[104:107], v[48:51]
    s_waitcnt lgkmcnt(4)
    v_mfma_f32_16x16x32_bf16 v[52:55], v[32:35], v[104:107], v[52:55]
    s_waitcnt lgkmcnt(2)
    v_mfma_f32_16x16x32_bf16 v[56:59], v[36:39], v[104:107], v[56:59]
    s_waitcnt lgkmcnt(0)
    v_mfma_f32_16x16x32_bf16 v[60:63], v[40:43], v[104:107], v[60:63]
    s_waitcnt vmcnt(8)
    ds_read_b64_tr_b16 v[12:13], v6 offset:8192
    ds_read_b64_tr_b16 v[14:15], v6 offset:8704
    ds_read_b64_tr_b16 v[16:17], v6 offset:8224
    ds_read_b64_tr_b16 v[18:19], v6 offset:8736
    ds_read_b64_tr_b16 v[20:21], v6 offset:8256
    ds_read_b64_tr_b16 v[22:23], v6 offset:8768
    ds_read_b64_tr_b16 v[24:25], v6 offset:8288
    ds_read_b64_tr_b16 v[26:27], v6 offset:8800
    s_waitcnt lgkmcnt(6)
    v_mfma_f32_16x16x32_bf16 v[48:51], v[12:15], v[108:111], v[48:51]
    s_waitcnt lgkmcnt(4)
    v_mfma_f32_16x16x32_bf16 v[52:55], v[16:19], v[108:111], v[52:55]
    s_waitcnt lgkmcnt(2)
    v_mfma_f32_16x16x32_bf16 v[56:59], v[20:23], v[108:111], v[56:59]
    s_waitcnt lgkmcnt(0)
    v_mfma_f32_16x16x32_bf16 v[60:63], v[24:27], v[108:111], v[60:63]
    s_waitcnt vmcnt(4)
    ds_read_b64_tr_b16 v[28:29], v6 offset:12288
    ds_read_b64_tr_b16 v[30:31], v6 offset:12800
    ds_read_b64_tr_b16 v[32:33], v6 offset:12320
    ds_read_b64_tr_b16 v[34:35], v6 offset:12832
    ds_read_b64_tr_b16 v[36:37], v6 offset:12352
    ds_read_b64_tr_b16 v[38:39], v6 offset:12864
    ds_read_b64_tr_b16 v[40:41], v6 offset:12384
    ds_read_b64_tr_b16 v[42:43], v6 offset:12896
    s_waitcnt lgkmcnt(6)
    v_mfma_f32_16x16x32_bf16 v[48:51], v[28:31], v[112:115], v[48:51]
    s_waitcnt lgkmcnt(4)
    v_mfma_f32_16x16x32_bf16 v[52:55], v[32:35], v[112:115], v[52:55]
    s_waitcnt lgkmcnt(2)
    v_mfma_f32_16x16x32_bf16 v[56:59], v[36:39], v[112:115], v[56:59]
    s_waitcnt lgkmcnt(0)
    v_mfma_f32_16x16x32_bf16 v[60:63], v[40:43], v[112:115], v[60:63]
    s_waitcnt vmcnt(0)
    ds_read_b64_tr_b16 v[12:13], v6 offset:16384
    ds_read_b64_tr_b16 v[14:15], v6 offset:16896
    ds_read_b64_tr_b16 v[16:17], v6 offset:16416
    ds_read_b64_tr_b16 v[18:19], v6 offset:16928
    ds_read_b64_tr_b16 v[20:21], v6 offset:16448
    ds_read_b64_tr_b16 v[22:23], v6 offset:16960
    ds_read_b64_tr_b16 v[24:25], v6 offset:16480
    ds_read_b64_tr_b16 v[26:27], v6 offset:16992
    s_waitcnt lgkmcnt(6)
    v_mfma_f32_16x16x32_bf16 v[48:51], v[12:15], v[116:119], v[48:51]
    s_waitcnt lgkmcnt(4)
    v_mfma_f32_16x16x32_bf16 v[52:55], v[16:19], v[116:119], v[52:55]
    s_waitcnt lgkmcnt(2)
    v_mfma_f32_16x16x32_bf16 v[56:59], v[20:23], v[116:119], v[56:59]
    s_waitcnt lgkmcnt(0)
    v_mfma_f32_16x16x32_bf16 v[60:63], v[24:27], v[116:119], v[60:63]
    s_nop 1
    ds_write_b128 v7, v[48:51] offset:0
    s_nop 0
    ds_write_b128 v7, v[52:55] offset:64
    s_nop 0
    ds_write_b128 v7, v[56:59] offset:128
    s_nop 0
    ds_write_b128 v7, v[60:63] offset:192
    s_waitcnt lgkmcnt(0)
    s_barrier
    s_cmp_lg_u32 s3, 3
    s_cbranch_scc1 mod_skip_13
    ds_read2st64_b32 v[92:93], v10 offset0:0 offset1:1
    ds_read2st64_b32 v[94:95], v10 offset0:2 offset1:3
    s_waitcnt lgkmcnt(1)
    v_add_f32 v92, v92, v93
    s_waitcnt lgkmcnt(0)
    v_add_f32 v94, v94, v95
    v_add_f32 v92, v92, v94
    v_cvt_pk_bf16_f32 v92, v92, v92
    v_and_b32 v92, 0xffff0000, v92
    v_add_f32 v92, s7, v92
    v_cvt_pk_bf16_f32 v92, v92, v92
    v_and_b32 v92, 0xffff0000, v92
    buffer_store_dword v92, v11, s[28:31], s5 offen sc1
    v_mov_b32 v247, 0
    s_mov_b64 exec, 1
    s_mov_b32 s58, 0
poll_14:
    buffer_load_dword v246, v247, s[96:99], 0 offen sc1
    s_add_u32 s58, s58, 1
    s_waitcnt vmcnt(0)
    v_cmp_gt_u32 vcc, 24, v246
    s_cmp_gt_u32 s58, 0x40000
    s_cbranch_scc1 poll_14_done
    s_nop 3
    s_cbranch_vccnz poll_14
poll_14_done:
    s_mov_b64 exec, -1
    s_add_u32 s34, s4, 64
    v_lshrrev_b32 v246, 4, v250
    v_mul_u32_u24 v246, 512, v246
    s_lshl_b32 s58, s34, 2
    s_add_u32 s58, s58, 196608
    s_mov_b32 exec_lo, 0x3ffff
    s_mov_b32 exec_hi, 0
    buffer_store_dword v244, v246, s[28:31], s58 offen sc1
    s_mov_b64 exec, -1
    s_cmp_lg_u32 s4, 0
    s_cbranch_scc1 mod_skip_13
    s_mov_b32 s34, 91
    v_lshrrev_b32 v246, 4, v250
    v_mul_u32_u24 v246, 512, v246
    s_lshl_b32 s58, s34, 2
    s_add_u32 s58, s58, 196608
    s_mov_b32 exec_lo, 0x3ffff
    s_mov_b32 exec_hi, 0
    buffer_store_dword v244, v246, s[28:31], s58 offen sc1
    s_mov_b64 exec, -1
mod_skip_13:
    s_add_u32 s5, s5, 6912
    s_barrier
    s_mov_b32 m0, s36
    s_add_u32 s6, s35, 3456
    buffer_load_dwordx4 v4, s[40:43], s6 offen nt lds
    s_add_u32 m0, m0, 1024
    s_add_u32 s6, s6, 55296
    buffer_load_dwordx4 v4, s[40:43], s6 offen nt lds
    s_add_u32 m0, m0, 1024
    s_add_u32 s6, s6, 55296
    buffer_load_dwordx4 v4, s[40:43], s6 offen nt lds
    s_add_u32 m0, m0, 1024
    s_add_u32 s6, s6, 55296
    buffer_load_dwordx4 v4, s[40:43], s6 offen nt lds
    s_add_u32 m0, m0, 1024
    s_add_u32 s6, s6, 718848
    buffer_load_dwordx4 v4, s[40:43], s6 offen nt lds
    s_add_u32 m0, m0, 1024
    s_add_u32 s6, s6, 55296
    buffer_load_dwordx4 v4, s[40:43], s6 offen nt lds
    s_add_u32 m0, m0, 1024
    s_add_u32 s6, s6, 55296
    buffer_load_dwordx4 v4, s[40:43], s6 offen nt lds
    s_add_u32 m0, m0, 1024
    s_add_u32 s6, s6, 55296
    buffer_load_dwordx4 v4, s[40:43], s6 offen nt lds
    s_add_u32 m0, m0, 1024
    s_add_u32 s6, s6, 718848
    buffer_load_dwordx4 v4, s[40:43], s6 offen nt lds
    s_add_u32 m0, m0, 1024
    s_add_u32 s6, s6, 55296
    buffer_load_dwordx4 v4, s[40:43], s6 offen nt lds
    s_add_u32 m0, m0, 1024
    s_add_u32 s6, s6, 55296
    buffer_load_dwordx4 v4, s[40:43], s6 offen nt lds
    s_add_u32 m0, m0, 1024
    s_add_u32 s6, s6, 55296
    buffer_load_dwordx4 v4, s[40:43], s6 offen nt lds
    s_add_u32 m0, m0, 1024
    s_add_u32 s6, s6, 718848
    buffer_load_dwordx4 v4, s[40:43], s6 offen nt lds
    s_add_u32 m0, m0, 1024
    s_add_u32 s6, s6, 55296
    buffer_load_dwordx4 v4, s[40:43], s6 offen nt lds
    s_add_u32 m0, m0, 1024
    s_add_u32 s6, s6, 55296
    buffer_load_dwordx4 v4, s[40:43], s6 offen nt lds
    s_add_u32 m0, m0, 1024
    s_add_u32 s6, s6, 55296
    buffer_load_dwordx4 v4, s[40:43], s6 offen nt lds
    s_add_u32 m0, m0, 1024
    s_add_u32 s6, s6, 718848
    buffer_load_dwordx4 v4, s[40:43], s6 offen nt lds
    s_add_u32 m0, m0, 1024
    s_add_u32 s6, s6, 55296
    buffer_load_dwordx4 v4, s[40:43], s6 offen nt lds
    s_add_u32 m0, m0, 1024
    s_add_u32 s6, s6, 55296
    buffer_load_dwordx4 v4, s[40:43], s6 offen nt lds
    s_add_u32 m0, m0, 1024
    s_add_u32 s6, s6, 55296
    buffer_load_dwordx4 v4, s[40:43], s6 offen nt lds
    s_add_u32 m0, m0, 1024
    s_add_u32 s6, s6, 718848
    s_waitcnt vmcnt(16)
    ds_read_b64_tr_b16 v[12:13], v6 offset:0
    ds_read_b64_tr_b16 v[14:15], v6 offset:512
    ds_read_b64_tr_b16 v[16:17], v6 offset:32
    ds_read_b64_tr_b16 v[18:19], v6 offset:544
    ds_read_b64_tr_b16 v[20:21], v6 offset:64
    ds_read_b64_tr_b16 v[22:23], v6 offset:576
    ds_read_b64_tr_b16 v[24:25], v6 offset:96
    ds_read_b64_tr_b16 v[26:27], v6 offset:608
    s_waitcnt lgkmcnt(6)
    v_mfma_f32_16x16x32_bf16 v[48:51], v[12:15], v[100:103], 0
    s_waitcnt lgkmcnt(4)
    v_mfma_f32_16x16x32_bf16 v[52:55], v[16:19], v[100:103], 0
    s_waitcnt lgkmcnt(2)
    v_mfma_f32_16x16x32_bf16 v[56:59], v[20:23], v[100:103], 0
    s_waitcnt lgkmcnt(0)
    v_mfma_f32_16x16x32_bf16 v[60:63], v[24:27], v[100:103], 0
    s_waitcnt vmcnt(12)
    ds_read_b64_tr_b16 v[28:29], v6 offset:4096
    ds_read_b64_tr_b16 v[30:31], v6 offset:4608
    ds_read_b64_tr_b16 v[32:33], v6 offset:4128
    ds_read_b64_tr_b16 v[34:35], v6 offset:4640
    ds_read_b64_tr_b16 v[36:37], v6 offset:4160
    ds_read_b64_tr_b16 v[38:39], v6 offset:4672
    ds_read_b64_tr_b16 v[40:41], v6 offset:4192
    ds_read_b64_tr_b16 v[42:43], v6 offset:4704
    s_waitcnt lgkmcnt(6)
    v_mfma_f32_16x16x32_bf16 v[48:51], v[28:31], v[104:107], v[48:51]
    s_waitcnt lgkmcnt(4)
    v_mfma_f32_16x16x32_bf16 v[52:55], v[32:35], v[104:107], v[52:55]
    s_waitcnt lgkmcnt(2)
    v_mfma_f32_16x16x32_bf16 v[56:59], v[36:39], v[104:107], v[56:59]
    s_waitcnt lgkmcnt(0)
    v_mfma_f32_16x16x32_bf16 v[60:63], v[40:43], v[104:107], v[60:63]
    s_waitcnt vmcnt(8)
    ds_read_b64_tr_b16 v[12:13], v6 offset:8192
    ds_read_b64_tr_b16 v[14:15], v6 offset:8704
    ds_read_b64_tr_b16 v[16:17], v6 offset:8224
    ds_read_b64_tr_b16 v[18:19], v6 offset:8736
    ds_read_b64_tr_b16 v[20:21], v6 offset:8256
    ds_read_b64_tr_b16 v[22:23], v6 offset:8768
    ds_read_b64_tr_b16 v[24:25], v6 offset:8288
    ds_read_b64_tr_b16 v[26:27], v6 offset:8800
    s_waitcnt lgkmcnt(6)
    v_mfma_f32_16x16x32_bf16 v[48:51], v[12:15], v[108:111], v[48:51]
    s_waitcnt lgkmcnt(4)
    v_mfma_f32_16x16x32_bf16 v[52:55], v[16:19], v[108:111], v[52:55]
    s_waitcnt lgkmcnt(2)
    v_mfma_f32_16x16x32_bf16 v[56:59], v[20:23], v[108:111], v[56:59]
    s_waitcnt lgkmcnt(0)
    v_mfma_f32_16x16x32_bf16 v[60:63], v[24:27], v[108:111], v[60:63]
    s_waitcnt vmcnt(4)
    ds_read_b64_tr_b16 v[28:29], v6 offset:12288
    ds_read_b64_tr_b16 v[30:31], v6 offset:12800
    ds_read_b64_tr_b16 v[32:33], v6 offset:12320
    ds_read_b64_tr_b16 v[34:35], v6 offset:12832
    ds_read_b64_tr_b16 v[36:37], v6 offset:12352
    ds_read_b64_tr_b16 v[38:39], v6 offset:12864
    ds_read_b64_tr_b16 v[40:41], v6 offset:12384
    ds_read_b64_tr_b16 v[42:43], v6 offset:12896
    s_waitcnt lgkmcnt(6)
    v_mfma_f32_16x16x32_bf16 v[48:51], v[28:31], v[112:115], v[48:51]
    s_waitcnt lgkmcnt(4)
    v_mfma_f32_16x16x32_bf16 v[52:55], v[32:35], v[112:115], v[52:55]
    s_waitcnt lgkmcnt(2)
    v_mfma_f32_16x16x32_bf16 v[56:59], v[36:39], v[112:115], v[56:59]
    s_waitcnt lgkmcnt(0)
    v_mfma_f32_16x16x32_bf16 v[60:63], v[40:43], v[112:115], v[60:63]
    s_waitcnt vmcnt(0)
    ds_read_b64_tr_b16 v[12:13], v6 offset:16384
    ds_read_b64_tr_b16 v[14:15], v6 offset:16896
    ds_read_b64_tr_b16 v[16:17], v6 offset:16416
    ds_read_b64_tr_b16 v[18:19], v6 offset:16928
    ds_read_b64_tr_b16 v[20:21], v6 offset:16448
    ds_read_b64_tr_b16 v[22:23], v6 offset:16960
    ds_read_b64_tr_b16 v[24:25], v6 offset:16480
    ds_read_b64_tr_b16 v[26:27], v6 offset:16992
    s_waitcnt lgkmcnt(6)
    v_mfma_f32_16x16x32_bf16 v[48:51], v[12:15], v[116:119], v[48:51]
    s_waitcnt lgkmcnt(4)
    v_mfma_f32_16x16x32_bf16 v[52:55], v[16:19], v[116:119], v[52:55]
    s_waitcnt lgkmcnt(2)
    v_mfma_f32_16x16x32_bf16 v[56:59], v[20:23], v[116:119], v[56:59]
    s_waitcnt lgkmcnt(0)
    v_mfma_f32_16x16x32_bf16 v[60:63], v[24:27], v[116:119], v[60:63]
    s_nop 1
    ds_write_b128 v7, v[48:51] offset:0
    s_nop 0
    ds_write_b128 v7, v[52:55] offset:64
    s_nop 0
    ds_write_b128 v7, v[56:59] offset:128
    s_nop 0
    ds_write_b128 v7, v[60:63] offset:192
    s_waitcnt lgkmcnt(0)
    s_barrier
    s_cmp_lg_u32 s3, 3
    s_cbranch_scc1 mod_skip_15
    ds_read2st64_b32 v[92:93], v10 offset0:0 offset1:1
    ds_read2st64_b32 v[94:95], v10 offset0:2 offset1:3
    s_waitcnt lgkmcnt(1)
    v_add_f32 v92, v92, v93
    s_waitcnt lgkmcnt(0)
    v_add_f32 v94, v94, v95
    v_add_f32 v92, v92, v94
    v_cvt_pk_bf16_f32 v92, v92, v92
    v_and_b32 v92, 0xffff0000, v92
    v_add_f32 v92, s7, v92
    v_cvt_pk_bf16_f32 v92, v92, v92
    v_and_b32 v92, 0xffff0000, v92
    buffer_store_dword v92, v11, s[28:31], s5 offen sc1
    s_mov_b32 s34, 230528
    s_waitcnt vmcnt(0)
    s_mov_b64 exec, 1
    v_mov_b32 v246, 1
    buffer_atomic_add v246, v245, s[28:31], s34 offen sc0 sc1
    s_waitcnt vmcnt(0)
    v_readfirstlane_b32 s58, v246
    s_mov_b64 exec, -1
    s_add_u32 s58, s58, 1
    s_cmp_lg_u32 s58, 45
    s_cbranch_scc1 arr_16
    v_lshrrev_b32 v246, 4, v250
    v_mul_u32_u24 v246, 128, v246
    s_lshl_b32 s58, 0, 7
    s_add_u32 s58, s58, 163840
    buffer_store_dword v244, v246, s[28:31], s58 offen offset:120 sc1
    s_add_u32 s58, s58, 8192
    buffer_store_dword v244, v246, s[28:31], s58 offen offset:120 sc1
    s_add_u32 s58, s58, 8192
    buffer_store_dword v244, v246, s[28:31], s58 offen offset:120 sc1
    s_add_u32 s58, s58, 8192
    buffer_store_dword v244, v246, s[28:31], s58 offen offset:120 sc1
    s_add_u32 s58, s58, 8192
    s_mov_b64 exec, -1
arr_16:
mod_skip_15:
    s_mul_i32 s4, s4, 2
    s_add_u32 s4, s4, s3
    s_add_u32 s4, s4, 226
    s_cmp_ge_u32 s3, 2
    s_cselect_b32 s4, s4, 1000
    s_branch side_strip_8
side_free_6:
    s_waitcnt lgkmcnt(0)
    s_mov_b32 s30, 53477376
    s_mov_b32 s31, 0x20000
    s_mov_b32 s98, 256
    s_mov_b32 s99, 0x20000
    v_lshlrev_b32 v250, 4, v2
    v_mov_b32 v244, 1
    v_mov_b32 v245, 0
    v_mov_b32 v247, 0
    v_mov_b32 v249, 0
    s_and_b32 s58, s2, 1
    s_bfe_u32 s61, s2, 131075
    s_lshl_b32 s58, s58, 2
    s_add_u32 s58, s58, s61
    s_bfe_u32 s61, s2, 131073
    s_lshl_b32 s61, s61, 3
    s_lshr_b32 s60, s2, 5
    s_add_u32 s61, s61, s60
    s_lshl_b32 s61, s61, 3
    s_add_u32 s60, s58, s61
    s_lshl_b32 s60, s60, 7
    s_add_u32 s60, s60, 163840
    s_mov_b32 s61, 0
    s_cmp_lt_u32 s4, 99
    s_cbranch_scc1 side_late_7
    s_cmp_lt_u32 s3, 2
    s_cbranch_scc1 side_late_7_n
    s_lshl_b32 s5, s4, 1
    s_add_u32 s5, s5, s3
    s_sub_u32 s5, s5, 200
    s_cmp_ge_u32 s5, 24
    s_cbranch_scc1 side_late_7_n
    v_mov_b32 v8, 0
    v_mov_b32 v9, 0
    v_mov_b32 v10, 0
    v_mov_b32 v11, 0
    s_mul_i32 s5, s5, 3072
    s_add_u32 s5, s5, 163840
    buffer_store_dwordx4 v[8:11], v250, s[28:31], s5 offen offset:0 sc1
    buffer_store_dwordx4 v[8:11], v250, s[28:31], s5 offen offset:1024 sc1
    buffer_store_dwordx4 v[8:11], v250, s[28:31], s5 offen offset:2048 sc1
    s_waitcnt vmcnt(0)
    s_mov_b64 exec, 1
    buffer_atomic_add v244, v245, s[96:99], 0 offen sc1
    s_mov_b64 exec, -1
side_late_7_n:
    s_sub_u32 s5, s4, 99
    s_mul_i32 s6, s3, 13
    s_add_u32 s5, s5, s6
    s_add_u32 s6, s5, 16
    s_cmp_lt_u32 s5, 20
    s_cselect_b32 s6, s6, 1000
    s_cmp_lt_u32 s5, 18
    s_cselect_b32 s5, s5, s6
    s_branch side_late_7_d
side_late_7:
    s_getpc_b64 s[6:7]
code_here:
    s_add_u32 s6, s6, code_begin-code_here
    s_addc_u32 s7, s7, -1
    s_mov_b32 s5, code_end-code_begin-16
    v_lshlrev_b32 v1, 4, v0
    v_lshlrev_b32 v1, 7, v0
    v_min_u32 v3, s5, v1
    v_mov_b32 v5, s7
    v_add_co_u32 v4, vcc, s6, v3
    s_nop 1
    v_addc_co_u32 v5, vcc, 0, v5, vcc
    global_load_dword v8, v[4:5], off
    v_add_u32 v1, 32768, v1
    v_min_u32 v3, s5, v1
    v_mov_b32 v5, s7
    v_add_co_u32 v4, vcc, s6, v3
    s_nop 1
    v_addc_co_u32 v5, vcc, 0, v5, vcc
    global_load_dword v9, v[4:5], off
    v_add_u32 v1, 32768, v1
    v_min_u32 v3, s5, v1
    v_mov_b32 v5, s7
    v_add_co_u32 v4, vcc, s6, v3
    s_nop 1
    v_addc_co_u32 v5, vcc, 0, v5, vcc
    global_load_dword v10, v[4:5], off
    v_add_u32 v1, 32768, v1
    s_load_dwordx2 s[8:9], s[0:1], 112
    s_load_dwordx2 s[12:13], s[0:1], 80
    s_load_dwordx2 s[16:17], s[0:1], 88
    s_load_dwordx2 s[20:21], s[0:1], 104
    s_load_dwordx2 s[24:25], s[0:1], 0
    s_mov_b32 s10, 2359296
    s_mov_b32 s11, 0x20000
    s_mov_b32 s14, 5308416
    s_mov_b32 s15, 0x20000
    s_mov_b32 s18, 5308416
    s_mov_b32 s19, 0x20000
    s_mov_b32 s22, 3981312
    s_mov_b32 s23, 0x20000
    s_mov_b32 s26, 2359296
    s_mov_b32 s27, 0x20000
    v_lshlrev_b32 v1, 21, v0
    s_waitcnt lgkmcnt(0)
    s_mov_b32 s5, 0
    buffer_load_dword v100, v1, s[28:31], s5 offen sc1
    s_mov_b32 s5, 0
    buffer_load_dword v101, v1, s[8:11], s5 offen sc1
    s_mov_b32 s5, 0
    buffer_load_dword v102, v1, s[12:15], s5 offen sc1
    s_mov_b32 s5, 0
    buffer_load_dword v103, v1, s[16:19], s5 offen sc1
    s_mov_b32 s5, 0
    buffer_load_dword v104, v1, s[20:23], s5 offen sc1
    s_mov_b32 s5, 0
    buffer_load_dword v105, v1, s[24:27], s5 offen sc1
    s_waitcnt vmcnt(0)
    s_sub_u32 s5, s4, 73
    s_lshl_b32 s6, s3, 3
    s_add_u32 s5, s5, s6
side_late_7_d:
    s_lshl_b32 s4, s4, 1
    s_add_u32 s4, s4, s3
    s_add_u32 s4, s4, 98
    s_cmp_ge_u32 s3, 2
    s_cselect_b32 s4, s4, s5
side_strip_8:
    s_load_dwordx4 s[12:15], s[0:1], 64
    s_load_dwordx4 s[16:19], s[0:1], 80
    s_mul_i32 s46, s3, 36864
    s_cmp_ge_u32 s4, 324
    s_cbranch_scc1 side_w1_9
    s_cmp_lt_u32 s4, 36
    s_cbranch_scc1 side_strip_8_m
    s_sub_u32 s5, s57, 144
    s_lshl_b32 s6, s5, 1
    s_add_u32 s6, s6, s3
    s_add_u32 s6, s6, 35
    s_add_u32 s5, s5, 180
    s_cmp_eq_u32 s3, 3
    s_cselect_b32 s5, s5, s6
    s_sub_u32 s6, s4, 64
    s_cmp_lt_u32 s4, 244
    s_cselect_b32 s6, s6, s4
    s_cmp_lt_u32 s4, 228
    s_cselect_b32 s4, s5, s6
side_strip_8_m:
    s_and_b32 s5, s4, 1
    s_lshr_b32 s32, s4, 1
    s_add_u32 s32, s32, 144
    s_cmp_ge_u32 s32, 162
    s_cselect_b32 s6, 162, 0
    s_sub_u32 s32, s32, s6
    s_mul_hi_u32 s6, s32, 477218589
    s_mul_i32 s7, s6, 9
    s_sub_u32 s7, s32, s7
    s_cmp_lt_u32 s4, 36
    s_cbranch_scc1 side_strip_8_go
    s_sub_u32 s32, s57, 144
    s_lshl_b32 s33, s3, 8
    s_add_u32 s32, s32, s33
    s_sub_u32 s32, s32, 256
    s_cmp_lt_u32 s32, 0
    s_cbranch_scc1 side_strip_8_go
    v_mov_b32 v247, 0
    s_mov_b64 exec, 1
    s_mov_b32 s58, 0
poll_17:
    buffer_load_dword v246, v247, s[96:99], 0 offen sc1
    s_add_u32 s58, s58, 1
    s_waitcnt vmcnt(0)
    v_cmp_gt_u32 vcc, 24, v246
    s_cmp_gt_u32 s58, 0x40000
    s_cbranch_scc1 poll_17_done
    s_nop 3
    s_cbranch_vccnz poll_17
poll_17_done:
    s_mov_b64 exec, -1
    v_lshrrev_b32 v247, 2, v250
    v_add_u32 v247, 124, v247
    s_mov_b64 exec, 1
    s_mov_b32 s58, 0
poll_18:
    buffer_load_dword v246, v247, s[28:31], s60 offen sc1
    s_add_u32 s58, s58, 1
    s_waitcnt vmcnt(0)
    v_cmp_gt_u32 vcc, 1, v246
    s_cmp_gt_u32 s58, 0x40000
    s_cbranch_scc1 poll_18_done
    s_nop 3
    s_cbranch_vccnz poll_18
poll_18_done:
    s_mov_b64 exec, -1
side_strip_8_go:
    s_waitcnt lgkmcnt(0)
    s_sub_u32 s32, s6, 8
    s_mul_i32 s32, s32, 663552
    s_mov_b32 s10, 5308416
    s_mov_b32 s11, 0x20000
    s_mov_b32 s33, 1152
    s_mov_b64 s[8:9], s[18:19]
    s_cmp_eq_u32 s6, 16
    s_cselect_b64 s[12:13], s[12:13], s[14:15]
    s_cmp_ge_u32 s6, 16
    s_cselect_b64 s[8:9], s[12:13], s[8:9]
    s_cselect_b32 s10, 663552, s10
    s_cselect_b32 s32, 0, s32
    s_mul_i32 s35, s6, 1152
    s_cmp_lt_u32 s6, 8
    s_cselect_b64 s[8:9], s[16:17], s[8:9]
    s_cselect_b32 s32, s35, s32
    s_cselect_b32 s33, 9216, s33
    s_lshl_b32 s35, s7, 7
    s_add_u32 s32, s32, s35
    s_mul_i32 s35, s33, 288
    s_mul_i32 s35, s35, s5
    s_add_u32 s32, s32, s35
    v_lshrrev_b32 v3, 3, v2
    v_mul_lo_u32 v3, v3, s33
    v_and_b32 v4, 7, v2
    v_lshl_add_u32 v3, v4, 4, v3
    s_lshl_b32 s33, s33, 3
    s_mov_b32 s34, s46
    s_mov_b32 m0, s34
    s_add_u32 s34, s34, 1024
    buffer_load_dwordx4 v3, s[8:11], s32 offen nt lds
    s_add_u32 s32, s32, s33
    s_mov_b32 m0, s34
    s_add_u32 s34, s34, 1024
    buffer_load_dwordx4 v3, s[8:11], s32 offen nt lds
    s_add_u32 s32, s32, s33
    s_mov_b32 m0, s34
    s_add_u32 s34, s34, 1024
    buffer_load_dwordx4 v3, s[8:11], s32 offen nt lds
    s_add_u32 s32, s32, s33
    s_mov_b32 m0, s34
    s_add_u32 s34, s34, 1024
    buffer_load_dwordx4 v3, s[8:11], s32 offen nt lds
    s_add_u32 s32, s32, s33
    s_mov_b32 m0, s34
    s_add_u32 s34, s34, 1024
    buffer_load_dwordx4 v3, s[8:11], s32 offen nt lds
    s_add_u32 s32, s32, s33
    s_mov_b32 m0, s34
    s_add_u32 s34, s34, 1024
    buffer_load_dwordx4 v3, s[8:11], s32 offen nt lds
    s_add_u32 s32, s32, s33
    s_mov_b32 m0, s34
    s_add_u32 s34, s34, 1024
    buffer_load_dwordx4 v3, s[8:11], s32 offen nt lds
    s_add_u32 s32, s32, s33
    s_mov_b32 m0, s34
    s_add_u32 s34, s34, 1024
    buffer_load_dwordx4 v3, s[8:11], s32 offen nt lds
    s_add_u32 s32, s32, s33
    s_mov_b32 s39, 3
    s_mov_b32 s40, 0
    s_lshr_b32 s41, s6, 3
    s_cmp_lg_u32 s41, 0
    s_cbranch_scc1 tr_w3_19
    s_cmp_ge_u32 s7, 0
    s_cselect_b32 s39, 3, s39
    s_cselect_b32 s40, 0, s40
    s_cmp_ge_u32 s7, 3
    s_cselect_b32 s39, 3, s39
    s_cselect_b32 s40, 12, s40
    s_cmp_ge_u32 s7, 6
    s_cselect_b32 s39, 3, s39
    s_cselect_b32 s40, 24, s40
tr_w3_19:
    s_cmp_eq_u32 s41, 1
    s_cselect_b32 s39, 9, s39
    s_lshl_b32 s42, s39, 10
    s_mov_b32 s43, 1024
    s_cmp_eq_u32 s41, 2
    s_cselect_b32 s42, s43, s42
    s_cselect_b32 s43, 18432, s43
    s_mov_b32 s44, 171
    s_cmp_eq_u32 s39, 2
    s_cselect_b32 s44, 256, s44
    s_cmp_eq_u32 s39, 9
    s_cselect_b32 s44, 57, s44
    s_mul_i32 s45, s6, 663552
    s_mul_i32 s35, s5, 9
    s_mul_i32 s35, s35, s42
    s_add_u32 s45, s45, s35
    s_add_u32 s45, s45, 18874368
    v_lshrrev_b32 v24, 4, v2
    v_bfe_u32 v25, v2, 2, 2
    v_lshl_add_u32 v26, v24, 3, v25
    v_and_b32 v27, 3, v2
    v_lshlrev_b32 v26, 7, v26
    v_add_u32 v26, s46, v26
    v_lshlrev_b32 v28, 4, v2
    v_lshl_add_u32 v29, v25, 3, v27
    v_and_b32 v30, 15, v2
    s_lshl_b32 s35, s7, 2
    s_add_u32 s35, s35, 0
    s_sub_u32 s35, s35, s40
    s_mul_i32 s36, s35, s44
    s_lshr_b32 s36, s36, 9
    s_mul_i32 s37, s36, s39
    s_sub_u32 s35, s35, s37
    s_cmp_eq_u32 s35, 0
    s_cselect_b32 s38, s39, s35
    s_sub_u32 s38, s38, 1
    s_and_b32 s36, s36, s39
    s_bitcmp1_b32 s36, 0
    s_cselect_b32 s35, s38, s35
    s_add_u32 s37, s37, s40
    s_mul_i32 s37, s37, 18432
    s_mul_i32 s36, s35, s43
    s_add_u32 s36, s36, s37
    v_add_u32 v8, s36, v28
    s_add_u32 s35, s35, 1
    s_cmp_eq_u32 s35, s39
    s_cselect_b32 s35, s39, 0
    s_bitcmp1_b32 s35, 0
    s_cselect_b32 s35, 3, 4
    s_cselect_b32 s36, 0, 0
    s_cselect_b64 vcc, -1, 0
    v_lshlrev_b32 v16, s35, v27
    v_add3_u32 v16, v16, s36, v26
    v_add_u32 v31, 0, v29
    v_add_u32 v32, 0, v30
    v_cndmask_b32 v20, v31, v32, vcc
    s_lshl_b32 s35, s7, 2
    s_add_u32 s35, s35, 1
    s_sub_u32 s35, s35, s40
    s_mul_i32 s36, s35, s44
    s_lshr_b32 s36, s36, 9
    s_mul_i32 s37, s36, s39
    s_sub_u32 s35, s35, s37
    s_cmp_eq_u32 s35, 0
    s_cselect_b32 s38, s39, s35
    s_sub_u32 s38, s38, 1
    s_and_b32 s36, s36, s39
    s_bitcmp1_b32 s36, 0
    s_cselect_b32 s35, s38, s35
    s_add_u32 s37, s37, s40
    s_mul_i32 s37, s37, 18432
    s_mul_i32 s36, s35, s43
    s_add_u32 s36, s36, s37
    v_add_u32 v9, s36, v28
    s_add_u32 s35, s35, 1
    s_cmp_eq_u32 s35, s39
    s_cselect_b32 s35, s39, 0
    s_bitcmp1_b32 s35, 0
    s_cselect_b32 s35, 3, 4
    s_cselect_b32 s36, 32, 8
    s_cselect_b64 vcc, -1, 0
    v_lshlrev_b32 v17, s35, v27
    v_add3_u32 v17, v17, s36, v26
    v_add_u32 v31, 4, v29
    v_add_u32 v32, 16, v30
    v_cndmask_b32 v21, v31, v32, vcc
    s_lshl_b32 s35, s7, 2
    s_add_u32 s35, s35, 2
    s_sub_u32 s35, s35, s40
    s_mul_i32 s36, s35, s44
    s_lshr_b32 s36, s36, 9
    s_mul_i32 s37, s36, s39
    s_sub_u32 s35, s35, s37
    s_cmp_eq_u32 s35, 0
    s_cselect_b32 s38, s39, s35
    s_sub_u32 s38, s38, 1
    s_and_b32 s36, s36, s39
    s_bitcmp1_b32 s36, 0
    s_cselect_b32 s35, s38, s35
    s_add_u32 s37, s37, s40
    s_mul_i32 s37, s37, 18432
    s_mul_i32 s36, s35, s43
    s_add_u32 s36, s36, s37
    v_add_u32 v10, s36, v28
    s_add_u32 s35, s35, 1
    s_cmp_eq_u32 s35, s39
    s_cselect_b32 s35, s39, 0
    s_bitcmp1_b32 s35, 0
    s_cselect_b32 s35, 3, 4
    s_cselect_b32 s36, 0, 0
    s_cselect_b64 vcc, -1, 0
    v_lshlrev_b32 v18, s35, v27
    v_add3_u32 v18, v18, s36, v26
    v_add_u32 v31, 32, v29
    v_add_u32 v32, 32, v30
    v_cndmask_b32 v22, v31, v32, vcc
    s_lshl_b32 s35, s7, 2
    s_add_u32 s35, s35, 3
    s_sub_u32 s35, s35, s40
    s_mul_i32 s36, s35, s44
    s_lshr_b32 s36, s36, 9
    s_mul_i32 s37, s36, s39
    s_sub_u32 s35, s35, s37
    s_cmp_eq_u32 s35, 0
    s_cselect_b32 s38, s39, s35
    s_sub_u32 s38, s38, 1
    s_and_b32 s36, s36, s39
    s_bitcmp1_b32 s36, 0
    s_cselect_b32 s35, s38, s35
    s_add_u32 s37, s37, s40
    s_mul_i32 s37, s37, 18432
    s_mul_i32 s36, s35, s43
    s_add_u32 s36, s36, s37
    v_add_u32 v11, s36, v28
    s_add_u32 s35, s35, 1
    s_cmp_eq_u32 s35, s39
    s_cselect_b32 s35, s39, 0
    s_bitcmp1_b32 s35, 0
    s_cselect_b32 s35, 3, 4
    s_cselect_b32 s36, 32, 8
    s_cselect_b64 vcc, -1, 0
    v_lshlrev_b32 v19, s35, v27
    v_add3_u32 v19, v19, s36, v26
    v_add_u32 v31, 36, v29
    v_add_u32 v32, 48, v30
    v_cndmask_b32 v23, v31, v32, vcc
    v_mov_b32 v32, 0x3f803f80
    v_mov_b32 v33, 0x3f803f80
    v_mov_b32 v34, 0x3f803f80
    v_mov_b32 v35, 0x3f803f80
    s_mov_b32 m0, s34
    s_add_u32 s34, s34, 1024
    buffer_load_dwordx4 v3, s[8:11], s32 offen nt lds
    s_add_u32 s32, s32, s33
    s_mov_b32 m0, s34
    s_add_u32 s34, s34, 1024
    buffer_load_dwordx4 v3, s[8:11], s32 offen nt lds
    s_add_u32 s32, s32, s33
    s_mov_b32 m0, s34
    s_add_u32 s34, s34, 1024
    buffer_load_dwordx4 v3, s[8:11], s32 offen nt lds
    s_add_u32 s32, s32, s33
    s_mov_b32 m0, s34
    s_add_u32 s34, s34, 1024
    buffer_load_dwordx4 v3, s[8:11], s32 offen nt lds
    s_add_u32 s32, s32, s33
    s_mov_b32 m0, s34
    s_add_u32 s34, s34, 1024
    buffer_load_dwordx4 v3, s[8:11], s32 offen nt lds
    s_add_u32 s32, s32, s33
    s_mov_b32 m0, s34
    s_add_u32 s34, s34, 1024
    buffer_load_dwordx4 v3, s[8:11], s32 offen nt lds
    s_add_u32 s32, s32, s33
    s_mov_b32 m0, s34
    s_add_u32 s34, s34, 1024
    buffer_load_dwordx4 v3, s[8:11], s32 offen nt lds
    s_add_u32 s32, s32, s33
    s_mov_b32 m0, s34
    s_add_u32 s34, s34, 1024
    buffer_load_dwordx4 v3, s[8:11], s32 offen nt lds
    s_add_u32 s32, s32, s33
    s_mov_b32 m0, s34
    s_add_u32 s34, s34, 1024
    buffer_load_dwordx4 v3, s[8:11], s32 offen nt lds
    s_add_u32 s32, s32, s33
    s_mov_b32 m0, s34
    s_add_u32 s34, s34, 1024
    buffer_load_dwordx4 v3, s[8:11], s32 offen nt lds
    s_add_u32 s32, s32, s33
    s_mov_b32 m0, s34
    s_add_u32 s34, s34, 1024
    buffer_load_dwordx4 v3, s[8:11], s32 offen nt lds
    s_add_u32 s32, s32, s33
    s_mov_b32 m0, s34
    s_add_u32 s34, s34, 1024
    buffer_load_dwordx4 v3, s[8:11], s32 offen nt lds
    s_add_u32 s32, s32, s33
    s_mov_b32 m0, s34
    s_add_u32 s34, s34, 1024
    buffer_load_dwordx4 v3, s[8:11], s32 offen nt lds
    s_add_u32 s32, s32, s33
    s_mov_b32 m0, s34
    s_add_u32 s34, s34, 1024
    buffer_load_dwordx4 v3, s[8:11], s32 offen nt lds
    s_add_u32 s32, s32, s33
    s_mov_b32 m0, s34
    s_add_u32 s34, s34, 1024
    buffer_load_dwordx4 v3, s[8:11], s32 offen nt lds
    s_add_u32 s32, s32, s33
    s_mov_b32 m0, s34
    s_add_u32 s34, s34, 1024
    buffer_load_dwordx4 v3, s[8:11], s32 offen nt lds
    s_add_u32 s32, s32, s33
    s_mov_b32 m0, s34
    s_add_u32 s34, s34, 1024
    buffer_load_dwordx4 v3, s[8:11], s32 offen nt lds
    s_add_u32 s32, s32, s33
    s_mov_b32 m0, s34
    s_add_u32 s34, s34, 1024
    buffer_load_dwordx4 v3, s[8:11], s32 offen nt lds
    s_add_u32 s32, s32, s33
    s_mov_b32 m0, s34
    s_add_u32 s34, s34, 1024
    buffer_load_dwordx4 v3, s[8:11], s32 offen nt lds
    s_add_u32 s32, s32, s33
    s_mov_b32 m0, s34
    s_add_u32 s34, s34, 1024
    buffer_load_dwordx4 v3, s[8:11], s32 offen nt lds
    s_add_u32 s32, s32, s33
    s_mov_b32 m0, s34
    s_add_u32 s34, s34, 1024
    buffer_load_dwordx4 v3, s[8:11], s32 offen nt lds
    s_add_u32 s32, s32, s33
    s_mov_b32 m0, s34
    s_add_u32 s34, s34, 1024
    buffer_load_dwordx4 v3, s[8:11], s32 offen nt lds
    s_add_u32 s32, s32, s33
    s_mov_b32 m0, s34
    s_add_u32 s34, s34, 1024
    buffer_load_dwordx4 v3, s[8:11], s32 offen nt lds
    s_add_u32 s32, s32, s33
    s_mov_b32 m0, s34
    s_add_u32 s34, s34, 1024
    buffer_load_dwordx4 v3, s[8:11], s32 offen nt lds
    s_add_u32 s32, s32, s33
    s_mov_b32 m0, s34
    s_add_u32 s34, s34, 1024
    buffer_load_dwordx4 v3, s[8:11], s32 offen nt lds
    s_add_u32 s32, s32, s33
    s_mov_b32 m0, s34
    s_add_u32 s34, s34, 1024
    buffer_load_dwordx4 v3, s[8:11], s32 offen nt lds
    s_add_u32 s32, s32, s33
    s_mov_b32 m0, s34
    s_add_u32 s34, s34, 1024
    buffer_load_dwordx4 v3, s[8:11], s32 offen nt lds
    s_add_u32 s32, s32, s33
    s_mov_b32 m0, s34
    s_add_u32 s34, s34, 1024
    buffer_load_dwordx4 v3, s[8:11], s32 offen nt lds
    s_add_u32 s32, s32, s33
    s_waitcnt vmcnt(32)
    ds_read_b64_tr_b16 v[36:37], v16 offset:0
    ds_read_b64_tr_b16 v[38:39], v16 offset:512
    ds_read_b64_tr_b16 v[40:41], v17 offset:0
    ds_read_b64_tr_b16 v[42:43], v17 offset:512
    ds_read_b64_tr_b16 v[44:45], v18 offset:64
    ds_read_b64_tr_b16 v[46:47], v18 offset:576
    ds_read_b64_tr_b16 v[48:49], v19 offset:64
    ds_read_b64_tr_b16 v[50:51], v19 offset:576
    s_waitcnt vmcnt(28)
    ds_read_b64_tr_b16 v[52:53], v16 offset:4096
    ds_read_b64_tr_b16 v[54:55], v16 offset:4608
    ds_read_b64_tr_b16 v[56:57], v17 offset:4096
    ds_read_b64_tr_b16 v[58:59], v17 offset:4608
    ds_read_b64_tr_b16 v[60:61], v18 offset:4160
    ds_read_b64_tr_b16 v[62:63], v18 offset:4672
    ds_read_b64_tr_b16 v[64:65], v19 offset:4160
    ds_read_b64_tr_b16 v[66:67], v19 offset:4672
    s_waitcnt lgkmcnt(14)
    buffer_store_dwordx4 v[36:39], v8, s[28:31], s45 offen sc1
    v_mfma_f32_16x16x32_bf16 v[68:71], v[32:35], v[36:39], 0
    s_waitcnt lgkmcnt(12)
    buffer_store_dwordx4 v[40:43], v9, s[28:31], s45 offen sc1
    v_mfma_f32_16x16x32_bf16 v[72:75], v[32:35], v[40:43], 0
    s_waitcnt lgkmcnt(10)
    buffer_store_dwordx4 v[44:47], v10, s[28:31], s45 offen sc1
    v_mfma_f32_16x16x32_bf16 v[76:79], v[32:35], v[44:47], 0
    s_waitcnt lgkmcnt(8)
    buffer_store_dwordx4 v[48:51], v11, s[28:31], s45 offen sc1
    v_mfma_f32_16x16x32_bf16 v[80:83], v[32:35], v[48:51], 0
    s_add_u32 s45, s45, s42
    s_waitcnt vmcnt(28)
    ds_read_b64_tr_b16 v[36:37], v16 offset:8192
    ds_read_b64_tr_b16 v[38:39], v16 offset:8704
    ds_read_b64_tr_b16 v[40:41], v17 offset:8192
    ds_read_b64_tr_b16 v[42:43], v17 offset:8704
    ds_read_b64_tr_b16 v[44:45], v18 offset:8256
    ds_read_b64_tr_b16 v[46:47], v18 offset:8768
    ds_read_b64_tr_b16 v[48:49], v19 offset:8256
    ds_read_b64_tr_b16 v[50:51], v19 offset:8768
    s_waitcnt lgkmcnt(14)
    buffer_store_dwordx4 v[52:55], v8, s[28:31], s45 offen sc1
    v_mfma_f32_16x16x32_bf16 v[68:71], v[32:35], v[52:55], v[68:71]
    s_waitcnt lgkmcnt(12)
    buffer_store_dwordx4 v[56:59], v9, s[28:31], s45 offen sc1
    v_mfma_f32_16x16x32_bf16 v[72:75], v[32:35], v[56:59], v[72:75]
    s_waitcnt lgkmcnt(10)
    buffer_store_dwordx4 v[60:63], v10, s[28:31], s45 offen sc1
    v_mfma_f32_16x16x32_bf16 v[76:79], v[32:35], v[60:63], v[76:79]
    s_waitcnt lgkmcnt(8)
    buffer_store_dwordx4 v[64:67], v11, s[28:31], s45 offen sc1
    v_mfma_f32_16x16x32_bf16 v[80:83], v[32:35], v[64:67], v[80:83]
    s_add_u32 s45, s45, s42
    s_waitcnt vmcnt(28)
    ds_read_b64_tr_b16 v[52:53], v16 offset:12288
    ds_read_b64_tr_b16 v[54:55], v16 offset:12800
    ds_read_b64_tr_b16 v[56:57], v17 offset:12288
    ds_read_b64_tr_b16 v[58:59], v17 offset:12800
    ds_read_b64_tr_b16 v[60:61], v18 offset:12352
    ds_read_b64_tr_b16 v[62:63], v18 offset:12864
    ds_read_b64_tr_b16 v[64:65], v19 offset:12352
    ds_read_b64_tr_b16 v[66:67], v19 offset:12864
    s_waitcnt lgkmcnt(14)
    buffer_store_dwordx4 v[36:39], v8, s[28:31], s45 offen sc1
    v_mfma_f32_16x16x32_bf16 v[68:71], v[32:35], v[36:39], v[68:71]
    s_waitcnt lgkmcnt(12)
    buffer_store_dwordx4 v[40:43], v9, s[28:31], s45 offen sc1
    v_mfma_f32_16x16x32_bf16 v[72:75], v[32:35], v[40:43], v[72:75]
    s_waitcnt lgkmcnt(10)
    buffer_store_dwordx4 v[44:47], v10, s[28:31], s45 offen sc1
    v_mfma_f32_16x16x32_bf16 v[76:79], v[32:35], v[44:47], v[76:79]
    s_waitcnt lgkmcnt(8)
    buffer_store_dwordx4 v[48:51], v11, s[28:31], s45 offen sc1
    v_mfma_f32_16x16x32_bf16 v[80:83], v[32:35], v[48:51], v[80:83]
    s_add_u32 s45, s45, s42
    s_waitcnt vmcnt(28)
    ds_read_b64_tr_b16 v[36:37], v16 offset:16384
    ds_read_b64_tr_b16 v[38:39], v16 offset:16896
    ds_read_b64_tr_b16 v[40:41], v17 offset:16384
    ds_read_b64_tr_b16 v[42:43], v17 offset:16896
    ds_read_b64_tr_b16 v[44:45], v18 offset:16448
    ds_read_b64_tr_b16 v[46:47], v18 offset:16960
    ds_read_b64_tr_b16 v[48:49], v19 offset:16448
    ds_read_b64_tr_b16 v[50:51], v19 offset:16960
    s_waitcnt lgkmcnt(14)
    buffer_store_dwordx4 v[52:55], v8, s[28:31], s45 offen sc1
    v_mfma_f32_16x16x32_bf16 v[68:71], v[32:35], v[52:55], v[68:71]
    s_waitcnt lgkmcnt(12)
    buffer_store_dwordx4 v[56:59], v9, s[28:31], s45 offen sc1
    v_mfma_f32_16x16x32_bf16 v[72:75], v[32:35], v[56:59], v[72:75]
    s_waitcnt lgkmcnt(10)
    buffer_store_dwordx4 v[60:63], v10, s[28:31], s45 offen sc1
    v_mfma_f32_16x16x32_bf16 v[76:79], v[32:35], v[60:63], v[76:79]
    s_waitcnt lgkmcnt(8)
    buffer_store_dwordx4 v[64:67], v11, s[28:31], s45 offen sc1
    v_mfma_f32_16x16x32_bf16 v[80:83], v[32:35], v[64:67], v[80:83]
    s_add_u32 s45, s45, s42
    s_waitcnt vmcnt(28)
    ds_read_b64_tr_b16 v[52:53], v16 offset:20480
    ds_read_b64_tr_b16 v[54:55], v16 offset:20992
    ds_read_b64_tr_b16 v[56:57], v17 offset:20480
    ds_read_b64_tr_b16 v[58:59], v17 offset:20992
    ds_read_b64_tr_b16 v[60:61], v18 offset:20544
    ds_read_b64_tr_b16 v[62:63], v18 offset:21056
    ds_read_b64_tr_b16 v[64:65], v19 offset:20544
    ds_read_b64_tr_b16 v[66:67], v19 offset:21056
    s_waitcnt lgkmcnt(14)
    buffer_store_dwordx4 v[36:39], v8, s[28:31], s45 offen sc1
    v_mfma_f32_16x16x32_bf16 v[68:71], v[32:35], v[36:39], v[68:71]
    s_waitcnt lgkmcnt(12)
    buffer_store_dwordx4 v[40:43], v9, s[28:31], s45 offen sc1
    v_mfma_f32_16x16x32_bf16 v[72:75], v[32:35], v[40:43], v[72:75]
    s_waitcnt lgkmcnt(10)
    buffer_store_dwordx4 v[44:47], v10, s[28:31], s45 offen sc1
    v_mfma_f32_16x16x32_bf16 v[76:79], v[32:35], v[44:47], v[76:79]
    s_waitcnt lgkmcnt(8)
    buffer_store_dwordx4 v[48:51], v11, s[28:31], s45 offen sc1
    v_mfma_f32_16x16x32_bf16 v[80:83], v[32:35], v[48:51], v[80:83]
    s_add_u32 s45, s45, s42
    s_waitcnt vmcnt(28)
    ds_read_b64_tr_b16 v[36:37], v16 offset:24576
    ds_read_b64_tr_b16 v[38:39], v16 offset:25088
    ds_read_b64_tr_b16 v[40:41], v17 offset:24576
    ds_read_b64_tr_b16 v[42:43], v17 offset:25088
    ds_read_b64_tr_b16 v[44:45], v18 offset:24640
    ds_read_b64_tr_b16 v[46:47], v18 offset:25152
    ds_read_b64_tr_b16 v[48:49], v19 offset:24640
    ds_read_b64_tr_b16 v[50:51], v19 offset:25152
    s_waitcnt lgkmcnt(14)
    buffer_store_dwordx4 v[52:55], v8, s[28:31], s45 offen sc1
    v_mfma_f32_16x16x32_bf16 v[68:71], v[32:35], v[52:55], v[68:71]
    s_waitcnt lgkmcnt(12)
    buffer_store_dwordx4 v[56:59], v9, s[28:31], s45 offen sc1
    v_mfma_f32_16x16x32_bf16 v[72:75], v[32:35], v[56:59], v[72:75]
    s_waitcnt lgkmcnt(10)
    buffer_store_dwordx4 v[60:63], v10, s[28:31], s45 offen sc1
    v_mfma_f32_16x16x32_bf16 v[76:79], v[32:35], v[60:63], v[76:79]
    s_waitcnt lgkmcnt(8)
    buffer_store_dwordx4 v[64:67], v11, s[28:31], s45 offen sc1
    v_mfma_f32_16x16x32_bf16 v[80:83], v[32:35], v[64:67], v[80:83]
    s_add_u32 s45, s45, s42
    s_waitcnt vmcnt(28)
    ds_read_b64_tr_b16 v[52:53], v16 offset:28672
    ds_read_b64_tr_b16 v[54:55], v16 offset:29184
    ds_read_b64_tr_b16 v[56:57], v17 offset:28672
    ds_read_b64_tr_b16 v[58:59], v17 offset:29184
    ds_read_b64_tr_b16 v[60:61], v18 offset:28736
    ds_read_b64_tr_b16 v[62:63], v18 offset:29248
    ds_read_b64_tr_b16 v[64:65], v19 offset:28736
    ds_read_b64_tr_b16 v[66:67], v19 offset:29248
    s_waitcnt lgkmcnt(14)
    buffer_store_dwordx4 v[36:39], v8, s[28:31], s45 offen sc1
    v_mfma_f32_16x16x32_bf16 v[68:71], v[32:35], v[36:39], v[68:71]
    s_waitcnt lgkmcnt(12)
    buffer_store_dwordx4 v[40:43], v9, s[28:31], s45 offen sc1
    v_mfma_f32_16x16x32_bf16 v[72:75], v[32:35], v[40:43], v[72:75]
    s_waitcnt lgkmcnt(10)
    buffer_store_dwordx4 v[44:47], v10, s[28:31], s45 offen sc1
    v_mfma_f32_16x16x32_bf16 v[76:79], v[32:35], v[44:47], v[76:79]
    s_waitcnt lgkmcnt(8)
    buffer_store_dwordx4 v[48:51], v11, s[28:31], s45 offen sc1
    v_mfma_f32_16x16x32_bf16 v[80:83], v[32:35], v[48:51], v[80:83]
    s_add_u32 s45, s45, s42
    s_waitcnt vmcnt(28)
    ds_read_b64_tr_b16 v[36:37], v16 offset:32768
    ds_read_b64_tr_b16 v[38:39], v16 offset:33280
    ds_read_b64_tr_b16 v[40:41], v17 offset:32768
    ds_read_b64_tr_b16 v[42:43], v17 offset:33280
    ds_read_b64_tr_b16 v[44:45], v18 offset:32832
    ds_read_b64_tr_b16 v[46:47], v18 offset:33344
    ds_read_b64_tr_b16 v[48:49], v19 offset:32832
    ds_read_b64_tr_b16 v[50:51], v19 offset:33344
    s_waitcnt lgkmcnt(14)
    buffer_store_dwordx4 v[52:55], v8, s[28:31], s45 offen sc1
    v_mfma_f32_16x16x32_bf16 v[68:71], v[32:35], v[52:55], v[68:71]
    s_waitcnt lgkmcnt(12)
    buffer_store_dwordx4 v[56:59], v9, s[28:31], s45 offen sc1
    v_mfma_f32_16x16x32_bf16 v[72:75], v[32:35], v[56:59], v[72:75]
    s_waitcnt lgkmcnt(10)
    buffer_store_dwordx4 v[60:63], v10, s[28:31], s45 offen sc1
    v_mfma_f32_16x16x32_bf16 v[76:79], v[32:35], v[60:63], v[76:79]
    s_waitcnt lgkmcnt(8)
    buffer_store_dwordx4 v[64:67], v11, s[28:31], s45 offen sc1
    v_mfma_f32_16x16x32_bf16 v[80:83], v[32:35], v[64:67], v[80:83]
    s_add_u32 s45, s45, s42
    s_waitcnt lgkmcnt(6)
    buffer_store_dwordx4 v[36:39], v8, s[28:31], s45 offen sc1
    v_mfma_f32_16x16x32_bf16 v[68:71], v[32:35], v[36:39], v[68:71]
    s_waitcnt lgkmcnt(4)
    buffer_store_dwordx4 v[40:43], v9, s[28:31], s45 offen sc1
    v_mfma_f32_16x16x32_bf16 v[72:75], v[32:35], v[40:43], v[72:75]
    s_waitcnt lgkmcnt(2)
    buffer_store_dwordx4 v[44:47], v10, s[28:31], s45 offen sc1
    v_mfma_f32_16x16x32_bf16 v[76:79], v[32:35], v[44:47], v[76:79]
    s_waitcnt lgkmcnt(0)
    buffer_store_dwordx4 v[48:51], v11, s[28:31], s45 offen sc1
    v_mfma_f32_16x16x32_bf16 v[80:83], v[32:35], v[48:51], v[80:83]
    s_add_u32 s45, s45, s42
    s_cmp_eq_u32 s6, 17
    s_cbranch_scc1 tr_nosum_20
    s_cmp_eq_u32 s41, 1
    s_cbranch_scc1 tr_nosum_20
    v_cmp_eq_u32 vcc, 1, v24
    s_nop 1
    v_cndmask_b32 v68, v68, v72, vcc
    v_cndmask_b32 v20, v20, v21, vcc
    v_cmp_eq_u32 vcc, 2, v24
    s_nop 1
    v_cndmask_b32 v68, v68, v76, vcc
    v_cndmask_b32 v20, v20, v22, vcc
    v_cmp_eq_u32 vcc, 3, v24
    s_nop 1
    v_cndmask_b32 v68, v68, v80, vcc
    v_cndmask_b32 v20, v20, v23, vcc
    v_lshlrev_b32 v20, 2, v20
    s_mul_i32 s45, s6, 2304
    s_mul_i32 s35, s5, 18432
    s_add_u32 s45, s45, s35
    s_add_u32 s45, s45, 98304
    s_mul_i32 s35, s5, 2304
    s_add_u32 s35, s35, 86016
    s_cmp_eq_u32 s6, 16
    s_cselect_b32 s45, s35, s45
    s_lshl_b32 s35, s7, 8
    s_add_u32 s45, s45, s35
    buffer_store_dword v68, v20, s[28:31], s45 offen sc1
tr_nosum_20:
    v_mov_b32 v247, 0
    s_mov_b64 exec, 1
    s_mov_b32 s58, 0
poll_21:
    buffer_load_dword v246, v247, s[96:99], 0 offen sc1
    s_add_u32 s58, s58, 1
    s_waitcnt vmcnt(0)
    v_cmp_gt_u32 vcc, 24, v246
    s_cmp_gt_u32 s58, 0x40000
    s_cbranch_scc1 poll_21_done
    s_nop 3
    s_cbranch_vccnz poll_21
poll_21_done:
    s_mov_b64 exec, -1
    s_cmp_ge_u32 s6, 16
    s_cbranch_scc1 side_small_22
    s_lshl_b32 s47, s6, 7
    s_add_u32 s47, s47, 230784
    s_and_b32 s47, s6, 7
    s_lshl_b32 s47, s47, 6
    s_lshr_b32 s48, s6, 3
    s_mul_i32 s48, s48, 18
    s_add_u32 s47, s47, s48
    s_lshl_b32 s48, s7, 1
    s_add_u32 s47, s47, s48
    s_add_u32 s47, s47, s5
    v_lshrrev_b32 v246, 4, v250
    v_mul_u32_u24 v246, 0, v246
    s_lshl_b32 s58, s47, 2
    s_add_u32 s58, s58, 231808
    s_mov_b32 exec_lo, 0x1
    s_mov_b32 exec_hi, 0
    buffer_store_dword v244, v246, s[28:31], s58 offen sc1
    s_mov_b64 exec, -1
    s_branch side_w1_9
side_small_22:
    s_sub_u32 s6, s6, 16
    s_lshl_b32 s47, s6, 7
    s_add_u32 s47, s47, 230400
    s_lshl_b32 s49, s6, 2
    s_add_u32 s49, s49, 116
    s_mul_i32 s48, s6, 27
    s_add_u32 s48, s48, 18
    s_waitcnt vmcnt(0)
    s_mov_b64 exec, 1
    v_mov_b32 v246, 1
    buffer_atomic_add v246, v245, s[28:31], s47 offen sc0 sc1
    s_waitcnt vmcnt(0)
    v_readfirstlane_b32 s58, v246
    s_mov_b64 exec, -1
    s_add_u32 s58, s58, 1
    s_cmp_lg_u32 s58, s48
    s_cbranch_scc1 arr_23
    v_lshrrev_b32 v246, 4, v250
    v_mul_u32_u24 v246, 128, v246
    s_lshl_b32 s58, 0, 7
    s_add_u32 s58, s58, 163840
    s_add_u32 s58, s58, s49
    buffer_store_dword v244, v246, s[28:31], s58 offen offset:0 sc1
    s_add_u32 s58, s58, 8192
    buffer_store_dword v244, v246, s[28:31], s58 offen offset:0 sc1
    s_add_u32 s58, s58, 8192
    buffer_store_dword v244, v246, s[28:31], s58 offen offset:0 sc1
    s_add_u32 s58, s58, 8192
    buffer_store_dword v244, v246, s[28:31], s58 offen offset:0 sc1
    s_add_u32 s58, s58, 8192
    s_mov_b64 exec, -1
arr_23:
side_w1_9:
    s_waitcnt vmcnt(0) lgkmcnt(0)
km_join:
    s_load_dwordx2 s[8:9], s[0:1], 112
    s_mov_b32 s10, 2359296
    s_mov_b32 s11, 0x20000
    s_load_dwordx4 s[40:43], s[0:1], 80
    s_and_b32 s6, s2, 1
    s_bfe_u32 s7, s2, 131075
    s_lshl_b32 s6, s6, 2
    s_add_u32 s13, s6, s7
    s_bfe_u32 s6, s2, 131073
    s_lshl_b32 s6, s6, 3
    s_lshr_b32 s12, s2, 5
    s_add_u32 s12, s12, s6
    s_lshr_b32 s14, s13, 2
    s_and_b32 s4, s13, 3
    s_lshl_b32 s16, s12, 1
    s_add_u32 s16, s16, s14
    s_lshl_b32 s5, s16, 1
    s_mul_i32 s15, s4, 3
    s_add_u32 s15, s15, s3
    v_lshrrev_b32 v5, 4, v2
    v_and_b32 v13, 15, v2
    v_lshlrev_b32 v6, 4, v2
    s_and_b32 s34, s3, 1
    s_lshr_b32 s35, s3, 1
    s_cmp_eq_u32 s3, 3
    s_cbranch_scc1 km_helper
    v_and_b32 v7, 32, v2
    v_xor_b32 v3, v6, v7
    s_mul_i32 s6, s16, 36992
    s_mul_i32 s7, s3, 9216
    s_add_u32 s6, s6, s7
    s_add_u32 s6, s6, 6029312
    s_mov_b32 m0, s7
    s_lshl_b32 s32, s3, 10
    s_add_u32 s33, s32, 72448
    s_add_u32 s32, s32, 73728
    s_mul_i32 s18, s15, 55296
    s_add_u32 s18, s18, 30154752
    v_mov_b32 v216, v3
    v_bfe_u32 v3, v2, 2, 2
    v_lshl_add_u32 v3, v5, 3, v3
    v_lshlrev_b32 v3, 6, v3
    v_bfe_u32 v4, v2, 1, 1
    s_lshl_b32 s36, s34, 1
    v_add_u32 v4, s36, v4
    v_and_b32 v7, 1, v5
    v_lshlrev_b32 v7, 1, v7
    v_xor_b32 v4, v4, v7
    v_lshl_add_u32 v3, v4, 4, v3
    v_and_b32 v4, 1, v2
    v_lshl_add_u32 v3, v4, 3, v3
    s_mul_i32 s36, s35, 18432
    v_add_u32 v3, s36, v3
    s_mul_i32 s36, s35, 1152
    s_add_u32 s36, s36, 73728
    v_lshl_add_u32 v4, v5, 5, s36
    s_lshl_b32 s36, s3, 7
    s_add_u32 s36, s36, 78848
    v_lshl_add_u32 v7, v13, 3, s36
    v_xor_b32 v8, 256, v7
    v_add_u32 v12, 4, v7
    v_mov_b32 v10, 79872
    v_lshrrev_b32 v11, 2, v13
    v_cmp_eq_u32 vcc, v11, v5
    s_nop 1
    v_cndmask_b32 v12, v10, v12, vcc
    v_and_b32 v11, 3, v13
    v_cmp_eq_u32 s[46:47], 1, v11
    v_cmp_eq_u32 s[48:49], 2, v11
    v_cmp_eq_u32 s[50:51], 3, v11
    s_mul_i32 s36, s34, 18
    s_mul_i32 s37, s35, 9
    s_add_u32 s36, s36, s37
    s_lshl_b32 s36, s36, 10
    s_add_u32 s36, s36, 36864
    v_add_u32 v9, s36, v6
    v_mov_b32 v196, 0x3f803f80
    v_mov_b32 v197, 0x3f803f80
    v_mov_b32 v198, 0x3f803f80
    v_mov_b32 v199, 0x3f803f80
    s_waitcnt vmcnt(0) lgkmcnt(0)
    s_barrier
    s_mul_i32 s41, s15, 3
    s_add_u32 s40, s41, 1
    s_lshr_b32 s40, s40, 1
    s_lshl_b32 s40, s40, 10
    s_and_b32 s42, s15, 1
    s_add_u32 s43, s41, 2
    s_cmp_eq_u32 s42, 1
    s_cselect_b32 s41, s41, s43
    s_lshr_b32 s41, s41, 1
    s_lshl_b32 s41, s41, 10
    s_lshl_b32 s43, s42, 9
    s_add_u32 s41, s41, s43
    s_mul_i32 s43, s5, 18432
    v_and_b32 v14, 1, v5
    v_mul_u32_u24 v14, 18432, v14
    v_lshrrev_b32 v15, 1, v5
    v_lshl_add_u32 v14, v15, 8, v14
    v_lshl_add_u32 v14, v13, 4, v14
    v_mov_b32 v219, v14
    v_lshlrev_b32 v217, 5, v5
    s_lshr_b32 s44, s40, 3
    s_add_u32 s44, s44, 86016
    s_lshr_b32 s45, s41, 3
    s_add_u32 s45, s45, 86016
    v_lshlrev_b32 v218, 4, v5
    s_mul_i32 s17, s15, 55296
    s_add_u32 s17, s17, 29491200
    s_mov_b32 s61, 0
    s_barrier
    buffer_load_dwordx4 a[0:3], v6, s[28:31], s17 offen offset:0 sc1
    buffer_load_dwordx4 a[4:7], v6, s[28:31], s17 offen offset:1024 sc1
    buffer_load_dwordx4 a[8:11], v6, s[28:31], s17 offen offset:2048 sc1
    buffer_load_dwordx4 a[12:15], v6, s[28:31], s17 offen offset:3072 sc1
    s_add_u32 s17, s17, 4096
    buffer_load_dwordx4 a[16:19], v6, s[28:31], s17 offen offset:0 sc1
    buffer_load_dwordx4 a[20:23], v6, s[28:31], s17 offen offset:1024 sc1
    buffer_load_dwordx4 a[24:27], v6, s[28:31], s17 offen offset:2048 sc1
    buffer_load_dwordx4 a[28:31], v6, s[28:31], s17 offen offset:3072 sc1
    s_add_u32 s17, s17, 4096
    buffer_load_dwordx4 a[32:35], v6, s[28:31], s17 offen offset:0 sc1
    buffer_load_dwordx4 a[36:39], v6, s[28:31], s17 offen offset:1024 sc1
    buffer_load_dwordx4 a[40:43], v6, s[28:31], s17 offen offset:2048 sc1
    buffer_load_dwordx4 a[44:47], v6, s[28:31], s17 offen offset:3072 sc1
    s_add_u32 s17, s17, 4096
    s_barrier
    buffer_load_dwordx4 v216, s[28:31], s6 offen sc1 lds
    s_add_u32 m0, m0, 1024
    s_add_u32 s6, s6, 1024
    buffer_load_dwordx4 v216, s[28:31], s6 offen sc1 lds
    s_add_u32 m0, m0, 1024
    s_add_u32 s6, s6, 1024
    buffer_load_dwordx4 v216, s[28:31], s6 offen sc1 lds
    s_add_u32 m0, m0, 1024
    s_add_u32 s6, s6, 1024
    buffer_load_dwordx4 v216, s[28:31], s6 offen sc1 lds
    s_add_u32 m0, m0, 1024
    s_add_u32 s6, s6, 1024
    buffer_load_dwordx4 v216, s[28:31], s6 offen sc1 lds
    s_add_u32 m0, m0, 1024
    s_add_u32 s6, s6, 1024
    buffer_load_dwordx4 v216, s[28:31], s6 offen sc1 lds
    s_add_u32 m0, m0, 1024
    s_add_u32 s6, s6, 1024
    buffer_load_dwordx4 v216, s[28:31], s6 offen sc1 lds
    s_add_u32 m0, m0, 1024
    s_add_u32 s6, s6, 1024
    buffer_load_dwordx4 v216, s[28:31], s6 offen sc1 lds
    s_add_u32 m0, m0, 1024
    s_add_u32 s6, s6, 1024
    buffer_load_dwordx4 v216, s[28:31], s6 offen sc1 lds
    s_mov_b32 m0, s32
    s_nop 0
    buffer_load_dwordx4 v6, s[28:31], s33 offen sc1 lds
    s_waitcnt vmcnt(0)
    s_barrier
    ds_read_b64_tr_b16 v[16:17], v3 offset:0
    ds_read_b64_tr_b16 v[18:19], v3 offset:256
    ds_read_b64_tr_b16 v[20:21], v3 offset:2048
    ds_read_b64_tr_b16 v[22:23], v3 offset:2304
    ds_read_b64_tr_b16 v[24:25], v3 offset:4096
    ds_read_b64_tr_b16 v[26:27], v3 offset:4352
    ds_read_b64_tr_b16 v[28:29], v3 offset:6144
    ds_read_b64_tr_b16 v[30:31], v3 offset:6400
    ds_read_b64_tr_b16 v[32:33], v3 offset:8192
    ds_read_b64_tr_b16 v[34:35], v3 offset:8448
    ds_read_b64_tr_b16 v[36:37], v3 offset:10240
    ds_read_b64_tr_b16 v[38:39], v3 offset:10496
    ds_read_b64_tr_b16 v[40:41], v3 offset:12288
    ds_read_b64_tr_b16 v[42:43], v3 offset:12544
    ds_read_b64_tr_b16 v[44:45], v3 offset:14336
    ds_read_b64_tr_b16 v[46:47], v3 offset:14592
    ds_read_b64_tr_b16 v[48:49], v3 offset:16384
    ds_read_b64_tr_b16 v[50:51], v3 offset:16640
    s_waitcnt lgkmcnt(15)
    v_mfma_f32_16x16x32_bf16 v[200:203], v[196:199], v[16:19], 0
    buffer_load_dwordx4 a[48:51], v6, s[28:31], s17 offen offset:0 sc1
    v_mfma_f32_16x16x32_bf16 v[204:207], v[16:19], v[16:19], 0
    s_waitcnt lgkmcnt(14)
    v_mfma_f32_16x16x32_bf16 v[200:203], v[196:199], v[20:23], v[200:203]
    buffer_load_dwordx4 a[52:55], v6, s[28:31], s17 offen offset:1024 sc1
    v_mfma_f32_16x16x32_bf16 v[204:207], v[20:23], v[20:23], v[204:207]
    s_waitcnt lgkmcnt(12)
    v_mfma_f32_16x16x32_bf16 v[200:203], v[196:199], v[24:27], v[200:203]
    buffer_load_dwordx4 a[56:59], v6, s[28:31], s17 offen offset:2048 sc1
    v_mfma_f32_16x16x32_bf16 v[204:207], v[24:27], v[24:27], v[204:207]
    s_waitcnt lgkmcnt(10)
    v_mfma_f32_16x16x32_bf16 v[200:203], v[196:199], v[28:31], v[200:203]
    buffer_load_dwordx4 a[60:63], v6, s[28:31], s17 offen offset:3072 sc1
    s_add_u32 s17, s17, 4096
    v_mfma_f32_16x16x32_bf16 v[204:207], v[28:31], v[28:31], v[204:207]
    s_waitcnt lgkmcnt(8)
    v_mfma_f32_16x16x32_bf16 v[200:203], v[196:199], v[32:35], v[200:203]
    buffer_load_dwordx4 a[64:67], v6, s[28:31], s17 offen offset:0 sc1
    v_mfma_f32_16x16x32_bf16 v[204:207], v[32:35], v[32:35], v[204:207]
    s_waitcnt lgkmcnt(6)
    v_mfma_f32_16x16x32_bf16 v[200:203], v[196:199], v[36:39], v[200:203]
    buffer_load_dwordx4 a[68:71], v6, s[28:31], s17 offen offset:1024 sc1
    v_mfma_f32_16x16x32_bf16 v[204:207], v[36:39], v[36:39], v[204:207]
    s_waitcnt lgkmcnt(4)
    v_mfma_f32_16x16x32_bf16 v[200:203], v[196:199], v[40:43], v[200:203]
    buffer_load_dwordx4 a[72:75], v6, s[28:31], s17 offen offset:2048 sc1
    v_mfma_f32_16x16x32_bf16 v[204:207], v[40:43], v[40:43], v[204:207]
    s_waitcnt lgkmcnt(2)
    v_mfma_f32_16x16x32_bf16 v[200:203], v[196:199], v[44:47], v[200:203]
    buffer_load_dwordx4 a[76:79], v6, s[28:31], s17 offen offset:3072 sc1
    s_add_u32 s17, s17, 4096
    v_mfma_f32_16x16x32_bf16 v[204:207], v[44:47], v[44:47], v[204:207]
    s_waitcnt lgkmcnt(0)
    v_mfma_f32_16x16x32_bf16 v[200:203], v[196:199], v[48:51], v[200:203]
    buffer_load_dwordx4 a[80:83], v6, s[28:31], s17 offen offset:0 sc1
    v_mfma_f32_16x16x32_bf16 v[204:207], v[48:51], v[48:51], v[204:207]
    ds_read_b128 v[52:55], v4 offset:0
    ds_read_b128 v[56:59], v4 offset:16
    ds_read_b128 v[60:63], v4 offset:2304
    ds_read_b128 v[64:67], v4 offset:2320
    ds_read_b128 v[68:71], v4 offset:128
    ds_read_b128 v[72:75], v4 offset:144
    ds_read_b128 v[76:79], v4 offset:2432
    ds_read_b128 v[80:83], v4 offset:2448
    v_cndmask_b32 v204, v204, v205, s[46:47]
    v_cndmask_b32 v204, v204, v206, s[48:49]
    v_cndmask_b32 v204, v204, v207, s[50:51]
    ds_write_b32 v7, v200 offset:0
    ds_write_b32 v12, v204 offset:0
    s_waitcnt lgkmcnt(0)
    s_barrier
    ds_read_b64 v[10:11], v7
    ds_read_b64 v[14:15], v8
    ds_read_b128 v[84:87], v4 offset:256
    ds_read_b128 v[88:91], v4 offset:272
    ds_read_b128 v[92:95], v4 offset:2560
    ds_read_b128 v[96:99], v4 offset:2576
    ds_read_b128 v[100:103], v4 offset:384
    ds_read_b128 v[104:107], v4 offset:400
    ds_read_b128 v[108:111], v4 offset:2688
    ds_read_b128 v[112:115], v4 offset:2704
    ds_read_b128 v[116:119], v4 offset:512
    ds_read_b128 v[120:123], v4 offset:528
    ds_read_b128 v[124:127], v4 offset:2816
    ds_read_b128 v[128:131], v4 offset:2832
    s_waitcnt lgkmcnt(12)
    v_add_f32 v10, v10, v14
    v_add_f32 v11, v11, v15
    v_mul_f32 v10, 0x3ae38e39, v10
    v_mul_f32 v11, 0x3ae38e39, v11
    v_fma_f32 v11, -v10, v10, v11
    v_max_f32 v11, 0, v11
    v_add_f32 v11, 0x3727c5ac, v11
    v_sqrt_f32 v11, v11
    v_rcp_f32 v11, v11
    buffer_load_dwordx4 a[84:87], v6, s[28:31], s17 offen offset:1024 sc1
    buffer_load_dwordx4 a[88:91], v6, s[28:31], s17 offen offset:2048 sc1
    buffer_load_dwordx4 a[92:95], v6, s[28:31], s17 offen offset:3072 sc1
    s_add_u32 s17, s17, 4096
    v_mul_f32 v10, -v10, v11
    v_lshlrev_b32 v208, 16, v16
    v_and_b32 v209, 0xffff0000, v16
    v_lshlrev_b32 v210, 16, v17
    v_and_b32 v211, 0xffff0000, v17
    v_lshlrev_b32 v212, 16, v18
    v_and_b32 v213, 0xffff0000, v18
    v_lshlrev_b32 v214, 16, v19
    v_and_b32 v215, 0xffff0000, v19
    v_pk_fma_f32 v[208:209], v[208:209], v[10:11], v[10:11] op_sel:[0,1,0] op_sel_hi:[1,1,0]
    v_pk_fma_f32 v[210:211], v[210:211], v[10:11], v[10:11] op_sel:[0,1,0] op_sel_hi:[1,1,0]
    v_pk_fma_f32 v[212:213], v[212:213], v[10:11], v[10:11] op_sel:[0,1,0] op_sel_hi:[1,1,0]
    v_pk_fma_f32 v[214:215], v[214:215], v[10:11], v[10:11] op_sel:[0,1,0] op_sel_hi:[1,1,0]
    v_pk_fma_f32 v[208:209], v[208:209], v[60:61], v[52:53]
    v_pk_fma_f32 v[210:211], v[210:211], v[62:63], v[54:55]
    v_pk_fma_f32 v[212:213], v[212:213], v[64:65], v[56:57]
    v_pk_fma_f32 v[214:215], v[214:215], v[66:67], v[58:59]
    v_cvt_pk_bf16_f32 v16, v208, v209
    v_cvt_pk_bf16_f32 v17, v210, v211
    v_cvt_pk_bf16_f32 v18, v212, v213
    v_cvt_pk_bf16_f32 v19, v214, v215
    ds_write_b128 v9, v[16:19] offset:0
    s_nop 0
    v_mfma_f32_16x16x32_bf16 v[200:203], v[196:199], v[16:19], 0
    buffer_load_dwordx4 a[96:99], v6, s[28:31], s17 offen offset:0 sc1
    buffer_load_dwordx4 a[100:103], v6, s[28:31], s17 offen offset:1024 sc1
    buffer_load_dwordx4 a[104:107], v6, s[28:31], s17 offen offset:2048 sc1
    v_mfma_f32_16x16x32_bf16 v[204:207], v[16:19], v[16:19], 0
    ds_read_b128 v[132:135], v4 offset:640
    ds_read_b128 v[136:139], v4 offset:656
    ds_read_b128 v[140:143], v4 offset:2944
    ds_read_b128 v[144:147], v4 offset:2960
    v_lshlrev_b32 v208, 16, v20
    v_and_b32 v209, 0xffff0000, v20
    v_lshlrev_b32 v210, 16, v21
    v_and_b32 v211, 0xffff0000, v21
    v_lshlrev_b32 v212, 16, v22
    v_and_b32 v213, 0xffff0000, v22
    v_lshlrev_b32 v214, 16, v23
    v_and_b32 v215, 0xffff0000, v23
    v_pk_fma_f32 v[208:209], v[208:209], v[10:11], v[10:11] op_sel:[0,1,0] op_sel_hi:[1,1,0]
    v_pk_fma_f32 v[210:211], v[210:211], v[10:11], v[10:11] op_sel:[0,1,0] op_sel_hi:[1,1,0]
    v_pk_fma_f32 v[212:213], v[212:213], v[10:11], v[10:11] op_sel:[0,1,0] op_sel_hi:[1,1,0]
    v_pk_fma_f32 v[214:215], v[214:215], v[10:11], v[10:11] op_sel:[0,1,0] op_sel_hi:[1,1,0]
    v_pk_fma_f32 v[208:209], v[208:209], v[76:77], v[68:69]
    v_pk_fma_f32 v[210:211], v[210:211], v[78:79], v[70:71]
    v_pk_fma_f32 v[212:213], v[212:213], v[80:81], v[72:73]
    v_pk_fma_f32 v[214:215], v[214:215], v[82:83], v[74:75]
    v_cvt_pk_bf16_f32 v20, v208, v209
    v_cvt_pk_bf16_f32 v21, v210, v211
    v_cvt_pk_bf16_f32 v22, v212, v213
    v_cvt_pk_bf16_f32 v23, v214, v215
    ds_write_b128 v9, v[20:23] offset:1024
    s_nop 0
    v_mfma_f32_16x16x32_bf16 v[200:203], v[196:199], v[20:23], v[200:203]
    buffer_load_dwordx4 a[108:111], v6, s[28:31], s17 offen offset:3072 sc1
    s_add_u32 s17, s17, 4096
    buffer_load_dwordx4 a[112:115], v6, s[28:31], s17 offen offset:0 sc1
    buffer_load_dwordx4 a[116:119], v6, s[28:31], s17 offen offset:1024 sc1
    v_mfma_f32_16x16x32_bf16 v[204:207], v[20:23], v[20:23], v[204:207]
    ds_read_b128 v[148:151], v4 offset:768
    ds_read_b128 v[152:155], v4 offset:784
    ds_read_b128 v[156:159], v4 offset:3072
    ds_read_b128 v[160:163], v4 offset:3088
    v_lshlrev_b32 v208, 16, v24
    v_and_b32 v209, 0xffff0000, v24
    v_lshlrev_b32 v210, 16, v25
    v_and_b32 v211, 0xffff0000, v25
    v_lshlrev_b32 v212, 16, v26
    v_and_b32 v213, 0xffff0000, v26
    v_lshlrev_b32 v214, 16, v27
    v_and_b32 v215, 0xffff0000, v27
    v_pk_fma_f32 v[208:209], v[208:209], v[10:11], v[10:11] op_sel:[0,1,0] op_sel_hi:[1,1,0]
    v_pk_fma_f32 v[210:211], v[210:211], v[10:11], v[10:11] op_sel:[0,1,0] op_sel_hi:[1,1,0]
    v_pk_fma_f32 v[212:213], v[212:213], v[10:11], v[10:11] op_sel:[0,1,0] op_sel_hi:[1,1,0]
    v_pk_fma_f32 v[214:215], v[214:215], v[10:11], v[10:11] op_sel:[0,1,0] op_sel_hi:[1,1,0]
    s_waitcnt lgkmcnt(15)
    v_pk_fma_f32 v[208:209], v[208:209], v[92:93], v[84:85]
    v_pk_fma_f32 v[210:211], v[210:211], v[94:95], v[86:87]
    v_pk_fma_f32 v[212:213], v[212:213], v[96:97], v[88:89]
    v_pk_fma_f32 v[214:215], v[214:215], v[98:99], v[90:91]
    v_cvt_pk_bf16_f32 v24, v208, v209
    v_cvt_pk_bf16_f32 v25, v210, v211
    v_cvt_pk_bf16_f32 v26, v212, v213
    v_cvt_pk_bf16_f32 v27, v214, v215
    ds_write_b128 v9, v[24:27] offset:2048
    s_nop 0
    v_mfma_f32_16x16x32_bf16 v[200:203], v[196:199], v[24:27], v[200:203]
    buffer_load_dwordx4 a[120:123], v6, s[28:31], s17 offen offset:2048 sc1
    buffer_load_dwordx4 a[124:127], v6, s[28:31], s17 offen offset:3072 sc1
    s_add_u32 s17, s17, 4096
    buffer_load_dwordx4 v[220:223], v217, s[28:31], s44 offen offset:0 sc1
    v_mfma_f32_16x16x32_bf16 v[204:207], v[24:27], v[24:27], v[204:207]
    ds_read_b128 v[164:167], v4 offset:896
    ds_read_b128 v[168:171], v4 offset:912
    ds_read_b128 v[172:175], v4 offset:3200
    ds_read_b128 v[176:179], v4 offset:3216
    v_lshlrev_b32 v208, 16, v28
    v_and_b32 v209, 0xffff0000, v28
    v_lshlrev_b32 v210, 16, v29
    v_and_b32 v211, 0xffff0000, v29
    v_lshlrev_b32 v212, 16, v30
    v_and_b32 v213, 0xffff0000, v30
    v_lshlrev_b32 v214, 16, v31
    v_and_b32 v215, 0xffff0000, v31
    v_pk_fma_f32 v[208:209], v[208:209], v[10:11], v[10:11] op_sel:[0,1,0] op_sel_hi:[1,1,0]
    v_pk_fma_f32 v[210:211], v[210:211], v[10:11], v[10:11] op_sel:[0,1,0] op_sel_hi:[1,1,0]
    v_pk_fma_f32 v[212:213], v[212:213], v[10:11], v[10:11] op_sel:[0,1,0] op_sel_hi:[1,1,0]
    v_pk_fma_f32 v[214:215], v[214:215], v[10:11], v[10:11] op_sel:[0,1,0] op_sel_hi:[1,1,0]
    v_pk_fma_f32 v[208:209], v[208:209], v[108:109], v[100:101]
    v_pk_fma_f32 v[210:211], v[210:211], v[110:111], v[102:103]
    s_waitcnt lgkmcnt(15)
    v_pk_fma_f32 v[212:213], v[212:213], v[112:113], v[104:105]
    v_pk_fma_f32 v[214:215], v[214:215], v[114:115], v[106:107]
    v_cvt_pk_bf16_f32 v28, v208, v209
    v_cvt_pk_bf16_f32 v29, v210, v211
    v_cvt_pk_bf16_f32 v30, v212, v213
    v_cvt_pk_bf16_f32 v31, v214, v215
    ds_write_b128 v9, v[28:31] offset:3072
    s_nop 0
    v_mfma_f32_16x16x32_bf16 v[200:203], v[196:199], v[28:31], v[200:203]
    buffer_load_dwordx4 v[224:227], v217, s[28:31], s44 offen offset:16 sc1
    buffer_load_dwordx4 v[228:231], v218, s[28:31], s45 offen offset:0 sc1
    buffer_load_dwordx4 v[232:235], v217, s[28:31], s44 offen offset:2304 sc1
    v_mfma_f32_16x16x32_bf16 v[204:207], v[28:31], v[28:31], v[204:207]
    ds_read_b128 v[180:183], v4 offset:1024
    ds_read_b128 v[184:187], v4 offset:1040
    ds_read_b128 v[188:191], v4 offset:3328
    ds_read_b128 v[192:195], v4 offset:3344
    v_lshlrev_b32 v208, 16, v32
    v_and_b32 v209, 0xffff0000, v32
    v_lshlrev_b32 v210, 16, v33
    v_and_b32 v211, 0xffff0000, v33
    v_lshlrev_b32 v212, 16, v34
    v_and_b32 v213, 0xffff0000, v34
    v_lshlrev_b32 v214, 16, v35
    v_and_b32 v215, 0xffff0000, v35
    v_pk_fma_f32 v[208:209], v[208:209], v[10:11], v[10:11] op_sel:[0,1,0] op_sel_hi:[1,1,0]
    v_pk_fma_f32 v[210:211], v[210:211], v[10:11], v[10:11] op_sel:[0,1,0] op_sel_hi:[1,1,0]
    v_pk_fma_f32 v[212:213], v[212:213], v[10:11], v[10:11] op_sel:[0,1,0] op_sel_hi:[1,1,0]
    v_pk_fma_f32 v[214:215], v[214:215], v[10:11], v[10:11] op_sel:[0,1,0] op_sel_hi:[1,1,0]
    v_pk_fma_f32 v[208:209], v[208:209], v[124:125], v[116:117]
    v_pk_fma_f32 v[210:211], v[210:211], v[126:127], v[118:119]
    v_pk_fma_f32 v[212:213], v[212:213], v[128:129], v[120:121]
    v_pk_fma_f32 v[214:215], v[214:215], v[130:131], v[122:123]
    v_cvt_pk_bf16_f32 v32, v208, v209
    v_cvt_pk_bf16_f32 v33, v210, v211
    v_cvt_pk_bf16_f32 v34, v212, v213
    v_cvt_pk_bf16_f32 v35, v214, v215
    ds_write_b128 v9, v[32:35] offset:4096
    s_nop 0
    v_mfma_f32_16x16x32_bf16 v[200:203], v[196:199], v[32:35], v[200:203]
    buffer_load_dwordx4 v[236:239], v217, s[28:31], s44 offen offset:2320 sc1
    buffer_load_dwordx4 v[240:243], v218, s[28:31], s45 offen offset:2304 sc1
    buffer_load_dwordx4 a[128:131], v6, s[28:31], s17 offen offset:0 sc1
    v_mfma_f32_16x16x32_bf16 v[204:207], v[32:35], v[32:35], v[204:207]
    v_lshlrev_b32 v208, 16, v36
    v_and_b32 v209, 0xffff0000, v36
    v_lshlrev_b32 v210, 16, v37
    v_and_b32 v211, 0xffff0000, v37
    v_lshlrev_b32 v212, 16, v38
    v_and_b32 v213, 0xffff0000, v38
    v_lshlrev_b32 v214, 16, v39
    v_and_b32 v215, 0xffff0000, v39
    v_pk_fma_f32 v[208:209], v[208:209], v[10:11], v[10:11] op_sel:[0,1,0] op_sel_hi:[1,1,0]
    v_pk_fma_f32 v[210:211], v[210:211], v[10:11], v[10:11] op_sel:[0,1,0] op_sel_hi:[1,1,0]
    v_pk_fma_f32 v[212:213], v[212:213], v[10:11], v[10:11] op_sel:[0,1,0] op_sel_hi:[1,1,0]
    v_pk_fma_f32 v[214:215], v[214:215], v[10:11], v[10:11] op_sel:[0,1,0] op_sel_hi:[1,1,0]
    s_waitcnt lgkmcnt(15)
    v_pk_fma_f32 v[208:209], v[208:209], v[140:141], v[132:133]
    v_pk_fma_f32 v[210:211], v[210:211], v[142:143], v[134:135]
    v_pk_fma_f32 v[212:213], v[212:213], v[144:145], v[136:137]
    v_pk_fma_f32 v[214:215], v[214:215], v[146:147], v[138:139]
    v_cvt_pk_bf16_f32 v36, v208, v209
    v_cvt_pk_bf16_f32 v37, v210, v211
    v_cvt_pk_bf16_f32 v38, v212, v213
    v_cvt_pk_bf16_f32 v39, v214, v215
    ds_write_b128 v9, v[36:39] offset:5120
    s_nop 0
    v_mfma_f32_16x16x32_bf16 v[200:203], v[196:199], v[36:39], v[200:203]
    buffer_load_dwordx4 a[132:135], v6, s[28:31], s17 offen offset:1024 sc1
    buffer_load_dwordx4 a[136:139], v6, s[28:31], s17 offen offset:2048 sc1
    buffer_load_dwordx4 a[140:143], v6, s[28:31], s17 offen offset:3072 sc1
    s_add_u32 s17, s17, 4096
    v_mfma_f32_16x16x32_bf16 v[204:207], v[36:39], v[36:39], v[204:207]
    v_lshlrev_b32 v208, 16, v40
    v_and_b32 v209, 0xffff0000, v40
    v_lshlrev_b32 v210, 16, v41
    v_and_b32 v211, 0xffff0000, v41
    v_lshlrev_b32 v212, 16, v42
    v_and_b32 v213, 0xffff0000, v42
    v_lshlrev_b32 v214, 16, v43
    v_and_b32 v215, 0xffff0000, v43
    v_pk_fma_f32 v[208:209], v[208:209], v[10:11], v[10:11] op_sel:[0,1,0] op_sel_hi:[1,1,0]
    v_pk_fma_f32 v[210:211], v[210:211], v[10:11], v[10:11] op_sel:[0,1,0] op_sel_hi:[1,1,0]
    v_pk_fma_f32 v[212:213], v[212:213], v[10:11], v[10:11] op_sel:[0,1,0] op_sel_hi:[1,1,0]
    v_pk_fma_f32 v[214:215], v[214:215], v[10:11], v[10:11] op_sel:[0,1,0] op_sel_hi:[1,1,0]
    s_waitcnt lgkmcnt(13)
    v_pk_fma_f32 v[208:209], v[208:209], v[156:157], v[148:149]
    v_pk_fma_f32 v[210:211], v[210:211], v[158:159], v[150:151]
    s_waitcnt lgkmcnt(12)
    v_pk_fma_f32 v[212:213], v[212:213], v[160:161], v[152:153]
    v_pk_fma_f32 v[214:215], v[214:215], v[162:163], v[154:155]
    v_cvt_pk_bf16_f32 v40, v208, v209
    v_cvt_pk_bf16_f32 v41, v210, v211
    v_cvt_pk_bf16_f32 v42, v212, v213
    v_cvt_pk_bf16_f32 v43, v214, v215
    ds_write_b128 v9, v[40:43] offset:6144
    s_nop 0
    v_mfma_f32_16x16x32_bf16 v[200:203], v[196:199], v[40:43], v[200:203]
    buffer_load_dwordx4 a[144:147], v6, s[28:31], s17 offen offset:0 sc1
    buffer_load_dwordx4 a[148:151], v6, s[28:31], s17 offen offset:1024 sc1
    v_mfma_f32_16x16x32_bf16 v[204:207], v[40:43], v[40:43], v[204:207]
    v_lshlrev_b32 v208, 16, v44
    v_and_b32 v209, 0xffff0000, v44
    v_lshlrev_b32 v210, 16, v45
    v_and_b32 v211, 0xffff0000, v45
    v_lshlrev_b32 v212, 16, v46
    v_and_b32 v213, 0xffff0000, v46
    v_lshlrev_b32 v214, 16, v47
    v_and_b32 v215, 0xffff0000, v47
    v_pk_fma_f32 v[208:209], v[208:209], v[10:11], v[10:11] op_sel:[0,1,0] op_sel_hi:[1,1,0]
    v_pk_fma_f32 v[210:211], v[210:211], v[10:11], v[10:11] op_sel:[0,1,0] op_sel_hi:[1,1,0]
    v_pk_fma_f32 v[212:213], v[212:213], v[10:11], v[10:11] op_sel:[0,1,0] op_sel_hi:[1,1,0]
    v_pk_fma_f32 v[214:215], v[214:215], v[10:11], v[10:11] op_sel:[0,1,0] op_sel_hi:[1,1,0]
    s_waitcnt lgkmcnt(9)
    v_pk_fma_f32 v[208:209], v[208:209], v[172:173], v[164:165]
    v_pk_fma_f32 v[210:211], v[210:211], v[174:175], v[166:167]
    s_waitcnt lgkmcnt(8)
    v_pk_fma_f32 v[212:213], v[212:213], v[176:177], v[168:169]
    v_pk_fma_f32 v[214:215], v[214:215], v[178:179], v[170:171]
    v_cvt_pk_bf16_f32 v44, v208, v209
    v_cvt_pk_bf16_f32 v45, v210, v211
    v_cvt_pk_bf16_f32 v46, v212, v213
    v_cvt_pk_bf16_f32 v47, v214, v215
    ds_write_b128 v9, v[44:47] offset:7168
    s_nop 0
    v_mfma_f32_16x16x32_bf16 v[200:203], v[196:199], v[44:47], v[200:203]
    v_mfma_f32_16x16x32_bf16 v[204:207], v[44:47], v[44:47], v[204:207]
    v_lshlrev_b32 v208, 16, v48
    v_and_b32 v209, 0xffff0000, v48
    v_lshlrev_b32 v210, 16, v49
    v_and_b32 v211, 0xffff0000, v49
    v_lshlrev_b32 v212, 16, v50
    v_and_b32 v213, 0xffff0000, v50
    v_lshlrev_b32 v214, 16, v51
    v_and_b32 v215, 0xffff0000, v51
    v_pk_fma_f32 v[208:209], v[208:209], v[10:11], v[10:11] op_sel:[0,1,0] op_sel_hi:[1,1,0]
    v_pk_fma_f32 v[210:211], v[210:211], v[10:11], v[10:11] op_sel:[0,1,0] op_sel_hi:[1,1,0]
    v_pk_fma_f32 v[212:213], v[212:213], v[10:11], v[10:11] op_sel:[0,1,0] op_sel_hi:[1,1,0]
    v_pk_fma_f32 v[214:215], v[214:215], v[10:11], v[10:11] op_sel:[0,1,0] op_sel_hi:[1,1,0]
    s_waitcnt lgkmcnt(5)
    v_pk_fma_f32 v[208:209], v[208:209], v[188:189], v[180:181]
    v_pk_fma_f32 v[210:211], v[210:211], v[190:191], v[182:183]
    s_waitcnt lgkmcnt(4)
    v_pk_fma_f32 v[212:213], v[212:213], v[192:193], v[184:185]
    v_pk_fma_f32 v[214:215], v[214:215], v[194:195], v[186:187]
    v_cvt_pk_bf16_f32 v48, v208, v209
    v_cvt_pk_bf16_f32 v49, v210, v211
    v_cvt_pk_bf16_f32 v50, v212, v213
    v_cvt_pk_bf16_f32 v51, v214, v215
    ds_write_b128 v9, v[48:51] offset:8192
    s_nop 0
    v_mfma_f32_16x16x32_bf16 v[200:203], v[196:199], v[48:51], v[200:203]
    v_mfma_f32_16x16x32_bf16 v[204:207], v[48:51], v[48:51], v[204:207]
    s_nop 7
    v_cndmask_b32 v204, v204, v205, s[46:47]
    v_cndmask_b32 v204, v204, v206, s[48:49]
    v_cndmask_b32 v204, v204, v207, s[50:51]
    ds_write_b32 v7, v200 offset:512
    ds_write_b32 v12, v204 offset:512
    v_lshlrev_b32 v7, 3, v13
    v_add_u32 v7, 79360, v7
    v_add_u32 v8, 36864, v6
    s_add_u32 s44, s40, s43
    s_add_u32 s45, s41, s43
    s_add_u32 s44, s44, 13238272
    s_add_u32 s45, s45, 13238272
    s_waitcnt lgkmcnt(0)
    s_barrier
    ds_read_b64 v[40:41], v7 offset:0
    ds_read_b64 v[42:43], v7 offset:128
    ds_read_b64 v[44:45], v7 offset:256
    ds_read_b64 v[46:47], v7 offset:384
    ds_read_b128 v[52:55], v8 offset:0
    ds_read_b128 v[56:59], v8 offset:18432
    ds_read_b128 v[60:63], v8 offset:1024
    ds_read_b128 v[64:67], v8 offset:19456
    ds_read_b128 v[68:71], v8 offset:2048
    ds_read_b128 v[72:75], v8 offset:20480
    s_waitcnt lgkmcnt(5)
    v_mfma_f32_16x16x32_bf16 v[16:19], a[0:3], v[52:55], 0
    s_waitcnt lgkmcnt(4)
    ds_read_b128 v[76:79], v8 offset:3072
    v_add_f32 v196, v40, v44
    v_mfma_f32_16x16x32_bf16 v[20:23], a[0:3], v[56:59], 0
    s_waitcnt lgkmcnt(4)
    ds_read_b128 v[80:83], v8 offset:21504
    buffer_load_dwordx4 a[152:155], v6, s[28:31], s17 offen offset:2048 sc1
    v_mfma_f32_16x16x32_bf16 v[16:19], a[4:7], v[60:63], v[16:19]
    s_waitcnt lgkmcnt(4)
    ds_read_b128 v[84:87], v8 offset:4096
    v_add_f32 v197, v41, v45
    v_mul_f32 v196, 0x3ae38e39, v196
    v_mfma_f32_16x16x32_bf16 v[20:23], a[4:7], v[64:67], v[20:23]
    s_waitcnt lgkmcnt(4)
    ds_read_b128 v[88:91], v8 offset:22528
    buffer_load_dwordx4 a[156:159], v6, s[28:31], s17 offen offset:3072 sc1
    v_mfma_f32_16x16x32_bf16 v[16:19], a[8:11], v[68:71], v[16:19]
    s_add_u32 s17, s17, 4096
    ds_read_b128 v[92:95], v8 offset:5120
    v_mul_f32 v197, 0x3ae38e39, v197
    v_fma_f32 v197, -v196, v196, v197
    s_waitcnt lgkmcnt(5)
    v_mfma_f32_16x16x32_bf16 v[20:23], a[8:11], v[72:75], v[20:23]
    s_waitcnt lgkmcnt(4)
    ds_read_b128 v[96:99], v8 offset:23552
    buffer_load_dwordx4 a[160:163], v6, s[28:31], s17 offen offset:0 sc1
    v_mfma_f32_16x16x32_bf16 v[16:19], a[12:15], v[76:79], v[16:19]
    s_waitcnt lgkmcnt(4)
    ds_read_b128 v[100:103], v8 offset:6144
    v_max_f32 v197, 0, v197
    v_mfma_f32_16x16x32_bf16 v[20:23], a[12:15], v[80:83], v[20:23]
    s_waitcnt lgkmcnt(4)
    ds_read_b128 v[104:107], v8 offset:24576
    buffer_load_dwordx4 a[164:167], v6, s[28:31], s17 offen offset:1024 sc1
    v_add_f32 v197, 0x3727c5ac, v197
    v_mfma_f32_16x16x32_bf16 v[16:19], a[16:19], v[84:87], v[16:19]
    s_waitcnt lgkmcnt(4)
    ds_read_b128 v[108:111], v8 offset:7168
    v_sqrt_f32 v197, v197
    v_mfma_f32_16x16x32_bf16 v[20:23], a[16:19], v[88:91], v[20:23]
    s_waitcnt lgkmcnt(4)
    ds_read_b128 v[112:115], v8 offset:25600
    buffer_load_dwordx4 a[168:171], v6, s[28:31], s17 offen offset:2048 sc1
    v_mfma_f32_16x16x32_bf16 v[16:19], a[20:23], v[92:95], v[16:19]
    s_waitcnt lgkmcnt(4)
    ds_read_b128 v[116:119], v8 offset:8192
    v_rcp_f32 v198, v197
    v_mfma_f32_16x16x32_bf16 v[20:23], a[20:23], v[96:99], v[20:23]
    s_waitcnt lgkmcnt(4)
    ds_read_b128 v[120:123], v8 offset:26624
    buffer_load_dwordx4 a[172:175], v6, s[28:31], s17 offen offset:3072 sc1
    v_mfma_f32_16x16x32_bf16 v[16:19], a[24:27], v[100:103], v[16:19]
    s_add_u32 s17, s17, 4096
    ds_read_b128 v[124:127], v8 offset:9216
    v_sub_f32 v196, 0, v196
    s_waitcnt lgkmcnt(5)
    v_mfma_f32_16x16x32_bf16 v[20:23], a[24:27], v[104:107], v[20:23]
    s_waitcnt lgkmcnt(4)
    ds_read_b128 v[128:131], v8 offset:27648
    buffer_load_dwordx4 a[176:179], v6, s[28:31], s17 offen offset:0 sc1
    v_mfma_f32_16x16x32_bf16 v[16:19], a[28:31], v[108:111], v[16:19]
    s_waitcnt lgkmcnt(4)
    ds_read_b128 v[132:135], v8 offset:10240
    v_mul_f32 v199, v198, v198
    v_mfma_f32_16x16x32_bf16 v[20:23], a[28:31], v[112:115], v[20:23]
    s_waitcnt lgkmcnt(4)
    ds_read_b128 v[136:139], v8 offset:28672
    buffer_load_dwordx4 a[180:183], v6, s[28:31], s17 offen offset:1024 sc1
    v_mul_f32 v198, 0xc0135761, v198
    v_mfma_f32_16x16x32_bf16 v[16:19], a[32:35], v[116:119], v[16:19]
    s_waitcnt lgkmcnt(4)
    ds_read_b128 v[140:143], v8 offset:11264
    v_mul_f32 v199, 0x3d372713, v199
    v_mfma_f32_16x16x32_bf16 v[20:23], a[32:35], v[120:123], v[20:23]
    s_waitcnt lgkmcnt(4)
    ds_read_b128 v[144:147], v8 offset:29696
    buffer_load_dwordx4 a[184:187], v6, s[28:31], s17 offen offset:2048 sc1
    v_mul_f32 v199, v199, v198
    v_mfma_f32_16x16x32_bf16 v[16:19], a[36:39], v[124:127], v[16:19]
    s_waitcnt lgkmcnt(4)
    ds_read_b128 v[148:151], v8 offset:12288
    v_add_f32 v200, v42, v46
    v_mfma_f32_16x16x32_bf16 v[20:23], a[36:39], v[128:131], v[20:23]
    s_waitcnt lgkmcnt(4)
    ds_read_b128 v[152:155], v8 offset:30720
    buffer_load_dwordx4 a[188:191], v6, s[28:31], s17 offen offset:3072 sc1
    v_add_f32 v201, v43, v47
    v_mfma_f32_16x16x32_bf16 v[16:19], a[40:43], v[132:135], v[16:19]
    s_add_u32 s17, s17, 4096
    ds_read_b128 v[156:159], v8 offset:13312
    v_mul_f32 v200, 0x3ae38e39, v200
    s_waitcnt lgkmcnt(5)
    v_mfma_f32_16x16x32_bf16 v[20:23], a[40:43], v[136:139], v[20:23]
    s_waitcnt lgkmcnt(4)
    ds_read_b128 v[160:163], v8 offset:31744
    buffer_load_dwordx4 a[192:195], v6, s[28:31], s17 offen offset:0 sc1
    v_mfma_f32_16x16x32_bf16 v[16:19], a[44:47], v[140:143], v[16:19]
    s_waitcnt lgkmcnt(4)
    ds_read_b128 v[164:167], v8 offset:14336
    v_mul_f32 v201, 0x3ae38e39, v201
    v_fma_f32 v201, -v200, v200, v201
    v_mfma_f32_16x16x32_bf16 v[20:23], a[44:47], v[144:147], v[20:23]
    s_waitcnt vmcnt(42) lgkmcnt(4)
    ds_read_b128 v[168:171], v8 offset:32768
    buffer_load_dwordx4 a[196:199], v6, s[28:31], s17 offen offset:1024 sc1
    v_mfma_f32_16x16x32_bf16 v[16:19], a[48:51], v[148:151], v[16:19]
    s_waitcnt lgkmcnt(4)
    ds_read_b128 v[172:175], v8 offset:15360
    v_max_f32 v201, 0, v201
    v_add_f32 v201, 0x3727c5ac, v201
    v_mfma_f32_16x16x32_bf16 v[20:23], a[48:51], v[152:155], v[20:23]
    s_waitcnt vmcnt(42) lgkmcnt(4)
    ds_read_b128 v[176:179], v8 offset:33792
    buffer_load_dwordx4 a[200:203], v6, s[28:31], s17 offen offset:2048 sc1
    v_mfma_f32_16x16x32_bf16 v[16:19], a[52:55], v[156:159], v[16:19]
    s_waitcnt lgkmcnt(4)
    ds_read_b128 v[180:183], v8 offset:16384
    v_sqrt_f32 v201, v201
    v_mfma_f32_16x16x32_bf16 v[20:23], a[52:55], v[160:163], v[20:23]
    s_waitcnt vmcnt(42) lgkmcnt(4)
    ds_read_b128 v[184:187], v8 offset:34816
    buffer_load_dwordx4 a[204:207], v6, s[28:31], s17 offen offset:3072 sc1
    v_mfma_f32_16x16x32_bf16 v[16:19], a[56:59], v[164:167], v[16:19]
    s_add_u32 s17, s17, 4096
    ds_read_b128 v[188:191], v8 offset:17408
    v_rcp_f32 v202, v201
    s_waitcnt lgkmcnt(5)
    v_mfma_f32_16x16x32_bf16 v[20:23], a[56:59], v[168:171], v[20:23]
    s_waitcnt vmcnt(42) lgkmcnt(4)
    ds_read_b128 v[192:195], v8 offset:35840
    buffer_load_dwordx4 a[208:211], v6, s[28:31], s17 offen offset:0 sc1
    v_mfma_f32_16x16x32_bf16 v[16:19], a[60:63], v[172:175], v[16:19]
    s_waitcnt lgkmcnt(4)
    v_sub_f32 v200, 0, v200
    v_mul_f32 v203, v202, v202
    v_mfma_f32_16x16x32_bf16 v[20:23], a[60:63], v[176:179], v[20:23]
    s_waitcnt vmcnt(42) lgkmcnt(3)
    buffer_load_dwordx4 a[212:215], v6, s[28:31], s17 offen offset:1024 sc1
    v_mfma_f32_16x16x32_bf16 v[16:19], a[64:67], v[180:183], v[16:19]
    s_waitcnt lgkmcnt(2)
    v_mul_f32 v202, 0xc0135761, v202
    v_mul_f32 v203, 0x3d372713, v203
    v_mul_f32 v203, v203, v202
    v_mfma_f32_16x16x32_bf16 v[20:23], a[64:67], v[184:187], v[20:23]
    s_waitcnt vmcnt(24)
    v_add_f32 v220, v220, v232
    v_add_f32 v221, v221, v233
    s_waitcnt lgkmcnt(1)
    v_mfma_f32_16x16x32_bf16 v[16:19], a[68:71], v[188:191], v[16:19]
    v_add_f32 v222, v222, v234
    v_add_f32 v223, v223, v235
    s_waitcnt vmcnt(23)
    v_add_f32 v224, v224, v236
    s_waitcnt lgkmcnt(0)
    v_mfma_f32_16x16x32_bf16 v[20:23], a[68:71], v[192:195], v[20:23]
    v_add_f32 v225, v225, v237
    v_add_f32 v226, v226, v238
    v_mfma_f32_16x16x32_bf16 v[24:27], a[72:75], v[52:55], 0
    v_add_f32 v227, v227, v239
    s_waitcnt vmcnt(22)
    v_add_f32 v228, v228, v240
    v_add_f32 v229, v229, v241
    v_mfma_f32_16x16x32_bf16 v[28:31], a[72:75], v[56:59], 0
    v_add_f32 v230, v230, v242
    v_add_f32 v231, v231, v243
    buffer_load_dwordx4 a[216:219], v6, s[28:31], s18 offen offset:0 sc1
    v_mfma_f32_16x16x32_bf16 v[24:27], a[76:79], v[60:63], v[24:27]
    buffer_load_dwordx4 a[220:223], v6, s[28:31], s18 offen offset:1024 sc1
    v_mfma_f32_16x16x32_bf16 v[28:31], a[76:79], v[64:67], v[28:31]
    buffer_load_dwordx4 a[224:227], v6, s[28:31], s18 offen offset:2048 sc1
    v_mfma_f32_16x16x32_bf16 v[24:27], a[80:83], v[68:71], v[24:27]
    buffer_load_dwordx4 a[228:231], v6, s[28:31], s18 offen offset:3072 sc1
    v_fmac_f32 v16, v196, v220
    v_mfma_f32_16x16x32_bf16 v[28:31], a[80:83], v[72:75], v[28:31]
    s_add_u32 s18, s18, 4096
    v_fmac_f32 v17, v196, v221
    v_fmac_f32 v18, v196, v222
    v_fmac_f32 v19, v196, v223
    v_mul_f32 v244, v16, v16
    v_mfma_f32_16x16x32_bf16 v[24:27], a[84:87], v[76:79], v[24:27]
    buffer_load_dwordx4 a[232:235], v6, s[28:31], s18 offen offset:0 sc1
    v_mul_f32 v245, v17, v17
    v_mul_f32 v246, v18, v18
    v_mfma_f32_16x16x32_bf16 v[28:31], a[84:87], v[80:83], v[28:31]
    buffer_load_dwordx4 a[236:239], v6, s[28:31], s18 offen offset:1024 sc1
    v_mul_f32 v247, v19, v19
    v_fma_f32 v244, v244, v199, v198
    v_mfma_f32_16x16x32_bf16 v[24:27], a[88:91], v[84:87], v[24:27]
    buffer_load_dwordx4 a[240:243], v6, s[28:31], s18 offen offset:2048 sc1
    v_fma_f32 v245, v245, v199, v198
    v_fma_f32 v246, v246, v199, v198
    v_mfma_f32_16x16x32_bf16 v[28:31], a[88:91], v[88:91], v[28:31]
    buffer_load_dwordx4 a[244:247], v6, s[28:31], s18 offen offset:3072 sc1
    v_fma_f32 v247, v247, v199, v198
    v_mul_f32 v244, v244, v16
    v_mfma_f32_16x16x32_bf16 v[24:27], a[92:95], v[92:95], v[24:27]
    s_add_u32 s18, s18, 4096
    v_mul_f32 v245, v245, v17
    v_mul_f32 v246, v246, v18
    v_mul_f32 v247, v247, v19
    v_mfma_f32_16x16x32_bf16 v[28:31], a[92:95], v[96:99], v[28:31]
    buffer_load_dwordx4 a[248:251], v6, s[28:31], s18 offen offset:0 sc1
    v_exp_f32 v244, v244
    v_mfma_f32_16x16x32_bf16 v[24:27], a[96:99], v[100:103], v[24:27]
    buffer_load_dwordx4 a[252:255], v6, s[28:31], s18 offen offset:1024 sc1
    v_exp_f32 v245, v245
    v_mfma_f32_16x16x32_bf16 v[28:31], a[96:99], v[104:107], v[28:31]
    buffer_load_dwordx4 a[0:3], v6, s[28:31], s18 offen offset:2048 sc1
    v_exp_f32 v246, v246
    v_mfma_f32_16x16x32_bf16 v[24:27], a[100:103], v[108:111], v[24:27]
    buffer_load_dwordx4 a[4:7], v6, s[28:31], s18 offen offset:3072 sc1
    v_exp_f32 v247, v247
    v_fma_f32 v244, v244, v197, v197
    v_mfma_f32_16x16x32_bf16 v[28:31], a[100:103], v[112:115], v[28:31]
    s_add_u32 s18, s18, 4096
    v_fma_f32 v245, v245, v197, v197
    v_fma_f32 v246, v246, v197, v197
    v_fma_f32 v247, v247, v197, v197
    v_mfma_f32_16x16x32_bf16 v[24:27], a[104:107], v[116:119], v[24:27]
    buffer_load_dwordx4 a[8:11], v6, s[28:31], s18 offen offset:0 sc1
    v_rcp_f32 v244, v244
    v_mfma_f32_16x16x32_bf16 v[28:31], a[104:107], v[120:123], v[28:31]
    buffer_load_dwordx4 a[12:15], v6, s[28:31], s18 offen offset:1024 sc1
    v_rcp_f32 v245, v245
    v_mfma_f32_16x16x32_bf16 v[24:27], a[108:111], v[124:127], v[24:27]
    buffer_load_dwordx4 a[16:19], v6, s[28:31], s18 offen offset:2048 sc1
    v_rcp_f32 v246, v246
    v_mfma_f32_16x16x32_bf16 v[28:31], a[108:111], v[128:131], v[28:31]
    buffer_load_dwordx4 a[20:23], v6, s[28:31], s18 offen offset:3072 sc1
    v_rcp_f32 v247, v247
    v_mul_f32 v244, v244, v16
    v_mfma_f32_16x16x32_bf16 v[24:27], a[112:115], v[132:135], v[24:27]
    s_add_u32 s18, s18, 4096
    v_mul_f32 v245, v245, v17
    v_mul_f32 v246, v246, v18
    v_mul_f32 v247, v247, v19
    v_cvt_pk_bf16_f32 v232, v244, v245
    v_mfma_f32_16x16x32_bf16 v[28:31], a[112:115], v[136:139], v[28:31]
    buffer_load_dwordx4 a[24:27], v6, s[28:31], s18 offen offset:0 sc1
    v_cvt_pk_bf16_f32 v233, v246, v247
    v_fmac_f32 v20, v200, v220
    v_mfma_f32_16x16x32_bf16 v[24:27], a[116:119], v[140:143], v[24:27]
    buffer_load_dwordx4 a[28:31], v6, s[28:31], s18 offen offset:1024 sc1
    v_fmac_f32 v21, v200, v221
    v_fmac_f32 v22, v200, v222
    v_mfma_f32_16x16x32_bf16 v[28:31], a[116:119], v[144:147], v[28:31]
    buffer_load_dwordx4 a[32:35], v6, s[28:31], s18 offen offset:2048 sc1
    v_fmac_f32 v23, v200, v223
    v_mul_f32 v248, v20, v20
    v_mfma_f32_16x16x32_bf16 v[24:27], a[120:123], v[148:151], v[24:27]
    buffer_load_dwordx4 a[36:39], v6, s[28:31], s18 offen offset:3072 sc1
    v_mul_f32 v249, v21, v21
    v_mul_f32 v250, v22, v22
    v_mfma_f32_16x16x32_bf16 v[28:31], a[120:123], v[152:155], v[28:31]
    s_add_u32 s18, s18, 4096
    v_mul_f32 v251, v23, v23
    v_fma_f32 v248, v248, v203, v202
    v_fma_f32 v249, v249, v203, v202
    v_fma_f32 v250, v250, v203, v202
    v_mfma_f32_16x16x32_bf16 v[24:27], a[124:127], v[156:159], v[24:27]
    buffer_load_dwordx4 a[40:43], v6, s[28:31], s18 offen offset:0 sc1
    v_fma_f32 v251, v251, v203, v202
    v_mul_f32 v248, v248, v20
    v_mfma_f32_16x16x32_bf16 v[28:31], a[124:127], v[160:163], v[28:31]
    s_waitcnt vmcnt(42)
    buffer_load_dwordx4 a[44:47], v6, s[28:31], s18 offen offset:1024 sc1
    v_mul_f32 v249, v249, v21
    v_mul_f32 v250, v250, v22
    v_mfma_f32_16x16x32_bf16 v[24:27], a[128:131], v[164:167], v[24:27]
    buffer_load_dwordx4 a[48:51], v6, s[28:31], s18 offen offset:2048 sc1
    v_mul_f32 v251, v251, v23
    v_mfma_f32_16x16x32_bf16 v[28:31], a[128:131], v[168:171], v[28:31]
    s_waitcnt vmcnt(43)
    buffer_load_dwordx4 a[52:55], v6, s[28:31], s18 offen offset:3072 sc1
    v_exp_f32 v248, v248
    v_mfma_f32_16x16x32_bf16 v[24:27], a[132:135], v[172:175], v[24:27]
    s_add_u32 s18, s18, 4096
    v_exp_f32 v249, v249
    v_exp_f32 v250, v250
    v_mfma_f32_16x16x32_bf16 v[28:31], a[132:135], v[176:179], v[28:31]
    s_waitcnt vmcnt(43)
    buffer_load_dwordx4 a[56:59], v6, s[28:31], s18 offen offset:0 sc1
    v_exp_f32 v251, v251
    v_fma_f32 v248, v248, v201, v201
    v_mfma_f32_16x16x32_bf16 v[24:27], a[136:139], v[180:183], v[24:27]
    buffer_load_dwordx4 a[60:63], v6, s[28:31], s18 offen offset:1024 sc1
    v_fma_f32 v249, v249, v201, v201
    v_mfma_f32_16x16x32_bf16 v[28:31], a[136:139], v[184:187], v[28:31]
    s_waitcnt vmcnt(44)
    buffer_load_dwordx4 a[64:67], v6, s[28:31], s18 offen offset:2048 sc1
    v_fma_f32 v250, v250, v201, v201
    v_fma_f32 v251, v251, v201, v201
    v_mfma_f32_16x16x32_bf16 v[24:27], a[140:143], v[188:191], v[24:27]
    buffer_load_dwordx4 a[68:71], v6, s[28:31], s18 offen offset:3072 sc1
    v_rcp_f32 v248, v248
    v_mfma_f32_16x16x32_bf16 v[28:31], a[140:143], v[192:195], v[28:31]
    s_add_u32 s18, s18, 4096
    v_rcp_f32 v249, v249
    v_rcp_f32 v250, v250
    s_waitcnt vmcnt(45)
    v_mfma_f32_16x16x32_bf16 v[32:35], a[144:147], v[52:55], 0
    v_rcp_f32 v251, v251
    v_mul_f32 v248, v248, v20
    v_mul_f32 v249, v249, v21
    v_mfma_f32_16x16x32_bf16 v[36:39], a[144:147], v[56:59], 0
    s_waitcnt vmcnt(44)
    v_mul_f32 v250, v250, v22
    v_mul_f32 v251, v251, v23
    v_cvt_pk_bf16_f32 v236, v248, v249
    v_cvt_pk_bf16_f32 v237, v250, v251
    v_mfma_f32_16x16x32_bf16 v[32:35], a[148:151], v[60:63], v[32:35]
    v_mfma_f32_16x16x32_bf16 v[36:39], a[148:151], v[64:67], v[36:39]
    s_waitcnt vmcnt(43)
    v_mfma_f32_16x16x32_bf16 v[32:35], a[152:155], v[68:71], v[32:35]
    v_fmac_f32 v24, v196, v224
    v_fmac_f32 v25, v196, v225
    v_mfma_f32_16x16x32_bf16 v[36:39], a[152:155], v[72:75], v[36:39]
    s_waitcnt vmcnt(42)
    v_fmac_f32 v26, v196, v226
    v_fmac_f32 v27, v196, v227
    v_mul_f32 v244, v24, v24
    v_mfma_f32_16x16x32_bf16 v[32:35], a[156:159], v[76:79], v[32:35]
    v_mul_f32 v245, v25, v25
    v_mul_f32 v246, v26, v26
    v_mul_f32 v247, v27, v27
    v_mfma_f32_16x16x32_bf16 v[36:39], a[156:159], v[80:83], v[36:39]
    s_waitcnt vmcnt(41)
    v_fma_f32 v244, v244, v199, v198
    v_fma_f32 v245, v245, v199, v198
    v_fma_f32 v246, v246, v199, v198
    v_mfma_f32_16x16x32_bf16 v[32:35], a[160:163], v[84:87], v[32:35]
    v_fma_f32 v247, v247, v199, v198
    v_mul_f32 v244, v244, v24
    v_mfma_f32_16x16x32_bf16 v[36:39], a[160:163], v[88:91], v[36:39]
    s_waitcnt vmcnt(40)
    v_mul_f32 v245, v245, v25
    v_mul_f32 v246, v246, v26
    v_mul_f32 v247, v247, v27
    v_mfma_f32_16x16x32_bf16 v[32:35], a[164:167], v[92:95], v[32:35]
    v_exp_f32 v244, v244
    v_mfma_f32_16x16x32_bf16 v[36:39], a[164:167], v[96:99], v[36:39]
    s_waitcnt vmcnt(39)
    v_exp_f32 v245, v245
    v_exp_f32 v246, v246
    v_mfma_f32_16x16x32_bf16 v[32:35], a[168:171], v[100:103], v[32:35]
    v_exp_f32 v247, v247
    v_mfma_f32_16x16x32_bf16 v[36:39], a[168:171], v[104:107], v[36:39]
    s_waitcnt vmcnt(38)
    v_fma_f32 v244, v244, v197, v197
    v_fma_f32 v245, v245, v197, v197
    v_fma_f32 v246, v246, v197, v197
    v_mfma_f32_16x16x32_bf16 v[32:35], a[172:175], v[108:111], v[32:35]
    v_fma_f32 v247, v247, v197, v197
    v_rcp_f32 v244, v244
    v_mfma_f32_16x16x32_bf16 v[36:39], a[172:175], v[112:115], v[36:39]
    s_waitcnt vmcnt(37)
    v_rcp_f32 v245, v245
    v_mfma_f32_16x16x32_bf16 v[32:35], a[176:179], v[116:119], v[32:35]
    v_rcp_f32 v246, v246
    v_rcp_f32 v247, v247
    v_mfma_f32_16x16x32_bf16 v[36:39], a[176:179], v[120:123], v[36:39]
    s_waitcnt vmcnt(36)
    v_mul_f32 v244, v244, v24
    v_mul_f32 v245, v245, v25
    v_mfma_f32_16x16x32_bf16 v[32:35], a[180:183], v[124:127], v[32:35]
    v_mul_f32 v246, v246, v26
    v_mul_f32 v247, v247, v27
    v_cvt_pk_bf16_f32 v234, v244, v245
    v_mfma_f32_16x16x32_bf16 v[36:39], a[180:183], v[128:131], v[36:39]
    s_waitcnt vmcnt(35)
    v_cvt_pk_bf16_f32 v235, v246, v247
    buffer_store_dwordx4 v[232:235], v6, s[28:31], s44 offen sc1
    v_mfma_f32_16x16x32_bf16 v[32:35], a[184:187], v[132:135], v[32:35]
    s_add_u32 s44, s44, 18432
    v_fmac_f32 v28, v200, v224
    v_fmac_f32 v29, v200, v225
    v_fmac_f32 v30, v200, v226
    v_mfma_f32_16x16x32_bf16 v[36:39], a[184:187], v[136:139], v[36:39]
    s_waitcnt vmcnt(35)
    v_fmac_f32 v31, v200, v227
    v_mul_f32 v248, v28, v28
    v_mfma_f32_16x16x32_bf16 v[32:35], a[188:191], v[140:143], v[32:35]
    v_mul_f32 v249, v29, v29
    v_mul_f32 v250, v30, v30
    v_mul_f32 v251, v31, v31
    v_mfma_f32_16x16x32_bf16 v[36:39], a[188:191], v[144:147], v[36:39]
    s_waitcnt vmcnt(34)
    v_fma_f32 v248, v248, v203, v202
    v_fma_f32 v249, v249, v203, v202
    v_fma_f32 v250, v250, v203, v202
    v_mfma_f32_16x16x32_bf16 v[32:35], a[192:195], v[148:151], v[32:35]
    v_fma_f32 v251, v251, v203, v202
    v_mul_f32 v248, v248, v28
    v_mul_f32 v249, v249, v29
    v_mfma_f32_16x16x32_bf16 v[36:39], a[192:195], v[152:155], v[36:39]
    s_waitcnt vmcnt(33)
    v_mul_f32 v250, v250, v30
    v_mul_f32 v251, v251, v31
    v_mfma_f32_16x16x32_bf16 v[32:35], a[196:199], v[156:159], v[32:35]
    v_exp_f32 v248, v248
    v_mfma_f32_16x16x32_bf16 v[36:39], a[196:199], v[160:163], v[36:39]
    s_waitcnt vmcnt(32)
    v_exp_f32 v249, v249
    v_exp_f32 v250, v250
    v_mfma_f32_16x16x32_bf16 v[32:35], a[200:203], v[164:167], v[32:35]
    v_exp_f32 v251, v251
    v_fma_f32 v248, v248, v201, v201
    v_mfma_f32_16x16x32_bf16 v[36:39], a[200:203], v[168:171], v[36:39]
    s_waitcnt vmcnt(31)
    v_fma_f32 v249, v249, v201, v201
    v_fma_f32 v250, v250, v201, v201
    v_mfma_f32_16x16x32_bf16 v[32:35], a[204:207], v[172:175], v[32:35]
    v_fma_f32 v251, v251, v201, v201
    v_rcp_f32 v248, v248
    v_mfma_f32_16x16x32_bf16 v[36:39], a[204:207], v[176:179], v[36:39]
    s_waitcnt vmcnt(30)
    v_rcp_f32 v249, v249
    v_mfma_f32_16x16x32_bf16 v[32:35], a[208:211], v[180:183], v[32:35]
    v_rcp_f32 v250, v250
    v_rcp_f32 v251, v251
    v_mfma_f32_16x16x32_bf16 v[36:39], a[208:211], v[184:187], v[36:39]
    s_waitcnt vmcnt(29)
    v_mul_f32 v248, v248, v28
    v_mul_f32 v249, v249, v29
    v_mul_f32 v250, v250, v30
    v_mfma_f32_16x16x32_bf16 v[32:35], a[212:215], v[188:191], v[32:35]
    v_mul_f32 v251, v251, v31
    v_cvt_pk_bf16_f32 v238, v248, v249
    v_mfma_f32_16x16x32_bf16 v[36:39], a[212:215], v[192:195], v[36:39]
    v_cvt_pk_bf16_f32 v239, v250, v251
    buffer_store_dwordx4 v[236:239], v6, s[28:31], s44 offen sc1
    s_nop 2
    v_fmac_f32 v32, v196, v228
    v_fmac_f32 v33, v196, v229
    v_fmac_f32 v34, v196, v230
    v_fmac_f32 v35, v196, v231
    v_mul_f32 v244, v32, v32
    v_mul_f32 v245, v33, v33
    v_mul_f32 v246, v34, v34
    v_mul_f32 v247, v35, v35
    v_fma_f32 v244, v244, v199, v198
    v_fma_f32 v245, v245, v199, v198
    v_fma_f32 v246, v246, v199, v198
    v_fma_f32 v247, v247, v199, v198
    v_mul_f32 v244, v244, v32
    v_mul_f32 v245, v245, v33
    v_mul_f32 v246, v246, v34
    v_mul_f32 v247, v247, v35
    v_exp_f32 v244, v244
    v_exp_f32 v245, v245
    v_exp_f32 v246, v246
    v_exp_f32 v247, v247
    v_fma_f32 v244, v244, v197, v197
    v_fma_f32 v245, v245, v197, v197
    v_fma_f32 v246, v246, v197, v197
    v_fma_f32 v247, v247, v197, v197
    v_rcp_f32 v244, v244
    v_rcp_f32 v245, v245
    v_rcp_f32 v246, v246
    v_rcp_f32 v247, v247
    v_mul_f32 v244, v244, v32
    v_mul_f32 v245, v245, v33
    v_mul_f32 v246, v246, v34
    v_mul_f32 v247, v247, v35
    v_cvt_pk_bf16_f32 v240, v244, v245
    v_cvt_pk_bf16_f32 v241, v246, v247
    v_fmac_f32 v36, v200, v228
    v_fmac_f32 v37, v200, v229
    v_fmac_f32 v38, v200, v230
    v_fmac_f32 v39, v200, v231
    v_mul_f32 v248, v36, v36
    v_mul_f32 v249, v37, v37
    v_mul_f32 v250, v38, v38
    v_mul_f32 v251, v39, v39
    v_fma_f32 v248, v248, v203, v202
    v_fma_f32 v249, v249, v203, v202
    v_fma_f32 v250, v250, v203, v202
    v_fma_f32 v251, v251, v203, v202
    v_mul_f32 v248, v248, v36
    v_mul_f32 v249, v249, v37
    v_mul_f32 v250, v250, v38
    v_mul_f32 v251, v251, v39
    v_exp_f32 v248, v248
    v_exp_f32 v249, v249
    v_exp_f32 v250, v250
    v_exp_f32 v251, v251
    v_fma_f32 v248, v248, v201, v201
    v_fma_f32 v249, v249, v201, v201
    v_fma_f32 v250, v250, v201, v201
    v_fma_f32 v251, v251, v201, v201
    v_rcp_f32 v248, v248
    v_rcp_f32 v249, v249
    v_rcp_f32 v250, v250
    v_rcp_f32 v251, v251
    v_mul_f32 v248, v248, v36
    v_mul_f32 v249, v249, v37
    v_mul_f32 v250, v250, v38
    v_mul_f32 v251, v251, v39
    v_cvt_pk_bf16_f32 v242, v248, v249
    v_cvt_pk_bf16_f32 v243, v250, v251
    s_nop 0
    v_permlane16_swap_b32 v240, v242
    v_permlane16_swap_b32 v241, v243
    buffer_store_dwordx4 v[240:243], v219, s[28:31], s45 offen sc1
    s_add_u32 s36, s5, s34
    s_lshl_b32 s36, s36, 4
    s_add_u32 s37, s35, 1
    v_add_u32 v3, s36, v13
    v_subrev_u32 v7, s37, v3
    v_add_u32 v8, s37, v3
    v_mov_b32 v9, 2147483632
    v_lshrrev_b32 v10, 4, v7
    v_mul_u32_u24 v10, 18432, v10
    v_and_b32 v11, 15, v7
    v_lshl_add_u32 v10, v11, 4, v10
    v_lshl_add_u32 v10, v5, 8, v10
    v_cmp_gt_u32 vcc, 2048, v7
    s_nop 1
    v_cndmask_b32 v7, v9, v10, vcc
    v_lshrrev_b32 v10, 4, v8
    v_mul_u32_u24 v10, 18432, v10
    v_and_b32 v11, 15, v8
    v_lshl_add_u32 v10, v11, 4, v10
    v_lshl_add_u32 v10, v5, 8, v10
    v_cmp_gt_u32 vcc, 2048, v8
    s_nop 1
    v_cndmask_b32 v8, v9, v10, vcc
    v_cmp_gt_u32 vcc, 2, v5
    s_nop 1
    v_cndmask_b32 v9, v8, v7, vcc
    s_mul_i32 s32, s13, 663552
    s_mul_i32 s33, s3, 165888
    s_add_u32 s33, s33, s32
    s_add_u32 s33, s33, 24182784
    s_mul_i32 s37, s3, 55296
    s_add_u32 s37, s37, s32
    s_add_u32 s20, s37, 18874368
    s_mul_i32 s37, s3, 55296
    s_add_u32 s37, s37, s32
    s_add_u32 s21, s37, 19095552
    s_mul_i32 s37, s3, 55296
    s_add_u32 s37, s37, s32
    s_add_u32 s22, s37, 19316736
    v_bfe_u32 v10, v2, 2, 2
    v_add_u32 v11, s16, v10
    v_subrev_u32 v11, 1, v11
    v_cmp_gt_u32 vcc, 64, v11
    s_nop 0
    s_and_b64 s[36:37], vcc, 0xfff
    v_lshlrev_b32 v11, 2, v11
    v_and_b32 v15, 3, v2
    v_add_u32 v11, v11, v15
    v_lshlrev_b32 v11, 7, v11
    v_sub_u32 v10, 2, v10
    v_lshl_add_u32 v11, v10, 4, v11
    s_lshl_b32 s38, s4, 2
    s_add_u32 s38, s38, 0
    v_add_u32 v249, s38, v11
    v_mov_b32 v244, 1
    v_lshlrev_b32 v250, 4, v2
    s_mov_b64 s[38:39], s[36:37]
    s_mul_i32 s36, s35, 9216
    s_mul_i32 s37, s34, 18432
    s_add_u32 s37, s37, s36
    s_add_u32 s36, s36, 13238272
    s_mov_b32 m0, s37
    s_waitcnt vmcnt(0)
    s_barrier
    s_cmp_lg_u32 s3, 0
    s_cbranch_scc1 t_go_24
    s_mov_b32 s58, 163840
    s_mov_b64 exec, s[38:39]
    buffer_store_dword v244, v249, s[28:31], s58 offen sc1
    s_mov_b64 exec, -1
t_go_24:
    buffer_load_dwordx4 a[72:75], v6, s[28:31], s18 offen offset:0 sc1
    buffer_load_dwordx4 a[76:79], v6, s[28:31], s18 offen offset:1024 sc1
    buffer_load_dwordx4 a[80:83], v6, s[28:31], s18 offen offset:2048 sc1
    buffer_load_dwordx4 a[84:87], v6, s[28:31], s18 offen offset:3072 sc1
    s_add_u32 s18, s18, 4096
    buffer_load_dwordx4 a[88:91], v6, s[28:31], s18 offen offset:0 sc1
    buffer_load_dwordx4 a[92:95], v6, s[28:31], s18 offen offset:1024 sc1
    buffer_load_dwordx4 a[96:99], v6, s[28:31], s18 offen offset:2048 sc1
    buffer_load_dwordx4 a[100:103], v6, s[28:31], s18 offen offset:3072 sc1
    s_add_u32 s18, s18, 4096
    buffer_load_dwordx4 a[104:107], v6, s[28:31], s18 offen offset:0 sc1
    buffer_load_dwordx4 a[108:111], v6, s[28:31], s18 offen offset:1024 sc1
    buffer_load_dwordx4 a[112:115], v6, s[28:31], s18 offen offset:2048 sc1
    buffer_load_dwordx4 a[116:119], v6, s[28:31], s18 offen offset:3072 sc1
    s_add_u32 s18, s18, 4096
    buffer_load_dwordx4 a[120:123], v6, s[28:31], s18 offen offset:0 sc1
    buffer_load_dwordx4 a[124:127], v6, s[28:31], s18 offen offset:1024 sc1
    s_cmp_lg_u32 s3, 0
    s_cbranch_scc1 t_go_24_w
    v_lshrrev_b32 v247, 2, v250
    v_add_u32 v247, 0, v247
    s_mov_b64 exec, s[38:39]
    s_mov_b32 s58, 0
poll_25:
    buffer_load_dword v246, v247, s[28:31], s60 offen sc1
    s_add_u32 s58, s58, 1
    s_waitcnt vmcnt(0)
    v_cmp_gt_u32 vcc, 1, v246
    s_cmp_gt_u32 s58, 0x40000
    s_cbranch_scc1 poll_25_done
    s_nop 3
    s_cbranch_vccnz poll_25
poll_25_done:
    s_mov_b64 exec, -1
t_go_24_w:
    s_barrier
    buffer_load_dwordx4 v7, s[28:31], s36 offen sc1 lds
    s_add_u32 m0, m0, 1024
    s_add_u32 s36, s36, 1024
    buffer_load_dwordx4 v7, s[28:31], s36 offen sc1 lds
    s_add_u32 m0, m0, 1024
    s_add_u32 s36, s36, 1024
    buffer_load_dwordx4 v7, s[28:31], s36 offen sc1 lds
    s_add_u32 m0, m0, 1024
    s_add_u32 s36, s36, 1024
    buffer_load_dwordx4 v7, s[28:31], s36 offen sc1 lds
    s_add_u32 m0, m0, 1024
    s_add_u32 s36, s36, 1024
    buffer_load_dwordx4 v9, s[28:31], s36 offen sc1 lds
    s_add_u32 m0, m0, 1024
    s_add_u32 s36, s36, 1024
    buffer_load_dwordx4 v8, s[28:31], s36 offen sc1 lds
    s_add_u32 m0, m0, 1024
    s_add_u32 s36, s36, 1024
    buffer_load_dwordx4 v8, s[28:31], s36 offen sc1 lds
    s_add_u32 m0, m0, 1024
    s_add_u32 s36, s36, 1024
    buffer_load_dwordx4 v8, s[28:31], s36 offen sc1 lds
    s_add_u32 m0, m0, 1024
    s_add_u32 s36, s36, 1024
    buffer_load_dwordx4 v8, s[28:31], s36 offen sc1 lds
    s_add_u32 s44, s40, 36864
    s_add_u32 s45, s41, 36864
    v_add_u32 v3, s44, v6
    v_lshrrev_b32 v4, 1, v5
    v_lshlrev_b32 v4, 8, v4
    v_lshl_add_u32 v4, v13, 4, v4
    v_and_b32 v10, 1, v5
    v_lshl_add_u32 v4, v10, 3, v4
    v_add_u32 v4, s45, v4
    ds_read_b128 v[200:203], v3 offset:0
    ds_read_b64 v[208:209], v4 offset:0
    ds_read_b128 v[204:207], v3 offset:18432
    ds_read_b64 v[210:211], v4 offset:18432
    s_add_u32 s44, s40, s43
    s_add_u32 s45, s41, s43
    s_add_u32 s44, s44, 15597568
    s_add_u32 s45, s45, 15597568
    s_mov_b32 s38, 0x3f803f80
    v_lshlrev_b32 v3, 3, v2
    v_mov_b32 v4, 2147483632
    v_cmp_gt_u32 vcc, 2, v5
    s_nop 1
    v_cndmask_b32 v3, v4, v3, vcc
    s_mul_i32 s36, s16, 3072
    s_lshl_b32 s37, s15, 8
    s_add_u32 s36, s36, s37
    s_add_u32 s36, s36, 17956864
    v_mov_b32 v40, 0
    v_mov_b32 v41, 0
    v_mov_b32 v42, 0
    v_mov_b32 v43, 0
    s_waitcnt vmcnt(0)
    s_barrier
    ds_read_b128 v[52:55], v6 offset:0
    ds_read_b128 v[56:59], v6 offset:18432
    ds_read_b128 v[60:63], v6 offset:1024
    ds_read_b128 v[64:67], v6 offset:19456
    ds_read_b128 v[68:71], v6 offset:2048
    ds_read_b128 v[72:75], v6 offset:20480
    s_waitcnt lgkmcnt(5)
    v_mfma_f32_16x16x32_bf16 v[16:19], a[216:219], v[52:55], 0
    s_waitcnt lgkmcnt(4)
    ds_read_b128 v[76:79], v6 offset:3072
    buffer_load_dwordx4 a[128:131], v6, s[28:31], s18 offen offset:2048 sc1
    v_mfma_f32_16x16x32_bf16 v[20:23], a[216:219], v[56:59], 0
    s_waitcnt lgkmcnt(4)
    ds_read_b128 v[80:83], v6 offset:21504
    v_mfma_f32_16x16x32_bf16 v[16:19], a[220:223], v[60:63], v[16:19]
    s_waitcnt lgkmcnt(4)
    ds_read_b128 v[84:87], v6 offset:4096
    buffer_load_dwordx4 a[132:135], v6, s[28:31], s18 offen offset:3072 sc1
    v_mfma_f32_16x16x32_bf16 v[20:23], a[220:223], v[64:67], v[20:23]
    s_add_u32 s18, s18, 4096
    ds_read_b128 v[88:91], v6 offset:22528
    s_waitcnt lgkmcnt(5)
    v_mfma_f32_16x16x32_bf16 v[16:19], a[224:227], v[68:71], v[16:19]
    s_waitcnt lgkmcnt(4)
    ds_read_b128 v[92:95], v6 offset:5120
    v_mfma_f32_16x16x32_bf16 v[20:23], a[224:227], v[72:75], v[20:23]
    s_waitcnt lgkmcnt(4)
    ds_read_b128 v[96:99], v6 offset:23552
    buffer_load_dwordx4 a[136:139], v6, s[28:31], s18 offen offset:0 sc1
    v_mfma_f32_16x16x32_bf16 v[16:19], a[228:231], v[76:79], v[16:19]
    s_waitcnt lgkmcnt(4)
    ds_read_b128 v[100:103], v6 offset:6144
    v_mfma_f32_16x16x32_bf16 v[20:23], a[228:231], v[80:83], v[20:23]
    s_waitcnt lgkmcnt(4)
    ds_read_b128 v[104:107], v6 offset:24576
    v_mfma_f32_16x16x32_bf16 v[16:19], a[232:235], v[84:87], v[16:19]
    s_waitcnt lgkmcnt(4)
    ds_read_b128 v[108:111], v6 offset:7168
    buffer_load_dwordx4 a[140:143], v6, s[28:31], s18 offen offset:1024 sc1
    v_mfma_f32_16x16x32_bf16 v[20:23], a[232:235], v[88:91], v[20:23]
    s_waitcnt lgkmcnt(4)
    ds_read_b128 v[112:115], v6 offset:25600
    v_mfma_f32_16x16x32_bf16 v[16:19], a[236:239], v[92:95], v[16:19]
    s_waitcnt lgkmcnt(4)
    ds_read_b128 v[116:119], v6 offset:8192
    v_mfma_f32_16x16x32_bf16 v[20:23], a[236:239], v[96:99], v[20:23]
    s_waitcnt lgkmcnt(4)
    ds_read_b128 v[120:123], v6 offset:26624
    buffer_load_dwordx4 a[144:147], v6, s[28:31], s18 offen offset:2048 sc1
    v_mfma_f32_16x16x32_bf16 v[16:19], a[240:243], v[100:103], v[16:19]
    s_waitcnt lgkmcnt(4)
    ds_read_b128 v[124:127], v6 offset:9216
    v_mfma_f32_16x16x32_bf16 v[20:23], a[240:243], v[104:107], v[20:23]
    s_waitcnt lgkmcnt(4)
    ds_read_b128 v[128:131], v6 offset:27648
    v_mfma_f32_16x16x32_bf16 v[16:19], a[244:247], v[108:111], v[16:19]
    s_waitcnt lgkmcnt(4)
    ds_read_b128 v[132:135], v6 offset:10240
    buffer_load_dwordx4 a[148:151], v6, s[28:31], s18 offen offset:3072 sc1
    v_mfma_f32_16x16x32_bf16 v[20:23], a[244:247], v[112:115], v[20:23]
    s_add_u32 s18, s18, 4096
    ds_read_b128 v[136:139], v6 offset:28672
    s_waitcnt lgkmcnt(5)
    v_mfma_f32_16x16x32_bf16 v[16:19], a[248:251], v[116:119], v[16:19]
    s_waitcnt lgkmcnt(4)
    ds_read_b128 v[140:143], v6 offset:11264
    v_mfma_f32_16x16x32_bf16 v[20:23], a[248:251], v[120:123], v[20:23]
    s_waitcnt lgkmcnt(4)
    ds_read_b128 v[144:147], v6 offset:29696
    buffer_load_dwordx4 a[152:155], v6, s[28:31], s18 offen offset:0 sc1
    v_mfma_f32_16x16x32_bf16 v[16:19], a[252:255], v[124:127], v[16:19]
    s_waitcnt lgkmcnt(4)
    ds_read_b128 v[148:151], v6 offset:12288
    v_mfma_f32_16x16x32_bf16 v[20:23], a[252:255], v[128:131], v[20:23]
    s_waitcnt lgkmcnt(4)
    ds_read_b128 v[152:155], v6 offset:30720
    buffer_load_dwordx4 a[156:159], v6, s[28:31], s18 offen offset:1024 sc1
    v_mfma_f32_16x16x32_bf16 v[16:19], a[0:3], v[132:135], v[16:19]
    s_waitcnt lgkmcnt(4)
    ds_read_b128 v[156:159], v6 offset:13312
    v_mfma_f32_16x16x32_bf16 v[20:23], a[0:3], v[136:139], v[20:23]
    s_waitcnt lgkmcnt(4)
    ds_read_b128 v[160:163], v6 offset:31744
    v_mfma_f32_16x16x32_bf16 v[16:19], a[4:7], v[140:143], v[16:19]
    s_waitcnt lgkmcnt(4)
    ds_read_b128 v[164:167], v6 offset:14336
    buffer_load_dwordx4 a[160:163], v6, s[28:31], s18 offen offset:2048 sc1
    v_mfma_f32_16x16x32_bf16 v[20:23], a[4:7], v[144:147], v[20:23]
    s_waitcnt lgkmcnt(4)
    ds_read_b128 v[168:171], v6 offset:32768
    v_mfma_f32_16x16x32_bf16 v[16:19], a[8:11], v[148:151], v[16:19]
    s_waitcnt lgkmcnt(4)
    ds_read_b128 v[172:175], v6 offset:15360
    v_mfma_f32_16x16x32_bf16 v[20:23], a[8:11], v[152:155], v[20:23]
    s_waitcnt lgkmcnt(4)
    ds_read_b128 v[176:179], v6 offset:33792
    buffer_load_dwordx4 a[164:167], v6, s[28:31], s18 offen offset:3072 sc1
    v_mfma_f32_16x16x32_bf16 v[16:19], a[12:15], v[156:159], v[16:19]
    s_add_u32 s18, s18, 4096
    ds_read_b128 v[180:183], v6 offset:16384
    s_waitcnt lgkmcnt(5)
    v_mfma_f32_16x16x32_bf16 v[20:23], a[12:15], v[160:163], v[20:23]
    s_waitcnt lgkmcnt(4)
    ds_read_b128 v[184:187], v6 offset:34816
    v_mfma_f32_16x16x32_bf16 v[16:19], a[16:19], v[164:167], v[16:19]
    s_waitcnt lgkmcnt(4)
    ds_read_b128 v[188:191], v6 offset:17408
    buffer_load_dwordx4 a[168:171], v6, s[28:31], s18 offen offset:0 sc1
    v_mfma_f32_16x16x32_bf16 v[20:23], a[16:19], v[168:171], v[20:23]
    s_waitcnt lgkmcnt(4)
    ds_read_b128 v[192:195], v6 offset:35840
    v_mfma_f32_16x16x32_bf16 v[16:19], a[20:23], v[172:175], v[16:19]
    s_waitcnt lgkmcnt(4)
    v_mfma_f32_16x16x32_bf16 v[20:23], a[20:23], v[176:179], v[20:23]
    s_waitcnt lgkmcnt(3)
    buffer_load_dwordx4 a[172:175], v6, s[28:31], s18 offen offset:1024 sc1
    v_mfma_f32_16x16x32_bf16 v[16:19], a[24:27], v[180:183], v[16:19]
    s_waitcnt lgkmcnt(2)
    v_mfma_f32_16x16x32_bf16 v[20:23], a[24:27], v[184:187], v[20:23]
    s_waitcnt lgkmcnt(1)
    v_mfma_f32_16x16x32_bf16 v[16:19], a[28:31], v[188:191], v[16:19]
    s_waitcnt lgkmcnt(0)
    v_mfma_f32_16x16x32_bf16 v[20:23], a[28:31], v[192:195], v[20:23]
    v_mfma_f32_16x16x32_bf16 v[24:27], a[32:35], v[52:55], 0
    v_mfma_f32_16x16x32_bf16 v[28:31], a[32:35], v[56:59], 0
    v_mfma_f32_16x16x32_bf16 v[24:27], a[36:39], v[60:63], v[24:27]
    buffer_load_dwordx4 a[0:3], v6, s[28:31], s20 offen offset:0 sc1
    v_mfma_f32_16x16x32_bf16 v[28:31], a[36:39], v[64:67], v[28:31]
    v_mfma_f32_16x16x32_bf16 v[24:27], a[40:43], v[68:71], v[24:27]
    v_lshlrev_b32 v220, 16, v200
    v_mfma_f32_16x16x32_bf16 v[28:31], a[40:43], v[72:75], v[28:31]
    v_and_b32 v221, 0xffff0000, v200
    v_mfma_f32_16x16x32_bf16 v[24:27], a[44:47], v[76:79], v[24:27]
    buffer_load_dwordx4 a[4:7], v6, s[28:31], s20 offen offset:1024 sc1
    v_mfma_f32_16x16x32_bf16 v[28:31], a[44:47], v[80:83], v[28:31]
    v_lshlrev_b32 v222, 16, v201
    v_mfma_f32_16x16x32_bf16 v[24:27], a[48:51], v[84:87], v[24:27]
    v_and_b32 v223, 0xffff0000, v201
    v_add_f32 v220, v220, v16
    v_mfma_f32_16x16x32_bf16 v[28:31], a[48:51], v[88:91], v[28:31]
    v_add_f32 v221, v221, v17
    v_mfma_f32_16x16x32_bf16 v[24:27], a[52:55], v[92:95], v[24:27]
    buffer_load_dwordx4 a[8:11], v6, s[28:31], s20 offen offset:2048 sc1
    v_mfma_f32_16x16x32_bf16 v[28:31], a[52:55], v[96:99], v[28:31]
    v_add_f32 v222, v222, v18
    v_mfma_f32_16x16x32_bf16 v[24:27], a[56:59], v[100:103], v[24:27]
    v_add_f32 v223, v223, v19
    v_mfma_f32_16x16x32_bf16 v[28:31], a[56:59], v[104:107], v[28:31]
    v_cvt_pk_bf16_f32 v200, v220, v221
    v_mfma_f32_16x16x32_bf16 v[24:27], a[60:63], v[108:111], v[24:27]
    buffer_load_dwordx4 a[12:15], v6, s[28:31], s20 offen offset:3072 sc1
    v_mfma_f32_16x16x32_bf16 v[28:31], a[60:63], v[112:115], v[28:31]
    s_add_u32 s20, s20, 4096
    v_cvt_pk_bf16_f32 v201, v222, v223
    v_mfma_f32_16x16x32_bf16 v[24:27], a[64:67], v[116:119], v[24:27]
    v_dot2c_f32_bf16 v40, s38, v200
    v_mfma_f32_16x16x32_bf16 v[28:31], a[64:67], v[120:123], v[28:31]
    v_dot2c_f32_bf16 v41, v200, v200
    v_mfma_f32_16x16x32_bf16 v[24:27], a[68:71], v[124:127], v[24:27]
    buffer_load_dwordx4 a[16:19], v6, s[28:31], s20 offen offset:0 sc1
    v_mfma_f32_16x16x32_bf16 v[28:31], a[68:71], v[128:131], v[28:31]
    v_dot2c_f32_bf16 v40, s38, v201
    v_mfma_f32_16x16x32_bf16 v[24:27], a[72:75], v[132:135], v[24:27]
    v_dot2c_f32_bf16 v41, v201, v201
    v_lshlrev_b32 v224, 16, v204
    v_mfma_f32_16x16x32_bf16 v[28:31], a[72:75], v[136:139], v[28:31]
    v_and_b32 v225, 0xffff0000, v204
    v_mfma_f32_16x16x32_bf16 v[24:27], a[76:79], v[140:143], v[24:27]
    buffer_load_dwordx4 a[20:23], v6, s[28:31], s20 offen offset:1024 sc1
    v_mfma_f32_16x16x32_bf16 v[28:31], a[76:79], v[144:147], v[28:31]
    v_lshlrev_b32 v226, 16, v205
    v_mfma_f32_16x16x32_bf16 v[24:27], a[80:83], v[148:151], v[24:27]
    v_and_b32 v227, 0xffff0000, v205
    v_mfma_f32_16x16x32_bf16 v[28:31], a[80:83], v[152:155], v[28:31]
    v_add_f32 v224, v224, v20
    v_mfma_f32_16x16x32_bf16 v[24:27], a[84:87], v[156:159], v[24:27]
    buffer_load_dwordx4 a[24:27], v6, s[28:31], s20 offen offset:2048 sc1
    v_mfma_f32_16x16x32_bf16 v[28:31], a[84:87], v[160:163], v[28:31]
    v_add_f32 v225, v225, v21
    v_mfma_f32_16x16x32_bf16 v[24:27], a[88:91], v[164:167], v[24:27]
    v_add_f32 v226, v226, v22
    v_mfma_f32_16x16x32_bf16 v[28:31], a[88:91], v[168:171], v[28:31]
    v_add_f32 v227, v227, v23
    v_mfma_f32_16x16x32_bf16 v[24:27], a[92:95], v[172:175], v[24:27]
    buffer_load_dwordx4 a[28:31], v6, s[28:31], s20 offen offset:3072 sc1
    v_mfma_f32_16x16x32_bf16 v[28:31], a[92:95], v[176:179], v[28:31]
    s_add_u32 s20, s20, 4096
    v_cvt_pk_bf16_f32 v204, v224, v225
    v_cvt_pk_bf16_f32 v205, v226, v227
    v_mfma_f32_16x16x32_bf16 v[24:27], a[96:99], v[180:183], v[24:27]
    v_dot2c_f32_bf16 v42, s38, v204
    v_mfma_f32_16x16x32_bf16 v[28:31], a[96:99], v[184:187], v[28:31]
    v_dot2c_f32_bf16 v43, v204, v204
    v_mfma_f32_16x16x32_bf16 v[24:27], a[100:103], v[188:191], v[24:27]
    v_dot2c_f32_bf16 v42, s38, v205
    v_mfma_f32_16x16x32_bf16 v[28:31], a[100:103], v[192:195], v[28:31]
    v_dot2c_f32_bf16 v43, v205, v205
    v_mfma_f32_16x16x32_bf16 v[32:35], a[104:107], v[52:55], 0
    v_mfma_f32_16x16x32_bf16 v[36:39], a[104:107], v[56:59], 0
    buffer_load_dwordx4 a[32:35], v6, s[28:31], s20 offen offset:0 sc1
    v_mfma_f32_16x16x32_bf16 v[32:35], a[108:111], v[60:63], v[32:35]
    buffer_load_dwordx4 a[36:39], v6, s[28:31], s20 offen offset:1024 sc1
    v_mfma_f32_16x16x32_bf16 v[36:39], a[108:111], v[64:67], v[36:39]
    buffer_load_dwordx4 a[40:43], v6, s[28:31], s20 offen offset:2048 sc1
    v_mfma_f32_16x16x32_bf16 v[32:35], a[112:115], v[68:71], v[32:35]
    buffer_load_dwordx4 a[44:47], v6, s[28:31], s20 offen offset:3072 sc1
    v_mfma_f32_16x16x32_bf16 v[36:39], a[112:115], v[72:75], v[36:39]
    s_add_u32 s20, s20, 4096
    buffer_load_dwordx4 a[48:51], v6, s[28:31], s20 offen offset:0 sc1
    v_mfma_f32_16x16x32_bf16 v[32:35], a[116:119], v[76:79], v[32:35]
    buffer_load_dwordx4 a[52:55], v6, s[28:31], s20 offen offset:1024 sc1
    v_mfma_f32_16x16x32_bf16 v[36:39], a[116:119], v[80:83], v[36:39]
    buffer_load_dwordx4 a[56:59], v6, s[28:31], s20 offen offset:2048 sc1
    v_mfma_f32_16x16x32_bf16 v[32:35], a[120:123], v[84:87], v[32:35]
    buffer_load_dwordx4 a[60:63], v6, s[28:31], s20 offen offset:3072 sc1
    v_mfma_f32_16x16x32_bf16 v[36:39], a[120:123], v[88:91], v[36:39]
    s_add_u32 s20, s20, 4096
    buffer_load_dwordx4 a[64:67], v6, s[28:31], s20 offen offset:0 sc1
    v_mfma_f32_16x16x32_bf16 v[32:35], a[124:127], v[92:95], v[32:35]
    v_lshlrev_b32 v220, 16, v202
    v_mfma_f32_16x16x32_bf16 v[36:39], a[124:127], v[96:99], v[36:39]
    s_waitcnt vmcnt(28)
    v_and_b32 v221, 0xffff0000, v202
    v_mfma_f32_16x16x32_bf16 v[32:35], a[128:131], v[100:103], v[32:35]
    v_lshlrev_b32 v222, 16, v203
    v_and_b32 v223, 0xffff0000, v203
    v_mfma_f32_16x16x32_bf16 v[36:39], a[128:131], v[104:107], v[36:39]
    s_waitcnt vmcnt(27)
    v_add_f32 v220, v220, v24
    v_mfma_f32_16x16x32_bf16 v[32:35], a[132:135], v[108:111], v[32:35]
    v_add_f32 v221, v221, v25
    v_mfma_f32_16x16x32_bf16 v[36:39], a[132:135], v[112:115], v[36:39]
    s_waitcnt vmcnt(26)
    v_add_f32 v222, v222, v26
    v_mfma_f32_16x16x32_bf16 v[32:35], a[136:139], v[116:119], v[32:35]
    v_add_f32 v223, v223, v27
    v_cvt_pk_bf16_f32 v202, v220, v221
    v_mfma_f32_16x16x32_bf16 v[36:39], a[136:139], v[120:123], v[36:39]
    s_waitcnt vmcnt(25)
    v_cvt_pk_bf16_f32 v203, v222, v223
    v_mfma_f32_16x16x32_bf16 v[32:35], a[140:143], v[124:127], v[32:35]
    buffer_store_dwordx4 v[200:203], v6, s[28:31], s44 offen sc1
    v_mfma_f32_16x16x32_bf16 v[36:39], a[140:143], v[128:131], v[36:39]
    s_add_u32 s44, s44, 18432
    s_waitcnt vmcnt(25)
    v_mfma_f32_16x16x32_bf16 v[32:35], a[144:147], v[132:135], v[32:35]
    v_dot2c_f32_bf16 v40, s38, v202
    v_dot2c_f32_bf16 v41, v202, v202
    v_mfma_f32_16x16x32_bf16 v[36:39], a[144:147], v[136:139], v[36:39]
    s_waitcnt vmcnt(24)
    v_dot2c_f32_bf16 v40, s38, v203
    v_mfma_f32_16x16x32_bf16 v[32:35], a[148:151], v[140:143], v[32:35]
    v_dot2c_f32_bf16 v41, v203, v203
    v_mfma_f32_16x16x32_bf16 v[36:39], a[148:151], v[144:147], v[36:39]
    s_waitcnt vmcnt(23)
    v_lshlrev_b32 v224, 16, v206
    v_mfma_f32_16x16x32_bf16 v[32:35], a[152:155], v[148:151], v[32:35]
    v_and_b32 v225, 0xffff0000, v206
    v_mfma_f32_16x16x32_bf16 v[36:39], a[152:155], v[152:155], v[36:39]
    s_waitcnt vmcnt(22)
    v_lshlrev_b32 v226, 16, v207
    v_and_b32 v227, 0xffff0000, v207
    v_mfma_f32_16x16x32_bf16 v[32:35], a[156:159], v[156:159], v[32:35]
    v_add_f32 v224, v224, v28
    v_mfma_f32_16x16x32_bf16 v[36:39], a[156:159], v[160:163], v[36:39]
    s_waitcnt vmcnt(21)
    v_add_f32 v225, v225, v29
    v_mfma_f32_16x16x32_bf16 v[32:35], a[160:163], v[164:167], v[32:35]
    v_add_f32 v226, v226, v30
    v_mfma_f32_16x16x32_bf16 v[36:39], a[160:163], v[168:171], v[36:39]
    s_waitcnt vmcnt(20)
    v_add_f32 v227, v227, v31
    v_cvt_pk_bf16_f32 v206, v224, v225
    v_mfma_f32_16x16x32_bf16 v[32:35], a[164:167], v[172:175], v[32:35]
    v_cvt_pk_bf16_f32 v207, v226, v227
    v_mfma_f32_16x16x32_bf16 v[36:39], a[164:167], v[176:179], v[36:39]
    s_waitcnt vmcnt(19)
    buffer_store_dwordx4 v[204:207], v6, s[28:31], s44 offen sc1
    v_mfma_f32_16x16x32_bf16 v[32:35], a[168:171], v[180:183], v[32:35]
    v_mfma_f32_16x16x32_bf16 v[36:39], a[168:171], v[184:187], v[36:39]
    s_waitcnt vmcnt(19)
    v_dot2c_f32_bf16 v42, s38, v206
    v_mfma_f32_16x16x32_bf16 v[32:35], a[172:175], v[188:191], v[32:35]
    v_dot2c_f32_bf16 v43, v206, v206
    v_dot2c_f32_bf16 v42, s38, v207
    v_mfma_f32_16x16x32_bf16 v[36:39], a[172:175], v[192:195], v[36:39]
    v_dot2c_f32_bf16 v43, v207, v207
    v_lshlrev_b32 v220, 16, v208
    v_and_b32 v221, 0xffff0000, v208
    v_lshlrev_b32 v222, 16, v209
    v_and_b32 v223, 0xffff0000, v209
    v_add_f32 v220, v220, v32
    v_add_f32 v221, v221, v33
    v_add_f32 v222, v222, v34
    v_add_f32 v223, v223, v35
    v_cvt_pk_bf16_f32 v208, v220, v221
    v_cvt_pk_bf16_f32 v209, v222, v223
    v_dot2c_f32_bf16 v40, s38, v208
    v_dot2c_f32_bf16 v41, v208, v208
    v_dot2c_f32_bf16 v40, s38, v209
    v_dot2c_f32_bf16 v41, v209, v209
    v_lshlrev_b32 v224, 16, v210
    v_and_b32 v225, 0xffff0000, v210
    v_lshlrev_b32 v226, 16, v211
    v_and_b32 v227, 0xffff0000, v211
    v_add_f32 v224, v224, v36
    v_add_f32 v225, v225, v37
    v_add_f32 v226, v226, v38
    v_add_f32 v227, v227, v39
    v_cvt_pk_bf16_f32 v210, v224, v225
    v_cvt_pk_bf16_f32 v211, v226, v227
    v_dot2c_f32_bf16 v42, s38, v210
    v_dot2c_f32_bf16 v43, v210, v210
    v_dot2c_f32_bf16 v42, s38, v211
    v_dot2c_f32_bf16 v43, v211, v211
    v_permlane16_swap_b32 v208, v210
    v_permlane16_swap_b32 v209, v211
    buffer_store_dwordx4 v[208:211], v219, s[28:31], s45 offen sc1
    v_mov_b32 v44, v40
    s_nop 1
    v_permlane16_swap_b32 v40, v44
    v_add_f32 v40, v40, v44
    v_mov_b32 v44, v40
    s_nop 1
    v_permlane32_swap_b32 v40, v44
    v_add_f32 v40, v40, v44
    v_mov_b32 v45, v41
    s_nop 1
    v_permlane16_swap_b32 v41, v45
    v_add_f32 v41, v41, v45
    v_mov_b32 v45, v41
    s_nop 1
    v_permlane32_swap_b32 v41, v45
    v_add_f32 v41, v41, v45
    v_mov_b32 v46, v42
    s_nop 1
    v_permlane16_swap_b32 v42, v46
    v_add_f32 v42, v42, v46
    v_mov_b32 v46, v42
    s_nop 1
    v_permlane32_swap_b32 v42, v46
    v_add_f32 v42, v42, v46
    v_mov_b32 v47, v43
    s_nop 1
    v_permlane16_swap_b32 v43, v47
    v_add_f32 v43, v43, v47
    v_mov_b32 v47, v43
    s_nop 1
    v_permlane32_swap_b32 v43, v47
    v_add_f32 v43, v43, v47
    v_cmp_eq_u32 vcc, 1, v5
    s_nop 1
    v_cndmask_b32 v40, v40, v42, vcc
    v_cndmask_b32 v41, v41, v43, vcc
    buffer_store_dwordx2 v[40:41], v3, s[28:31], s36 offen sc1
    s_waitcnt vmcnt(0)
    s_barrier
    buffer_load_dwordx4 a[68:71], v6, s[28:31], s20 offen offset:1024 sc1
    buffer_load_dwordx4 a[72:75], v6, s[28:31], s20 offen offset:2048 sc1
    buffer_load_dwordx4 a[76:79], v6, s[28:31], s20 offen offset:3072 sc1
    s_add_u32 s20, s20, 4096
    buffer_load_dwordx4 a[80:83], v6, s[28:31], s20 offen offset:0 sc1
    buffer_load_dwordx4 a[84:87], v6, s[28:31], s20 offen offset:1024 sc1
    buffer_load_dwordx4 a[88:91], v6, s[28:31], s20 offen offset:2048 sc1
    buffer_load_dwordx4 a[92:95], v6, s[28:31], s20 offen offset:3072 sc1
    s_add_u32 s20, s20, 4096
    buffer_load_dwordx4 a[96:99], v6, s[28:31], s20 offen offset:0 sc1
    buffer_load_dwordx4 a[100:103], v6, s[28:31], s20 offen offset:1024 sc1
    buffer_load_dwordx4 a[104:107], v6, s[28:31], s20 offen offset:2048 sc1
    buffer_load_dwordx4 a[108:111], v6, s[28:31], s20 offen offset:3072 sc1
    s_add_u32 s20, s20, 4096
    buffer_load_dwordx4 a[112:115], v6, s[28:31], s20 offen offset:0 sc1
    buffer_load_dwordx4 a[116:119], v6, s[28:31], s20 offen offset:1024 sc1
    buffer_load_dwordx4 a[120:123], v6, s[28:31], s20 offen offset:2048 sc1
    buffer_load_dwordx4 a[124:127], v6, s[28:31], s20 offen offset:3072 sc1
    s_add_u32 s20, s20, 4096
    buffer_load_dwordx4 a[128:131], v6, s[28:31], s20 offen offset:0 sc1
    buffer_load_dwordx4 a[132:135], v6, s[28:31], s20 offen offset:1024 sc1
    buffer_load_dwordx4 a[136:139], v6, s[28:31], s20 offen offset:2048 sc1
    buffer_load_dwordx4 a[140:143], v6, s[28:31], s20 offen offset:3072 sc1
    s_add_u32 s20, s20, 4096
    s_and_b32 s55, s4, 1
    s_lshl_b32 s56, s14, 1
    s_add_u32 s56, s56, s55
    s_lshl_b32 s6, s12, 2
    s_xor_b32 s7, s3, s56
    s_add_u32 s6, s6, s7
    s_mul_i32 s6, s6, 18432
    s_add_u32 s6, s6, 15597568
    s_mul_i32 s7, s3, 18432
    s_mov_b32 m0, s7
    v_mul_u32_u24 v3, 768, v5
    v_lshl_add_u32 v3, v13, 3, v3
    s_mul_i32 s34, s12, 6144
    s_add_u32 s34, s34, 17956864
    s_mul_i32 s35, s3, 3
    s_add_u32 s36, s35, 1
    s_lshr_b32 s36, s36, 1
    s_and_b32 s38, s3, 1
    s_add_u32 s37, s35, 2
    s_cmp_eq_u32 s38, 1
    s_cselect_b32 s37, s35, s37
    s_lshr_b32 s37, s37, 1
    s_lshl_b32 s39, s3, 12
    s_add_u32 s39, s39, 73728
    v_add_u32 v0, s39, v6
    s_lshl_b32 s39, s36, 12
    s_add_u32 s39, s39, 73728
    v_add_u32 v1, s39, v6
    s_lshl_b32 s39, s37, 12
    s_lshl_b32 s40, s38, 9
    s_add_u32 s39, s39, s40
    s_add_u32 s39, s39, 73728
    v_lshrrev_b32 v2, 1, v5
    v_lshlrev_b32 v2, 8, v2
    v_lshl_add_u32 v2, v13, 4, v2
    v_and_b32 v4, 1, v5
    v_xor_b32 v248, s55, v4
    v_mul_u32_u24 v248, 18432, v248
    v_add_u32 v248, v248, v2
    v_mul_u32_u24 v254, 18432, v4
    v_add_u32 v254, v254, v2
    v_lshl_add_u32 v2, v4, 3, v2
    v_add_u32 v2, s39, v2
    s_lshl_b32 s39, s3, 7
    s_add_u32 s39, s39, 156672
    v_lshl_add_u32 v4, v5, 5, s39
    s_lshl_b32 s36, s36, 7
    s_add_u32 s36, s36, 156672
    v_lshl_add_u32 v7, v5, 5, s36
    s_lshl_b32 s37, s37, 7
    s_lshl_b32 s40, s38, 6
    s_add_u32 s37, s37, s40
    s_add_u32 s37, s37, 156672
    v_lshl_add_u32 v243, v5, 4, s37
    v_add_u32 v240, 36864, v6
    v_add_u32 v238, 73728, v6
    v_add_u32 v239, 110592, v6
    s_mov_b32 s59, 18874368
    v_mov_b32 v241, v5
    v_mov_b32 v242, v13
    s_mul_i32 s41, s3, 9
    s_add_u32 s42, s41, 1
    s_lshr_b32 s42, s42, 1
    s_lshl_b32 s42, s42, 10
    s_add_u32 s43, s41, 8
    s_cmp_eq_u32 s38, 1
    s_cselect_b32 s43, s41, s43
    s_lshr_b32 s43, s43, 1
    s_lshl_b32 s43, s43, 10
    s_lshl_b32 s40, s38, 9
    s_add_u32 s43, s43, s40
    s_mul_i32 s44, s13, 2359296
    s_mul_i32 s45, s12, 73728
    s_add_u32 s44, s44, s45
    s_add_u32 s44, s44, 31457280
    s_add_u32 s40, s43, 18432
    v_add_u32 v254, s40, v254
    s_add_u32 s40, s42, 18432
    v_add_u32 v252, s40, v6
    s_add_u32 s41, s42, s44
    s_add_u32 s43, s43, s44
    s_mul_i32 s40, s14, 36864
    s_sub_u32 s51, 36864, s40
    s_add_u32 s51, s51, s43
    s_add_u32 s43, s43, s40
    s_mov_b64 s[16:17], s[28:29]
    s_mov_b32 s19, 0x20000
    s_lshr_b32 s40, s3, 1
    s_lshr_b32 s45, s4, 1
    s_cmp_eq_u32 s40, s45
    s_cselect_b32 s18, 0, s30
    s_cselect_b64 vcc, -1, 0
    s_and_b32 vcc_lo, vcc_lo, 0xffff
    s_and_b32 vcc_hi, vcc_hi, 0xffff
    v_mov_b32 v253, 2147483632
    v_cndmask_b32 v253, v248, v253, vcc
    s_xor_b32 s40, s56, 0
    s_mul_i32 s45, s40, 18432
    s_add_u32 s42, s41, s45
    s_lshr_b32 s45, s40, 1
    s_mul_i32 s45, s45, 3072
    s_and_b32 s40, s40, 1
    s_lshl_b32 s40, s40, 7
    s_add_u32 s45, s45, s40
    s_add_u32 s24, s34, s45
    s_xor_b32 s40, s56, 1
    s_mul_i32 s45, s40, 18432
    s_add_u32 s48, s41, s45
    s_lshr_b32 s45, s40, 1
    s_mul_i32 s45, s45, 3072
    s_and_b32 s40, s40, 1
    s_lshl_b32 s40, s40, 7
    s_add_u32 s45, s45, s40
    s_add_u32 s25, s34, s45
    s_xor_b32 s40, s56, 2
    s_mul_i32 s45, s40, 18432
    s_add_u32 s49, s41, s45
    s_lshr_b32 s45, s40, 1
    s_mul_i32 s45, s45, 3072
    s_and_b32 s40, s40, 1
    s_lshl_b32 s40, s40, 7
    s_add_u32 s45, s45, s40
    s_add_u32 s26, s34, s45
    s_xor_b32 s40, s56, 3
    s_mul_i32 s45, s40, 18432
    s_add_u32 s50, s41, s45
    s_lshr_b32 s45, s40, 1
    s_mul_i32 s45, s45, 3072
    s_and_b32 s40, s40, 1
    s_lshl_b32 s40, s40, 7
    s_add_u32 s45, s45, s40
    s_add_u32 s27, s34, s45
    s_branch km_mlp
km_helper:
    v_and_b32 v7, 32, v2
    v_xor_b32 v3, v6, v7
    s_mul_i32 s6, s16, 36992
    s_mul_i32 s7, s3, 9216
    s_add_u32 s6, s6, s7
    s_add_u32 s6, s6, 6029312
    s_mov_b32 m0, s7
    s_lshl_b32 s32, s3, 10
    s_add_u32 s33, s32, 72448
    s_add_u32 s32, s32, 73728
    s_mul_i32 s18, s15, 55296
    s_add_u32 s18, s18, 30154752
    v_mov_b32 v216, v3
    v_bfe_u32 v3, v2, 2, 2
    v_lshl_add_u32 v3, v5, 3, v3
    v_lshlrev_b32 v3, 6, v3
    v_bfe_u32 v4, v2, 1, 1
    s_lshl_b32 s36, s34, 1
    v_add_u32 v4, s36, v4
    v_and_b32 v7, 1, v5
    v_lshlrev_b32 v7, 1, v7
    v_xor_b32 v4, v4, v7
    v_lshl_add_u32 v3, v4, 4, v3
    v_and_b32 v4, 1, v2
    v_lshl_add_u32 v3, v4, 3, v3
    s_mul_i32 s36, s35, 18432
    v_add_u32 v3, s36, v3
    s_mul_i32 s36, s35, 1152
    s_add_u32 s36, s36, 73728
    v_lshl_add_u32 v4, v5, 5, s36
    s_lshl_b32 s36, s3, 7
    s_add_u32 s36, s36, 78848
    v_lshl_add_u32 v7, v13, 3, s36
    v_xor_b32 v8, 256, v7
    v_add_u32 v12, 4, v7
    v_mov_b32 v10, 79872
    v_lshrrev_b32 v11, 2, v13
    v_cmp_eq_u32 vcc, v11, v5
    s_nop 1
    v_cndmask_b32 v12, v10, v12, vcc
    v_and_b32 v11, 3, v13
    v_cmp_eq_u32 s[46:47], 1, v11
    v_cmp_eq_u32 s[48:49], 2, v11
    v_cmp_eq_u32 s[50:51], 3, v11
    s_mul_i32 s36, s34, 18
    s_mul_i32 s37, s35, 9
    s_add_u32 s36, s36, s37
    s_lshl_b32 s36, s36, 10
    s_add_u32 s36, s36, 36864
    v_add_u32 v9, s36, v6
    v_mov_b32 v196, 0x3f803f80
    v_mov_b32 v197, 0x3f803f80
    v_mov_b32 v198, 0x3f803f80
    v_mov_b32 v199, 0x3f803f80
    s_waitcnt vmcnt(0) lgkmcnt(0)
    s_barrier
    s_cmp_ge_u32 s57, 144
    s_cbranch_scc1 no_conv_26
    v_lshrrev_b32 v246, 4, v250
    v_mul_u32_u24 v246, 768, v246
    s_lshl_b32 s58, s57, 2
    s_add_u32 s58, s58, 205824
    s_mov_b32 exec_lo, 0xffffffff
    s_mov_b32 exec_hi, 0
    buffer_store_dword v244, v246, s[28:31], s58 offen sc1
    s_mov_b64 exec, -1
    s_branch no_conv_26_p
no_conv_26:
    v_mov_b32 v247, 0
    s_mov_b64 exec, 1
    s_mov_b32 s58, 0
poll_27:
    buffer_load_dword v246, v247, s[96:99], 0 offen sc1
    s_add_u32 s58, s58, 1
    s_waitcnt vmcnt(0)
    v_cmp_gt_u32 vcc, 24, v246
    s_cmp_gt_u32 s58, 0x40000
    s_cbranch_scc1 poll_27_done
    s_nop 3
    s_cbranch_vccnz poll_27
poll_27_done:
    s_mov_b64 exec, -1
no_conv_26_p:
    v_lshrrev_b32 v247, 2, v250
    v_add_u32 v247, 116, v247
    s_mov_b64 exec, 3
    s_mov_b32 s58, 0
poll_28:
    buffer_load_dword v246, v247, s[28:31], s60 offen sc1
    s_add_u32 s58, s58, 1
    s_waitcnt vmcnt(0)
    v_cmp_gt_u32 vcc, 1, v246
    s_cmp_gt_u32 s58, 0x40000
    s_cbranch_scc1 poll_28_done
    s_nop 3
    s_cbranch_vccnz poll_28
poll_28_done:
    s_mov_b64 exec, -1
    s_barrier
    s_mul_i32 s39, s12, 768
    s_add_u32 s39, s39, 205824
    v_lshrrev_b32 v247, 0, v250
    s_mov_b32 s100, 0xffffffff
    s_mov_b32 s101, 0xf
    s_mov_b64 exec, s[100:101]
    s_mov_b32 s58, 0
poll_29:
    buffer_load_dwordx4 v[236:239], v247, s[28:31], s39 offen sc1
    s_add_u32 s58, s58, 1
    s_waitcnt vmcnt(0)
    v_min_u32 v246, v236, v237
    v_min3_u32 v246, v246, v238, v239
    v_cmp_gt_u32 vcc, 1, v246
    s_cmp_gt_u32 s58, 0x40000
    s_cbranch_scc1 poll_29_done
    s_nop 3
    s_cbranch_vccnz poll_29
poll_29_done:
    s_mov_b64 exec, -1
    s_barrier
    buffer_load_dwordx4 v216, s[28:31], s6 offen sc1 lds
    s_add_u32 m0, m0, 1024
    s_add_u32 s6, s6, 1024
    buffer_load_dwordx4 v216, s[28:31], s6 offen sc1 lds
    s_add_u32 m0, m0, 1024
    s_add_u32 s6, s6, 1024
    buffer_load_dwordx4 v216, s[28:31], s6 offen sc1 lds
    s_add_u32 m0, m0, 1024
    s_add_u32 s6, s6, 1024
    buffer_load_dwordx4 v216, s[28:31], s6 offen sc1 lds
    s_add_u32 m0, m0, 1024
    s_add_u32 s6, s6, 1024
    buffer_load_dwordx4 v216, s[28:31], s6 offen sc1 lds
    s_add_u32 m0, m0, 1024
    s_add_u32 s6, s6, 1024
    buffer_load_dwordx4 v216, s[28:31], s6 offen sc1 lds
    s_add_u32 m0, m0, 1024
    s_add_u32 s6, s6, 1024
    buffer_load_dwordx4 v216, s[28:31], s6 offen sc1 lds
    s_add_u32 m0, m0, 1024
    s_add_u32 s6, s6, 1024
    buffer_load_dwordx4 v216, s[28:31], s6 offen sc1 lds
    s_add_u32 m0, m0, 1024
    s_add_u32 s6, s6, 1024
    buffer_load_dwordx4 v216, s[28:31], s6 offen sc1 lds
    s_mov_b32 m0, s32
    s_nop 0
    buffer_load_dwordx4 v6, s[28:31], s33 offen sc1 lds
    s_mov_b32 m0, 77824
    s_mov_b32 s33, 76544
    buffer_load_dwordx4 v6, s[28:31], s33 offen sc1 lds
    s_lshr_b32 s38, s12, 3
    s_lshl_b32 s38, s38, 2
    s_and_b32 s39, s12, 3
    s_add_u32 s38, s38, s39
    s_lshl_b32 s39, s13, 4
    s_add_u32 s38, s38, s39
    s_add_u32 s38, s38, 288
    s_bitcmp1_b32 s12, 2
    s_cselect_b32 s38, s38, 1000
    s_cmp_lt_u32 s38, 288
    s_cselect_b32 s61, 1, 0
    s_cselect_b32 s38, s38, 287
    s_and_b32 s20, s38, 1
    s_lshr_b32 s38, s38, 1
    s_mul_hi_u32 s17, s38, 477218589
    s_mul_i32 s18, s17, 9
    s_sub_u32 s18, s38, s18
    s_sub_u32 s21, s17, 8
    s_mul_i32 s21, s21, 663552
    s_mov_b32 s26, 5308416
    s_mov_b32 s27, 0x20000
    s_mov_b32 s22, 1152
    s_mov_b64 s[24:25], s[42:43]
    s_mul_i32 s38, s17, 1152
    s_cmp_lt_u32 s17, 8
    s_cselect_b64 s[24:25], s[40:41], s[24:25]
    s_cselect_b32 s21, s38, s21
    s_cselect_b32 s22, 9216, s22
    s_lshl_b32 s38, s18, 7
    s_add_u32 s21, s21, s38
    s_mul_i32 s38, s22, 288
    s_mul_i32 s38, s38, s20
    s_add_u32 s21, s21, s38
    v_lshrrev_b32 v217, 3, v2
    v_mul_lo_u32 v217, v217, s22
    v_and_b32 v218, 7, v2
    v_lshl_add_u32 v217, v218, 4, v217
    s_lshl_b32 s22, s22, 3
    s_mov_b32 s23, 92160
    s_cmp_eq_u32 s61, 1
    s_cselect_b32 s26, s26, 0
    s_waitcnt vmcnt(0)
    s_barrier
    ds_read_b64_tr_b16 v[16:17], v3 offset:0
    ds_read_b64_tr_b16 v[18:19], v3 offset:256
    ds_read_b64_tr_b16 v[20:21], v3 offset:2048
    ds_read_b64_tr_b16 v[22:23], v3 offset:2304
    ds_read_b64_tr_b16 v[24:25], v3 offset:4096
    ds_read_b64_tr_b16 v[26:27], v3 offset:4352
    ds_read_b64_tr_b16 v[28:29], v3 offset:6144
    ds_read_b64_tr_b16 v[30:31], v3 offset:6400
    ds_read_b64_tr_b16 v[32:33], v3 offset:8192
    ds_read_b64_tr_b16 v[34:35], v3 offset:8448
    ds_read_b64_tr_b16 v[36:37], v3 offset:10240
    ds_read_b64_tr_b16 v[38:39], v3 offset:10496
    ds_read_b64_tr_b16 v[40:41], v3 offset:12288
    ds_read_b64_tr_b16 v[42:43], v3 offset:12544
    ds_read_b64_tr_b16 v[44:45], v3 offset:14336
    ds_read_b64_tr_b16 v[46:47], v3 offset:14592
    ds_read_b64_tr_b16 v[48:49], v3 offset:16384
    ds_read_b64_tr_b16 v[50:51], v3 offset:16640
    s_waitcnt lgkmcnt(15)
    v_mfma_f32_16x16x32_bf16 v[200:203], v[196:199], v[16:19], 0
    v_mfma_f32_16x16x32_bf16 v[204:207], v[16:19], v[16:19], 0
    s_waitcnt lgkmcnt(14)
    v_mfma_f32_16x16x32_bf16 v[200:203], v[196:199], v[20:23], v[200:203]
    v_mfma_f32_16x16x32_bf16 v[204:207], v[20:23], v[20:23], v[204:207]
    s_waitcnt lgkmcnt(12)
    v_mfma_f32_16x16x32_bf16 v[200:203], v[196:199], v[24:27], v[200:203]
    v_mfma_f32_16x16x32_bf16 v[204:207], v[24:27], v[24:27], v[204:207]
    s_waitcnt lgkmcnt(10)
    v_mfma_f32_16x16x32_bf16 v[200:203], v[196:199], v[28:31], v[200:203]
    v_mfma_f32_16x16x32_bf16 v[204:207], v[28:31], v[28:31], v[204:207]
    s_waitcnt lgkmcnt(8)
    v_mfma_f32_16x16x32_bf16 v[200:203], v[196:199], v[32:35], v[200:203]
    v_mfma_f32_16x16x32_bf16 v[204:207], v[32:35], v[32:35], v[204:207]
    s_waitcnt lgkmcnt(6)
    v_mfma_f32_16x16x32_bf16 v[200:203], v[196:199], v[36:39], v[200:203]
    v_mfma_f32_16x16x32_bf16 v[204:207], v[36:39], v[36:39], v[204:207]
    s_waitcnt lgkmcnt(4)
    v_mfma_f32_16x16x32_bf16 v[200:203], v[196:199], v[40:43], v[200:203]
    v_mfma_f32_16x16x32_bf16 v[204:207], v[40:43], v[40:43], v[204:207]
    s_waitcnt lgkmcnt(2)
    v_mfma_f32_16x16x32_bf16 v[200:203], v[196:199], v[44:47], v[200:203]
    v_mfma_f32_16x16x32_bf16 v[204:207], v[44:47], v[44:47], v[204:207]
    s_waitcnt lgkmcnt(0)
    v_mfma_f32_16x16x32_bf16 v[200:203], v[196:199], v[48:51], v[200:203]
    v_mfma_f32_16x16x32_bf16 v[204:207], v[48:51], v[48:51], v[204:207]
    ds_read_b128 v[52:55], v4 offset:0
    ds_read_b128 v[56:59], v4 offset:16
    ds_read_b128 v[60:63], v4 offset:2304
    ds_read_b128 v[64:67], v4 offset:2320
    ds_read_b128 v[68:71], v4 offset:128
    ds_read_b128 v[72:75], v4 offset:144
    ds_read_b128 v[76:79], v4 offset:2432
    ds_read_b128 v[80:83], v4 offset:2448
    v_cndmask_b32 v204, v204, v205, s[46:47]
    v_cndmask_b32 v204, v204, v206, s[48:49]
    v_cndmask_b32 v204, v204, v207, s[50:51]
    ds_write_b32 v7, v200 offset:0
    ds_write_b32 v12, v204 offset:0
    s_waitcnt lgkmcnt(0)
    s_barrier
    ds_read_b64 v[10:11], v7
    ds_read_b64 v[14:15], v8
    ds_read_b128 v[84:87], v4 offset:256
    ds_read_b128 v[88:91], v4 offset:272
    ds_read_b128 v[92:95], v4 offset:2560
    ds_read_b128 v[96:99], v4 offset:2576
    ds_read_b128 v[100:103], v4 offset:384
    ds_read_b128 v[104:107], v4 offset:400
    ds_read_b128 v[108:111], v4 offset:2688
    ds_read_b128 v[112:115], v4 offset:2704
    ds_read_b128 v[116:119], v4 offset:512
    ds_read_b128 v[120:123], v4 offset:528
    ds_read_b128 v[124:127], v4 offset:2816
    ds_read_b128 v[128:131], v4 offset:2832
    s_waitcnt lgkmcnt(12)
    v_add_f32 v10, v10, v14
    v_add_f32 v11, v11, v15
    v_mul_f32 v10, 0x3ae38e39, v10
    v_mul_f32 v11, 0x3ae38e39, v11
    v_fma_f32 v11, -v10, v10, v11
    v_max_f32 v11, 0, v11
    v_add_f32 v11, 0x3727c5ac, v11
    v_sqrt_f32 v11, v11
    v_rcp_f32 v11, v11
    s_nop 0
    v_mul_f32 v10, -v10, v11
    v_lshlrev_b32 v208, 16, v16
    v_and_b32 v209, 0xffff0000, v16
    v_lshlrev_b32 v210, 16, v17
    v_and_b32 v211, 0xffff0000, v17
    v_lshlrev_b32 v212, 16, v18
    v_and_b32 v213, 0xffff0000, v18
    v_lshlrev_b32 v214, 16, v19
    v_and_b32 v215, 0xffff0000, v19
    v_pk_fma_f32 v[208:209], v[208:209], v[10:11], v[10:11] op_sel:[0,1,0] op_sel_hi:[1,1,0]
    v_pk_fma_f32 v[210:211], v[210:211], v[10:11], v[10:11] op_sel:[0,1,0] op_sel_hi:[1,1,0]
    v_pk_fma_f32 v[212:213], v[212:213], v[10:11], v[10:11] op_sel:[0,1,0] op_sel_hi:[1,1,0]
    v_pk_fma_f32 v[214:215], v[214:215], v[10:11], v[10:11] op_sel:[0,1,0] op_sel_hi:[1,1,0]
    v_pk_fma_f32 v[208:209], v[208:209], v[60:61], v[52:53]
    v_pk_fma_f32 v[210:211], v[210:211], v[62:63], v[54:55]
    v_pk_fma_f32 v[212:213], v[212:213], v[64:65], v[56:57]
    v_pk_fma_f32 v[214:215], v[214:215], v[66:67], v[58:59]
    v_cvt_pk_bf16_f32 v16, v208, v209
    v_cvt_pk_bf16_f32 v17, v210, v211
    v_cvt_pk_bf16_f32 v18, v212, v213
    v_cvt_pk_bf16_f32 v19, v214, v215
    ds_write_b128 v9, v[16:19] offset:0
    s_nop 0
    v_mfma_f32_16x16x32_bf16 v[200:203], v[196:199], v[16:19], 0
    v_mfma_f32_16x16x32_bf16 v[204:207], v[16:19], v[16:19], 0
    ds_read_b128 v[132:135], v4 offset:640
    ds_read_b128 v[136:139], v4 offset:656
    ds_read_b128 v[140:143], v4 offset:2944
    ds_read_b128 v[144:147], v4 offset:2960
    v_lshlrev_b32 v208, 16, v20
    v_and_b32 v209, 0xffff0000, v20
    v_lshlrev_b32 v210, 16, v21
    v_and_b32 v211, 0xffff0000, v21
    v_lshlrev_b32 v212, 16, v22
    v_and_b32 v213, 0xffff0000, v22
    v_lshlrev_b32 v214, 16, v23
    v_and_b32 v215, 0xffff0000, v23
    v_pk_fma_f32 v[208:209], v[208:209], v[10:11], v[10:11] op_sel:[0,1,0] op_sel_hi:[1,1,0]
    v_pk_fma_f32 v[210:211], v[210:211], v[10:11], v[10:11] op_sel:[0,1,0] op_sel_hi:[1,1,0]
    v_pk_fma_f32 v[212:213], v[212:213], v[10:11], v[10:11] op_sel:[0,1,0] op_sel_hi:[1,1,0]
    v_pk_fma_f32 v[214:215], v[214:215], v[10:11], v[10:11] op_sel:[0,1,0] op_sel_hi:[1,1,0]
    v_pk_fma_f32 v[208:209], v[208:209], v[76:77], v[68:69]
    v_pk_fma_f32 v[210:211], v[210:211], v[78:79], v[70:71]
    v_pk_fma_f32 v[212:213], v[212:213], v[80:81], v[72:73]
    v_pk_fma_f32 v[214:215], v[214:215], v[82:83], v[74:75]
    v_cvt_pk_bf16_f32 v20, v208, v209
    v_cvt_pk_bf16_f32 v21, v210, v211
    v_cvt_pk_bf16_f32 v22, v212, v213
    v_cvt_pk_bf16_f32 v23, v214, v215
    ds_write_b128 v9, v[20:23] offset:1024
    s_nop 0
    v_mfma_f32_16x16x32_bf16 v[200:203], v[196:199], v[20:23], v[200:203]
    v_mfma_f32_16x16x32_bf16 v[204:207], v[20:23], v[20:23], v[204:207]
    ds_read_b128 v[148:151], v4 offset:768
    ds_read_b128 v[152:155], v4 offset:784
    ds_read_b128 v[156:159], v4 offset:3072
    ds_read_b128 v[160:163], v4 offset:3088
    v_lshlrev_b32 v208, 16, v24
    v_and_b32 v209, 0xffff0000, v24
    v_lshlrev_b32 v210, 16, v25
    v_and_b32 v211, 0xffff0000, v25
    v_lshlrev_b32 v212, 16, v26
    v_and_b32 v213, 0xffff0000, v26
    v_lshlrev_b32 v214, 16, v27
    v_and_b32 v215, 0xffff0000, v27
    v_pk_fma_f32 v[208:209], v[208:209], v[10:11], v[10:11] op_sel:[0,1,0] op_sel_hi:[1,1,0]
    v_pk_fma_f32 v[210:211], v[210:211], v[10:11], v[10:11] op_sel:[0,1,0] op_sel_hi:[1,1,0]
    v_pk_fma_f32 v[212:213], v[212:213], v[10:11], v[10:11] op_sel:[0,1,0] op_sel_hi:[1,1,0]
    v_pk_fma_f32 v[214:215], v[214:215], v[10:11], v[10:11] op_sel:[0,1,0] op_sel_hi:[1,1,0]
    s_waitcnt lgkmcnt(15)
    v_pk_fma_f32 v[208:209], v[208:209], v[92:93], v[84:85]
    v_pk_fma_f32 v[210:211], v[210:211], v[94:95], v[86:87]
    v_pk_fma_f32 v[212:213], v[212:213], v[96:97], v[88:89]
    v_pk_fma_f32 v[214:215], v[214:215], v[98:99], v[90:91]
    v_cvt_pk_bf16_f32 v24, v208, v209
    v_cvt_pk_bf16_f32 v25, v210, v211
    v_cvt_pk_bf16_f32 v26, v212, v213
    v_cvt_pk_bf16_f32 v27, v214, v215
    ds_write_b128 v9, v[24:27] offset:2048
    s_nop 0
    v_mfma_f32_16x16x32_bf16 v[200:203], v[196:199], v[24:27], v[200:203]
    v_mfma_f32_16x16x32_bf16 v[204:207], v[24:27], v[24:27], v[204:207]
    ds_read_b128 v[164:167], v4 offset:896
    ds_read_b128 v[168:171], v4 offset:912
    ds_read_b128 v[172:175], v4 offset:3200
    ds_read_b128 v[176:179], v4 offset:3216
    v_lshlrev_b32 v208, 16, v28
    v_and_b32 v209, 0xffff0000, v28
    v_lshlrev_b32 v210, 16, v29
    v_and_b32 v211, 0xffff0000, v29
    v_lshlrev_b32 v212, 16, v30
    v_and_b32 v213, 0xffff0000, v30
    v_lshlrev_b32 v214, 16, v31
    v_and_b32 v215, 0xffff0000, v31
    v_pk_fma_f32 v[208:209], v[208:209], v[10:11], v[10:11] op_sel:[0,1,0] op_sel_hi:[1,1,0]
    v_pk_fma_f32 v[210:211], v[210:211], v[10:11], v[10:11] op_sel:[0,1,0] op_sel_hi:[1,1,0]
    v_pk_fma_f32 v[212:213], v[212:213], v[10:11], v[10:11] op_sel:[0,1,0] op_sel_hi:[1,1,0]
    v_pk_fma_f32 v[214:215], v[214:215], v[10:11], v[10:11] op_sel:[0,1,0] op_sel_hi:[1,1,0]
    v_pk_fma_f32 v[208:209], v[208:209], v[108:109], v[100:101]
    v_pk_fma_f32 v[210:211], v[210:211], v[110:111], v[102:103]
    s_waitcnt lgkmcnt(15)
    v_pk_fma_f32 v[212:213], v[212:213], v[112:113], v[104:105]
    v_pk_fma_f32 v[214:215], v[214:215], v[114:115], v[106:107]
    v_cvt_pk_bf16_f32 v28, v208, v209
    v_cvt_pk_bf16_f32 v29, v210, v211
    v_cvt_pk_bf16_f32 v30, v212, v213
    v_cvt_pk_bf16_f32 v31, v214, v215
    ds_write_b128 v9, v[28:31] offset:3072
    s_nop 0
    v_mfma_f32_16x16x32_bf16 v[200:203], v[196:199], v[28:31], v[200:203]
    v_mfma_f32_16x16x32_bf16 v[204:207], v[28:31], v[28:31], v[204:207]
    ds_read_b128 v[180:183], v4 offset:1024
    ds_read_b128 v[184:187], v4 offset:1040
    ds_read_b128 v[188:191], v4 offset:3328
    ds_read_b128 v[192:195], v4 offset:3344
    v_lshlrev_b32 v208, 16, v32
    v_and_b32 v209, 0xffff0000, v32
    v_lshlrev_b32 v210, 16, v33
    v_and_b32 v211, 0xffff0000, v33
    v_lshlrev_b32 v212, 16, v34
    v_and_b32 v213, 0xffff0000, v34
    v_lshlrev_b32 v214, 16, v35
    v_and_b32 v215, 0xffff0000, v35
    v_pk_fma_f32 v[208:209], v[208:209], v[10:11], v[10:11] op_sel:[0,1,0] op_sel_hi:[1,1,0]
    v_pk_fma_f32 v[210:211], v[210:211], v[10:11], v[10:11] op_sel:[0,1,0] op_sel_hi:[1,1,0]
    v_pk_fma_f32 v[212:213], v[212:213], v[10:11], v[10:11] op_sel:[0,1,0] op_sel_hi:[1,1,0]
    v_pk_fma_f32 v[214:215], v[214:215], v[10:11], v[10:11] op_sel:[0,1,0] op_sel_hi:[1,1,0]
    v_pk_fma_f32 v[208:209], v[208:209], v[124:125], v[116:117]
    v_pk_fma_f32 v[210:211], v[210:211], v[126:127], v[118:119]
    v_pk_fma_f32 v[212:213], v[212:213], v[128:129], v[120:121]
    v_pk_fma_f32 v[214:215], v[214:215], v[130:131], v[122:123]
    v_cvt_pk_bf16_f32 v32, v208, v209
    v_cvt_pk_bf16_f32 v33, v210, v211
    v_cvt_pk_bf16_f32 v34, v212, v213
    v_cvt_pk_bf16_f32 v35, v214, v215
    ds_write_b128 v9, v[32:35] offset:4096
    s_nop 0
    v_mfma_f32_16x16x32_bf16 v[200:203], v[196:199], v[32:35], v[200:203]
    v_mfma_f32_16x16x32_bf16 v[204:207], v[32:35], v[32:35], v[204:207]
    v_lshlrev_b32 v208, 16, v36
    v_and_b32 v209, 0xffff0000, v36
    v_lshlrev_b32 v210, 16, v37
    v_and_b32 v211, 0xffff0000, v37
    v_lshlrev_b32 v212, 16, v38
    v_and_b32 v213, 0xffff0000, v38
    v_lshlrev_b32 v214, 16, v39
    v_and_b32 v215, 0xffff0000, v39
    v_pk_fma_f32 v[208:209], v[208:209], v[10:11], v[10:11] op_sel:[0,1,0] op_sel_hi:[1,1,0]
    v_pk_fma_f32 v[210:211], v[210:211], v[10:11], v[10:11] op_sel:[0,1,0] op_sel_hi:[1,1,0]
    v_pk_fma_f32 v[212:213], v[212:213], v[10:11], v[10:11] op_sel:[0,1,0] op_sel_hi:[1,1,0]
    v_pk_fma_f32 v[214:215], v[214:215], v[10:11], v[10:11] op_sel:[0,1,0] op_sel_hi:[1,1,0]
    s_waitcnt lgkmcnt(15)
    v_pk_fma_f32 v[208:209], v[208:209], v[140:141], v[132:133]
    v_pk_fma_f32 v[210:211], v[210:211], v[142:143], v[134:135]
    v_pk_fma_f32 v[212:213], v[212:213], v[144:145], v[136:137]
    v_pk_fma_f32 v[214:215], v[214:215], v[146:147], v[138:139]
    v_cvt_pk_bf16_f32 v36, v208, v209
    v_cvt_pk_bf16_f32 v37, v210, v211
    v_cvt_pk_bf16_f32 v38, v212, v213
    v_cvt_pk_bf16_f32 v39, v214, v215
    ds_write_b128 v9, v[36:39] offset:5120
    s_nop 0
    v_mfma_f32_16x16x32_bf16 v[200:203], v[196:199], v[36:39], v[200:203]
    v_mfma_f32_16x16x32_bf16 v[204:207], v[36:39], v[36:39], v[204:207]
    v_lshlrev_b32 v208, 16, v40
    v_and_b32 v209, 0xffff0000, v40
    v_lshlrev_b32 v210, 16, v41
    v_and_b32 v211, 0xffff0000, v41
    v_lshlrev_b32 v212, 16, v42
    v_and_b32 v213, 0xffff0000, v42
    v_lshlrev_b32 v214, 16, v43
    v_and_b32 v215, 0xffff0000, v43
    v_pk_fma_f32 v[208:209], v[208:209], v[10:11], v[10:11] op_sel:[0,1,0] op_sel_hi:[1,1,0]
    v_pk_fma_f32 v[210:211], v[210:211], v[10:11], v[10:11] op_sel:[0,1,0] op_sel_hi:[1,1,0]
    v_pk_fma_f32 v[212:213], v[212:213], v[10:11], v[10:11] op_sel:[0,1,0] op_sel_hi:[1,1,0]
    v_pk_fma_f32 v[214:215], v[214:215], v[10:11], v[10:11] op_sel:[0,1,0] op_sel_hi:[1,1,0]
    s_waitcnt lgkmcnt(13)
    v_pk_fma_f32 v[208:209], v[208:209], v[156:157], v[148:149]
    v_pk_fma_f32 v[210:211], v[210:211], v[158:159], v[150:151]
    s_waitcnt lgkmcnt(12)
    v_pk_fma_f32 v[212:213], v[212:213], v[160:161], v[152:153]
    v_pk_fma_f32 v[214:215], v[214:215], v[162:163], v[154:155]
    v_cvt_pk_bf16_f32 v40, v208, v209
    v_cvt_pk_bf16_f32 v41, v210, v211
    v_cvt_pk_bf16_f32 v42, v212, v213
    v_cvt_pk_bf16_f32 v43, v214, v215
    ds_write_b128 v9, v[40:43] offset:6144
    s_nop 0
    v_mfma_f32_16x16x32_bf16 v[200:203], v[196:199], v[40:43], v[200:203]
    v_mfma_f32_16x16x32_bf16 v[204:207], v[40:43], v[40:43], v[204:207]
    v_lshlrev_b32 v208, 16, v44
    v_and_b32 v209, 0xffff0000, v44
    v_lshlrev_b32 v210, 16, v45
    v_and_b32 v211, 0xffff0000, v45
    v_lshlrev_b32 v212, 16, v46
    v_and_b32 v213, 0xffff0000, v46
    v_lshlrev_b32 v214, 16, v47
    v_and_b32 v215, 0xffff0000, v47
    v_pk_fma_f32 v[208:209], v[208:209], v[10:11], v[10:11] op_sel:[0,1,0] op_sel_hi:[1,1,0]
    v_pk_fma_f32 v[210:211], v[210:211], v[10:11], v[10:11] op_sel:[0,1,0] op_sel_hi:[1,1,0]
    v_pk_fma_f32 v[212:213], v[212:213], v[10:11], v[10:11] op_sel:[0,1,0] op_sel_hi:[1,1,0]
    v_pk_fma_f32 v[214:215], v[214:215], v[10:11], v[10:11] op_sel:[0,1,0] op_sel_hi:[1,1,0]
    s_waitcnt lgkmcnt(9)
    v_pk_fma_f32 v[208:209], v[208:209], v[172:173], v[164:165]
    v_pk_fma_f32 v[210:211], v[210:211], v[174:175], v[166:167]
    s_waitcnt lgkmcnt(8)
    v_pk_fma_f32 v[212:213], v[212:213], v[176:177], v[168:169]
    v_pk_fma_f32 v[214:215], v[214:215], v[178:179], v[170:171]
    v_cvt_pk_bf16_f32 v44, v208, v209
    v_cvt_pk_bf16_f32 v45, v210, v211
    v_cvt_pk_bf16_f32 v46, v212, v213
    v_cvt_pk_bf16_f32 v47, v214, v215
    ds_write_b128 v9, v[44:47] offset:7168
    s_nop 0
    v_mfma_f32_16x16x32_bf16 v[200:203], v[196:199], v[44:47], v[200:203]
    v_mfma_f32_16x16x32_bf16 v[204:207], v[44:47], v[44:47], v[204:207]
    v_lshlrev_b32 v208, 16, v48
    v_and_b32 v209, 0xffff0000, v48
    v_lshlrev_b32 v210, 16, v49
    v_and_b32 v211, 0xffff0000, v49
    v_lshlrev_b32 v212, 16, v50
    v_and_b32 v213, 0xffff0000, v50
    v_lshlrev_b32 v214, 16, v51
    v_and_b32 v215, 0xffff0000, v51
    v_pk_fma_f32 v[208:209], v[208:209], v[10:11], v[10:11] op_sel:[0,1,0] op_sel_hi:[1,1,0]
    v_pk_fma_f32 v[210:211], v[210:211], v[10:11], v[10:11] op_sel:[0,1,0] op_sel_hi:[1,1,0]
    v_pk_fma_f32 v[212:213], v[212:213], v[10:11], v[10:11] op_sel:[0,1,0] op_sel_hi:[1,1,0]
    v_pk_fma_f32 v[214:215], v[214:215], v[10:11], v[10:11] op_sel:[0,1,0] op_sel_hi:[1,1,0]
    s_waitcnt lgkmcnt(5)
    v_pk_fma_f32 v[208:209], v[208:209], v[188:189], v[180:181]
    v_pk_fma_f32 v[210:211], v[210:211], v[190:191], v[182:183]
    s_waitcnt lgkmcnt(4)
    v_pk_fma_f32 v[212:213], v[212:213], v[192:193], v[184:185]
    v_pk_fma_f32 v[214:215], v[214:215], v[194:195], v[186:187]
    v_cvt_pk_bf16_f32 v48, v208, v209
    v_cvt_pk_bf16_f32 v49, v210, v211
    v_cvt_pk_bf16_f32 v50, v212, v213
    v_cvt_pk_bf16_f32 v51, v214, v215
    ds_write_b128 v9, v[48:51] offset:8192
    s_nop 0
    v_mfma_f32_16x16x32_bf16 v[200:203], v[196:199], v[48:51], v[200:203]
    v_mfma_f32_16x16x32_bf16 v[204:207], v[48:51], v[48:51], v[204:207]
    s_nop 7
    v_cndmask_b32 v204, v204, v205, s[46:47]
    v_cndmask_b32 v204, v204, v206, s[48:49]
    v_cndmask_b32 v204, v204, v207, s[50:51]
    ds_write_b32 v7, v200 offset:512
    ds_write_b32 v12, v204 offset:512
    s_waitcnt lgkmcnt(0)
    s_barrier
    s_and_b32 s36, s4, 1
    s_xor_b32 s36, s36, 1
    s_lshl_b32 s36, s36, 5
    v_xor_b32 v3, s36, v3
    s_lshr_b32 s36, s4, 1
    s_xor_b32 s36, s36, 1
    s_mul_i32 s36, s36, 18432
    v_subrev_u32 v3, s36, v3
    v_add_u32 v1, 147456, v6
    ds_read_b64_tr_b16 v[16:17], v3 offset:0
    ds_read_b64_tr_b16 v[18:19], v3 offset:256
    ds_read_b64_tr_b16 v[20:21], v3 offset:2048
    ds_read_b64_tr_b16 v[22:23], v3 offset:2304
    ds_read_b64_tr_b16 v[24:25], v3 offset:4096
    ds_read_b64_tr_b16 v[26:27], v3 offset:4352
    ds_read_b64_tr_b16 v[28:29], v3 offset:6144
    ds_read_b64_tr_b16 v[30:31], v3 offset:6400
    ds_read_b64_tr_b16 v[32:33], v3 offset:8192
    ds_read_b64_tr_b16 v[34:35], v3 offset:8448
    ds_read_b64_tr_b16 v[36:37], v3 offset:10240
    ds_read_b64_tr_b16 v[38:39], v3 offset:10496
    ds_read_b64_tr_b16 v[40:41], v3 offset:12288
    ds_read_b64_tr_b16 v[42:43], v3 offset:12544
    ds_read_b64_tr_b16 v[44:45], v3 offset:14336
    ds_read_b64_tr_b16 v[46:47], v3 offset:14592
    ds_read_b64_tr_b16 v[48:49], v3 offset:16384
    ds_read_b64_tr_b16 v[50:51], v3 offset:16640
    s_waitcnt lgkmcnt(15)
    ds_write_b128 v1, v[16:19] offset:0
    s_waitcnt lgkmcnt(15)
    ds_write_b128 v1, v[20:23] offset:1024
    s_waitcnt lgkmcnt(14)
    ds_write_b128 v1, v[24:27] offset:2048
    s_waitcnt lgkmcnt(13)
    ds_write_b128 v1, v[28:31] offset:3072
    s_waitcnt lgkmcnt(12)
    ds_write_b128 v1, v[32:35] offset:4096
    s_waitcnt lgkmcnt(11)
    ds_write_b128 v1, v[36:39] offset:5120
    s_waitcnt lgkmcnt(10)
    ds_write_b128 v1, v[40:43] offset:6144
    s_waitcnt lgkmcnt(9)
    ds_write_b128 v1, v[44:47] offset:7168
    s_waitcnt lgkmcnt(8)
    ds_write_b128 v1, v[48:51] offset:8192
    s_waitcnt lgkmcnt(0)
    s_add_u32 s36, s5, s34
    s_lshl_b32 s36, s36, 4
    s_add_u32 s37, s35, 1
    v_add_u32 v3, s36, v13
    v_subrev_u32 v7, s37, v3
    v_add_u32 v8, s37, v3
    v_mov_b32 v9, 2147483632
    v_lshrrev_b32 v10, 4, v7
    v_mul_u32_u24 v10, 18432, v10
    v_and_b32 v11, 15, v7
    v_lshl_add_u32 v10, v11, 4, v10
    v_lshl_add_u32 v10, v5, 8, v10
    v_cmp_gt_u32 vcc, 2048, v7
    s_nop 1
    v_cndmask_b32 v7, v9, v10, vcc
    v_lshrrev_b32 v10, 4, v8
    v_mul_u32_u24 v10, 18432, v10
    v_and_b32 v11, 15, v8
    v_lshl_add_u32 v10, v11, 4, v10
    v_lshl_add_u32 v10, v5, 8, v10
    v_cmp_gt_u32 vcc, 2048, v8
    s_nop 1
    v_cndmask_b32 v8, v9, v10, vcc
    v_cmp_gt_u32 vcc, 2, v5
    s_nop 1
    v_cndmask_b32 v9, v8, v7, vcc
    s_mul_i32 s32, s13, 663552
    s_mul_i32 s33, s3, 165888
    s_add_u32 s33, s33, s32
    s_add_u32 s33, s33, 24182784
    s_mul_i32 s37, s3, 55296
    s_add_u32 s37, s37, s32
    s_add_u32 s20, s37, 18874368
    s_mul_i32 s37, s3, 55296
    s_add_u32 s37, s37, s32
    s_add_u32 s21, s37, 19095552
    s_mul_i32 s37, s3, 55296
    s_add_u32 s37, s37, s32
    s_add_u32 s22, s37, 19316736
    s_barrier
    s_lshl_b32 s38, s13, 8
    s_add_u32 s38, s38, 231808
    v_lshrrev_b32 v247, 1, v250
    s_mov_b32 s100, 0x3ffff
    s_mov_b32 s101, 0x0
    s_mov_b64 exec, s[100:101]
    s_mov_b32 s58, 0
poll_30:
    buffer_load_dwordx2 v[236:237], v247, s[28:31], s38 offen sc1
    s_add_u32 s58, s58, 1
    s_waitcnt vmcnt(0)
    v_min_u32 v246, v236, v237
    v_cmp_gt_u32 vcc, 1, v246
    s_cmp_gt_u32 s58, 0x40000
    s_cbranch_scc1 poll_30_done
    s_nop 3
    s_cbranch_vccnz poll_30
poll_30_done:
    s_mov_b64 exec, -1
    s_mul_i32 s36, s35, 9216
    s_mul_i32 s37, s34, 18432
    s_add_u32 s37, s37, s36
    s_add_u32 s36, s36, 13238272
    s_mov_b32 m0, s37
    s_barrier
    buffer_load_dwordx4 v7, s[28:31], s36 offen sc1 lds
    s_add_u32 m0, m0, 1024
    s_add_u32 s36, s36, 1024
    buffer_load_dwordx4 v7, s[28:31], s36 offen sc1 lds
    s_add_u32 m0, m0, 1024
    s_add_u32 s36, s36, 1024
    buffer_load_dwordx4 v7, s[28:31], s36 offen sc1 lds
    s_add_u32 m0, m0, 1024
    s_add_u32 s36, s36, 1024
    buffer_load_dwordx4 v7, s[28:31], s36 offen sc1 lds
    s_add_u32 m0, m0, 1024
    s_add_u32 s36, s36, 1024
    buffer_load_dwordx4 v9, s[28:31], s36 offen sc1 lds
    s_add_u32 m0, m0, 1024
    s_add_u32 s36, s36, 1024
    buffer_load_dwordx4 v8, s[28:31], s36 offen sc1 lds
    s_add_u32 m0, m0, 1024
    s_add_u32 s36, s36, 1024
    buffer_load_dwordx4 v8, s[28:31], s36 offen sc1 lds
    s_add_u32 m0, m0, 1024
    s_add_u32 s36, s36, 1024
    buffer_load_dwordx4 v8, s[28:31], s36 offen sc1 lds
    s_add_u32 m0, m0, 1024
    s_add_u32 s36, s36, 1024
    buffer_load_dwordx4 v8, s[28:31], s36 offen sc1 lds
    s_waitcnt vmcnt(0)
    s_barrier
    s_mul_i32 s36, s13, 2304
    s_add_u32 s36, s36, 98304
    s_mov_b32 m0, 156672
    s_nop 0
    buffer_load_dwordx4 v6, s[28:31], s36 offen sc1 lds
    s_add_u32 m0, m0, 1024
    s_add_u32 s36, s36, 1024
    buffer_load_dwordx4 v6, s[28:31], s36 offen sc1 lds
    s_add_u32 m0, m0, 1024
    s_add_u32 s36, s36, 1024
    buffer_load_dwordx4 v6, s[28:31], s36 offen sc1 lds
    s_add_u32 m0, m0, 1024
    s_add_u32 s36, s36, 16384
    buffer_load_dwordx4 v6, s[28:31], s36 offen sc1 lds
    s_add_u32 m0, m0, 1024
    s_add_u32 s36, s36, 1024
    buffer_load_dwordx4 v6, s[28:31], s36 offen sc1 lds
    s_add_u32 m0, m0, 1024
    s_add_u32 s36, s36, 1024
    buffer_load_dwordx4 v6, s[28:31], s36 offen sc1 lds
    s_add_u32 m0, m0, 1024
    s_add_u32 s36, s36, 16384
    buffer_load_dwordx4 a[0:3], v6, s[28:31], s20 offen offset:0 sc1
    buffer_load_dwordx4 a[4:7], v6, s[28:31], s20 offen offset:1024 sc1
    buffer_load_dwordx4 a[8:11], v6, s[28:31], s20 offen offset:2048 sc1
    buffer_load_dwordx4 a[12:15], v6, s[28:31], s20 offen offset:3072 sc1
    s_add_u32 s20, s20, 4096
    buffer_load_dwordx4 a[16:19], v6, s[28:31], s20 offen offset:0 sc1
    buffer_load_dwordx4 a[20:23], v6, s[28:31], s20 offen offset:1024 sc1
    buffer_load_dwordx4 a[24:27], v6, s[28:31], s20 offen offset:2048 sc1
    buffer_load_dwordx4 a[28:31], v6, s[28:31], s20 offen offset:3072 sc1
    s_add_u32 s20, s20, 4096
    buffer_load_dwordx4 a[32:35], v6, s[28:31], s20 offen offset:0 sc1
    buffer_load_dwordx4 a[36:39], v6, s[28:31], s20 offen offset:1024 sc1
    buffer_load_dwordx4 a[40:43], v6, s[28:31], s20 offen offset:2048 sc1
    buffer_load_dwordx4 a[44:47], v6, s[28:31], s20 offen offset:3072 sc1
    s_add_u32 s20, s20, 4096
    buffer_load_dwordx4 a[48:51], v6, s[28:31], s20 offen offset:0 sc1
    buffer_load_dwordx4 a[52:55], v6, s[28:31], s20 offen offset:1024 sc1
    buffer_load_dwordx4 a[56:59], v6, s[28:31], s20 offen offset:2048 sc1
    buffer_load_dwordx4 a[60:63], v6, s[28:31], s20 offen offset:3072 sc1
    s_add_u32 s20, s20, 4096
    buffer_load_dwordx4 a[64:67], v6, s[28:31], s20 offen offset:0 sc1
    buffer_load_dwordx4 a[68:71], v6, s[28:31], s20 offen offset:1024 sc1
    buffer_load_dwordx4 a[72:75], v6, s[28:31], s20 offen offset:2048 sc1
    buffer_load_dwordx4 a[76:79], v6, s[28:31], s20 offen offset:3072 sc1
    s_add_u32 s20, s20, 4096
    buffer_load_dwordx4 a[80:83], v6, s[28:31], s20 offen offset:0 sc1
    buffer_load_dwordx4 a[84:87], v6, s[28:31], s20 offen offset:1024 sc1
    buffer_load_dwordx4 a[88:91], v6, s[28:31], s20 offen offset:2048 sc1
    buffer_load_dwordx4 a[92:95], v6, s[28:31], s20 offen offset:3072 sc1
    s_add_u32 s20, s20, 4096
    buffer_load_dwordx4 a[96:99], v6, s[28:31], s20 offen offset:0 sc1
    buffer_load_dwordx4 a[100:103], v6, s[28:31], s20 offen offset:1024 sc1
    buffer_load_dwordx4 a[104:107], v6, s[28:31], s20 offen offset:2048 sc1
    buffer_load_dwordx4 a[108:111], v6, s[28:31], s20 offen offset:3072 sc1
    s_add_u32 s20, s20, 4096
    buffer_load_dwordx4 a[112:115], v6, s[28:31], s20 offen offset:0 sc1
    buffer_load_dwordx4 a[116:119], v6, s[28:31], s20 offen offset:1024 sc1
    buffer_load_dwordx4 a[120:123], v6, s[28:31], s20 offen offset:2048 sc1
    buffer_load_dwordx4 a[124:127], v6, s[28:31], s20 offen offset:3072 sc1
    s_add_u32 s20, s20, 4096
    buffer_load_dwordx4 a[128:131], v6, s[28:31], s20 offen offset:0 sc1
    buffer_load_dwordx4 a[132:135], v6, s[28:31], s20 offen offset:1024 sc1
    buffer_load_dwordx4 a[136:139], v6, s[28:31], s20 offen offset:2048 sc1
    buffer_load_dwordx4 a[140:143], v6, s[28:31], s20 offen offset:3072 sc1
    s_add_u32 s20, s20, 4096
    v_add_u32 v3, 156672, v6
    s_waitcnt vmcnt(36)
    ds_read_b128 v[16:19], v3 offset:0
    ds_read_b128 v[20:23], v3 offset:3072
    ds_read_b128 v[24:27], v3 offset:1024
    ds_read_b128 v[28:31], v3 offset:4096
    ds_read_b128 v[32:35], v3 offset:2048
    ds_read_b128 v[36:39], v3 offset:5120
    s_waitcnt lgkmcnt(4)
    v_add_f32 v16, v16, v20
    v_add_f32 v17, v17, v21
    v_add_f32 v18, v18, v22
    v_add_f32 v19, v19, v23
    ds_write_b128 v3, v[16:19] offset:0
    s_waitcnt lgkmcnt(3)
    v_add_f32 v24, v24, v28
    v_add_f32 v25, v25, v29
    v_add_f32 v26, v26, v30
    v_add_f32 v27, v27, v31
    ds_write_b128 v3, v[24:27] offset:1024
    s_waitcnt lgkmcnt(2)
    v_add_f32 v32, v32, v36
    v_add_f32 v33, v33, v37
    v_add_f32 v34, v34, v38
    v_add_f32 v35, v35, v39
    ds_write_b128 v3, v[32:35] offset:2048
    s_and_b32 s55, s4, 1
    s_lshl_b32 s56, s14, 1
    s_add_u32 s56, s56, s55
    s_lshl_b32 s6, s12, 2
    s_xor_b32 s7, s3, s56
    s_add_u32 s6, s6, s7
    s_mul_i32 s6, s6, 18432
    s_add_u32 s6, s6, 15597568
    s_mul_i32 s7, s3, 18432
    s_mov_b32 m0, s7
    v_mul_u32_u24 v3, 768, v5
    v_lshl_add_u32 v3, v13, 3, v3
    s_mul_i32 s34, s12, 6144
    s_add_u32 s34, s34, 17956864
    s_mul_i32 s35, s3, 3
    s_add_u32 s36, s35, 1
    s_lshr_b32 s36, s36, 1
    s_and_b32 s38, s3, 1
    s_add_u32 s37, s35, 2
    s_cmp_eq_u32 s38, 1
    s_cselect_b32 s37, s35, s37
    s_lshr_b32 s37, s37, 1
    s_lshl_b32 s39, s3, 12
    s_add_u32 s39, s39, 73728
    v_add_u32 v0, s39, v6
    s_lshl_b32 s39, s36, 12
    s_add_u32 s39, s39, 73728
    v_add_u32 v1, s39, v6
    s_lshl_b32 s39, s37, 12
    s_lshl_b32 s40, s38, 9
    s_add_u32 s39, s39, s40
    s_add_u32 s39, s39, 73728
    v_lshrrev_b32 v2, 1, v5
    v_lshlrev_b32 v2, 8, v2
    v_lshl_add_u32 v2, v13, 4, v2
    v_and_b32 v4, 1, v5
    v_xor_b32 v248, s55, v4
    v_mul_u32_u24 v248, 18432, v248
    v_add_u32 v248, v248, v2
    v_mul_u32_u24 v254, 18432, v4
    v_add_u32 v254, v254, v2
    v_lshl_add_u32 v2, v4, 3, v2
    v_add_u32 v2, s39, v2
    s_lshl_b32 s39, s3, 7
    s_add_u32 s39, s39, 156672
    v_lshl_add_u32 v4, v5, 5, s39
    s_lshl_b32 s36, s36, 7
    s_add_u32 s36, s36, 156672
    v_lshl_add_u32 v7, v5, 5, s36
    s_lshl_b32 s37, s37, 7
    s_lshl_b32 s40, s38, 6
    s_add_u32 s37, s37, s40
    s_add_u32 s37, s37, 156672
    v_lshl_add_u32 v243, v5, 4, s37
    v_add_u32 v240, 36864, v6
    v_add_u32 v238, 73728, v6
    v_add_u32 v239, 110592, v6
    s_mov_b32 s59, 18874368
    v_mov_b32 v241, v5
    v_mov_b32 v242, v13
    s_mul_i32 s41, s3, 9
    s_add_u32 s42, s41, 1
    s_lshr_b32 s42, s42, 1
    s_lshl_b32 s42, s42, 10
    s_add_u32 s43, s41, 8
    s_cmp_eq_u32 s38, 1
    s_cselect_b32 s43, s41, s43
    s_lshr_b32 s43, s43, 1
    s_lshl_b32 s43, s43, 10
    s_lshl_b32 s40, s38, 9
    s_add_u32 s43, s43, s40
    s_mul_i32 s44, s13, 2359296
    s_mul_i32 s45, s12, 73728
    s_add_u32 s44, s44, s45
    s_add_u32 s44, s44, 31457280
    s_add_u32 s40, s43, 18432
    v_add_u32 v254, s40, v254
    s_add_u32 s40, s42, 18432
    v_add_u32 v252, s40, v6
    s_add_u32 s41, s42, s44
    s_add_u32 s43, s43, s44
    s_mul_i32 s40, s14, 36864
    s_sub_u32 s51, 36864, s40
    s_add_u32 s51, s51, s43
    s_add_u32 s43, s43, s40
    s_mov_b64 s[16:17], s[28:29]
    s_mov_b32 s19, 0x20000
    s_lshr_b32 s40, s3, 1
    s_lshr_b32 s45, s4, 1
    s_cmp_eq_u32 s40, s45
    s_cselect_b32 s18, 0, s30
    s_cselect_b64 vcc, -1, 0
    s_and_b32 vcc_lo, vcc_lo, 0xffff
    s_and_b32 vcc_hi, vcc_hi, 0xffff
    v_mov_b32 v253, 2147483632
    v_cndmask_b32 v253, v248, v253, vcc
    s_xor_b32 s40, s56, 0
    s_mul_i32 s45, s40, 18432
    s_add_u32 s42, s41, s45
    s_lshr_b32 s45, s40, 1
    s_mul_i32 s45, s45, 3072
    s_and_b32 s40, s40, 1
    s_lshl_b32 s40, s40, 7
    s_add_u32 s45, s45, s40
    s_add_u32 s24, s34, s45
    s_xor_b32 s40, s56, 1
    s_mul_i32 s45, s40, 18432
    s_add_u32 s48, s41, s45
    s_lshr_b32 s45, s40, 1
    s_mul_i32 s45, s45, 3072
    s_and_b32 s40, s40, 1
    s_lshl_b32 s40, s40, 7
    s_add_u32 s45, s45, s40
    s_add_u32 s25, s34, s45
    s_xor_b32 s40, s56, 2
    s_mul_i32 s45, s40, 18432
    s_add_u32 s49, s41, s45
    s_lshr_b32 s45, s40, 1
    s_mul_i32 s45, s45, 3072
    s_and_b32 s40, s40, 1
    s_lshl_b32 s40, s40, 7
    s_add_u32 s45, s45, s40
    s_add_u32 s26, s34, s45
    s_xor_b32 s40, s56, 3
    s_mul_i32 s45, s40, 18432
    s_add_u32 s50, s41, s45
    s_lshr_b32 s45, s40, 1
    s_mul_i32 s45, s45, 3072
    s_and_b32 s40, s40, 1
    s_lshl_b32 s40, s40, 7
    s_add_u32 s45, s45, s40
    s_add_u32 s27, s34, s45
    s_lshl_b32 s61, s12, 10
    s_lshl_b32 s58, s13, 2
    s_add_u32 s61, s61, s58
    s_add_u32 s61, s61, 48
    v_lshl_add_u32 v249, v250, 3, s61
    s_waitcnt vmcnt(0) lgkmcnt(0)
    s_barrier
    s_mov_b32 s58, 163840
    s_mov_b64 exec, 0xff
    buffer_store_dword v244, v249, s[28:31], s58 offen sc1
    s_mov_b64 exec, -1
    v_lshrrev_b32 v247, 2, v250
    v_add_u32 v247, 48, v247
    s_mov_b64 exec, 0xff
    s_mov_b32 s58, 0
poll_31:
    buffer_load_dword v246, v247, s[28:31], s60 offen sc1
    s_add_u32 s58, s58, 1
    s_waitcnt vmcnt(0)
    v_cmp_gt_u32 vcc, 1, v246
    s_cmp_gt_u32 s58, 0x40000
    s_cbranch_scc1 poll_31_done
    s_nop 3
    s_cbranch_vccnz poll_31
poll_31_done:
    s_mov_b64 exec, -1
km_mlp:
    s_barrier
    buffer_load_dwordx4 v6, s[28:31], s6 offen sc1 lds
    s_add_u32 m0, m0, 1024
    s_add_u32 s6, s6, 1024
    buffer_load_dwordx4 v6, s[28:31], s6 offen sc1 lds
    s_add_u32 m0, m0, 1024
    s_add_u32 s6, s6, 1024
    buffer_load_dwordx4 v6, s[28:31], s6 offen sc1 lds
    s_add_u32 m0, m0, 1024
    s_add_u32 s6, s6, 1024
    buffer_load_dwordx4 v6, s[28:31], s6 offen sc1 lds
    s_add_u32 m0, m0, 1024
    s_add_u32 s6, s6, 1024
    buffer_load_dwordx4 v6, s[28:31], s6 offen sc1 lds
    s_add_u32 m0, m0, 1024
    s_add_u32 s6, s6, 1024
    buffer_load_dwordx4 v6, s[28:31], s6 offen sc1 lds
    s_add_u32 m0, m0, 1024
    s_add_u32 s6, s6, 1024
    buffer_load_dwordx2 v[104:105], v3, s[28:31], s24 offen offset:0 sc1
    buffer_load_dwordx2 v[106:107], v3, s[28:31], s24 offen offset:256 sc1
    buffer_load_dwordx2 v[108:109], v3, s[28:31], s24 offen offset:512 sc1
    buffer_load_dwordx2 v[112:113], v3, s[28:31], s25 offen offset:0 sc1
    buffer_load_dwordx2 v[114:115], v3, s[28:31], s25 offen offset:256 sc1
    buffer_load_dwordx2 v[116:117], v3, s[28:31], s25 offen offset:512 sc1
    buffer_load_dwordx2 v[120:121], v3, s[28:31], s26 offen offset:0 sc1
    buffer_load_dwordx2 v[122:123], v3, s[28:31], s26 offen offset:256 sc1
    buffer_load_dwordx2 v[124:125], v3, s[28:31], s26 offen offset:512 sc1
    buffer_load_dwordx2 v[128:129], v3, s[28:31], s27 offen offset:0 sc1
    buffer_load_dwordx2 v[130:131], v3, s[28:31], s27 offen offset:256 sc1
    buffer_load_dwordx2 v[132:133], v3, s[28:31], s27 offen offset:512 sc1
    s_waitcnt vmcnt(12)
    s_barrier
    ds_read_b128 v[152:155], v6 offset:0
    ds_read_b128 v[156:159], v6 offset:18432
    ds_read_b128 v[160:163], v240 offset:0
    ds_read_b128 v[164:167], v240 offset:18432
    s_waitcnt lgkmcnt(3)
    v_mfma_f32_16x16x32_bf16 v[8:11], a[0:3], v[152:155], 0
    s_waitcnt lgkmcnt(2)
    buffer_load_dwordx4 v6, s[28:31], s6 offen sc1 lds
    v_mfma_f32_16x16x32_bf16 v[12:15], a[0:3], v[156:159], 0
    s_add_u32 m0, m0, 1024
    ds_read_b128 v[168:171], v6 offset:1024
    s_waitcnt lgkmcnt(2)
    v_mfma_f32_16x16x32_bf16 v[16:19], a[0:3], v[160:163], 0
    s_add_u32 s6, s6, 1024
    ds_read_b128 v[172:175], v6 offset:19456
    s_waitcnt lgkmcnt(2)
    v_mfma_f32_16x16x32_bf16 v[20:23], a[0:3], v[164:167], 0
    ds_read_b128 v[176:179], v240 offset:1024
    v_mfma_f32_16x16x32_bf16 v[24:27], a[4:7], v[152:155], 0
    buffer_load_dwordx4 v6, s[28:31], s6 offen sc1 lds
    v_mfma_f32_16x16x32_bf16 v[28:31], a[4:7], v[156:159], 0
    s_add_u32 m0, m0, 1024
    ds_read_b128 v[180:183], v240 offset:19456
    v_mfma_f32_16x16x32_bf16 v[32:35], a[4:7], v[160:163], 0
    s_add_u32 s6, s6, 1024
    v_mfma_f32_16x16x32_bf16 v[36:39], a[4:7], v[164:167], 0
    v_mfma_f32_16x16x32_bf16 v[40:43], a[8:11], v[152:155], 0
    buffer_load_dwordx4 v6, s[28:31], s6 offen sc1 lds
    v_mfma_f32_16x16x32_bf16 v[44:47], a[8:11], v[156:159], 0
    s_add_u32 m0, m0, 1024
    v_mfma_f32_16x16x32_bf16 v[48:51], a[8:11], v[160:163], 0
    s_add_u32 s6, s6, 1024
    v_mfma_f32_16x16x32_bf16 v[52:55], a[8:11], v[164:167], 0
    s_waitcnt lgkmcnt(1)
    v_mfma_f32_16x16x32_bf16 v[8:11], a[12:15], v[168:171], v[8:11]
    buffer_load_dwordx4 v6, s[28:31], s6 offen sc1 lds
    v_mfma_f32_16x16x32_bf16 v[12:15], a[12:15], v[172:175], v[12:15]
    s_add_u32 m0, m0, 1024
    ds_read_b128 v[152:155], v6 offset:2048
    v_mfma_f32_16x16x32_bf16 v[16:19], a[12:15], v[176:179], v[16:19]
    s_add_u32 s6, s6, 1024
    s_waitcnt lgkmcnt(1)
    ds_read_b128 v[156:159], v6 offset:20480
    v_mfma_f32_16x16x32_bf16 v[20:23], a[12:15], v[180:183], v[20:23]
    ds_read_b128 v[160:163], v240 offset:2048
    v_mfma_f32_16x16x32_bf16 v[24:27], a[16:19], v[168:171], v[24:27]
    buffer_load_dwordx4 v6, s[28:31], s6 offen sc1 lds
    v_mfma_f32_16x16x32_bf16 v[28:31], a[16:19], v[172:175], v[28:31]
    s_add_u32 m0, m0, 1024
    ds_read_b128 v[164:167], v240 offset:20480
    v_mfma_f32_16x16x32_bf16 v[32:35], a[16:19], v[176:179], v[32:35]
    s_add_u32 s6, s6, 1024
    v_mfma_f32_16x16x32_bf16 v[36:39], a[16:19], v[180:183], v[36:39]
    v_mfma_f32_16x16x32_bf16 v[40:43], a[20:23], v[168:171], v[40:43]
    buffer_load_dwordx4 v6, s[28:31], s6 offen sc1 lds
    v_mfma_f32_16x16x32_bf16 v[44:47], a[20:23], v[172:175], v[44:47]
    s_add_u32 m0, m0, 1024
    v_mfma_f32_16x16x32_bf16 v[48:51], a[20:23], v[176:179], v[48:51]
    s_add_u32 s6, s6, 1024
    v_mfma_f32_16x16x32_bf16 v[52:55], a[20:23], v[180:183], v[52:55]
    s_waitcnt lgkmcnt(1)
    v_mfma_f32_16x16x32_bf16 v[8:11], a[24:27], v[152:155], v[8:11]
    buffer_load_dwordx4 v6, s[28:31], s6 offen sc1 lds
    v_mfma_f32_16x16x32_bf16 v[12:15], a[24:27], v[156:159], v[12:15]
    s_add_u32 m0, m0, 1024
    ds_read_b128 v[168:171], v6 offset:3072
    s_waitcnt vmcnt(17)
    v_add_f32 v184, v104, v106
    v_mfma_f32_16x16x32_bf16 v[16:19], a[24:27], v[160:163], v[16:19]
    s_add_u32 s6, s6, 1024
    s_waitcnt lgkmcnt(1)
    ds_read_b128 v[172:175], v6 offset:21504
    v_mfma_f32_16x16x32_bf16 v[20:23], a[24:27], v[164:167], v[20:23]
    ds_read_b128 v[176:179], v240 offset:3072
    v_add_f32 v185, v105, v107
    v_mfma_f32_16x16x32_bf16 v[24:27], a[28:31], v[152:155], v[24:27]
    buffer_load_dwordx4 v6, s[28:31], s6 offen sc1 lds
    v_mfma_f32_16x16x32_bf16 v[28:31], a[28:31], v[156:159], v[28:31]
    s_add_u32 m0, m0, 1024
    ds_read_b128 v[180:183], v240 offset:21504
    s_waitcnt vmcnt(17)
    v_add_f32 v184, v184, v108
    v_mfma_f32_16x16x32_bf16 v[32:35], a[28:31], v[160:163], v[32:35]
    s_add_u32 s6, s6, 1024
    v_add_f32 v185, v185, v109
    s_waitcnt vmcnt(15)
    v_add_f32 v188, v112, v114
    v_mfma_f32_16x16x32_bf16 v[36:39], a[28:31], v[164:167], v[36:39]
    v_add_f32 v189, v113, v115
    s_waitcnt vmcnt(14)
    v_add_f32 v188, v188, v116
    v_mfma_f32_16x16x32_bf16 v[40:43], a[32:35], v[152:155], v[40:43]
    buffer_load_dwordx4 v6, s[28:31], s6 offen sc1 lds
    v_mfma_f32_16x16x32_bf16 v[44:47], a[32:35], v[156:159], v[44:47]
    s_add_u32 m0, m0, 1024
    v_add_f32 v189, v189, v117
    s_waitcnt vmcnt(13)
    v_add_f32 v192, v120, v122
    v_mfma_f32_16x16x32_bf16 v[48:51], a[32:35], v[160:163], v[48:51]
    s_add_u32 s6, s6, 1024
    v_add_f32 v193, v121, v123
    s_waitcnt vmcnt(12)
    v_add_f32 v192, v192, v124
    v_mfma_f32_16x16x32_bf16 v[52:55], a[32:35], v[164:167], v[52:55]
    s_waitcnt lgkmcnt(1)
    v_add_f32 v193, v193, v125
    s_waitcnt vmcnt(10)
    v_add_f32 v196, v128, v130
    v_mfma_f32_16x16x32_bf16 v[8:11], a[36:39], v[168:171], v[8:11]
    buffer_load_dwordx4 v6, s[28:31], s6 offen sc1 lds
    v_mfma_f32_16x16x32_bf16 v[12:15], a[36:39], v[172:175], v[12:15]
    s_add_u32 m0, m0, 1024
    ds_read_b128 v[152:155], v6 offset:4096
    v_add_f32 v197, v129, v131
    v_mfma_f32_16x16x32_bf16 v[16:19], a[36:39], v[176:179], v[16:19]
    s_add_u32 s6, s6, 1024
    s_waitcnt lgkmcnt(1)
    ds_read_b128 v[156:159], v6 offset:22528
    v_mfma_f32_16x16x32_bf16 v[20:23], a[36:39], v[180:183], v[20:23]
    ds_read_b128 v[160:163], v240 offset:4096
    s_waitcnt vmcnt(10)
    v_add_f32 v196, v196, v132
    v_mfma_f32_16x16x32_bf16 v[24:27], a[40:43], v[168:171], v[24:27]
    buffer_load_dwordx4 v6, s[28:31], s6 offen sc1 lds
    v_add_f32 v197, v197, v133
    v_mfma_f32_16x16x32_bf16 v[28:31], a[40:43], v[172:175], v[28:31]
    s_add_u32 m0, m0, 1024
    ds_read_b128 v[164:167], v240 offset:22528
    v_mov_b32 v104, v184
    v_mfma_f32_16x16x32_bf16 v[32:35], a[40:43], v[176:179], v[32:35]
    s_add_u32 s6, s6, 1024
    v_mov_b32 v105, v185
    v_mov_b32 v112, v188
    v_mfma_f32_16x16x32_bf16 v[36:39], a[40:43], v[180:183], v[36:39]
    v_mov_b32 v113, v189
    v_mov_b32 v120, v192
    v_mfma_f32_16x16x32_bf16 v[40:43], a[44:47], v[168:171], v[40:43]
    buffer_load_dwordx4 v6, s[28:31], s6 offen sc1 lds
    v_mfma_f32_16x16x32_bf16 v[44:47], a[44:47], v[172:175], v[44:47]
    s_add_u32 m0, m0, 1024
    v_mov_b32 v121, v193
    v_mov_b32 v128, v196
    v_mfma_f32_16x16x32_bf16 v[48:51], a[44:47], v[176:179], v[48:51]
    s_add_u32 s6, s6, 1024
    v_mov_b32 v129, v197
    v_permlane16_swap_b32 v184, v104
    v_mfma_f32_16x16x32_bf16 v[52:55], a[44:47], v[180:183], v[52:55]
    s_waitcnt lgkmcnt(1)
    v_permlane16_swap_b32 v185, v105
    v_permlane16_swap_b32 v188, v112
    v_mfma_f32_16x16x32_bf16 v[8:11], a[48:51], v[152:155], v[8:11]
    buffer_load_dwordx4 a[144:147], v6, s[28:31], s20 offen offset:0 sc1
    v_mfma_f32_16x16x32_bf16 v[12:15], a[48:51], v[156:159], v[12:15]
    ds_read_b128 v[168:171], v6 offset:5120
    v_permlane16_swap_b32 v189, v113
    v_mfma_f32_16x16x32_bf16 v[16:19], a[48:51], v[160:163], v[16:19]
    s_waitcnt lgkmcnt(1)
    ds_read_b128 v[172:175], v6 offset:23552
    v_permlane16_swap_b32 v192, v120
    v_mfma_f32_16x16x32_bf16 v[20:23], a[48:51], v[164:167], v[20:23]
    ds_read_b128 v[176:179], v240 offset:5120
    v_permlane16_swap_b32 v193, v121
    v_mfma_f32_16x16x32_bf16 v[24:27], a[52:55], v[152:155], v[24:27]
    buffer_load_dwordx4 a[148:151], v6, s[28:31], s20 offen offset:1024 sc1
    v_mfma_f32_16x16x32_bf16 v[28:31], a[52:55], v[156:159], v[28:31]
    ds_read_b128 v[180:183], v240 offset:23552
    v_permlane16_swap_b32 v196, v128
    v_mfma_f32_16x16x32_bf16 v[32:35], a[52:55], v[160:163], v[32:35]
    v_permlane16_swap_b32 v197, v129
    v_add_f32 v184, v184, v104
    v_mfma_f32_16x16x32_bf16 v[36:39], a[52:55], v[164:167], v[36:39]
    v_add_f32 v185, v185, v105
    v_add_f32 v188, v188, v112
    v_mfma_f32_16x16x32_bf16 v[40:43], a[56:59], v[152:155], v[40:43]
    buffer_load_dwordx4 a[152:155], v6, s[28:31], s20 offen offset:2048 sc1
    v_add_f32 v189, v189, v113
    v_mfma_f32_16x16x32_bf16 v[44:47], a[56:59], v[156:159], v[44:47]
    v_add_f32 v192, v192, v120
    v_add_f32 v193, v193, v121
    v_mfma_f32_16x16x32_bf16 v[48:51], a[56:59], v[160:163], v[48:51]
    v_add_f32 v196, v196, v128
    v_add_f32 v197, v197, v129
    v_mfma_f32_16x16x32_bf16 v[52:55], a[56:59], v[164:167], v[52:55]
    s_waitcnt vmcnt(9) lgkmcnt(1)
    s_barrier
    v_mov_b32 v104, v184
    v_mfma_f32_16x16x32_bf16 v[8:11], a[60:63], v[168:171], v[8:11]
    buffer_load_dwordx4 a[156:159], v6, s[28:31], s20 offen offset:3072 sc1
    v_mfma_f32_16x16x32_bf16 v[12:15], a[60:63], v[172:175], v[12:15]
    s_add_u32 s20, s20, 4096
    ds_read_b128 v[152:155], v6 offset:6144
    v_mov_b32 v105, v185
    v_mfma_f32_16x16x32_bf16 v[16:19], a[60:63], v[176:179], v[16:19]
    s_waitcnt lgkmcnt(1)
    ds_read_b128 v[156:159], v6 offset:24576
    v_mov_b32 v112, v188
    v_mfma_f32_16x16x32_bf16 v[20:23], a[60:63], v[180:183], v[20:23]
    ds_read_b128 v[160:163], v240 offset:6144
    v_mov_b32 v113, v189
    v_mfma_f32_16x16x32_bf16 v[24:27], a[64:67], v[168:171], v[24:27]
    buffer_load_dwordx4 a[0:3], v6, s[28:31], s20 offen offset:0 sc1
    v_mfma_f32_16x16x32_bf16 v[28:31], a[64:67], v[172:175], v[28:31]
    ds_read_b128 v[164:167], v240 offset:24576
    v_mov_b32 v120, v192
    v_mfma_f32_16x16x32_bf16 v[32:35], a[64:67], v[176:179], v[32:35]
    v_mov_b32 v121, v193
    v_mov_b32 v128, v196
    v_mfma_f32_16x16x32_bf16 v[36:39], a[64:67], v[180:183], v[36:39]
    v_mov_b32 v129, v197
    v_permlane32_swap_b32 v184, v104
    v_mfma_f32_16x16x32_bf16 v[40:43], a[68:71], v[168:171], v[40:43]
    buffer_load_dwordx4 a[4:7], v6, s[28:31], s20 offen offset:1024 sc1
    v_mfma_f32_16x16x32_bf16 v[44:47], a[68:71], v[172:175], v[44:47]
    v_permlane32_swap_b32 v185, v105
    v_permlane32_swap_b32 v188, v112
    v_mfma_f32_16x16x32_bf16 v[48:51], a[68:71], v[176:179], v[48:51]
    v_permlane32_swap_b32 v189, v113
    v_permlane32_swap_b32 v192, v120
    v_mfma_f32_16x16x32_bf16 v[52:55], a[68:71], v[180:183], v[52:55]
    s_waitcnt lgkmcnt(1)
    v_permlane32_swap_b32 v193, v121
    v_permlane32_swap_b32 v196, v128
    v_mfma_f32_16x16x32_bf16 v[8:11], a[72:75], v[152:155], v[8:11]
    buffer_load_dwordx4 a[8:11], v6, s[28:31], s20 offen offset:2048 sc1
    v_mfma_f32_16x16x32_bf16 v[12:15], a[72:75], v[156:159], v[12:15]
    ds_read_b128 v[168:171], v6 offset:7168
    v_permlane32_swap_b32 v197, v129
    v_add_f32 v184, v184, v104
    v_mfma_f32_16x16x32_bf16 v[16:19], a[72:75], v[160:163], v[16:19]
    s_waitcnt lgkmcnt(1)
    ds_read_b128 v[172:175], v6 offset:25600
    v_add_f32 v185, v185, v105
    v_mfma_f32_16x16x32_bf16 v[20:23], a[72:75], v[164:167], v[20:23]
    ds_read_b128 v[176:179], v240 offset:7168
    v_add_f32 v188, v188, v112
    v_mfma_f32_16x16x32_bf16 v[24:27], a[76:79], v[152:155], v[24:27]
    buffer_load_dwordx4 a[12:15], v6, s[28:31], s20 offen offset:3072 sc1
    v_mfma_f32_16x16x32_bf16 v[28:31], a[76:79], v[156:159], v[28:31]
    s_add_u32 s20, s20, 4096
    ds_read_b128 v[180:183], v240 offset:25600
    v_add_f32 v189, v189, v113
    v_mfma_f32_16x16x32_bf16 v[32:35], a[76:79], v[160:163], v[32:35]
    v_add_f32 v192, v192, v120
    v_add_f32 v193, v193, v121
    v_mfma_f32_16x16x32_bf16 v[36:39], a[76:79], v[164:167], v[36:39]
    v_add_f32 v196, v196, v128
    v_add_f32 v197, v197, v129
    v_mfma_f32_16x16x32_bf16 v[40:43], a[80:83], v[152:155], v[40:43]
    buffer_load_dwordx4 a[16:19], v6, s[28:31], s20 offen offset:0 sc1
    v_mfma_f32_16x16x32_bf16 v[44:47], a[80:83], v[156:159], v[44:47]
    v_mul_f32 v184, 0x3ae38e39, v184
    v_mul_f32 v188, 0x3ae38e39, v188
    v_mfma_f32_16x16x32_bf16 v[48:51], a[80:83], v[160:163], v[48:51]
    v_mul_f32 v192, 0x3ae38e39, v192
    v_mul_f32 v196, 0x3ae38e39, v196
    v_mfma_f32_16x16x32_bf16 v[52:55], a[80:83], v[164:167], v[52:55]
    s_waitcnt lgkmcnt(1)
    v_mul_f32 v185, 0x3ae38e39, v185
    v_mul_f32 v189, 0x3ae38e39, v189
    v_mfma_f32_16x16x32_bf16 v[8:11], a[84:87], v[168:171], v[8:11]
    buffer_load_dwordx4 a[20:23], v6, s[28:31], s20 offen offset:1024 sc1
    v_mfma_f32_16x16x32_bf16 v[12:15], a[84:87], v[172:175], v[12:15]
    ds_read_b128 v[152:155], v6 offset:8192
    v_mul_f32 v193, 0x3ae38e39, v193
    v_mfma_f32_16x16x32_bf16 v[16:19], a[84:87], v[176:179], v[16:19]
    s_waitcnt lgkmcnt(1)
    ds_read_b128 v[156:159], v6 offset:26624
    v_mul_f32 v197, 0x3ae38e39, v197
    v_mfma_f32_16x16x32_bf16 v[20:23], a[84:87], v[180:183], v[20:23]
    ds_read_b128 v[160:163], v240 offset:8192
    v_fma_f32 v185, -v184, v184, v185
    v_mfma_f32_16x16x32_bf16 v[24:27], a[88:91], v[168:171], v[24:27]
    buffer_load_dwordx4 a[24:27], v6, s[28:31], s20 offen offset:2048 sc1
    v_mfma_f32_16x16x32_bf16 v[28:31], a[88:91], v[172:175], v[28:31]
    ds_read_b128 v[164:167], v240 offset:26624
    v_fma_f32 v189, -v188, v188, v189
    v_fma_f32 v193, -v192, v192, v193
    v_mfma_f32_16x16x32_bf16 v[32:35], a[88:91], v[176:179], v[32:35]
    v_fma_f32 v197, -v196, v196, v197
    v_max_f32 v185, 0, v185
    v_mfma_f32_16x16x32_bf16 v[36:39], a[88:91], v[180:183], v[36:39]
    v_max_f32 v189, 0, v189
    v_max_f32 v193, 0, v193
    v_mfma_f32_16x16x32_bf16 v[40:43], a[92:95], v[168:171], v[40:43]
    buffer_load_dwordx4 a[28:31], v6, s[28:31], s20 offen offset:3072 sc1
    v_mfma_f32_16x16x32_bf16 v[44:47], a[92:95], v[172:175], v[44:47]
    s_add_u32 s20, s20, 4096
    v_max_f32 v197, 0, v197
    v_add_f32 v185, 0x3727c5ac, v185
    v_mfma_f32_16x16x32_bf16 v[48:51], a[92:95], v[176:179], v[48:51]
    v_add_f32 v189, 0x3727c5ac, v189
    v_add_f32 v193, 0x3727c5ac, v193
    v_mfma_f32_16x16x32_bf16 v[52:55], a[92:95], v[180:183], v[52:55]
    s_waitcnt lgkmcnt(1)
    v_add_f32 v197, 0x3727c5ac, v197
    v_sqrt_f32 v185, v185
    v_mfma_f32_16x16x32_bf16 v[8:11], a[96:99], v[152:155], v[8:11]
    buffer_load_dwordx4 a[32:35], v6, s[28:31], s20 offen offset:0 sc1
    v_mfma_f32_16x16x32_bf16 v[12:15], a[96:99], v[156:159], v[12:15]
    ds_read_b128 v[168:171], v6 offset:9216
    v_sqrt_f32 v189, v189
    v_mfma_f32_16x16x32_bf16 v[16:19], a[96:99], v[160:163], v[16:19]
    s_waitcnt lgkmcnt(1)
    ds_read_b128 v[172:175], v6 offset:27648
    v_sqrt_f32 v193, v193
    v_mfma_f32_16x16x32_bf16 v[20:23], a[96:99], v[164:167], v[20:23]
    ds_read_b128 v[176:179], v240 offset:9216
    v_sqrt_f32 v197, v197
    v_mfma_f32_16x16x32_bf16 v[24:27], a[100:103], v[152:155], v[24:27]
    buffer_load_dwordx4 a[36:39], v6, s[28:31], s20 offen offset:1024 sc1
    v_mfma_f32_16x16x32_bf16 v[28:31], a[100:103], v[156:159], v[28:31]
    ds_read_b128 v[180:183], v240 offset:27648
    v_rcp_f32 v186, v185
    v_mfma_f32_16x16x32_bf16 v[32:35], a[100:103], v[160:163], v[32:35]
    v_rcp_f32 v190, v189
    v_mfma_f32_16x16x32_bf16 v[36:39], a[100:103], v[164:167], v[36:39]
    v_rcp_f32 v194, v193
    v_mfma_f32_16x16x32_bf16 v[40:43], a[104:107], v[152:155], v[40:43]
    buffer_load_dwordx4 a[40:43], v6, s[28:31], s20 offen offset:2048 sc1
    v_mfma_f32_16x16x32_bf16 v[44:47], a[104:107], v[156:159], v[44:47]
    v_rcp_f32 v198, v197
    v_mfma_f32_16x16x32_bf16 v[48:51], a[104:107], v[160:163], v[48:51]
    v_sub_f32 v184, 0, v184
    v_sub_f32 v188, 0, v188
    v_mfma_f32_16x16x32_bf16 v[52:55], a[104:107], v[164:167], v[52:55]
    s_waitcnt lgkmcnt(1)
    v_sub_f32 v192, 0, v192
    v_sub_f32 v196, 0, v196
    v_mfma_f32_16x16x32_bf16 v[8:11], a[108:111], v[168:171], v[8:11]
    buffer_load_dwordx4 a[44:47], v6, s[28:31], s20 offen offset:3072 sc1
    v_mfma_f32_16x16x32_bf16 v[12:15], a[108:111], v[172:175], v[12:15]
    s_add_u32 s20, s20, 4096
    ds_read_b128 v[152:155], v6 offset:10240
    v_mul_f32 v187, v186, v186
    v_mfma_f32_16x16x32_bf16 v[16:19], a[108:111], v[176:179], v[16:19]
    s_waitcnt lgkmcnt(1)
    ds_read_b128 v[156:159], v6 offset:28672
    v_mul_f32 v191, v190, v190
    v_mfma_f32_16x16x32_bf16 v[20:23], a[108:111], v[180:183], v[20:23]
    ds_read_b128 v[160:163], v240 offset:10240
    v_mul_f32 v195, v194, v194
    v_mfma_f32_16x16x32_bf16 v[24:27], a[112:115], v[168:171], v[24:27]
    buffer_load_dwordx4 a[48:51], v6, s[28:31], s20 offen offset:0 sc1
    v_mfma_f32_16x16x32_bf16 v[28:31], a[112:115], v[172:175], v[28:31]
    ds_read_b128 v[164:167], v240 offset:28672
    v_mul_f32 v199, v198, v198
    v_mfma_f32_16x16x32_bf16 v[32:35], a[112:115], v[176:179], v[32:35]
    v_mul_f32 v186, 0xc0135761, v186
    v_mul_f32 v190, 0xc0135761, v190
    v_mfma_f32_16x16x32_bf16 v[36:39], a[112:115], v[180:183], v[36:39]
    v_mul_f32 v194, 0xc0135761, v194
    v_mul_f32 v198, 0xc0135761, v198
    v_mfma_f32_16x16x32_bf16 v[40:43], a[116:119], v[168:171], v[40:43]
    buffer_load_dwordx4 a[52:55], v6, s[28:31], s20 offen offset:1024 sc1
    v_mfma_f32_16x16x32_bf16 v[44:47], a[116:119], v[172:175], v[44:47]
    v_mul_f32 v187, 0x3d372713, v187
    v_mul_f32 v191, 0x3d372713, v191
    v_mfma_f32_16x16x32_bf16 v[48:51], a[116:119], v[176:179], v[48:51]
    v_mul_f32 v195, 0x3d372713, v195
    v_mul_f32 v199, 0x3d372713, v199
    v_mfma_f32_16x16x32_bf16 v[52:55], a[116:119], v[180:183], v[52:55]
    s_waitcnt lgkmcnt(1)
    v_mul_f32 v187, v187, v186
    v_mul_f32 v191, v191, v190
    v_mfma_f32_16x16x32_bf16 v[8:11], a[120:123], v[152:155], v[8:11]
    buffer_load_dwordx4 a[56:59], v6, s[28:31], s21 offen offset:0 sc1
    v_mfma_f32_16x16x32_bf16 v[12:15], a[120:123], v[156:159], v[12:15]
    ds_read_b128 v[168:171], v6 offset:11264
    v_mul_f32 v195, v195, v194
    v_mfma_f32_16x16x32_bf16 v[16:19], a[120:123], v[160:163], v[16:19]
    s_waitcnt lgkmcnt(1)
    ds_read_b128 v[172:175], v6 offset:29696
    v_mul_f32 v199, v199, v198
    v_mfma_f32_16x16x32_bf16 v[20:23], a[120:123], v[164:167], v[20:23]
    ds_read_b128 v[176:179], v240 offset:11264
    ds_read_b128 v[200:203], v7 offset:0
    v_mfma_f32_16x16x32_bf16 v[24:27], a[124:127], v[152:155], v[24:27]
    buffer_load_dwordx4 a[60:63], v6, s[28:31], s21 offen offset:1024 sc1
    v_mfma_f32_16x16x32_bf16 v[28:31], a[124:127], v[156:159], v[28:31]
    ds_read_b128 v[180:183], v240 offset:29696
    ds_read_b128 v[204:207], v7 offset:16
    v_mfma_f32_16x16x32_bf16 v[32:35], a[124:127], v[160:163], v[32:35]
    ds_read_b128 v[208:211], v243 offset:0
    ds_read_b128 v[212:215], v7 offset:768
    v_mfma_f32_16x16x32_bf16 v[36:39], a[124:127], v[164:167], v[36:39]
    ds_read_b128 v[216:219], v7 offset:784
    ds_read_b128 v[220:223], v243 offset:768
    v_mfma_f32_16x16x32_bf16 v[40:43], a[128:131], v[152:155], v[40:43]
    buffer_load_dwordx4 a[64:67], v6, s[28:31], s21 offen offset:2048 sc1
    v_mfma_f32_16x16x32_bf16 v[44:47], a[128:131], v[156:159], v[44:47]
    s_waitcnt lgkmcnt(2)
    v_mul_f32 v56, v184, v212
    v_mul_f32 v57, v184, v213
    v_mfma_f32_16x16x32_bf16 v[48:51], a[128:131], v[160:163], v[48:51]
    v_mul_f32 v58, v184, v214
    v_mul_f32 v59, v184, v215
    v_mfma_f32_16x16x32_bf16 v[52:55], a[128:131], v[164:167], v[52:55]
    s_waitcnt vmcnt(21)
    s_barrier
    v_mul_f32 v60, v188, v212
    v_mfma_f32_16x16x32_bf16 v[8:11], a[132:135], v[168:171], v[8:11]
    buffer_load_dwordx4 a[68:71], v6, s[28:31], s21 offen offset:3072 sc1
    v_mfma_f32_16x16x32_bf16 v[12:15], a[132:135], v[172:175], v[12:15]
    s_add_u32 s21, s21, 4096
    ds_read_b128 v[152:155], v6 offset:12288
    v_mul_f32 v61, v188, v213
    v_mfma_f32_16x16x32_bf16 v[16:19], a[132:135], v[176:179], v[16:19]
    ds_read_b128 v[156:159], v6 offset:30720
    v_mul_f32 v62, v188, v214
    v_mfma_f32_16x16x32_bf16 v[20:23], a[132:135], v[180:183], v[20:23]
    ds_read_b128 v[160:163], v240 offset:12288
    v_mul_f32 v63, v188, v215
    v_mfma_f32_16x16x32_bf16 v[24:27], a[136:139], v[168:171], v[24:27]
    buffer_load_dwordx4 a[72:75], v6, s[28:31], s21 offen offset:0 sc1
    v_mfma_f32_16x16x32_bf16 v[28:31], a[136:139], v[172:175], v[28:31]
    ds_read_b128 v[164:167], v240 offset:30720
    v_mul_f32 v64, v192, v212
    v_mfma_f32_16x16x32_bf16 v[32:35], a[136:139], v[176:179], v[32:35]
    v_mul_f32 v65, v192, v213
    v_mul_f32 v66, v192, v214
    v_mfma_f32_16x16x32_bf16 v[36:39], a[136:139], v[180:183], v[36:39]
    v_mul_f32 v67, v192, v215
    v_mul_f32 v68, v196, v212
    v_mfma_f32_16x16x32_bf16 v[40:43], a[140:143], v[168:171], v[40:43]
    buffer_load_dwordx4 a[76:79], v6, s[28:31], s21 offen offset:1024 sc1
    v_mfma_f32_16x16x32_bf16 v[44:47], a[140:143], v[172:175], v[44:47]
    v_mul_f32 v69, v196, v213
    v_mul_f32 v70, v196, v214
    v_mfma_f32_16x16x32_bf16 v[48:51], a[140:143], v[176:179], v[48:51]
    v_mul_f32 v71, v196, v215
    s_waitcnt lgkmcnt(5)
    v_mul_f32 v72, v184, v216
    v_mfma_f32_16x16x32_bf16 v[52:55], a[140:143], v[180:183], v[52:55]
    s_waitcnt vmcnt(21) lgkmcnt(1)
    v_mul_f32 v73, v184, v217
    v_mul_f32 v74, v184, v218
    v_mfma_f32_16x16x32_bf16 v[8:11], a[144:147], v[152:155], v[8:11]
    buffer_load_dwordx4 a[80:83], v6, s[28:31], s21 offen offset:2048 sc1
    v_mfma_f32_16x16x32_bf16 v[12:15], a[144:147], v[156:159], v[12:15]
    ds_read_b128 v[168:171], v6 offset:13312
    v_mul_f32 v75, v184, v219
    v_mfma_f32_16x16x32_bf16 v[16:19], a[144:147], v[160:163], v[16:19]
    s_waitcnt lgkmcnt(1)
    ds_read_b128 v[172:175], v6 offset:31744
    v_mul_f32 v76, v188, v216
    v_mfma_f32_16x16x32_bf16 v[20:23], a[144:147], v[164:167], v[20:23]
    ds_read_b128 v[176:179], v240 offset:13312
    v_mul_f32 v77, v188, v217
    v_mfma_f32_16x16x32_bf16 v[24:27], a[148:151], v[152:155], v[24:27]
    buffer_load_dwordx4 a[84:87], v6, s[28:31], s21 offen offset:3072 sc1
    v_mfma_f32_16x16x32_bf16 v[28:31], a[148:151], v[156:159], v[28:31]
    s_add_u32 s21, s21, 4096
    ds_read_b128 v[180:183], v240 offset:31744
    v_mul_f32 v78, v188, v218
    v_mfma_f32_16x16x32_bf16 v[32:35], a[148:151], v[160:163], v[32:35]
    v_mul_f32 v79, v188, v219
    v_mul_f32 v80, v192, v216
    v_mfma_f32_16x16x32_bf16 v[36:39], a[148:151], v[164:167], v[36:39]
    v_mul_f32 v81, v192, v217
    v_mul_f32 v82, v192, v218
    v_mfma_f32_16x16x32_bf16 v[40:43], a[152:155], v[152:155], v[40:43]
    buffer_load_dwordx4 a[88:91], v6, s[28:31], s21 offen offset:0 sc1
    v_mfma_f32_16x16x32_bf16 v[44:47], a[152:155], v[156:159], v[44:47]
    v_mul_f32 v83, v192, v219
    v_mul_f32 v84, v196, v216
    v_mfma_f32_16x16x32_bf16 v[48:51], a[152:155], v[160:163], v[48:51]
    v_mul_f32 v85, v196, v217
    v_mul_f32 v86, v196, v218
    v_mfma_f32_16x16x32_bf16 v[52:55], a[152:155], v[164:167], v[52:55]
    s_waitcnt vmcnt(21) lgkmcnt(1)
    v_mul_f32 v87, v196, v219
    v_mul_f32 v88, v184, v220
    v_mfma_f32_16x16x32_bf16 v[8:11], a[156:159], v[168:171], v[8:11]
    buffer_load_dwordx4 a[92:95], v6, s[28:31], s21 offen offset:1024 sc1
    v_mfma_f32_16x16x32_bf16 v[12:15], a[156:159], v[172:175], v[12:15]
    ds_read_b128 v[152:155], v6 offset:14336
    v_mul_f32 v89, v184, v221
    v_mfma_f32_16x16x32_bf16 v[16:19], a[156:159], v[176:179], v[16:19]
    s_waitcnt lgkmcnt(1)
    ds_read_b128 v[156:159], v6 offset:32768
    v_mul_f32 v90, v184, v222
    v_mfma_f32_16x16x32_bf16 v[20:23], a[156:159], v[180:183], v[20:23]
    ds_read_b128 v[160:163], v240 offset:14336
    v_mul_f32 v91, v184, v223
    v_mfma_f32_16x16x32_bf16 v[24:27], a[0:3], v[168:171], v[24:27]
    buffer_load_dwordx4 a[96:99], v6, s[28:31], s21 offen offset:2048 sc1
    v_mfma_f32_16x16x32_bf16 v[28:31], a[0:3], v[172:175], v[28:31]
    ds_read_b128 v[164:167], v240 offset:32768
    v_mul_f32 v92, v188, v220
    v_mfma_f32_16x16x32_bf16 v[32:35], a[0:3], v[176:179], v[32:35]
    v_mul_f32 v93, v188, v221
    v_mul_f32 v94, v188, v222
    v_mfma_f32_16x16x32_bf16 v[36:39], a[0:3], v[180:183], v[36:39]
    v_mul_f32 v95, v188, v223
    v_mul_f32 v96, v192, v220
    v_mfma_f32_16x16x32_bf16 v[40:43], a[4:7], v[168:171], v[40:43]
    buffer_load_dwordx4 a[100:103], v6, s[28:31], s21 offen offset:3072 sc1
    v_mfma_f32_16x16x32_bf16 v[44:47], a[4:7], v[172:175], v[44:47]
    s_add_u32 s21, s21, 4096
    v_mul_f32 v97, v192, v221
    v_mul_f32 v98, v192, v222
    v_mfma_f32_16x16x32_bf16 v[48:51], a[4:7], v[176:179], v[48:51]
    v_mul_f32 v99, v192, v223
    v_mul_f32 v100, v196, v220
    v_mfma_f32_16x16x32_bf16 v[52:55], a[4:7], v[180:183], v[52:55]
    s_waitcnt vmcnt(21) lgkmcnt(1)
    v_mul_f32 v101, v196, v221
    v_mul_f32 v102, v196, v222
    v_mfma_f32_16x16x32_bf16 v[8:11], a[8:11], v[152:155], v[8:11]
    buffer_load_dwordx4 a[104:107], v6, s[28:31], s21 offen offset:0 sc1
    v_mfma_f32_16x16x32_bf16 v[12:15], a[8:11], v[156:159], v[12:15]
    ds_read_b128 v[168:171], v6 offset:15360
    v_mul_f32 v103, v196, v223
    v_mfma_f32_16x16x32_bf16 v[16:19], a[8:11], v[160:163], v[16:19]
    s_waitcnt lgkmcnt(1)
    ds_read_b128 v[172:175], v6 offset:33792
    ds_read_b128 v[212:215], v7 offset:1536
    v_mfma_f32_16x16x32_bf16 v[20:23], a[8:11], v[164:167], v[20:23]
    ds_read_b128 v[176:179], v240 offset:15360
    ds_read_b128 v[216:219], v7 offset:1552
    v_mfma_f32_16x16x32_bf16 v[24:27], a[12:15], v[152:155], v[24:27]
    buffer_load_dwordx4 a[108:111], v6, s[28:31], s21 offen offset:1024 sc1
    v_mfma_f32_16x16x32_bf16 v[28:31], a[12:15], v[156:159], v[28:31]
    ds_read_b128 v[180:183], v240 offset:33792
    ds_read_b128 v[220:223], v243 offset:1536
    v_mfma_f32_16x16x32_bf16 v[32:35], a[12:15], v[160:163], v[32:35]
    s_waitcnt lgkmcnt(4)
    v_mul_f32 v104, v184, v212
    v_mul_f32 v105, v184, v213
    v_mfma_f32_16x16x32_bf16 v[36:39], a[12:15], v[164:167], v[36:39]
    v_mul_f32 v106, v184, v214
    v_mul_f32 v107, v184, v215
    v_mfma_f32_16x16x32_bf16 v[40:43], a[16:19], v[152:155], v[40:43]
    buffer_load_dwordx4 a[112:115], v6, s[28:31], s21 offen offset:2048 sc1
    v_mfma_f32_16x16x32_bf16 v[44:47], a[16:19], v[156:159], v[44:47]
    v_mul_f32 v108, v188, v212
    v_mul_f32 v109, v188, v213
    v_mfma_f32_16x16x32_bf16 v[48:51], a[16:19], v[160:163], v[48:51]
    v_mul_f32 v110, v188, v214
    v_mul_f32 v111, v188, v215
    v_mfma_f32_16x16x32_bf16 v[52:55], a[16:19], v[164:167], v[52:55]
    s_waitcnt vmcnt(21) lgkmcnt(3)
    v_mul_f32 v112, v192, v212
    v_mul_f32 v113, v192, v213
    v_mfma_f32_16x16x32_bf16 v[8:11], a[20:23], v[168:171], v[8:11]
    buffer_load_dwordx4 a[116:119], v6, s[28:31], s21 offen offset:3072 sc1
    v_mfma_f32_16x16x32_bf16 v[12:15], a[20:23], v[172:175], v[12:15]
    s_add_u32 s21, s21, 4096
    ds_read_b128 v[152:155], v6 offset:16384
    v_mul_f32 v114, v192, v214
    v_mfma_f32_16x16x32_bf16 v[16:19], a[20:23], v[176:179], v[16:19]
    s_waitcnt lgkmcnt(2)
    ds_read_b128 v[156:159], v6 offset:34816
    v_mul_f32 v115, v192, v215
    v_mfma_f32_16x16x32_bf16 v[20:23], a[20:23], v[180:183], v[20:23]
    ds_read_b128 v[160:163], v240 offset:16384
    v_mul_f32 v116, v196, v212
    v_mfma_f32_16x16x32_bf16 v[24:27], a[24:27], v[168:171], v[24:27]
    buffer_load_dwordx4 a[120:123], v6, s[28:31], s21 offen offset:0 sc1
    v_mfma_f32_16x16x32_bf16 v[28:31], a[24:27], v[172:175], v[28:31]
    ds_read_b128 v[164:167], v240 offset:34816
    v_mul_f32 v117, v196, v213
    v_mfma_f32_16x16x32_bf16 v[32:35], a[24:27], v[176:179], v[32:35]
    v_mul_f32 v118, v196, v214
    v_mul_f32 v119, v196, v215
    v_mfma_f32_16x16x32_bf16 v[36:39], a[24:27], v[180:183], v[36:39]
    v_mul_f32 v120, v184, v216
    v_mul_f32 v121, v184, v217
    v_mfma_f32_16x16x32_bf16 v[40:43], a[28:31], v[168:171], v[40:43]
    buffer_load_dwordx4 a[124:127], v6, s[28:31], s21 offen offset:1024 sc1
    v_mfma_f32_16x16x32_bf16 v[44:47], a[28:31], v[172:175], v[44:47]
    v_mul_f32 v122, v184, v218
    v_mul_f32 v123, v184, v219
    v_mfma_f32_16x16x32_bf16 v[48:51], a[28:31], v[176:179], v[48:51]
    v_mul_f32 v124, v188, v216
    v_mul_f32 v125, v188, v217
    v_mfma_f32_16x16x32_bf16 v[52:55], a[28:31], v[180:183], v[52:55]
    s_waitcnt vmcnt(21) lgkmcnt(1)
    v_mul_f32 v126, v188, v218
    v_mul_f32 v127, v188, v219
    v_mfma_f32_16x16x32_bf16 v[8:11], a[32:35], v[152:155], v[8:11]
    buffer_load_dwordx4 a[128:131], v6, s[28:31], s21 offen offset:2048 sc1
    v_mfma_f32_16x16x32_bf16 v[12:15], a[32:35], v[156:159], v[12:15]
    ds_read_b128 v[168:171], v6 offset:17408
    v_mul_f32 v128, v192, v216
    v_mfma_f32_16x16x32_bf16 v[16:19], a[32:35], v[160:163], v[16:19]
    s_waitcnt lgkmcnt(1)
    ds_read_b128 v[172:175], v6 offset:35840
    v_mul_f32 v129, v192, v217
    v_mfma_f32_16x16x32_bf16 v[20:23], a[32:35], v[164:167], v[20:23]
    ds_read_b128 v[176:179], v240 offset:17408
    v_mul_f32 v130, v192, v218
    v_mfma_f32_16x16x32_bf16 v[24:27], a[36:39], v[152:155], v[24:27]
    buffer_load_dwordx4 a[132:135], v6, s[28:31], s21 offen offset:3072 sc1
    v_mfma_f32_16x16x32_bf16 v[28:31], a[36:39], v[156:159], v[28:31]
    s_add_u32 s21, s21, 4096
    ds_read_b128 v[180:183], v240 offset:35840
    v_mul_f32 v131, v192, v219
    v_mfma_f32_16x16x32_bf16 v[32:35], a[36:39], v[160:163], v[32:35]
    v_mul_f32 v132, v196, v216
    v_mul_f32 v133, v196, v217
    v_mfma_f32_16x16x32_bf16 v[36:39], a[36:39], v[164:167], v[36:39]
    v_mul_f32 v134, v196, v218
    v_mul_f32 v135, v196, v219
    v_mfma_f32_16x16x32_bf16 v[40:43], a[40:43], v[152:155], v[40:43]
    buffer_load_dwordx4 a[136:139], v6, s[28:31], s21 offen offset:0 sc1
    v_mfma_f32_16x16x32_bf16 v[44:47], a[40:43], v[156:159], v[44:47]
    v_mul_f32 v136, v184, v220
    v_mul_f32 v137, v184, v221
    v_mfma_f32_16x16x32_bf16 v[48:51], a[40:43], v[160:163], v[48:51]
    v_mul_f32 v138, v184, v222
    v_mul_f32 v139, v184, v223
    v_mfma_f32_16x16x32_bf16 v[52:55], a[40:43], v[164:167], v[52:55]
    s_waitcnt vmcnt(21) lgkmcnt(1)
    v_mul_f32 v140, v188, v220
    v_mul_f32 v141, v188, v221
    v_mfma_f32_16x16x32_bf16 v[8:11], a[44:47], v[168:171], v[8:11]
    buffer_load_dwordx4 a[140:143], v6, s[28:31], s21 offen offset:1024 sc1
    v_mfma_f32_16x16x32_bf16 v[12:15], a[44:47], v[172:175], v[12:15]
    ds_read_b128 v[152:155], v6 offset:0
    v_mul_f32 v142, v188, v222
    v_mfma_f32_16x16x32_bf16 v[16:19], a[44:47], v[176:179], v[16:19]
    s_waitcnt lgkmcnt(1)
    ds_read_b128 v[156:159], v6 offset:18432
    v_mul_f32 v143, v188, v223
    v_mul_f32 v144, v192, v220
    v_mfma_f32_16x16x32_bf16 v[20:23], a[44:47], v[180:183], v[20:23]
    ds_read_b128 v[160:163], v240 offset:0
    v_mul_f32 v145, v192, v221
    v_mfma_f32_16x16x32_bf16 v[24:27], a[48:51], v[168:171], v[24:27]
    buffer_load_dwordx4 a[144:147], v6, s[28:31], s21 offen offset:2048 sc1
    v_mfma_f32_16x16x32_bf16 v[28:31], a[48:51], v[172:175], v[28:31]
    ds_read_b128 v[164:167], v240 offset:18432
    v_mul_f32 v146, v192, v222
    v_mfma_f32_16x16x32_bf16 v[32:35], a[48:51], v[176:179], v[32:35]
    v_mul_f32 v147, v192, v223
    v_mul_f32 v148, v196, v220
    v_mul_f32 v149, v196, v221
    v_mfma_f32_16x16x32_bf16 v[36:39], a[48:51], v[180:183], v[36:39]
    v_mul_f32 v150, v196, v222
    v_mul_f32 v151, v196, v223
    v_mfma_f32_16x16x32_bf16 v[40:43], a[52:55], v[168:171], v[40:43]
    buffer_load_dwordx4 a[148:151], v6, s[28:31], s21 offen offset:3072 sc1
    v_mfma_f32_16x16x32_bf16 v[44:47], a[52:55], v[172:175], v[44:47]
    s_add_u32 s21, s21, 4096
    v_mfma_f32_16x16x32_bf16 v[48:51], a[52:55], v[176:179], v[48:51]
    v_mfma_f32_16x16x32_bf16 v[52:55], a[52:55], v[180:183], v[52:55]
    s_waitcnt vmcnt(21) lgkmcnt(1)
    v_mfma_f32_16x16x32_bf16 v[56:59], a[56:59], v[152:155], v[56:59]
    buffer_load_dwordx4 a[152:155], v6, s[28:31], s21 offen offset:0 sc1
    v_mfma_f32_16x16x32_bf16 v[60:63], a[56:59], v[156:159], v[60:63]
    ds_read_b128 v[168:171], v6 offset:1024
    v_mfma_f32_16x16x32_bf16 v[64:67], a[56:59], v[160:163], v[64:67]
    s_waitcnt lgkmcnt(1)
    ds_read_b128 v[172:175], v6 offset:19456
    v_mfma_f32_16x16x32_bf16 v[68:71], a[56:59], v[164:167], v[68:71]
    ds_read_b128 v[176:179], v240 offset:1024
    v_mfma_f32_16x16x32_bf16 v[72:75], a[60:63], v[152:155], v[72:75]
    buffer_load_dwordx4 a[156:159], v6, s[28:31], s21 offen offset:1024 sc1
    v_mfma_f32_16x16x32_bf16 v[76:79], a[60:63], v[156:159], v[76:79]
    ds_read_b128 v[180:183], v240 offset:19456
    v_fmac_f32 v8, v184, v200
    v_fmac_f32 v9, v184, v201
    v_mfma_f32_16x16x32_bf16 v[80:83], a[60:63], v[160:163], v[80:83]
    v_fmac_f32 v10, v184, v202
    v_fmac_f32 v11, v184, v203
    v_mul_f32 v224, v8, v8
    v_mfma_f32_16x16x32_bf16 v[84:87], a[60:63], v[164:167], v[84:87]
    v_mul_f32 v225, v9, v9
    v_mul_f32 v226, v10, v10
    v_mfma_f32_16x16x32_bf16 v[88:91], a[64:67], v[152:155], v[88:91]
    buffer_load_dwordx4 a[0:3], v6, s[28:31], s21 offen offset:2048 sc1
    v_mul_f32 v227, v11, v11
    v_mfma_f32_16x16x32_bf16 v[92:95], a[64:67], v[156:159], v[92:95]
    v_fma_f32 v224, v224, v187, v186
    v_fma_f32 v225, v225, v187, v186
    v_fma_f32 v226, v226, v187, v186
    v_mfma_f32_16x16x32_bf16 v[96:99], a[64:67], v[160:163], v[96:99]
    v_fma_f32 v227, v227, v187, v186
    v_mul_f32 v224, v224, v8
    v_mfma_f32_16x16x32_bf16 v[100:103], a[64:67], v[164:167], v[100:103]
    s_waitcnt vmcnt(21) lgkmcnt(1)
    v_mul_f32 v225, v225, v9
    v_mul_f32 v226, v226, v10
    v_mul_f32 v227, v227, v11
    v_mfma_f32_16x16x32_bf16 v[56:59], a[68:71], v[168:171], v[56:59]
    buffer_load_dwordx4 a[4:7], v6, s[28:31], s21 offen offset:3072 sc1
    v_mfma_f32_16x16x32_bf16 v[60:63], a[68:71], v[172:175], v[60:63]
    s_add_u32 s21, s21, 4096
    ds_read_b128 v[152:155], v6 offset:2048
    v_exp_f32 v224, v224
    v_mfma_f32_16x16x32_bf16 v[64:67], a[68:71], v[176:179], v[64:67]
    s_waitcnt lgkmcnt(1)
    ds_read_b128 v[156:159], v6 offset:20480
    v_exp_f32 v225, v225
    v_mfma_f32_16x16x32_bf16 v[68:71], a[68:71], v[180:183], v[68:71]
    ds_read_b128 v[160:163], v240 offset:2048
    v_exp_f32 v226, v226
    v_mfma_f32_16x16x32_bf16 v[72:75], a[72:75], v[168:171], v[72:75]
    buffer_load_dwordx4 a[8:11], v6, s[28:31], s21 offen offset:0 sc1
    v_mfma_f32_16x16x32_bf16 v[76:79], a[72:75], v[172:175], v[76:79]
    ds_read_b128 v[164:167], v240 offset:20480
    v_exp_f32 v227, v227
    v_mfma_f32_16x16x32_bf16 v[80:83], a[72:75], v[176:179], v[80:83]
    v_fma_f32 v224, v224, v185, v185
    v_fma_f32 v225, v225, v185, v185
    v_fma_f32 v226, v226, v185, v185
    v_mfma_f32_16x16x32_bf16 v[84:87], a[72:75], v[180:183], v[84:87]
    v_fma_f32 v227, v227, v185, v185
    v_rcp_f32 v224, v224
    v_mfma_f32_16x16x32_bf16 v[88:91], a[76:79], v[168:171], v[88:91]
    buffer_load_dwordx4 a[12:15], v6, s[28:31], s21 offen offset:1024 sc1
    v_mfma_f32_16x16x32_bf16 v[92:95], a[76:79], v[172:175], v[92:95]
    v_rcp_f32 v225, v225
    v_mfma_f32_16x16x32_bf16 v[96:99], a[76:79], v[176:179], v[96:99]
    v_rcp_f32 v226, v226
    v_rcp_f32 v227, v227
    v_mfma_f32_16x16x32_bf16 v[100:103], a[76:79], v[180:183], v[100:103]
    s_waitcnt vmcnt(21) lgkmcnt(1)
    v_mul_f32 v224, v224, v8
    v_mul_f32 v225, v225, v9
    v_mfma_f32_16x16x32_bf16 v[56:59], a[80:83], v[152:155], v[56:59]
    buffer_load_dwordx4 a[16:19], v6, s[28:31], s21 offen offset:2048 sc1
    v_mul_f32 v226, v226, v10
    v_mfma_f32_16x16x32_bf16 v[60:63], a[80:83], v[156:159], v[60:63]
    ds_read_b128 v[168:171], v6 offset:3072
    v_mul_f32 v227, v227, v11
    v_cvt_pk_bf16_f32 v232, v224, v225
    v_mfma_f32_16x16x32_bf16 v[64:67], a[80:83], v[160:163], v[64:67]
    s_waitcnt lgkmcnt(1)
    ds_read_b128 v[172:175], v6 offset:21504
    v_cvt_pk_bf16_f32 v233, v226, v227
    v_mfma_f32_16x16x32_bf16 v[68:71], a[80:83], v[164:167], v[68:71]
    ds_read_b128 v[176:179], v240 offset:3072
    v_fmac_f32 v24, v184, v204
    v_fmac_f32 v25, v184, v205
    v_mfma_f32_16x16x32_bf16 v[72:75], a[84:87], v[152:155], v[72:75]
    buffer_load_dwordx4 a[20:23], v6, s[28:31], s21 offen offset:3072 sc1
    v_fmac_f32 v26, v184, v206
    v_mfma_f32_16x16x32_bf16 v[76:79], a[84:87], v[156:159], v[76:79]
    s_add_u32 s21, s21, 4096
    ds_read_b128 v[180:183], v240 offset:21504
    v_fmac_f32 v27, v184, v207
    v_mfma_f32_16x16x32_bf16 v[80:83], a[84:87], v[160:163], v[80:83]
    v_mul_f32 v228, v24, v24
    v_mul_f32 v229, v25, v25
    v_mul_f32 v230, v26, v26
    v_mfma_f32_16x16x32_bf16 v[84:87], a[84:87], v[164:167], v[84:87]
    v_mul_f32 v231, v27, v27
    v_fma_f32 v228, v228, v187, v186
    v_fma_f32 v229, v229, v187, v186
    v_mfma_f32_16x16x32_bf16 v[88:91], a[88:91], v[152:155], v[88:91]
    buffer_load_dwordx4 a[24:27], v6, s[28:31], s21 offen offset:0 sc1
    v_mfma_f32_16x16x32_bf16 v[92:95], a[88:91], v[156:159], v[92:95]
    v_fma_f32 v230, v230, v187, v186
    v_fma_f32 v231, v231, v187, v186
    v_mul_f32 v228, v228, v24
    v_mfma_f32_16x16x32_bf16 v[96:99], a[88:91], v[160:163], v[96:99]
    v_mul_f32 v229, v229, v25
    v_mul_f32 v230, v230, v26
    v_mul_f32 v231, v231, v27
    v_mfma_f32_16x16x32_bf16 v[100:103], a[88:91], v[164:167], v[100:103]
    s_waitcnt vmcnt(21) lgkmcnt(1)
    v_exp_f32 v228, v228
    v_mfma_f32_16x16x32_bf16 v[56:59], a[92:95], v[168:171], v[56:59]
    buffer_load_dwordx4 a[28:31], v6, s[28:31], s21 offen offset:1024 sc1
    v_mfma_f32_16x16x32_bf16 v[60:63], a[92:95], v[172:175], v[60:63]
    ds_read_b128 v[152:155], v6 offset:4096
    v_exp_f32 v229, v229
    v_mfma_f32_16x16x32_bf16 v[64:67], a[92:95], v[176:179], v[64:67]
    s_waitcnt lgkmcnt(1)
    ds_read_b128 v[156:159], v6 offset:22528
    v_exp_f32 v230, v230
    v_mfma_f32_16x16x32_bf16 v[68:71], a[92:95], v[180:183], v[68:71]
    ds_read_b128 v[160:163], v240 offset:4096
    v_exp_f32 v231, v231
    v_mfma_f32_16x16x32_bf16 v[72:75], a[96:99], v[168:171], v[72:75]
    buffer_load_dwordx4 a[32:35], v6, s[28:31], s21 offen offset:2048 sc1
    v_fma_f32 v228, v228, v185, v185
    v_mfma_f32_16x16x32_bf16 v[76:79], a[96:99], v[172:175], v[76:79]
    ds_read_b128 v[164:167], v240 offset:22528
    v_fma_f32 v229, v229, v185, v185
    v_fma_f32 v230, v230, v185, v185
    v_mfma_f32_16x16x32_bf16 v[80:83], a[96:99], v[176:179], v[80:83]
    v_fma_f32 v231, v231, v185, v185
    v_rcp_f32 v228, v228
    v_mfma_f32_16x16x32_bf16 v[84:87], a[96:99], v[180:183], v[84:87]
    v_rcp_f32 v229, v229
    v_mfma_f32_16x16x32_bf16 v[88:91], a[100:103], v[168:171], v[88:91]
    buffer_load_dwordx4 a[36:39], v6, s[28:31], s21 offen offset:3072 sc1
    v_mfma_f32_16x16x32_bf16 v[92:95], a[100:103], v[172:175], v[92:95]
    s_add_u32 s21, s21, 4096
    v_rcp_f32 v230, v230
    v_mfma_f32_16x16x32_bf16 v[96:99], a[100:103], v[176:179], v[96:99]
    v_rcp_f32 v231, v231
    v_mul_f32 v228, v228, v24
    v_mul_f32 v229, v229, v25
    v_mfma_f32_16x16x32_bf16 v[100:103], a[100:103], v[180:183], v[100:103]
    s_waitcnt vmcnt(21) lgkmcnt(1)
    v_mul_f32 v230, v230, v26
    v_mul_f32 v231, v231, v27
    v_cvt_pk_bf16_f32 v234, v228, v229
    v_mfma_f32_16x16x32_bf16 v[56:59], a[104:107], v[152:155], v[56:59]
    buffer_load_dwordx4 a[40:43], v6, s[28:31], s21 offen offset:0 sc1
    v_mfma_f32_16x16x32_bf16 v[60:63], a[104:107], v[156:159], v[60:63]
    ds_read_b128 v[168:171], v6 offset:5120
    v_cvt_pk_bf16_f32 v235, v230, v231
    v_mfma_f32_16x16x32_bf16 v[64:67], a[104:107], v[160:163], v[64:67]
    s_waitcnt lgkmcnt(1)
    ds_read_b128 v[172:175], v6 offset:23552
    ds_write_b128 v1, v[232:235] offset:0
    v_mfma_f32_16x16x32_bf16 v[68:71], a[104:107], v[164:167], v[68:71]
    ds_read_b128 v[176:179], v240 offset:5120
    v_fmac_f32 v40, v184, v208
    v_mfma_f32_16x16x32_bf16 v[72:75], a[108:111], v[152:155], v[72:75]
    buffer_load_dwordx4 a[44:47], v6, s[28:31], s21 offen offset:1024 sc1
    v_mfma_f32_16x16x32_bf16 v[76:79], a[108:111], v[156:159], v[76:79]
    ds_read_b128 v[180:183], v240 offset:23552
    v_fmac_f32 v41, v184, v209
    v_mfma_f32_16x16x32_bf16 v[80:83], a[108:111], v[160:163], v[80:83]
    v_fmac_f32 v42, v184, v210
    v_fmac_f32 v43, v184, v211
    v_mul_f32 v224, v40, v40
    v_mfma_f32_16x16x32_bf16 v[84:87], a[108:111], v[164:167], v[84:87]
    v_mul_f32 v225, v41, v41
    v_mul_f32 v226, v42, v42
    v_mfma_f32_16x16x32_bf16 v[88:91], a[112:115], v[152:155], v[88:91]
    buffer_load_dwordx4 a[48:51], v6, s[28:31], s21 offen offset:2048 sc1
    v_mul_f32 v227, v43, v43
    v_mfma_f32_16x16x32_bf16 v[92:95], a[112:115], v[156:159], v[92:95]
    v_fma_f32 v224, v224, v187, v186
    v_fma_f32 v225, v225, v187, v186
    v_fma_f32 v226, v226, v187, v186
    v_mfma_f32_16x16x32_bf16 v[96:99], a[112:115], v[160:163], v[96:99]
    v_fma_f32 v227, v227, v187, v186
    v_mul_f32 v224, v224, v40
    v_mfma_f32_16x16x32_bf16 v[100:103], a[112:115], v[164:167], v[100:103]
    s_waitcnt vmcnt(21) lgkmcnt(1)
    v_mul_f32 v225, v225, v41
    v_mul_f32 v226, v226, v42
    v_mul_f32 v227, v227, v43
    v_mfma_f32_16x16x32_bf16 v[56:59], a[116:119], v[168:171], v[56:59]
    buffer_load_dwordx4 a[52:55], v6, s[28:31], s21 offen offset:3072 sc1
    v_mfma_f32_16x16x32_bf16 v[60:63], a[116:119], v[172:175], v[60:63]
    s_add_u32 s21, s21, 4096
    ds_read_b128 v[152:155], v6 offset:6144
    v_exp_f32 v224, v224
    v_mfma_f32_16x16x32_bf16 v[64:67], a[116:119], v[176:179], v[64:67]
    s_waitcnt lgkmcnt(1)
    ds_read_b128 v[156:159], v6 offset:24576
    v_exp_f32 v225, v225
    v_mfma_f32_16x16x32_bf16 v[68:71], a[116:119], v[180:183], v[68:71]
    ds_read_b128 v[160:163], v240 offset:6144
    v_exp_f32 v226, v226
    v_mfma_f32_16x16x32_bf16 v[72:75], a[120:123], v[168:171], v[72:75]
    buffer_load_dwordx4 a[56:59], v6, s[28:31], s21 offen offset:0 sc1
    v_mfma_f32_16x16x32_bf16 v[76:79], a[120:123], v[172:175], v[76:79]
    ds_read_b128 v[164:167], v240 offset:24576
    v_exp_f32 v227, v227
    v_mfma_f32_16x16x32_bf16 v[80:83], a[120:123], v[176:179], v[80:83]
    v_fma_f32 v224, v224, v185, v185
    v_fma_f32 v225, v225, v185, v185
    v_fma_f32 v226, v226, v185, v185
    v_mfma_f32_16x16x32_bf16 v[84:87], a[120:123], v[180:183], v[84:87]
    v_fma_f32 v227, v227, v185, v185
    v_rcp_f32 v224, v224
    v_mfma_f32_16x16x32_bf16 v[88:91], a[124:127], v[168:171], v[88:91]
    buffer_load_dwordx4 a[60:63], v6, s[28:31], s21 offen offset:1024 sc1
    v_mfma_f32_16x16x32_bf16 v[92:95], a[124:127], v[172:175], v[92:95]
    v_rcp_f32 v225, v225
    v_mfma_f32_16x16x32_bf16 v[96:99], a[124:127], v[176:179], v[96:99]
    v_rcp_f32 v226, v226
    v_rcp_f32 v227, v227
    v_mfma_f32_16x16x32_bf16 v[100:103], a[124:127], v[180:183], v[100:103]
    s_waitcnt vmcnt(21) lgkmcnt(1)
    v_mul_f32 v224, v224, v40
    v_mul_f32 v225, v225, v41
    v_mfma_f32_16x16x32_bf16 v[56:59], a[128:131], v[152:155], v[56:59]
    buffer_load_dwordx4 a[64:67], v6, s[28:31], s21 offen offset:2048 sc1
    v_mul_f32 v226, v226, v42
    v_mfma_f32_16x16x32_bf16 v[60:63], a[128:131], v[156:159], v[60:63]
    ds_read_b128 v[168:171], v6 offset:7168
    v_mul_f32 v227, v227, v43
    v_cvt_pk_bf16_f32 v236, v224, v225
    v_mfma_f32_16x16x32_bf16 v[64:67], a[128:131], v[160:163], v[64:67]
    s_waitcnt lgkmcnt(1)
    ds_read_b128 v[172:175], v6 offset:25600
    v_cvt_pk_bf16_f32 v237, v226, v227
    v_mfma_f32_16x16x32_bf16 v[68:71], a[128:131], v[164:167], v[68:71]
    ds_read_b128 v[176:179], v240 offset:7168
    ds_write_b64 v2, v[236:237] offset:0
    v_mfma_f32_16x16x32_bf16 v[72:75], a[132:135], v[152:155], v[72:75]
    buffer_load_dwordx4 a[68:71], v6, s[28:31], s21 offen offset:3072 sc1
    v_mfma_f32_16x16x32_bf16 v[76:79], a[132:135], v[156:159], v[76:79]
    s_add_u32 s21, s21, 4096
    ds_read_b128 v[180:183], v240 offset:25600
    v_fmac_f32 v12, v188, v200
    v_mfma_f32_16x16x32_bf16 v[80:83], a[132:135], v[160:163], v[80:83]
    v_fmac_f32 v13, v188, v201
    v_fmac_f32 v14, v188, v202
    v_fmac_f32 v15, v188, v203
    v_mfma_f32_16x16x32_bf16 v[84:87], a[132:135], v[164:167], v[84:87]
    v_mul_f32 v228, v12, v12
    v_mul_f32 v229, v13, v13
    v_mul_f32 v230, v14, v14
    v_mfma_f32_16x16x32_bf16 v[88:91], a[136:139], v[152:155], v[88:91]
    buffer_load_dwordx4 a[72:75], v6, s[28:31], s21 offen offset:0 sc1
    v_mfma_f32_16x16x32_bf16 v[92:95], a[136:139], v[156:159], v[92:95]
    v_mul_f32 v231, v15, v15
    v_fma_f32 v228, v228, v191, v190
    v_fma_f32 v229, v229, v191, v190
    v_mfma_f32_16x16x32_bf16 v[96:99], a[136:139], v[160:163], v[96:99]
    v_fma_f32 v230, v230, v191, v190
    v_fma_f32 v231, v231, v191, v190
    v_mul_f32 v228, v228, v12
    v_mfma_f32_16x16x32_bf16 v[100:103], a[136:139], v[164:167], v[100:103]
    s_waitcnt vmcnt(21) lgkmcnt(2)
    v_mul_f32 v229, v229, v13
    v_mul_f32 v230, v230, v14
    v_mul_f32 v231, v231, v15
    v_mfma_f32_16x16x32_bf16 v[56:59], a[140:143], v[168:171], v[56:59]
    buffer_load_dwordx4 a[76:79], v6, s[28:31], s21 offen offset:1024 sc1
    v_mfma_f32_16x16x32_bf16 v[60:63], a[140:143], v[172:175], v[60:63]
    ds_read_b128 v[152:155], v6 offset:8192
    v_exp_f32 v228, v228
    v_mfma_f32_16x16x32_bf16 v[64:67], a[140:143], v[176:179], v[64:67]
    s_waitcnt lgkmcnt(1)
    ds_read_b128 v[156:159], v6 offset:26624
    v_exp_f32 v229, v229
    v_mfma_f32_16x16x32_bf16 v[68:71], a[140:143], v[180:183], v[68:71]
    ds_read_b128 v[160:163], v240 offset:8192
    v_exp_f32 v230, v230
    v_mfma_f32_16x16x32_bf16 v[72:75], a[144:147], v[168:171], v[72:75]
    buffer_load_dwordx4 a[80:83], v6, s[28:31], s21 offen offset:2048 sc1
    v_mfma_f32_16x16x32_bf16 v[76:79], a[144:147], v[172:175], v[76:79]
    ds_read_b128 v[164:167], v240 offset:26624
    v_exp_f32 v231, v231
    v_mfma_f32_16x16x32_bf16 v[80:83], a[144:147], v[176:179], v[80:83]
    v_fma_f32 v228, v228, v189, v189
    v_fma_f32 v229, v229, v189, v189
    v_mfma_f32_16x16x32_bf16 v[84:87], a[144:147], v[180:183], v[84:87]
    v_fma_f32 v230, v230, v189, v189
    v_fma_f32 v231, v231, v189, v189
    v_mfma_f32_16x16x32_bf16 v[88:91], a[148:151], v[168:171], v[88:91]
    buffer_load_dwordx4 a[84:87], v6, s[28:31], s21 offen offset:3072 sc1
    v_rcp_f32 v228, v228
    v_mfma_f32_16x16x32_bf16 v[92:95], a[148:151], v[172:175], v[92:95]
    s_add_u32 s21, s21, 4096
    v_rcp_f32 v229, v229
    v_mfma_f32_16x16x32_bf16 v[96:99], a[148:151], v[176:179], v[96:99]
    v_rcp_f32 v230, v230
    v_mfma_f32_16x16x32_bf16 v[100:103], a[148:151], v[180:183], v[100:103]
    s_waitcnt vmcnt(21) lgkmcnt(1)
    v_rcp_f32 v231, v231
    v_mul_f32 v228, v228, v12
    v_mul_f32 v229, v229, v13
    v_mfma_f32_16x16x32_bf16 v[56:59], a[152:155], v[152:155], v[56:59]
    buffer_load_dwordx4 a[88:91], v6, s[28:31], s21 offen offset:0 sc1
    v_mfma_f32_16x16x32_bf16 v[60:63], a[152:155], v[156:159], v[60:63]
    ds_read_b128 v[168:171], v6 offset:9216
    v_mul_f32 v230, v230, v14
    v_mul_f32 v231, v231, v15
    v_mfma_f32_16x16x32_bf16 v[64:67], a[152:155], v[160:163], v[64:67]
    s_waitcnt lgkmcnt(1)
    ds_read_b128 v[172:175], v6 offset:27648
    v_cvt_pk_bf16_f32 v232, v228, v229
    v_cvt_pk_bf16_f32 v233, v230, v231
    v_mfma_f32_16x16x32_bf16 v[68:71], a[152:155], v[164:167], v[68:71]
    ds_read_b128 v[176:179], v240 offset:9216
    v_fmac_f32 v28, v188, v204
    v_fmac_f32 v29, v188, v205
    v_mfma_f32_16x16x32_bf16 v[72:75], a[156:159], v[152:155], v[72:75]
    buffer_load_dwordx4 a[92:95], v6, s[28:31], s21 offen offset:1024 sc1
    v_mfma_f32_16x16x32_bf16 v[76:79], a[156:159], v[156:159], v[76:79]
    ds_read_b128 v[180:183], v240 offset:27648
    v_fmac_f32 v30, v188, v206
    v_fmac_f32 v31, v188, v207
    v_mfma_f32_16x16x32_bf16 v[80:83], a[156:159], v[160:163], v[80:83]
    v_mul_f32 v224, v28, v28
    v_mul_f32 v225, v29, v29
    v_mul_f32 v226, v30, v30
    v_mfma_f32_16x16x32_bf16 v[84:87], a[156:159], v[164:167], v[84:87]
    v_mul_f32 v227, v31, v31
    v_fma_f32 v224, v224, v191, v190
    v_mfma_f32_16x16x32_bf16 v[88:91], a[0:3], v[152:155], v[88:91]
    buffer_load_dwordx4 a[96:99], v6, s[28:31], s21 offen offset:2048 sc1
    v_fma_f32 v225, v225, v191, v190
    v_mfma_f32_16x16x32_bf16 v[92:95], a[0:3], v[156:159], v[92:95]
    v_fma_f32 v226, v226, v191, v190
    v_fma_f32 v227, v227, v191, v190
    v_mul_f32 v224, v224, v28
    v_mfma_f32_16x16x32_bf16 v[96:99], a[0:3], v[160:163], v[96:99]
    v_mul_f32 v225, v225, v29
    v_mul_f32 v226, v226, v30
    v_mfma_f32_16x16x32_bf16 v[100:103], a[0:3], v[164:167], v[100:103]
    s_waitcnt vmcnt(21) lgkmcnt(1)
    v_mul_f32 v227, v227, v31
    v_exp_f32 v224, v224
    v_mfma_f32_16x16x32_bf16 v[56:59], a[4:7], v[168:171], v[56:59]
    buffer_load_dwordx4 a[100:103], v6, s[28:31], s21 offen offset:3072 sc1
    v_mfma_f32_16x16x32_bf16 v[60:63], a[4:7], v[172:175], v[60:63]
    s_add_u32 s21, s21, 4096
    ds_read_b128 v[152:155], v6 offset:10240
    v_exp_f32 v225, v225
    v_mfma_f32_16x16x32_bf16 v[64:67], a[4:7], v[176:179], v[64:67]
    s_waitcnt lgkmcnt(1)
    ds_read_b128 v[156:159], v6 offset:28672
    v_exp_f32 v226, v226
    v_mfma_f32_16x16x32_bf16 v[68:71], a[4:7], v[180:183], v[68:71]
    ds_read_b128 v[160:163], v240 offset:10240
    v_exp_f32 v227, v227
    v_mfma_f32_16x16x32_bf16 v[72:75], a[8:11], v[168:171], v[72:75]
    buffer_load_dwordx4 a[104:107], v6, s[28:31], s21 offen offset:0 sc1
    v_fma_f32 v224, v224, v189, v189
    v_mfma_f32_16x16x32_bf16 v[76:79], a[8:11], v[172:175], v[76:79]
    ds_read_b128 v[164:167], v240 offset:28672
    v_fma_f32 v225, v225, v189, v189
    v_mfma_f32_16x16x32_bf16 v[80:83], a[8:11], v[176:179], v[80:83]
    v_fma_f32 v226, v226, v189, v189
    v_fma_f32 v227, v227, v189, v189
    v_mfma_f32_16x16x32_bf16 v[84:87], a[8:11], v[180:183], v[84:87]
    v_rcp_f32 v224, v224
    v_rcp_f32 v225, v225
    v_mfma_f32_16x16x32_bf16 v[88:91], a[12:15], v[168:171], v[88:91]
    buffer_load_dwordx4 a[108:111], v6, s[28:31], s21 offen offset:1024 sc1
    v_mfma_f32_16x16x32_bf16 v[92:95], a[12:15], v[172:175], v[92:95]
    v_rcp_f32 v226, v226
    v_mfma_f32_16x16x32_bf16 v[96:99], a[12:15], v[176:179], v[96:99]
    v_rcp_f32 v227, v227
    v_mul_f32 v224, v224, v28
    v_mul_f32 v225, v225, v29
    v_mfma_f32_16x16x32_bf16 v[100:103], a[12:15], v[180:183], v[100:103]
    s_waitcnt vmcnt(21) lgkmcnt(1)
    v_mul_f32 v226, v226, v30
    v_mul_f32 v227, v227, v31
    v_mfma_f32_16x16x32_bf16 v[56:59], a[16:19], v[152:155], v[56:59]
    buffer_load_dwordx4 a[112:115], v6, s[28:31], s22 offen offset:0 sc1
    v_cvt_pk_bf16_f32 v234, v224, v225
    v_mfma_f32_16x16x32_bf16 v[60:63], a[16:19], v[156:159], v[60:63]
    ds_read_b128 v[168:171], v6 offset:11264
    v_cvt_pk_bf16_f32 v235, v226, v227
    v_mfma_f32_16x16x32_bf16 v[64:67], a[16:19], v[160:163], v[64:67]
    s_waitcnt lgkmcnt(1)
    ds_read_b128 v[172:175], v6 offset:29696
    ds_write_b128 v1, v[232:235] offset:1024
    v_mfma_f32_16x16x32_bf16 v[68:71], a[16:19], v[164:167], v[68:71]
    ds_read_b128 v[176:179], v240 offset:11264
    v_fmac_f32 v44, v188, v208
    v_mfma_f32_16x16x32_bf16 v[72:75], a[20:23], v[152:155], v[72:75]
    buffer_load_dwordx4 a[116:119], v6, s[28:31], s22 offen offset:1024 sc1
    v_mfma_f32_16x16x32_bf16 v[76:79], a[20:23], v[156:159], v[76:79]
    ds_read_b128 v[180:183], v240 offset:29696
    v_fmac_f32 v45, v188, v209
    v_mfma_f32_16x16x32_bf16 v[80:83], a[20:23], v[160:163], v[80:83]
    v_fmac_f32 v46, v188, v210
    v_fmac_f32 v47, v188, v211
    v_mfma_f32_16x16x32_bf16 v[84:87], a[20:23], v[164:167], v[84:87]
    v_mul_f32 v228, v44, v44
    v_mul_f32 v229, v45, v45
    v_mul_f32 v230, v46, v46
    v_mfma_f32_16x16x32_bf16 v[88:91], a[24:27], v[152:155], v[88:91]
    buffer_load_dwordx4 a[120:123], v6, s[28:31], s22 offen offset:2048 sc1
    v_mfma_f32_16x16x32_bf16 v[92:95], a[24:27], v[156:159], v[92:95]
    v_mul_f32 v231, v47, v47
    v_fma_f32 v228, v228, v191, v190
    v_fma_f32 v229, v229, v191, v190
    v_mfma_f32_16x16x32_bf16 v[96:99], a[24:27], v[160:163], v[96:99]
    v_fma_f32 v230, v230, v191, v190
    v_fma_f32 v231, v231, v191, v190
    v_mul_f32 v228, v228, v44
    v_mfma_f32_16x16x32_bf16 v[100:103], a[24:27], v[164:167], v[100:103]
    s_waitcnt vmcnt(21) lgkmcnt(1)
    v_mul_f32 v229, v229, v45
    v_mul_f32 v230, v230, v46
    v_mul_f32 v231, v231, v47
    v_mfma_f32_16x16x32_bf16 v[56:59], a[28:31], v[168:171], v[56:59]
    buffer_load_dwordx4 a[124:127], v6, s[28:31], s22 offen offset:3072 sc1
    v_mfma_f32_16x16x32_bf16 v[60:63], a[28:31], v[172:175], v[60:63]
    s_add_u32 s22, s22, 4096
    ds_read_b128 v[152:155], v6 offset:12288
    v_exp_f32 v228, v228
    v_mfma_f32_16x16x32_bf16 v[64:67], a[28:31], v[176:179], v[64:67]
    s_waitcnt lgkmcnt(1)
    ds_read_b128 v[156:159], v6 offset:30720
    v_exp_f32 v229, v229
    v_mfma_f32_16x16x32_bf16 v[68:71], a[28:31], v[180:183], v[68:71]
    ds_read_b128 v[160:163], v240 offset:12288
    v_exp_f32 v230, v230
    v_mfma_f32_16x16x32_bf16 v[72:75], a[32:35], v[168:171], v[72:75]
    buffer_load_dwordx4 a[128:131], v6, s[28:31], s22 offen offset:0 sc1
    v_mfma_f32_16x16x32_bf16 v[76:79], a[32:35], v[172:175], v[76:79]
    ds_read_b128 v[164:167], v240 offset:30720
    v_exp_f32 v231, v231
    v_mfma_f32_16x16x32_bf16 v[80:83], a[32:35], v[176:179], v[80:83]
    v_fma_f32 v228, v228, v189, v189
    v_fma_f32 v229, v229, v189, v189
    v_mfma_f32_16x16x32_bf16 v[84:87], a[32:35], v[180:183], v[84:87]
    v_fma_f32 v230, v230, v189, v189
    v_fma_f32 v231, v231, v189, v189
    v_mfma_f32_16x16x32_bf16 v[88:91], a[36:39], v[168:171], v[88:91]
    buffer_load_dwordx4 a[132:135], v6, s[28:31], s22 offen offset:1024 sc1
    v_rcp_f32 v228, v228
    v_mfma_f32_16x16x32_bf16 v[92:95], a[36:39], v[172:175], v[92:95]
    v_rcp_f32 v229, v229
    v_mfma_f32_16x16x32_bf16 v[96:99], a[36:39], v[176:179], v[96:99]
    v_rcp_f32 v230, v230
    v_mfma_f32_16x16x32_bf16 v[100:103], a[36:39], v[180:183], v[100:103]
    s_waitcnt vmcnt(21) lgkmcnt(1)
    v_rcp_f32 v231, v231
    v_mul_f32 v228, v228, v44
    v_mul_f32 v229, v229, v45
    v_mfma_f32_16x16x32_bf16 v[56:59], a[40:43], v[152:155], v[56:59]
    buffer_load_dwordx4 a[136:139], v6, s[28:31], s22 offen offset:2048 sc1
    v_mul_f32 v230, v230, v46
    v_mfma_f32_16x16x32_bf16 v[60:63], a[40:43], v[156:159], v[60:63]
    ds_read_b128 v[168:171], v6 offset:13312
    v_mul_f32 v231, v231, v47
    v_mfma_f32_16x16x32_bf16 v[64:67], a[40:43], v[160:163], v[64:67]
    s_waitcnt lgkmcnt(1)
    ds_read_b128 v[172:175], v6 offset:31744
    v_cvt_pk_bf16_f32 v236, v228, v229
    v_cvt_pk_bf16_f32 v237, v230, v231
    v_mfma_f32_16x16x32_bf16 v[68:71], a[40:43], v[164:167], v[68:71]
    ds_read_b128 v[176:179], v240 offset:13312
    ds_write_b64 v2, v[236:237] offset:1024
    v_mfma_f32_16x16x32_bf16 v[72:75], a[44:47], v[152:155], v[72:75]
    buffer_load_dwordx4 a[140:143], v6, s[28:31], s22 offen offset:3072 sc1
    v_mfma_f32_16x16x32_bf16 v[76:79], a[44:47], v[156:159], v[76:79]
    s_add_u32 s22, s22, 4096
    ds_read_b128 v[180:183], v240 offset:31744
    v_fmac_f32 v16, v192, v200
    v_mfma_f32_16x16x32_bf16 v[80:83], a[44:47], v[160:163], v[80:83]
    v_fmac_f32 v17, v192, v201
    v_fmac_f32 v18, v192, v202
    v_fmac_f32 v19, v192, v203
    v_mfma_f32_16x16x32_bf16 v[84:87], a[44:47], v[164:167], v[84:87]
    v_mul_f32 v224, v16, v16
    v_mul_f32 v225, v17, v17
    v_mfma_f32_16x16x32_bf16 v[88:91], a[48:51], v[152:155], v[88:91]
    buffer_load_dwordx4 a[144:147], v6, s[28:31], s22 offen offset:0 sc1
    v_mul_f32 v226, v18, v18
    v_mfma_f32_16x16x32_bf16 v[92:95], a[48:51], v[156:159], v[92:95]
    v_mul_f32 v227, v19, v19
    v_fma_f32 v224, v224, v195, v194
    v_fma_f32 v225, v225, v195, v194
    v_mfma_f32_16x16x32_bf16 v[96:99], a[48:51], v[160:163], v[96:99]
    v_fma_f32 v226, v226, v195, v194
    v_fma_f32 v227, v227, v195, v194
    v_mfma_f32_16x16x32_bf16 v[100:103], a[48:51], v[164:167], v[100:103]
    s_waitcnt vmcnt(21) lgkmcnt(2)
    v_mul_f32 v224, v224, v16
    v_mul_f32 v225, v225, v17
    v_mul_f32 v226, v226, v18
    v_mfma_f32_16x16x32_bf16 v[56:59], a[52:55], v[168:171], v[56:59]
    buffer_load_dwordx4 a[148:151], v6, s[28:31], s22 offen offset:1024 sc1
    v_mul_f32 v227, v227, v19
    v_mfma_f32_16x16x32_bf16 v[60:63], a[52:55], v[172:175], v[60:63]
    ds_read_b128 v[152:155], v6 offset:14336
    v_exp_f32 v224, v224
    v_mfma_f32_16x16x32_bf16 v[64:67], a[52:55], v[176:179], v[64:67]
    s_waitcnt lgkmcnt(1)
    ds_read_b128 v[156:159], v6 offset:32768
    v_exp_f32 v225, v225
    v_mfma_f32_16x16x32_bf16 v[68:71], a[52:55], v[180:183], v[68:71]
    ds_read_b128 v[160:163], v240 offset:14336
    v_exp_f32 v226, v226
    v_mfma_f32_16x16x32_bf16 v[72:75], a[56:59], v[168:171], v[72:75]
    buffer_load_dwordx4 a[152:155], v6, s[28:31], s22 offen offset:2048 sc1
    v_mfma_f32_16x16x32_bf16 v[76:79], a[56:59], v[172:175], v[76:79]
    ds_read_b128 v[164:167], v240 offset:32768
    v_exp_f32 v227, v227
    v_mfma_f32_16x16x32_bf16 v[80:83], a[56:59], v[176:179], v[80:83]
    v_fma_f32 v224, v224, v193, v193
    v_fma_f32 v225, v225, v193, v193
    v_mfma_f32_16x16x32_bf16 v[84:87], a[56:59], v[180:183], v[84:87]
    v_fma_f32 v226, v226, v193, v193
    v_fma_f32 v227, v227, v193, v193
    v_mfma_f32_16x16x32_bf16 v[88:91], a[60:63], v[168:171], v[88:91]
    buffer_load_dwordx4 a[156:159], v6, s[28:31], s22 offen offset:3072 sc1
    v_mfma_f32_16x16x32_bf16 v[92:95], a[60:63], v[172:175], v[92:95]
    s_add_u32 s22, s22, 4096
    v_rcp_f32 v224, v224
    v_rcp_f32 v225, v225
    v_mfma_f32_16x16x32_bf16 v[96:99], a[60:63], v[176:179], v[96:99]
    v_rcp_f32 v226, v226
    v_mfma_f32_16x16x32_bf16 v[100:103], a[60:63], v[180:183], v[100:103]
    s_waitcnt vmcnt(21) lgkmcnt(1)
    v_rcp_f32 v227, v227
    v_mul_f32 v224, v224, v16
    v_mfma_f32_16x16x32_bf16 v[56:59], a[64:67], v[152:155], v[56:59]
    buffer_load_dwordx4 a[0:3], v6, s[28:31], s22 offen offset:0 sc1
    v_mul_f32 v225, v225, v17
    v_mfma_f32_16x16x32_bf16 v[60:63], a[64:67], v[156:159], v[60:63]
    ds_read_b128 v[168:171], v6 offset:15360
    v_mul_f32 v226, v226, v18
    v_mul_f32 v227, v227, v19
    v_mfma_f32_16x16x32_bf16 v[64:67], a[64:67], v[160:163], v[64:67]
    s_waitcnt lgkmcnt(1)
    ds_read_b128 v[172:175], v6 offset:33792
    v_cvt_pk_bf16_f32 v232, v224, v225
    v_mfma_f32_16x16x32_bf16 v[68:71], a[64:67], v[164:167], v[68:71]
    ds_read_b128 v[176:179], v240 offset:15360
    v_cvt_pk_bf16_f32 v233, v226, v227
    v_fmac_f32 v32, v192, v204
    v_mfma_f32_16x16x32_bf16 v[72:75], a[68:71], v[152:155], v[72:75]
    buffer_load_dwordx4 a[4:7], v6, s[28:31], s22 offen offset:1024 sc1
    v_fmac_f32 v33, v192, v205
    v_mfma_f32_16x16x32_bf16 v[76:79], a[68:71], v[156:159], v[76:79]
    ds_read_b128 v[180:183], v240 offset:33792
    v_fmac_f32 v34, v192, v206
    v_mfma_f32_16x16x32_bf16 v[80:83], a[68:71], v[160:163], v[80:83]
    v_fmac_f32 v35, v192, v207
    v_mul_f32 v228, v32, v32
    v_mul_f32 v229, v33, v33
    v_mfma_f32_16x16x32_bf16 v[84:87], a[68:71], v[164:167], v[84:87]
    v_mul_f32 v230, v34, v34
    v_mul_f32 v231, v35, v35
    v_fma_f32 v228, v228, v195, v194
    v_mfma_f32_16x16x32_bf16 v[88:91], a[72:75], v[152:155], v[88:91]
    buffer_load_dwordx4 a[8:11], v6, s[28:31], s22 offen offset:2048 sc1
    v_mfma_f32_16x16x32_bf16 v[92:95], a[72:75], v[156:159], v[92:95]
    v_fma_f32 v229, v229, v195, v194
    v_fma_f32 v230, v230, v195, v194
    v_fma_f32 v231, v231, v195, v194
    v_mfma_f32_16x16x32_bf16 v[96:99], a[72:75], v[160:163], v[96:99]
    v_mul_f32 v228, v228, v32
    v_mul_f32 v229, v229, v33
    v_mul_f32 v230, v230, v34
    v_mfma_f32_16x16x32_bf16 v[100:103], a[72:75], v[164:167], v[100:103]
    s_waitcnt vmcnt(21) lgkmcnt(1)
    v_mul_f32 v231, v231, v35
    v_exp_f32 v228, v228
    v_mfma_f32_16x16x32_bf16 v[56:59], a[76:79], v[168:171], v[56:59]
    buffer_load_dwordx4 a[12:15], v6, s[28:31], s22 offen offset:3072 sc1
    v_mfma_f32_16x16x32_bf16 v[60:63], a[76:79], v[172:175], v[60:63]
    s_add_u32 s22, s22, 4096
    ds_read_b128 v[152:155], v6 offset:16384
    v_exp_f32 v229, v229
    v_mfma_f32_16x16x32_bf16 v[64:67], a[76:79], v[176:179], v[64:67]
    s_waitcnt lgkmcnt(1)
    ds_read_b128 v[156:159], v6 offset:34816
    v_exp_f32 v230, v230
    v_mfma_f32_16x16x32_bf16 v[68:71], a[76:79], v[180:183], v[68:71]
    ds_read_b128 v[160:163], v240 offset:16384
    v_exp_f32 v231, v231
    v_mfma_f32_16x16x32_bf16 v[72:75], a[80:83], v[168:171], v[72:75]
    buffer_load_dwordx4 a[16:19], v6, s[28:31], s22 offen offset:0 sc1
    v_mfma_f32_16x16x32_bf16 v[76:79], a[80:83], v[172:175], v[76:79]
    ds_read_b128 v[164:167], v240 offset:34816
    v_fma_f32 v228, v228, v193, v193
    v_fma_f32 v229, v229, v193, v193
    v_mfma_f32_16x16x32_bf16 v[80:83], a[80:83], v[176:179], v[80:83]
    v_fma_f32 v230, v230, v193, v193
    v_fma_f32 v231, v231, v193, v193
    v_mfma_f32_16x16x32_bf16 v[84:87], a[80:83], v[180:183], v[84:87]
    v_rcp_f32 v228, v228
    v_mfma_f32_16x16x32_bf16 v[88:91], a[84:87], v[168:171], v[88:91]
    buffer_load_dwordx4 a[20:23], v6, s[28:31], s22 offen offset:1024 sc1
    v_rcp_f32 v229, v229
    v_mfma_f32_16x16x32_bf16 v[92:95], a[84:87], v[172:175], v[92:95]
    v_rcp_f32 v230, v230
    v_mfma_f32_16x16x32_bf16 v[96:99], a[84:87], v[176:179], v[96:99]
    v_rcp_f32 v231, v231
    v_mul_f32 v228, v228, v32
    v_mfma_f32_16x16x32_bf16 v[100:103], a[84:87], v[180:183], v[100:103]
    s_waitcnt vmcnt(21) lgkmcnt(1)
    v_mul_f32 v229, v229, v33
    v_mul_f32 v230, v230, v34
    v_mul_f32 v231, v231, v35
    v_mfma_f32_16x16x32_bf16 v[56:59], a[88:91], v[152:155], v[56:59]
    buffer_load_dwordx4 a[24:27], v6, s[28:31], s22 offen offset:2048 sc1
    v_cvt_pk_bf16_f32 v234, v228, v229
    v_mfma_f32_16x16x32_bf16 v[60:63], a[88:91], v[156:159], v[60:63]
    ds_read_b128 v[168:171], v6 offset:17408
    v_cvt_pk_bf16_f32 v235, v230, v231
    v_mfma_f32_16x16x32_bf16 v[64:67], a[88:91], v[160:163], v[64:67]
    s_waitcnt lgkmcnt(1)
    ds_read_b128 v[172:175], v6 offset:35840
    ds_write_b128 v1, v[232:235] offset:2048
    v_mfma_f32_16x16x32_bf16 v[68:71], a[88:91], v[164:167], v[68:71]
    ds_read_b128 v[176:179], v240 offset:17408
    v_fmac_f32 v48, v192, v208
    v_mfma_f32_16x16x32_bf16 v[72:75], a[92:95], v[152:155], v[72:75]
    buffer_load_dwordx4 a[28:31], v6, s[28:31], s22 offen offset:3072 sc1
    v_mfma_f32_16x16x32_bf16 v[76:79], a[92:95], v[156:159], v[76:79]
    s_add_u32 s22, s22, 4096
    ds_read_b128 v[180:183], v240 offset:35840
    v_fmac_f32 v49, v192, v209
    v_mfma_f32_16x16x32_bf16 v[80:83], a[92:95], v[160:163], v[80:83]
    v_fmac_f32 v50, v192, v210
    v_fmac_f32 v51, v192, v211
    v_mfma_f32_16x16x32_bf16 v[84:87], a[92:95], v[164:167], v[84:87]
    v_mul_f32 v224, v48, v48
    v_mul_f32 v225, v49, v49
    v_mfma_f32_16x16x32_bf16 v[88:91], a[96:99], v[152:155], v[88:91]
    buffer_load_dwordx4 a[32:35], v6, s[28:31], s22 offen offset:0 sc1
    v_mul_f32 v226, v50, v50
    v_mfma_f32_16x16x32_bf16 v[92:95], a[96:99], v[156:159], v[92:95]
    v_mul_f32 v227, v51, v51
    v_fma_f32 v224, v224, v195, v194
    v_fma_f32 v225, v225, v195, v194
    v_mfma_f32_16x16x32_bf16 v[96:99], a[96:99], v[160:163], v[96:99]
    v_fma_f32 v226, v226, v195, v194
    v_fma_f32 v227, v227, v195, v194
    v_mfma_f32_16x16x32_bf16 v[100:103], a[96:99], v[164:167], v[100:103]
    s_waitcnt vmcnt(21) lgkmcnt(1)
    v_mul_f32 v224, v224, v48
    v_mul_f32 v225, v225, v49
    v_mul_f32 v226, v226, v50
    v_mfma_f32_16x16x32_bf16 v[56:59], a[100:103], v[168:171], v[56:59]
    buffer_load_dwordx4 a[36:39], v6, s[28:31], s22 offen offset:1024 sc1
    v_mul_f32 v227, v227, v51
    v_mfma_f32_16x16x32_bf16 v[60:63], a[100:103], v[172:175], v[60:63]
    ds_read_b128 v[152:155], v6 offset:0
    v_exp_f32 v224, v224
    v_mfma_f32_16x16x32_bf16 v[64:67], a[100:103], v[176:179], v[64:67]
    s_waitcnt lgkmcnt(1)
    ds_read_b128 v[156:159], v6 offset:18432
    v_exp_f32 v225, v225
    v_mfma_f32_16x16x32_bf16 v[68:71], a[100:103], v[180:183], v[68:71]
    ds_read_b128 v[160:163], v240 offset:0
    v_exp_f32 v226, v226
    v_mfma_f32_16x16x32_bf16 v[72:75], a[104:107], v[168:171], v[72:75]
    buffer_load_dwordx4 a[40:43], v6, s[28:31], s22 offen offset:2048 sc1
    v_mfma_f32_16x16x32_bf16 v[76:79], a[104:107], v[172:175], v[76:79]
    ds_read_b128 v[164:167], v240 offset:18432
    v_exp_f32 v227, v227
    v_mfma_f32_16x16x32_bf16 v[80:83], a[104:107], v[176:179], v[80:83]
    v_fma_f32 v224, v224, v193, v193
    v_fma_f32 v225, v225, v193, v193
    v_mfma_f32_16x16x32_bf16 v[84:87], a[104:107], v[180:183], v[84:87]
    v_fma_f32 v226, v226, v193, v193
    v_fma_f32 v227, v227, v193, v193
    v_mfma_f32_16x16x32_bf16 v[88:91], a[108:111], v[168:171], v[88:91]
    buffer_load_dwordx4 a[44:47], v6, s[28:31], s22 offen offset:3072 sc1
    v_mfma_f32_16x16x32_bf16 v[92:95], a[108:111], v[172:175], v[92:95]
    s_add_u32 s22, s22, 4096
    v_rcp_f32 v224, v224
    v_rcp_f32 v225, v225
    v_mfma_f32_16x16x32_bf16 v[96:99], a[108:111], v[176:179], v[96:99]
    v_rcp_f32 v226, v226
    v_mfma_f32_16x16x32_bf16 v[100:103], a[108:111], v[180:183], v[100:103]
    s_waitcnt vmcnt(21) lgkmcnt(1)
    v_rcp_f32 v227, v227
    v_mul_f32 v224, v224, v48
    v_mfma_f32_16x16x32_bf16 v[104:107], a[112:115], v[152:155], v[104:107]
    buffer_load_dwordx4 a[48:51], v6, s[28:31], s22 offen offset:0 sc1
    v_mul_f32 v225, v225, v49
    v_mfma_f32_16x16x32_bf16 v[108:111], a[112:115], v[156:159], v[108:111]
    ds_read_b128 v[168:171], v6 offset:1024
    v_mul_f32 v226, v226, v50
    v_mul_f32 v227, v227, v51
    v_mfma_f32_16x16x32_bf16 v[112:115], a[112:115], v[160:163], v[112:115]
    s_waitcnt lgkmcnt(1)
    ds_read_b128 v[172:175], v6 offset:19456
    v_cvt_pk_bf16_f32 v236, v224, v225
    v_mfma_f32_16x16x32_bf16 v[116:119], a[112:115], v[164:167], v[116:119]
    ds_read_b128 v[176:179], v240 offset:1024
    v_cvt_pk_bf16_f32 v237, v226, v227
    v_mfma_f32_16x16x32_bf16 v[120:123], a[116:119], v[152:155], v[120:123]
    buffer_load_dwordx4 a[52:55], v6, s[28:31], s22 offen offset:1024 sc1
    v_mfma_f32_16x16x32_bf16 v[124:127], a[116:119], v[156:159], v[124:127]
    ds_read_b128 v[180:183], v240 offset:19456
    ds_write_b64 v2, v[236:237] offset:2048
    v_mfma_f32_16x16x32_bf16 v[128:131], a[116:119], v[160:163], v[128:131]
    v_fmac_f32 v20, v196, v200
    v_fmac_f32 v21, v196, v201
    v_fmac_f32 v22, v196, v202
    v_mfma_f32_16x16x32_bf16 v[132:135], a[116:119], v[164:167], v[132:135]
    v_fmac_f32 v23, v196, v203
    v_mul_f32 v228, v20, v20
    v_mul_f32 v229, v21, v21
    v_mfma_f32_16x16x32_bf16 v[136:139], a[120:123], v[152:155], v[136:139]
    buffer_load_dwordx4 a[56:59], v6, s[28:31], s22 offen offset:2048 sc1
    v_mfma_f32_16x16x32_bf16 v[140:143], a[120:123], v[156:159], v[140:143]
    v_mul_f32 v230, v22, v22
    v_mul_f32 v231, v23, v23
    v_fma_f32 v228, v228, v199, v198
    v_mfma_f32_16x16x32_bf16 v[144:147], a[120:123], v[160:163], v[144:147]
    v_fma_f32 v229, v229, v199, v198
    v_fma_f32 v230, v230, v199, v198
    v_fma_f32 v231, v231, v199, v198
    v_mfma_f32_16x16x32_bf16 v[148:151], a[120:123], v[164:167], v[148:151]
    s_waitcnt vmcnt(21) lgkmcnt(2)
    v_mul_f32 v228, v228, v20
    v_mul_f32 v229, v229, v21
    v_mul_f32 v230, v230, v22
    v_mfma_f32_16x16x32_bf16 v[104:107], a[124:127], v[168:171], v[104:107]
    buffer_load_dwordx4 a[60:63], v6, s[28:31], s22 offen offset:3072 sc1
    v_mfma_f32_16x16x32_bf16 v[108:111], a[124:127], v[172:175], v[108:111]
    s_add_u32 s22, s22, 4096
    ds_read_b128 v[152:155], v6 offset:2048
    v_mul_f32 v231, v231, v23
    v_mfma_f32_16x16x32_bf16 v[112:115], a[124:127], v[176:179], v[112:115]
    s_waitcnt lgkmcnt(2)
    ds_read_b128 v[156:159], v6 offset:20480
    v_exp_f32 v228, v228
    v_mfma_f32_16x16x32_bf16 v[116:119], a[124:127], v[180:183], v[116:119]
    ds_read_b128 v[160:163], v240 offset:2048
    v_exp_f32 v229, v229
    v_mfma_f32_16x16x32_bf16 v[120:123], a[128:131], v[168:171], v[120:123]
    buffer_load_dwordx4 a[64:67], v6, s[28:31], s22 offen offset:0 sc1
    v_mfma_f32_16x16x32_bf16 v[124:127], a[128:131], v[172:175], v[124:127]
    ds_read_b128 v[164:167], v240 offset:20480
    v_exp_f32 v230, v230
    v_mfma_f32_16x16x32_bf16 v[128:131], a[128:131], v[176:179], v[128:131]
    v_exp_f32 v231, v231
    v_fma_f32 v228, v228, v197, v197
    v_mfma_f32_16x16x32_bf16 v[132:135], a[128:131], v[180:183], v[132:135]
    v_fma_f32 v229, v229, v197, v197
    v_fma_f32 v230, v230, v197, v197
    v_fma_f32 v231, v231, v197, v197
    v_mfma_f32_16x16x32_bf16 v[136:139], a[132:135], v[168:171], v[136:139]
    buffer_load_dwordx4 a[68:71], v6, s[28:31], s22 offen offset:1024 sc1
    v_mfma_f32_16x16x32_bf16 v[140:143], a[132:135], v[172:175], v[140:143]
    v_rcp_f32 v228, v228
    v_rcp_f32 v229, v229
    v_mfma_f32_16x16x32_bf16 v[144:147], a[132:135], v[176:179], v[144:147]
    v_rcp_f32 v230, v230
    v_mfma_f32_16x16x32_bf16 v[148:151], a[132:135], v[180:183], v[148:151]
    s_waitcnt vmcnt(21) lgkmcnt(1)
    v_rcp_f32 v231, v231
    v_mul_f32 v228, v228, v20
    v_mfma_f32_16x16x32_bf16 v[104:107], a[136:139], v[152:155], v[104:107]
    buffer_load_dwordx4 a[72:75], v6, s[28:31], s22 offen offset:2048 sc1
    v_mul_f32 v229, v229, v21
    v_mfma_f32_16x16x32_bf16 v[108:111], a[136:139], v[156:159], v[108:111]
    ds_read_b128 v[168:171], v6 offset:3072
    v_mul_f32 v230, v230, v22
    v_mfma_f32_16x16x32_bf16 v[112:115], a[136:139], v[160:163], v[112:115]
    s_waitcnt lgkmcnt(1)
    ds_read_b128 v[172:175], v6 offset:21504
    v_mul_f32 v231, v231, v23
    v_cvt_pk_bf16_f32 v232, v228, v229
    v_mfma_f32_16x16x32_bf16 v[116:119], a[136:139], v[164:167], v[116:119]
    ds_read_b128 v[176:179], v240 offset:3072
    v_cvt_pk_bf16_f32 v233, v230, v231
    v_fmac_f32 v36, v196, v204
    v_mfma_f32_16x16x32_bf16 v[120:123], a[140:143], v[152:155], v[120:123]
    buffer_load_dwordx4 a[76:79], v6, s[28:31], s22 offen offset:3072 sc1
    v_mfma_f32_16x16x32_bf16 v[124:127], a[140:143], v[156:159], v[124:127]
    s_add_u32 s22, s22, 4096
    ds_read_b128 v[180:183], v240 offset:21504
    v_fmac_f32 v37, v196, v205
    v_fmac_f32 v38, v196, v206
    v_mfma_f32_16x16x32_bf16 v[128:131], a[140:143], v[160:163], v[128:131]
    v_fmac_f32 v39, v196, v207
    v_mul_f32 v224, v36, v36
    v_mul_f32 v225, v37, v37
    v_mfma_f32_16x16x32_bf16 v[132:135], a[140:143], v[164:167], v[132:135]
    v_mul_f32 v226, v38, v38
    v_mul_f32 v227, v39, v39
    v_mfma_f32_16x16x32_bf16 v[136:139], a[144:147], v[152:155], v[136:139]
    buffer_load_dwordx4 a[80:83], v6, s[28:31], s22 offen offset:0 sc1
    v_fma_f32 v224, v224, v199, v198
    v_mfma_f32_16x16x32_bf16 v[140:143], a[144:147], v[156:159], v[140:143]
    v_fma_f32 v225, v225, v199, v198
    v_fma_f32 v226, v226, v199, v198
    v_fma_f32 v227, v227, v199, v198
    v_mfma_f32_16x16x32_bf16 v[144:147], a[144:147], v[160:163], v[144:147]
    v_mul_f32 v224, v224, v36
    v_mul_f32 v225, v225, v37
    v_mfma_f32_16x16x32_bf16 v[148:151], a[144:147], v[164:167], v[148:151]
    s_waitcnt vmcnt(21) lgkmcnt(1)
    v_mul_f32 v226, v226, v38
    v_mul_f32 v227, v227, v39
    v_mfma_f32_16x16x32_bf16 v[104:107], a[148:151], v[168:171], v[104:107]
    buffer_load_dwordx4 a[84:87], v6, s[28:31], s22 offen offset:1024 sc1
    v_exp_f32 v224, v224
    v_mfma_f32_16x16x32_bf16 v[108:111], a[148:151], v[172:175], v[108:111]
    ds_read_b128 v[152:155], v6 offset:4096
    v_exp_f32 v225, v225
    v_mfma_f32_16x16x32_bf16 v[112:115], a[148:151], v[176:179], v[112:115]
    s_waitcnt lgkmcnt(1)
    ds_read_b128 v[156:159], v6 offset:22528
    v_exp_f32 v226, v226
    v_mfma_f32_16x16x32_bf16 v[116:119], a[148:151], v[180:183], v[116:119]
    ds_read_b128 v[160:163], v240 offset:4096
    v_exp_f32 v227, v227
    v_mfma_f32_16x16x32_bf16 v[120:123], a[152:155], v[168:171], v[120:123]
    buffer_load_dwordx4 a[88:91], v6, s[28:31], s22 offen offset:2048 sc1
    v_mfma_f32_16x16x32_bf16 v[124:127], a[152:155], v[172:175], v[124:127]
    ds_read_b128 v[164:167], v240 offset:22528
    v_fma_f32 v224, v224, v197, v197
    v_mfma_f32_16x16x32_bf16 v[128:131], a[152:155], v[176:179], v[128:131]
    v_fma_f32 v225, v225, v197, v197
    v_fma_f32 v226, v226, v197, v197
    v_fma_f32 v227, v227, v197, v197
    v_mfma_f32_16x16x32_bf16 v[132:135], a[152:155], v[180:183], v[132:135]
    v_rcp_f32 v224, v224
    v_mfma_f32_16x16x32_bf16 v[136:139], a[156:159], v[168:171], v[136:139]
    buffer_load_dwordx4 a[92:95], v6, s[28:31], s22 offen offset:3072 sc1
    v_mfma_f32_16x16x32_bf16 v[140:143], a[156:159], v[172:175], v[140:143]
    s_add_u32 s22, s22, 4096
    v_rcp_f32 v225, v225
    v_rcp_f32 v226, v226
    v_mfma_f32_16x16x32_bf16 v[144:147], a[156:159], v[176:179], v[144:147]
    v_rcp_f32 v227, v227
    v_mul_f32 v224, v224, v36
    v_mfma_f32_16x16x32_bf16 v[148:151], a[156:159], v[180:183], v[148:151]
    s_waitcnt vmcnt(21) lgkmcnt(1)
    v_mul_f32 v225, v225, v37
    v_mul_f32 v226, v226, v38
    v_mfma_f32_16x16x32_bf16 v[104:107], a[0:3], v[152:155], v[104:107]
    buffer_load_dwordx4 a[96:99], v6, s[28:31], s22 offen offset:0 sc1
    v_mul_f32 v227, v227, v39
    v_mfma_f32_16x16x32_bf16 v[108:111], a[0:3], v[156:159], v[108:111]
    ds_read_b128 v[168:171], v6 offset:5120
    v_cvt_pk_bf16_f32 v234, v224, v225
    v_cvt_pk_bf16_f32 v235, v226, v227
    v_mfma_f32_16x16x32_bf16 v[112:115], a[0:3], v[160:163], v[112:115]
    s_waitcnt lgkmcnt(1)
    ds_read_b128 v[172:175], v6 offset:23552
    ds_write_b128 v1, v[232:235] offset:3072
    v_mfma_f32_16x16x32_bf16 v[116:119], a[0:3], v[164:167], v[116:119]
    ds_read_b128 v[176:179], v240 offset:5120
    v_fmac_f32 v52, v196, v208
    v_mfma_f32_16x16x32_bf16 v[120:123], a[4:7], v[152:155], v[120:123]
    buffer_load_dwordx4 a[100:103], v6, s[28:31], s22 offen offset:1024 sc1
    v_mfma_f32_16x16x32_bf16 v[124:127], a[4:7], v[156:159], v[124:127]
    ds_read_b128 v[180:183], v240 offset:23552
    v_fmac_f32 v53, v196, v209
    v_mfma_f32_16x16x32_bf16 v[128:131], a[4:7], v[160:163], v[128:131]
    v_fmac_f32 v54, v196, v210
    v_fmac_f32 v55, v196, v211
    v_mfma_f32_16x16x32_bf16 v[132:135], a[4:7], v[164:167], v[132:135]
    v_mul_f32 v228, v52, v52
    v_mul_f32 v229, v53, v53
    v_mfma_f32_16x16x32_bf16 v[136:139], a[8:11], v[152:155], v[136:139]
    buffer_load_dwordx4 a[104:107], v6, s[28:31], s22 offen offset:2048 sc1
    v_mfma_f32_16x16x32_bf16 v[140:143], a[8:11], v[156:159], v[140:143]
    v_mul_f32 v230, v54, v54
    v_mul_f32 v231, v55, v55
    v_fma_f32 v228, v228, v199, v198
    v_mfma_f32_16x16x32_bf16 v[144:147], a[8:11], v[160:163], v[144:147]
    v_fma_f32 v229, v229, v199, v198
    v_fma_f32 v230, v230, v199, v198
    v_fma_f32 v231, v231, v199, v198
    v_mfma_f32_16x16x32_bf16 v[148:151], a[8:11], v[164:167], v[148:151]
    s_waitcnt vmcnt(21) lgkmcnt(1)
    v_mul_f32 v228, v228, v52
    v_mul_f32 v229, v229, v53
    v_mfma_f32_16x16x32_bf16 v[104:107], a[12:15], v[168:171], v[104:107]
    buffer_load_dwordx4 a[108:111], v6, s[28:31], s22 offen offset:3072 sc1
    v_mul_f32 v230, v230, v54
    v_mfma_f32_16x16x32_bf16 v[108:111], a[12:15], v[172:175], v[108:111]
    s_add_u32 s22, s22, 4096
    ds_read_b128 v[152:155], v6 offset:6144
    v_mul_f32 v231, v231, v55
    v_mfma_f32_16x16x32_bf16 v[112:115], a[12:15], v[176:179], v[112:115]
    s_waitcnt lgkmcnt(1)
    ds_read_b128 v[156:159], v6 offset:24576
    v_exp_f32 v228, v228
    v_mfma_f32_16x16x32_bf16 v[116:119], a[12:15], v[180:183], v[116:119]
    ds_read_b128 v[160:163], v240 offset:6144
    v_exp_f32 v229, v229
    v_mfma_f32_16x16x32_bf16 v[120:123], a[16:19], v[168:171], v[120:123]
    buffer_load_dwordx4 a[112:115], v6, s[28:31], s22 offen offset:0 sc1
    v_mfma_f32_16x16x32_bf16 v[124:127], a[16:19], v[172:175], v[124:127]
    ds_read_b128 v[164:167], v240 offset:24576
    v_exp_f32 v230, v230
    v_mfma_f32_16x16x32_bf16 v[128:131], a[16:19], v[176:179], v[128:131]
    v_exp_f32 v231, v231
    v_fma_f32 v228, v228, v197, v197
    v_mfma_f32_16x16x32_bf16 v[132:135], a[16:19], v[180:183], v[132:135]
    v_fma_f32 v229, v229, v197, v197
    v_fma_f32 v230, v230, v197, v197
    v_fma_f32 v231, v231, v197, v197
    v_mfma_f32_16x16x32_bf16 v[136:139], a[20:23], v[168:171], v[136:139]
    buffer_load_dwordx4 a[116:119], v6, s[28:31], s22 offen offset:1024 sc1
    v_mfma_f32_16x16x32_bf16 v[140:143], a[20:23], v[172:175], v[140:143]
    v_rcp_f32 v228, v228
    v_rcp_f32 v229, v229
    v_mfma_f32_16x16x32_bf16 v[144:147], a[20:23], v[176:179], v[144:147]
    v_rcp_f32 v230, v230
    v_mfma_f32_16x16x32_bf16 v[148:151], a[20:23], v[180:183], v[148:151]
    s_waitcnt vmcnt(21) lgkmcnt(1)
    v_rcp_f32 v231, v231
    v_mul_f32 v228, v228, v52
    v_mfma_f32_16x16x32_bf16 v[104:107], a[24:27], v[152:155], v[104:107]
    buffer_load_dwordx4 a[120:123], v6, s[28:31], s22 offen offset:2048 sc1
    v_mul_f32 v229, v229, v53
    v_mfma_f32_16x16x32_bf16 v[108:111], a[24:27], v[156:159], v[108:111]
    ds_read_b128 v[168:171], v6 offset:7168
    v_mul_f32 v230, v230, v54
    v_mfma_f32_16x16x32_bf16 v[112:115], a[24:27], v[160:163], v[112:115]
    s_waitcnt lgkmcnt(1)
    ds_read_b128 v[172:175], v6 offset:25600
    v_mul_f32 v231, v231, v55
    v_cvt_pk_bf16_f32 v236, v228, v229
    v_mfma_f32_16x16x32_bf16 v[116:119], a[24:27], v[164:167], v[116:119]
    ds_read_b128 v[176:179], v240 offset:7168
    v_cvt_pk_bf16_f32 v237, v230, v231
    v_mfma_f32_16x16x32_bf16 v[120:123], a[28:31], v[152:155], v[120:123]
    buffer_load_dwordx4 a[124:127], v6, s[28:31], s22 offen offset:3072 sc1
    v_mfma_f32_16x16x32_bf16 v[124:127], a[28:31], v[156:159], v[124:127]
    s_add_u32 s22, s22, 4096
    ds_read_b128 v[180:183], v240 offset:25600
    ds_write_b64 v2, v[236:237] offset:3072
    v_mfma_f32_16x16x32_bf16 v[128:131], a[28:31], v[160:163], v[128:131]
    v_mfma_f32_16x16x32_bf16 v[132:135], a[28:31], v[164:167], v[132:135]
    v_mfma_f32_16x16x32_bf16 v[136:139], a[32:35], v[152:155], v[136:139]
    buffer_load_dwordx4 a[128:131], v6, s[28:31], s22 offen offset:0 sc1
    v_mfma_f32_16x16x32_bf16 v[140:143], a[32:35], v[156:159], v[140:143]
    v_mul_f32 v224, v56, v56
    v_mul_f32 v225, v57, v57
    v_mul_f32 v226, v58, v58
    v_mfma_f32_16x16x32_bf16 v[144:147], a[32:35], v[160:163], v[144:147]
    v_mul_f32 v227, v59, v59
    v_fma_f32 v224, v224, v187, v186
    v_mfma_f32_16x16x32_bf16 v[148:151], a[32:35], v[164:167], v[148:151]
    s_waitcnt vmcnt(21) lgkmcnt(2)
    v_fma_f32 v225, v225, v187, v186
    v_fma_f32 v226, v226, v187, v186
    v_fma_f32 v227, v227, v187, v186
    v_mfma_f32_16x16x32_bf16 v[104:107], a[36:39], v[168:171], v[104:107]
    buffer_load_dwordx4 a[132:135], v6, s[28:31], s22 offen offset:1024 sc1
    v_mfma_f32_16x16x32_bf16 v[108:111], a[36:39], v[172:175], v[108:111]
    ds_read_b128 v[152:155], v6 offset:8192
    v_mul_f32 v224, v224, v56
    v_mul_f32 v225, v225, v57
    v_mfma_f32_16x16x32_bf16 v[112:115], a[36:39], v[176:179], v[112:115]
    s_waitcnt lgkmcnt(2)
    ds_read_b128 v[156:159], v6 offset:26624
    v_mul_f32 v226, v226, v58
    v_mul_f32 v227, v227, v59
    v_mfma_f32_16x16x32_bf16 v[116:119], a[36:39], v[180:183], v[116:119]
    ds_read_b128 v[160:163], v240 offset:8192
    v_exp_f32 v224, v224
    v_mfma_f32_16x16x32_bf16 v[120:123], a[40:43], v[168:171], v[120:123]
    buffer_load_dwordx4 a[136:139], v6, s[28:31], s22 offen offset:2048 sc1
    v_mfma_f32_16x16x32_bf16 v[124:127], a[40:43], v[172:175], v[124:127]
    ds_read_b128 v[164:167], v240 offset:26624
    v_exp_f32 v225, v225
    v_mfma_f32_16x16x32_bf16 v[128:131], a[40:43], v[176:179], v[128:131]
    v_exp_f32 v226, v226
    v_mfma_f32_16x16x32_bf16 v[132:135], a[40:43], v[180:183], v[132:135]
    v_exp_f32 v227, v227
    v_fma_f32 v224, v224, v185, v185
    v_mfma_f32_16x16x32_bf16 v[136:139], a[44:47], v[168:171], v[136:139]
    buffer_load_dwordx4 a[140:143], v6, s[28:31], s22 offen offset:3072 sc1
    v_mfma_f32_16x16x32_bf16 v[140:143], a[44:47], v[172:175], v[140:143]
    s_add_u32 s22, s22, 4096
    v_fma_f32 v225, v225, v185, v185
    v_fma_f32 v226, v226, v185, v185
    v_fma_f32 v227, v227, v185, v185
    v_mfma_f32_16x16x32_bf16 v[144:147], a[44:47], v[176:179], v[144:147]
    v_rcp_f32 v224, v224
    v_mfma_f32_16x16x32_bf16 v[148:151], a[44:47], v[180:183], v[148:151]
    s_waitcnt vmcnt(21) lgkmcnt(1)
    v_rcp_f32 v225, v225
    v_mfma_f32_16x16x32_bf16 v[104:107], a[48:51], v[152:155], v[104:107]
    buffer_load_dwordx4 a[144:147], v6, s[28:31], s22 offen offset:0 sc1
    v_mfma_f32_16x16x32_bf16 v[108:111], a[48:51], v[156:159], v[108:111]
    ds_read_b128 v[168:171], v6 offset:9216
    v_rcp_f32 v226, v226
    v_mfma_f32_16x16x32_bf16 v[112:115], a[48:51], v[160:163], v[112:115]
    s_waitcnt lgkmcnt(1)
    ds_read_b128 v[172:175], v6 offset:27648
    v_rcp_f32 v227, v227
    v_mul_f32 v224, v224, v56
    v_mfma_f32_16x16x32_bf16 v[116:119], a[48:51], v[164:167], v[116:119]
    ds_read_b128 v[176:179], v240 offset:9216
    v_mul_f32 v225, v225, v57
    v_mfma_f32_16x16x32_bf16 v[120:123], a[52:55], v[152:155], v[120:123]
    buffer_load_dwordx4 a[148:151], v6, s[28:31], s22 offen offset:1024 sc1
    v_mul_f32 v226, v226, v58
    v_mfma_f32_16x16x32_bf16 v[124:127], a[52:55], v[156:159], v[124:127]
    ds_read_b128 v[180:183], v240 offset:27648
    v_mul_f32 v227, v227, v59
    v_mfma_f32_16x16x32_bf16 v[128:131], a[52:55], v[160:163], v[128:131]
    v_cvt_pk_bf16_f32 v232, v224, v225
    v_cvt_pk_bf16_f32 v233, v226, v227
    v_mul_f32 v228, v72, v72
    v_mfma_f32_16x16x32_bf16 v[132:135], a[52:55], v[164:167], v[132:135]
    v_mul_f32 v229, v73, v73
    v_mul_f32 v230, v74, v74
    v_mul_f32 v231, v75, v75
    v_mfma_f32_16x16x32_bf16 v[136:139], a[56:59], v[152:155], v[136:139]
    buffer_load_dwordx4 a[152:155], v6, s[28:31], s22 offen offset:2048 sc1
    v_mfma_f32_16x16x32_bf16 v[140:143], a[56:59], v[156:159], v[140:143]
    v_fma_f32 v228, v228, v187, v186
    v_fma_f32 v229, v229, v187, v186
    v_fma_f32 v230, v230, v187, v186
    v_mfma_f32_16x16x32_bf16 v[144:147], a[56:59], v[160:163], v[144:147]
    v_fma_f32 v231, v231, v187, v186
    v_mul_f32 v228, v228, v72
    v_mfma_f32_16x16x32_bf16 v[148:151], a[56:59], v[164:167], v[148:151]
    s_waitcnt vmcnt(21) lgkmcnt(1)
    v_mul_f32 v229, v229, v73
    v_mul_f32 v230, v230, v74
    v_mul_f32 v231, v231, v75
    v_mfma_f32_16x16x32_bf16 v[104:107], a[60:63], v[168:171], v[104:107]
    buffer_load_dwordx4 a[156:159], v6, s[28:31], s22 offen offset:3072 sc1
    v_mfma_f32_16x16x32_bf16 v[108:111], a[60:63], v[172:175], v[108:111]
    s_add_u32 s22, s22, 4096
    ds_read_b128 v[152:155], v6 offset:10240
    v_exp_f32 v228, v228
    v_mfma_f32_16x16x32_bf16 v[112:115], a[60:63], v[176:179], v[112:115]
    s_waitcnt lgkmcnt(1)
    ds_read_b128 v[156:159], v6 offset:28672
    v_exp_f32 v229, v229
    v_mfma_f32_16x16x32_bf16 v[116:119], a[60:63], v[180:183], v[116:119]
    ds_read_b128 v[160:163], v240 offset:10240
    v_exp_f32 v230, v230
    v_mfma_f32_16x16x32_bf16 v[120:123], a[64:67], v[168:171], v[120:123]
    buffer_load_dwordx4 a[0:3], v6, s[28:31], s22 offen offset:0 sc1
    v_mfma_f32_16x16x32_bf16 v[124:127], a[64:67], v[172:175], v[124:127]
    ds_read_b128 v[164:167], v240 offset:28672
    v_exp_f32 v231, v231
    v_mfma_f32_16x16x32_bf16 v[128:131], a[64:67], v[176:179], v[128:131]
    v_fma_f32 v228, v228, v185, v185
    v_fma_f32 v229, v229, v185, v185
    v_mfma_f32_16x16x32_bf16 v[132:135], a[64:67], v[180:183], v[132:135]
    v_fma_f32 v230, v230, v185, v185
    v_fma_f32 v231, v231, v185, v185
    v_mfma_f32_16x16x32_bf16 v[136:139], a[68:71], v[168:171], v[136:139]
    buffer_load_dwordx4 a[4:7], v6, s[28:31], s22 offen offset:1024 sc1
    v_mfma_f32_16x16x32_bf16 v[140:143], a[68:71], v[172:175], v[140:143]
    v_rcp_f32 v228, v228
    v_rcp_f32 v229, v229
    v_mfma_f32_16x16x32_bf16 v[144:147], a[68:71], v[176:179], v[144:147]
    v_rcp_f32 v230, v230
    v_mfma_f32_16x16x32_bf16 v[148:151], a[68:71], v[180:183], v[148:151]
    s_waitcnt vmcnt(21) lgkmcnt(1)
    v_rcp_f32 v231, v231
    v_mul_f32 v228, v228, v72
    v_mfma_f32_16x16x32_bf16 v[104:107], a[72:75], v[152:155], v[104:107]
    s_add_u32 s54, s33, 0
    buffer_load_dwordx4 a[8:11], v6, s[28:31], s54 offen sc1
    v_mul_f32 v229, v229, v73
    v_mfma_f32_16x16x32_bf16 v[108:111], a[72:75], v[156:159], v[108:111]
    ds_read_b128 v[168:171], v6 offset:11264
    v_mul_f32 v230, v230, v74
    v_mfma_f32_16x16x32_bf16 v[112:115], a[72:75], v[160:163], v[112:115]
    s_waitcnt lgkmcnt(1)
    ds_read_b128 v[172:175], v6 offset:29696
    v_mul_f32 v231, v231, v75
    v_cvt_pk_bf16_f32 v234, v228, v229
    v_mfma_f32_16x16x32_bf16 v[116:119], a[72:75], v[164:167], v[116:119]
    ds_read_b128 v[176:179], v240 offset:11264
    v_cvt_pk_bf16_f32 v235, v230, v231
    v_mfma_f32_16x16x32_bf16 v[120:123], a[76:79], v[152:155], v[120:123]
    s_add_u32 s54, s33, 1024
    buffer_load_dwordx4 a[12:15], v6, s[28:31], s54 offen sc1
    v_mfma_f32_16x16x32_bf16 v[124:127], a[76:79], v[156:159], v[124:127]
    ds_read_b128 v[180:183], v240 offset:29696
    ds_write_b128 v1, v[232:235] offset:24576
    v_mfma_f32_16x16x32_bf16 v[128:131], a[76:79], v[160:163], v[128:131]
    v_mul_f32 v224, v88, v88
    v_mul_f32 v225, v89, v89
    v_mfma_f32_16x16x32_bf16 v[132:135], a[76:79], v[164:167], v[132:135]
    v_mul_f32 v226, v90, v90
    v_mul_f32 v227, v91, v91
    v_mfma_f32_16x16x32_bf16 v[136:139], a[80:83], v[152:155], v[136:139]
    s_add_u32 s54, s33, 2048
    buffer_load_dwordx4 a[16:19], v6, s[28:31], s54 offen sc1
    v_mfma_f32_16x16x32_bf16 v[140:143], a[80:83], v[156:159], v[140:143]
    v_fma_f32 v224, v224, v187, v186
    v_fma_f32 v225, v225, v187, v186
    v_mfma_f32_16x16x32_bf16 v[144:147], a[80:83], v[160:163], v[144:147]
    v_fma_f32 v226, v226, v187, v186
    v_fma_f32 v227, v227, v187, v186
    v_mfma_f32_16x16x32_bf16 v[148:151], a[80:83], v[164:167], v[148:151]
    s_waitcnt vmcnt(21) lgkmcnt(2)
    v_mul_f32 v224, v224, v88
    v_mul_f32 v225, v225, v89
    v_mul_f32 v226, v226, v90
    v_mfma_f32_16x16x32_bf16 v[104:107], a[84:87], v[168:171], v[104:107]
    s_add_u32 s54, s33, 3072
    buffer_load_dwordx4 a[20:23], v6, s[28:31], s54 offen sc1
    v_mul_f32 v227, v227, v91
    v_mfma_f32_16x16x32_bf16 v[108:111], a[84:87], v[172:175], v[108:111]
    ds_read_b128 v[152:155], v6 offset:12288
    v_exp_f32 v224, v224
    v_mfma_f32_16x16x32_bf16 v[112:115], a[84:87], v[176:179], v[112:115]
    s_waitcnt lgkmcnt(2)
    ds_read_b128 v[156:159], v6 offset:30720
    v_exp_f32 v225, v225
    v_mfma_f32_16x16x32_bf16 v[116:119], a[84:87], v[180:183], v[116:119]
    ds_read_b128 v[160:163], v240 offset:12288
    v_exp_f32 v226, v226
    v_mfma_f32_16x16x32_bf16 v[120:123], a[88:91], v[168:171], v[120:123]
    s_add_u32 s54, s33, 4096
    buffer_load_dwordx4 a[24:27], v6, s[28:31], s54 offen sc1
    v_mfma_f32_16x16x32_bf16 v[124:127], a[88:91], v[172:175], v[124:127]
    ds_read_b128 v[164:167], v240 offset:30720
    v_exp_f32 v227, v227
    v_mfma_f32_16x16x32_bf16 v[128:131], a[88:91], v[176:179], v[128:131]
    v_fma_f32 v224, v224, v185, v185
    v_fma_f32 v225, v225, v185, v185
    v_mfma_f32_16x16x32_bf16 v[132:135], a[88:91], v[180:183], v[132:135]
    v_fma_f32 v226, v226, v185, v185
    v_fma_f32 v227, v227, v185, v185
    v_mfma_f32_16x16x32_bf16 v[136:139], a[92:95], v[168:171], v[136:139]
    s_add_u32 s54, s33, 5120
    buffer_load_dwordx4 a[28:31], v6, s[28:31], s54 offen sc1
    v_mfma_f32_16x16x32_bf16 v[140:143], a[92:95], v[172:175], v[140:143]
    v_rcp_f32 v224, v224
    v_mfma_f32_16x16x32_bf16 v[144:147], a[92:95], v[176:179], v[144:147]
    v_rcp_f32 v225, v225
    v_rcp_f32 v226, v226
    v_mfma_f32_16x16x32_bf16 v[148:151], a[92:95], v[180:183], v[148:151]
    s_waitcnt vmcnt(21) lgkmcnt(1)
    v_rcp_f32 v227, v227
    v_mfma_f32_16x16x32_bf16 v[104:107], a[96:99], v[152:155], v[104:107]
    s_add_u32 s54, s33, 6144
    buffer_load_dwordx4 a[32:35], v6, s[28:31], s54 offen sc1
    v_mul_f32 v224, v224, v88
    v_mfma_f32_16x16x32_bf16 v[108:111], a[96:99], v[156:159], v[108:111]
    ds_read_b128 v[168:171], v6 offset:13312
    v_mul_f32 v225, v225, v89
    v_mfma_f32_16x16x32_bf16 v[112:115], a[96:99], v[160:163], v[112:115]
    s_waitcnt lgkmcnt(1)
    ds_read_b128 v[172:175], v6 offset:31744
    v_mul_f32 v226, v226, v90
    v_mul_f32 v227, v227, v91
    v_mfma_f32_16x16x32_bf16 v[116:119], a[96:99], v[164:167], v[116:119]
    ds_read_b128 v[176:179], v240 offset:13312
    v_cvt_pk_bf16_f32 v236, v224, v225
    v_mfma_f32_16x16x32_bf16 v[120:123], a[100:103], v[152:155], v[120:123]
    s_add_u32 s54, s33, 7168
    buffer_load_dwordx4 a[36:39], v6, s[28:31], s54 offen sc1
    v_cvt_pk_bf16_f32 v237, v226, v227
    v_mfma_f32_16x16x32_bf16 v[124:127], a[100:103], v[156:159], v[124:127]
    ds_read_b128 v[180:183], v240 offset:31744
    ds_write_b64 v2, v[236:237] offset:24576
    v_mfma_f32_16x16x32_bf16 v[128:131], a[100:103], v[160:163], v[128:131]
    v_mul_f32 v228, v60, v60
    v_mul_f32 v229, v61, v61
    v_mfma_f32_16x16x32_bf16 v[132:135], a[100:103], v[164:167], v[132:135]
    v_mul_f32 v230, v62, v62
    v_mul_f32 v231, v63, v63
    v_mfma_f32_16x16x32_bf16 v[136:139], a[104:107], v[152:155], v[136:139]
    s_add_u32 s54, s33, 8192
    buffer_load_dwordx4 a[40:43], v6, s[28:31], s54 offen sc1
    v_mfma_f32_16x16x32_bf16 v[140:143], a[104:107], v[156:159], v[140:143]
    v_fma_f32 v228, v228, v191, v190
    v_fma_f32 v229, v229, v191, v190
    v_fma_f32 v230, v230, v191, v190
    v_mfma_f32_16x16x32_bf16 v[144:147], a[104:107], v[160:163], v[144:147]
    v_fma_f32 v231, v231, v191, v190
    v_mul_f32 v228, v228, v60
    v_mul_f32 v229, v229, v61
    v_mfma_f32_16x16x32_bf16 v[148:151], a[104:107], v[164:167], v[148:151]
    s_waitcnt vmcnt(21) lgkmcnt(2)
    v_mul_f32 v230, v230, v62
    v_mul_f32 v231, v231, v63
    v_mfma_f32_16x16x32_bf16 v[104:107], a[108:111], v[168:171], v[104:107]
    s_add_u32 s54, s33, 9216
    buffer_load_dwordx4 a[44:47], v6, s[28:31], s54 offen sc1
    v_mfma_f32_16x16x32_bf16 v[108:111], a[108:111], v[172:175], v[108:111]
    ds_read_b128 v[152:155], v6 offset:14336
    v_exp_f32 v228, v228
    v_mfma_f32_16x16x32_bf16 v[112:115], a[108:111], v[176:179], v[112:115]
    s_waitcnt lgkmcnt(2)
    ds_read_b128 v[156:159], v6 offset:32768
    v_exp_f32 v229, v229
    v_mfma_f32_16x16x32_bf16 v[116:119], a[108:111], v[180:183], v[116:119]
    ds_read_b128 v[160:163], v240 offset:14336
    v_exp_f32 v230, v230
    v_mfma_f32_16x16x32_bf16 v[120:123], a[112:115], v[168:171], v[120:123]
    s_add_u32 s54, s33, 10240
    buffer_load_dwordx4 a[48:51], v6, s[28:31], s54 offen sc1
    v_mfma_f32_16x16x32_bf16 v[124:127], a[112:115], v[172:175], v[124:127]
    ds_read_b128 v[164:167], v240 offset:32768
    v_exp_f32 v231, v231
    v_mfma_f32_16x16x32_bf16 v[128:131], a[112:115], v[176:179], v[128:131]
    v_fma_f32 v228, v228, v189, v189
    v_fma_f32 v229, v229, v189, v189
    v_mfma_f32_16x16x32_bf16 v[132:135], a[112:115], v[180:183], v[132:135]
    v_fma_f32 v230, v230, v189, v189
    v_fma_f32 v231, v231, v189, v189
    v_mfma_f32_16x16x32_bf16 v[136:139], a[116:119], v[168:171], v[136:139]
    s_add_u32 s54, s33, 11264
    buffer_load_dwordx4 a[52:55], v6, s[28:31], s54 offen sc1
    v_mfma_f32_16x16x32_bf16 v[140:143], a[116:119], v[172:175], v[140:143]
    v_rcp_f32 v228, v228
    v_rcp_f32 v229, v229
    v_mfma_f32_16x16x32_bf16 v[144:147], a[116:119], v[176:179], v[144:147]
    v_rcp_f32 v230, v230
    v_mfma_f32_16x16x32_bf16 v[148:151], a[116:119], v[180:183], v[148:151]
    s_waitcnt vmcnt(21) lgkmcnt(1)
    v_rcp_f32 v231, v231
    v_mul_f32 v228, v228, v60
    v_mfma_f32_16x16x32_bf16 v[104:107], a[120:123], v[152:155], v[104:107]
    s_add_u32 s54, s33, 12288
    buffer_load_dwordx4 a[56:59], v6, s[28:31], s54 offen sc1
    v_mul_f32 v229, v229, v61
    v_mfma_f32_16x16x32_bf16 v[108:111], a[120:123], v[156:159], v[108:111]
    ds_read_b128 v[168:171], v6 offset:15360
    v_mul_f32 v230, v230, v62
    v_mfma_f32_16x16x32_bf16 v[112:115], a[120:123], v[160:163], v[112:115]
    s_waitcnt lgkmcnt(1)
    ds_read_b128 v[172:175], v6 offset:33792
    v_mul_f32 v231, v231, v63
    v_cvt_pk_bf16_f32 v232, v228, v229
    v_mfma_f32_16x16x32_bf16 v[116:119], a[120:123], v[164:167], v[116:119]
    ds_read_b128 v[176:179], v240 offset:15360
    v_cvt_pk_bf16_f32 v233, v230, v231
    v_mul_f32 v224, v76, v76
    v_mfma_f32_16x16x32_bf16 v[120:123], a[124:127], v[152:155], v[120:123]
    s_add_u32 s54, s33, 13312
    buffer_load_dwordx4 a[60:63], v6, s[28:31], s54 offen sc1
    v_mfma_f32_16x16x32_bf16 v[124:127], a[124:127], v[156:159], v[124:127]
    ds_read_b128 v[180:183], v240 offset:33792
    v_mul_f32 v225, v77, v77
    v_mul_f32 v226, v78, v78
    v_mfma_f32_16x16x32_bf16 v[128:131], a[124:127], v[160:163], v[128:131]
    v_mul_f32 v227, v79, v79
    v_fma_f32 v224, v224, v191, v190
    v_mfma_f32_16x16x32_bf16 v[132:135], a[124:127], v[164:167], v[132:135]
    v_fma_f32 v225, v225, v191, v190
    v_fma_f32 v226, v226, v191, v190
    v_fma_f32 v227, v227, v191, v190
    v_mfma_f32_16x16x32_bf16 v[136:139], a[128:131], v[152:155], v[136:139]
    s_add_u32 s54, s33, 14336
    buffer_load_dwordx4 a[64:67], v6, s[28:31], s54 offen sc1
    v_mul_f32 v224, v224, v76
    v_mfma_f32_16x16x32_bf16 v[140:143], a[128:131], v[156:159], v[140:143]
    v_mul_f32 v225, v225, v77
    v_mul_f32 v226, v226, v78
    v_mfma_f32_16x16x32_bf16 v[144:147], a[128:131], v[160:163], v[144:147]
    v_mul_f32 v227, v227, v79
    v_exp_f32 v224, v224
    v_mfma_f32_16x16x32_bf16 v[148:151], a[128:131], v[164:167], v[148:151]
    s_waitcnt vmcnt(21) lgkmcnt(1)
    v_exp_f32 v225, v225
    v_mfma_f32_16x16x32_bf16 v[104:107], a[132:135], v[168:171], v[104:107]
    s_add_u32 s54, s33, 15360
    buffer_load_dwordx4 a[68:71], v6, s[28:31], s54 offen sc1
    v_mfma_f32_16x16x32_bf16 v[108:111], a[132:135], v[172:175], v[108:111]
    ds_read_b128 v[152:155], v6 offset:16384
    v_exp_f32 v226, v226
    v_mfma_f32_16x16x32_bf16 v[112:115], a[132:135], v[176:179], v[112:115]
    s_waitcnt lgkmcnt(1)
    ds_read_b128 v[156:159], v6 offset:34816
    v_exp_f32 v227, v227
    v_mfma_f32_16x16x32_bf16 v[116:119], a[132:135], v[180:183], v[116:119]
    ds_read_b128 v[160:163], v240 offset:16384
    v_fma_f32 v224, v224, v189, v189
    v_fma_f32 v225, v225, v189, v189
    v_mfma_f32_16x16x32_bf16 v[120:123], a[136:139], v[168:171], v[120:123]
    s_add_u32 s54, s33, 16384
    buffer_load_dwordx4 a[72:75], v6, s[28:31], s54 offen sc1
    v_mfma_f32_16x16x32_bf16 v[124:127], a[136:139], v[172:175], v[124:127]
    ds_read_b128 v[164:167], v240 offset:34816
    v_fma_f32 v226, v226, v189, v189
    v_fma_f32 v227, v227, v189, v189
    v_mfma_f32_16x16x32_bf16 v[128:131], a[136:139], v[176:179], v[128:131]
    v_rcp_f32 v224, v224
    v_mfma_f32_16x16x32_bf16 v[132:135], a[136:139], v[180:183], v[132:135]
    v_rcp_f32 v225, v225
    v_mfma_f32_16x16x32_bf16 v[136:139], a[140:143], v[168:171], v[136:139]
    s_add_u32 s54, s33, 17408
    buffer_load_dwordx4 a[76:79], v6, s[28:31], s54 offen sc1
    v_rcp_f32 v226, v226
    v_mfma_f32_16x16x32_bf16 v[140:143], a[140:143], v[172:175], v[140:143]
    v_rcp_f32 v227, v227
    v_mfma_f32_16x16x32_bf16 v[144:147], a[140:143], v[176:179], v[144:147]
    v_mul_f32 v224, v224, v76
    v_mul_f32 v225, v225, v77
    v_mul_f32 v226, v226, v78
    v_mfma_f32_16x16x32_bf16 v[148:151], a[140:143], v[180:183], v[148:151]
    s_waitcnt vmcnt(21) lgkmcnt(1)
    v_mul_f32 v227, v227, v79
    v_cvt_pk_bf16_f32 v234, v224, v225
    v_mfma_f32_16x16x32_bf16 v[104:107], a[144:147], v[152:155], v[104:107]
    s_add_u32 s54, s33, 18432
    buffer_load_dwordx4 a[80:83], v6, s[28:31], s54 offen sc1
    v_cvt_pk_bf16_f32 v235, v226, v227
    v_mfma_f32_16x16x32_bf16 v[108:111], a[144:147], v[156:159], v[108:111]
    ds_read_b128 v[168:171], v6 offset:17408
    ds_write_b128 v1, v[232:235] offset:25600
    v_mfma_f32_16x16x32_bf16 v[112:115], a[144:147], v[160:163], v[112:115]
    s_waitcnt lgkmcnt(2)
    ds_read_b128 v[172:175], v6 offset:35840
    v_mul_f32 v228, v92, v92
    v_mfma_f32_16x16x32_bf16 v[116:119], a[144:147], v[164:167], v[116:119]
    ds_read_b128 v[176:179], v240 offset:17408
    v_mul_f32 v229, v93, v93
    v_mfma_f32_16x16x32_bf16 v[120:123], a[148:151], v[152:155], v[120:123]
    s_add_u32 s54, s33, 19456
    buffer_load_dwordx4 a[84:87], v6, s[28:31], s54 offen sc1
    v_mfma_f32_16x16x32_bf16 v[124:127], a[148:151], v[156:159], v[124:127]
    ds_read_b128 v[180:183], v240 offset:35840
    v_mul_f32 v230, v94, v94
    v_mfma_f32_16x16x32_bf16 v[128:131], a[148:151], v[160:163], v[128:131]
    v_mul_f32 v231, v95, v95
    v_fma_f32 v228, v228, v191, v190
    v_mfma_f32_16x16x32_bf16 v[132:135], a[148:151], v[164:167], v[132:135]
    v_fma_f32 v229, v229, v191, v190
    v_fma_f32 v230, v230, v191, v190
    v_mfma_f32_16x16x32_bf16 v[136:139], a[152:155], v[152:155], v[136:139]
    s_add_u32 s54, s33, 20480
    buffer_load_dwordx4 a[88:91], v6, s[28:31], s54 offen sc1
    v_fma_f32 v231, v231, v191, v190
    v_mfma_f32_16x16x32_bf16 v[140:143], a[152:155], v[156:159], v[140:143]
    v_mul_f32 v228, v228, v92
    v_mul_f32 v229, v229, v93
    v_mfma_f32_16x16x32_bf16 v[144:147], a[152:155], v[160:163], v[144:147]
    v_mul_f32 v230, v230, v94
    v_mul_f32 v231, v231, v95
    v_mfma_f32_16x16x32_bf16 v[148:151], a[152:155], v[164:167], v[148:151]
    s_waitcnt vmcnt(21) lgkmcnt(0)
    s_barrier
    v_exp_f32 v228, v228
    v_mfma_f32_16x16x32_bf16 v[104:107], a[156:159], v[168:171], v[104:107]
    s_add_u32 s54, s33, 21504
    buffer_load_dwordx4 a[92:95], v6, s[28:31], s54 offen sc1
    v_mfma_f32_16x16x32_bf16 v[108:111], a[156:159], v[172:175], v[108:111]
    ds_read_b128 v[152:155], v238 offset:0
    v_exp_f32 v229, v229
    v_mfma_f32_16x16x32_bf16 v[112:115], a[156:159], v[176:179], v[112:115]
    ds_read_b128 v[156:159], v238 offset:1024
    v_exp_f32 v230, v230
    v_mfma_f32_16x16x32_bf16 v[116:119], a[156:159], v[180:183], v[116:119]
    ds_read_b128 v[160:163], v238 offset:2048
    v_exp_f32 v231, v231
    v_mfma_f32_16x16x32_bf16 v[120:123], a[0:3], v[168:171], v[120:123]
    s_add_u32 s54, s33, 22528
    buffer_load_dwordx4 a[96:99], v6, s[28:31], s54 offen sc1
    v_mfma_f32_16x16x32_bf16 v[124:127], a[0:3], v[172:175], v[124:127]
    ds_read_b128 v[164:167], v238 offset:3072
    v_fma_f32 v228, v228, v189, v189
    v_fma_f32 v229, v229, v189, v189
    v_mfma_f32_16x16x32_bf16 v[128:131], a[0:3], v[176:179], v[128:131]
    v_fma_f32 v230, v230, v189, v189
    v_fma_f32 v231, v231, v189, v189
    v_mfma_f32_16x16x32_bf16 v[132:135], a[0:3], v[180:183], v[132:135]
    v_rcp_f32 v228, v228
    v_mfma_f32_16x16x32_bf16 v[136:139], a[4:7], v[168:171], v[136:139]
    s_add_u32 s54, s33, 23552
    buffer_load_dwordx4 a[100:103], v6, s[28:31], s54 offen sc1
    v_rcp_f32 v229, v229
    v_mfma_f32_16x16x32_bf16 v[140:143], a[4:7], v[172:175], v[140:143]
    v_rcp_f32 v230, v230
    v_mfma_f32_16x16x32_bf16 v[144:147], a[4:7], v[176:179], v[144:147]
    v_rcp_f32 v231, v231
    v_mul_f32 v228, v228, v92
    v_mfma_f32_16x16x32_bf16 v[148:151], a[4:7], v[180:183], v[148:151]
    s_waitcnt vmcnt(21) lgkmcnt(0)
    v_mul_f32 v229, v229, v93
    v_mul_f32 v230, v230, v94
    v_mfma_f32_16x16x32_bf16 v[8:11], a[8:11], v[152:155], 0
    s_add_u32 s54, s33, 24576
    buffer_load_dwordx4 a[104:107], v6, s[28:31], s54 offen sc1
    v_mul_f32 v231, v231, v95
    v_mfma_f32_16x16x32_bf16 v[12:15], a[8:11], v[156:159], 0
    v_cvt_pk_bf16_f32 v236, v228, v229
    v_cvt_pk_bf16_f32 v237, v230, v231
    v_mfma_f32_16x16x32_bf16 v[16:19], a[8:11], v[160:163], 0
    ds_write_b64 v2, v[236:237] offset:25600
    v_mfma_f32_16x16x32_bf16 v[20:23], a[8:11], v[164:167], 0
    v_mul_f32 v224, v64, v64
    v_mul_f32 v225, v65, v65
    v_mul_f32 v226, v66, v66
    v_mfma_f32_16x16x32_bf16 v[24:27], a[12:15], v[152:155], 0
    s_add_u32 s54, s33, 25600
    buffer_load_dwordx4 a[108:111], v6, s[28:31], s54 offen sc1
    v_mfma_f32_16x16x32_bf16 v[28:31], a[12:15], v[156:159], 0
    v_mul_f32 v227, v67, v67
    v_fma_f32 v224, v224, v195, v194
    v_fma_f32 v225, v225, v195, v194
    v_mfma_f32_16x16x32_bf16 v[32:35], a[12:15], v[160:163], 0
    v_fma_f32 v226, v226, v195, v194
    v_fma_f32 v227, v227, v195, v194
    v_mul_f32 v224, v224, v64
    v_mfma_f32_16x16x32_bf16 v[36:39], a[12:15], v[164:167], 0
    ds_read_b128 v[168:171], v238 offset:4096
    v_mul_f32 v225, v225, v65
    v_mfma_f32_16x16x32_bf16 v[40:43], a[16:19], v[152:155], 0
    s_add_u32 s54, s33, 26624
    buffer_load_dwordx4 a[112:115], v6, s[28:31], s54 offen sc1
    v_mul_f32 v226, v226, v66
    v_mfma_f32_16x16x32_bf16 v[44:47], a[16:19], v[156:159], 0
    v_mul_f32 v227, v227, v67
    v_exp_f32 v224, v224
    v_mfma_f32_16x16x32_bf16 v[48:51], a[16:19], v[160:163], 0
    v_exp_f32 v225, v225
    v_mfma_f32_16x16x32_bf16 v[52:55], a[16:19], v[164:167], 0
    s_waitcnt vmcnt(21)
    v_exp_f32 v226, v226
    v_mfma_f32_16x16x32_bf16 a[160:163], a[20:23], v[152:155], 0
    s_add_u32 s54, s33, 27648
    buffer_load_dwordx4 a[116:119], v6, s[28:31], s54 offen sc1
    v_mfma_f32_16x16x32_bf16 a[164:167], a[20:23], v[156:159], 0
    ds_read_b128 v[172:175], v238 offset:5120
    v_exp_f32 v227, v227
    v_fma_f32 v224, v224, v193, v193
    v_mfma_f32_16x16x32_bf16 a[168:171], a[20:23], v[160:163], 0
    v_fma_f32 v225, v225, v193, v193
    v_fma_f32 v226, v226, v193, v193
    v_mfma_f32_16x16x32_bf16 a[172:175], a[20:23], v[164:167], 0
    v_fma_f32 v227, v227, v193, v193
    v_rcp_f32 v224, v224
    v_mfma_f32_16x16x32_bf16 a[176:179], a[24:27], v[152:155], 0
    s_add_u32 s54, s33, 28672
    buffer_load_dwordx4 a[120:123], v6, s[28:31], s54 offen sc1
    v_mfma_f32_16x16x32_bf16 a[180:183], a[24:27], v[156:159], 0
    v_rcp_f32 v225, v225
    v_mfma_f32_16x16x32_bf16 a[184:187], a[24:27], v[160:163], 0
    v_rcp_f32 v226, v226
    v_rcp_f32 v227, v227
    v_mfma_f32_16x16x32_bf16 a[188:191], a[24:27], v[164:167], 0
    ds_read_b128 v[176:179], v238 offset:6144
    v_mul_f32 v224, v224, v64
    v_mfma_f32_16x16x32_bf16 a[192:195], a[28:31], v[152:155], 0
    s_add_u32 s54, s33, 29696
    buffer_load_dwordx4 a[124:127], v6, s[28:31], s54 offen sc1
    v_mul_f32 v225, v225, v65
    v_mfma_f32_16x16x32_bf16 a[196:199], a[28:31], v[156:159], 0
    v_mul_f32 v226, v226, v66
    v_mul_f32 v227, v227, v67
    v_mfma_f32_16x16x32_bf16 a[200:203], a[28:31], v[160:163], 0
    v_cvt_pk_bf16_f32 v232, v224, v225
    v_cvt_pk_bf16_f32 v233, v226, v227
    v_mul_f32 v228, v80, v80
    v_mfma_f32_16x16x32_bf16 a[204:207], a[28:31], v[164:167], 0
    s_waitcnt vmcnt(21)
    v_mul_f32 v229, v81, v81
    v_mul_f32 v230, v82, v82
    v_mul_f32 v231, v83, v83
    v_mfma_f32_16x16x32_bf16 a[208:211], a[32:35], v[152:155], 0
    s_add_u32 s54, s33, 30720
    buffer_load_dwordx4 a[128:131], v6, s[28:31], s54 offen sc1
    v_mfma_f32_16x16x32_bf16 a[212:215], a[32:35], v[156:159], 0
    ds_read_b128 v[180:183], v238 offset:7168
    v_fma_f32 v228, v228, v195, v194
    v_fma_f32 v229, v229, v195, v194
    v_mfma_f32_16x16x32_bf16 a[216:219], a[32:35], v[160:163], 0
    v_fma_f32 v230, v230, v195, v194
    v_fma_f32 v231, v231, v195, v194
    v_mfma_f32_16x16x32_bf16 a[220:223], a[32:35], v[164:167], 0
    v_mul_f32 v228, v228, v80
    v_mul_f32 v229, v229, v81
    v_mul_f32 v230, v230, v82
    v_mfma_f32_16x16x32_bf16 a[224:227], a[36:39], v[152:155], 0
    s_add_u32 s54, s33, 31744
    buffer_load_dwordx4 a[132:135], v6, s[28:31], s54 offen sc1
    v_mul_f32 v231, v231, v83
    v_mfma_f32_16x16x32_bf16 a[228:231], a[36:39], v[156:159], 0
    v_exp_f32 v228, v228
    v_mfma_f32_16x16x32_bf16 a[232:235], a[36:39], v[160:163], 0
    v_exp_f32 v229, v229
    v_mfma_f32_16x16x32_bf16 a[236:239], a[36:39], v[164:167], 0
    v_exp_f32 v230, v230
    v_mfma_f32_16x16x32_bf16 a[240:243], a[40:43], v[152:155], 0
    s_add_u32 s54, s33, 32768
    buffer_load_dwordx4 a[136:139], v6, s[28:31], s54 offen sc1
    v_exp_f32 v231, v231
    v_mfma_f32_16x16x32_bf16 a[244:247], a[40:43], v[156:159], 0
    v_fma_f32 v228, v228, v193, v193
    v_fma_f32 v229, v229, v193, v193
    v_fma_f32 v230, v230, v193, v193
    v_mfma_f32_16x16x32_bf16 a[248:251], a[40:43], v[160:163], 0
    v_fma_f32 v231, v231, v193, v193
    v_rcp_f32 v228, v228
    v_mfma_f32_16x16x32_bf16 a[252:255], a[40:43], v[164:167], 0
    s_waitcnt vmcnt(21) lgkmcnt(0)
    v_rcp_f32 v229, v229
    v_mfma_f32_16x16x32_bf16 v[8:11], a[44:47], v[168:171], v[8:11]
    s_add_u32 s54, s33, 33792
    buffer_load_dwordx4 a[140:143], v6, s[28:31], s54 offen sc1
    v_mfma_f32_16x16x32_bf16 v[12:15], a[44:47], v[172:175], v[12:15]
    v_rcp_f32 v230, v230
    v_mfma_f32_16x16x32_bf16 v[16:19], a[44:47], v[176:179], v[16:19]
    v_rcp_f32 v231, v231
    v_mul_f32 v228, v228, v80
    v_mfma_f32_16x16x32_bf16 v[20:23], a[44:47], v[180:183], v[20:23]
    v_mul_f32 v229, v229, v81
    v_mul_f32 v230, v230, v82
    v_mul_f32 v231, v231, v83
    v_mfma_f32_16x16x32_bf16 v[24:27], a[48:51], v[168:171], v[24:27]
    s_add_u32 s54, s33, 34816
    buffer_load_dwordx4 a[144:147], v6, s[28:31], s54 offen sc1
    v_cvt_pk_bf16_f32 v234, v228, v229
    v_mfma_f32_16x16x32_bf16 v[28:31], a[48:51], v[172:175], v[28:31]
    v_cvt_pk_bf16_f32 v235, v230, v231
    ds_write_b128 v1, v[232:235] offset:26624
    v_mfma_f32_16x16x32_bf16 v[32:35], a[48:51], v[176:179], v[32:35]
    v_mul_f32 v224, v96, v96
    v_mul_f32 v225, v97, v97
    v_mfma_f32_16x16x32_bf16 v[36:39], a[48:51], v[180:183], v[36:39]
    ds_read_b128 v[152:155], v238 offset:8192
    v_mul_f32 v226, v98, v98
    v_mfma_f32_16x16x32_bf16 v[40:43], a[52:55], v[168:171], v[40:43]
    s_add_u32 s54, s33, 35840
    buffer_load_dwordx4 a[148:151], v6, s[28:31], s54 offen sc1
    v_mfma_f32_16x16x32_bf16 v[44:47], a[52:55], v[172:175], v[44:47]
    v_mul_f32 v227, v99, v99
    v_fma_f32 v224, v224, v195, v194
    v_mfma_f32_16x16x32_bf16 v[48:51], a[52:55], v[176:179], v[48:51]
    s_add_u32 s54, s33, 36864
    buffer_load_dwordx4 a[152:155], v6, s[28:31], s54 offen sc1
    v_mfma_f32_16x16x32_bf16 v[52:55], a[52:55], v[180:183], v[52:55]
    s_waitcnt vmcnt(22)
    v_fma_f32 v225, v225, v195, v194
    v_fma_f32 v226, v226, v195, v194
    v_mfma_f32_16x16x32_bf16 a[160:163], a[56:59], v[168:171], a[160:163]
    s_add_u32 s54, s33, 37888
    buffer_load_dwordx4 a[156:159], v6, s[28:31], s54 offen sc1
    v_mfma_f32_16x16x32_bf16 a[164:167], a[56:59], v[172:175], a[164:167]
    ds_read_b128 v[156:159], v238 offset:9216
    v_fma_f32 v227, v227, v195, v194
    v_mul_f32 v224, v224, v96
    v_mfma_f32_16x16x32_bf16 a[168:171], a[56:59], v[176:179], a[168:171]
    v_mul_f32 v225, v225, v97
    v_mul_f32 v226, v226, v98
    v_mfma_f32_16x16x32_bf16 a[172:175], a[56:59], v[180:183], a[172:175]
    v_mul_f32 v227, v227, v99
    v_exp_f32 v224, v224
    v_mfma_f32_16x16x32_bf16 a[176:179], a[60:63], v[168:171], a[176:179]
    s_add_u32 s54, s33, 38912
    buffer_load_dwordx4 a[0:3], v6, s[28:31], s54 offen sc1
    v_mfma_f32_16x16x32_bf16 a[180:183], a[60:63], v[172:175], a[180:183]
    v_exp_f32 v225, v225
    v_mfma_f32_16x16x32_bf16 a[184:187], a[60:63], v[176:179], a[184:187]
    v_exp_f32 v226, v226
    v_exp_f32 v227, v227
    v_mfma_f32_16x16x32_bf16 a[188:191], a[60:63], v[180:183], a[188:191]
    ds_read_b128 v[160:163], v238 offset:10240
    v_fma_f32 v224, v224, v193, v193
    v_mfma_f32_16x16x32_bf16 a[192:195], a[64:67], v[168:171], a[192:195]
    s_add_u32 s54, s33, 39936
    buffer_load_dwordx4 a[4:7], v6, s[28:31], s54 offen sc1
    v_fma_f32 v225, v225, v193, v193
    v_mfma_f32_16x16x32_bf16 a[196:199], a[64:67], v[172:175], a[196:199]
    v_fma_f32 v226, v226, v193, v193
    v_fma_f32 v227, v227, v193, v193
    v_mfma_f32_16x16x32_bf16 a[200:203], a[64:67], v[176:179], a[200:203]
    v_rcp_f32 v224, v224
    v_mfma_f32_16x16x32_bf16 a[204:207], a[64:67], v[180:183], a[204:207]
    s_waitcnt vmcnt(22)
    v_rcp_f32 v225, v225
    v_rcp_f32 v226, v226
    v_mfma_f32_16x16x32_bf16 a[208:211], a[68:71], v[168:171], a[208:211]
    s_add_u32 s54, s33, 40960
    buffer_load_dwordx4 a[8:11], v6, s[28:31], s54 offen sc1
    v_mfma_f32_16x16x32_bf16 a[212:215], a[68:71], v[172:175], a[212:215]
    ds_read_b128 v[164:167], v238 offset:11264
    v_rcp_f32 v227, v227
    v_mfma_f32_16x16x32_bf16 a[216:219], a[68:71], v[176:179], a[216:219]
    v_mul_f32 v224, v224, v96
    v_mul_f32 v225, v225, v97
    v_mul_f32 v226, v226, v98
    v_mfma_f32_16x16x32_bf16 a[220:223], a[68:71], v[180:183], a[220:223]
    v_mul_f32 v227, v227, v99
    v_cvt_pk_bf16_f32 v236, v224, v225
    v_mfma_f32_16x16x32_bf16 a[224:227], a[72:75], v[168:171], a[224:227]
    s_add_u32 s54, s33, 41984
    buffer_load_dwordx4 a[12:15], v6, s[28:31], s54 offen sc1
    v_cvt_pk_bf16_f32 v237, v226, v227
    v_mfma_f32_16x16x32_bf16 a[228:231], a[72:75], v[172:175], a[228:231]
    ds_write_b64 v2, v[236:237] offset:26624
    v_mfma_f32_16x16x32_bf16 a[232:235], a[72:75], v[176:179], a[232:235]
    v_mul_f32 v228, v68, v68
    v_mul_f32 v229, v69, v69
    v_mfma_f32_16x16x32_bf16 a[236:239], a[72:75], v[180:183], a[236:239]
    v_mul_f32 v230, v70, v70
    v_mul_f32 v231, v71, v71
    v_mfma_f32_16x16x32_bf16 a[240:243], a[76:79], v[168:171], a[240:243]
    s_add_u32 s54, s33, 43008
    buffer_load_dwordx4 a[16:19], v6, s[28:31], s54 offen sc1
    v_fma_f32 v228, v228, v199, v198
    v_mfma_f32_16x16x32_bf16 a[244:247], a[76:79], v[172:175], a[244:247]
    v_fma_f32 v229, v229, v199, v198
    v_fma_f32 v230, v230, v199, v198
    v_fma_f32 v231, v231, v199, v198
    v_mfma_f32_16x16x32_bf16 a[248:251], a[76:79], v[176:179], a[248:251]
    v_mul_f32 v228, v228, v68
    v_mul_f32 v229, v229, v69
    v_mfma_f32_16x16x32_bf16 a[252:255], a[76:79], v[180:183], a[252:255]
    s_waitcnt vmcnt(22) lgkmcnt(0)
    v_mul_f32 v230, v230, v70
    v_mul_f32 v231, v231, v71
    v_mfma_f32_16x16x32_bf16 v[8:11], a[80:83], v[152:155], v[8:11]
    s_add_u32 s54, s33, 44032
    buffer_load_dwordx4 a[20:23], v6, s[28:31], s54 offen sc1
    v_mfma_f32_16x16x32_bf16 v[12:15], a[80:83], v[156:159], v[12:15]
    v_exp_f32 v228, v228
    v_exp_f32 v229, v229
    v_mfma_f32_16x16x32_bf16 v[16:19], a[80:83], v[160:163], v[16:19]
    v_exp_f32 v230, v230
    v_mfma_f32_16x16x32_bf16 v[20:23], a[80:83], v[164:167], v[20:23]
    v_exp_f32 v231, v231
    v_fma_f32 v228, v228, v197, v197
    v_mfma_f32_16x16x32_bf16 v[24:27], a[84:87], v[152:155], v[24:27]
    s_add_u32 s54, s33, 45056
    buffer_load_dwordx4 a[24:27], v6, s[28:31], s54 offen sc1
    v_fma_f32 v229, v229, v197, v197
    v_mfma_f32_16x16x32_bf16 v[28:31], a[84:87], v[156:159], v[28:31]
    v_fma_f32 v230, v230, v197, v197
    v_fma_f32 v231, v231, v197, v197
    v_mfma_f32_16x16x32_bf16 v[32:35], a[84:87], v[160:163], v[32:35]
    s_add_u32 s54, s33, 46080
    buffer_load_dwordx4 a[28:31], v6, s[28:31], s54 offen sc1
    v_mfma_f32_16x16x32_bf16 v[36:39], a[84:87], v[164:167], v[36:39]
    ds_read_b128 v[168:171], v238 offset:12288
    v_rcp_f32 v228, v228
    v_mfma_f32_16x16x32_bf16 v[40:43], a[88:91], v[152:155], v[40:43]
    s_add_u32 s54, s33, 47104
    buffer_load_dwordx4 a[32:35], v6, s[28:31], s54 offen sc1
    v_mfma_f32_16x16x32_bf16 v[44:47], a[88:91], v[156:159], v[44:47]
    v_rcp_f32 v229, v229
    v_rcp_f32 v230, v230
    v_mfma_f32_16x16x32_bf16 v[48:51], a[88:91], v[160:163], v[48:51]
    v_rcp_f32 v231, v231
    v_mfma_f32_16x16x32_bf16 v[52:55], a[88:91], v[164:167], v[52:55]
    s_waitcnt vmcnt(23)
    v_mul_f32 v228, v228, v68
    v_mul_f32 v229, v229, v69
    v_mul_f32 v230, v230, v70
    v_mfma_f32_16x16x32_bf16 a[160:163], a[92:95], v[152:155], a[160:163]
    s_add_u32 s54, s33, 48128
    buffer_load_dwordx4 a[36:39], v6, s[28:31], s54 offen sc1
    v_mul_f32 v231, v231, v71
    v_mfma_f32_16x16x32_bf16 a[164:167], a[92:95], v[156:159], a[164:167]
    ds_read_b128 v[172:175], v238 offset:13312
    v_cvt_pk_bf16_f32 v232, v228, v229
    v_mfma_f32_16x16x32_bf16 a[168:171], a[92:95], v[160:163], a[168:171]
    v_cvt_pk_bf16_f32 v233, v230, v231
    v_mul_f32 v224, v84, v84
    v_mul_f32 v225, v85, v85
    v_mfma_f32_16x16x32_bf16 a[172:175], a[92:95], v[164:167], a[172:175]
    v_mul_f32 v226, v86, v86
    v_mul_f32 v227, v87, v87
    v_mfma_f32_16x16x32_bf16 a[176:179], a[96:99], v[152:155], a[176:179]
    s_add_u32 s54, s33, 49152
    buffer_load_dwordx4 a[40:43], v6, s[28:31], s54 offen sc1
    v_fma_f32 v224, v224, v199, v198
    v_mfma_f32_16x16x32_bf16 a[180:183], a[96:99], v[156:159], a[180:183]
    v_fma_f32 v225, v225, v199, v198
    v_fma_f32 v226, v226, v199, v198
    v_mfma_f32_16x16x32_bf16 a[184:187], a[96:99], v[160:163], a[184:187]
    v_fma_f32 v227, v227, v199, v198
    v_mul_f32 v224, v224, v84
    v_mul_f32 v225, v225, v85
    v_mfma_f32_16x16x32_bf16 a[188:191], a[96:99], v[164:167], a[188:191]
    ds_read_b128 v[176:179], v238 offset:14336
    v_mul_f32 v226, v226, v86
    v_mul_f32 v227, v227, v87
    v_mfma_f32_16x16x32_bf16 a[192:195], a[100:103], v[152:155], a[192:195]
    s_add_u32 s54, s33, 50176
    buffer_load_dwordx4 a[44:47], v6, s[28:31], s54 offen sc1
    v_mfma_f32_16x16x32_bf16 a[196:199], a[100:103], v[156:159], a[196:199]
    v_exp_f32 v224, v224
    v_mfma_f32_16x16x32_bf16 a[200:203], a[100:103], v[160:163], a[200:203]
    v_exp_f32 v225, v225
    v_mfma_f32_16x16x32_bf16 a[204:207], a[100:103], v[164:167], a[204:207]
    s_waitcnt vmcnt(23)
    v_exp_f32 v226, v226
    v_exp_f32 v227, v227
    v_mfma_f32_16x16x32_bf16 a[208:211], a[104:107], v[152:155], a[208:211]
    s_add_u32 s54, s33, 51200
    buffer_load_dwordx4 a[48:51], v6, s[28:31], s54 offen sc1
    v_fma_f32 v224, v224, v197, v197
    v_mfma_f32_16x16x32_bf16 a[212:215], a[104:107], v[156:159], a[212:215]
    ds_read_b128 v[180:183], v238 offset:15360
    v_fma_f32 v225, v225, v197, v197
    v_mfma_f32_16x16x32_bf16 a[216:219], a[104:107], v[160:163], a[216:219]
    v_fma_f32 v226, v226, v197, v197
    v_fma_f32 v227, v227, v197, v197
    v_mfma_f32_16x16x32_bf16 a[220:223], a[104:107], v[164:167], a[220:223]
    v_rcp_f32 v224, v224
    v_mfma_f32_16x16x32_bf16 a[224:227], a[108:111], v[152:155], a[224:227]
    s_add_u32 s54, s33, 52224
    buffer_load_dwordx4 a[52:55], v6, s[28:31], s54 offen sc1
    v_rcp_f32 v225, v225
    v_mfma_f32_16x16x32_bf16 a[228:231], a[108:111], v[156:159], a[228:231]
    v_rcp_f32 v226, v226
    v_mfma_f32_16x16x32_bf16 a[232:235], a[108:111], v[160:163], a[232:235]
    v_rcp_f32 v227, v227
    v_mul_f32 v224, v224, v84
    v_mfma_f32_16x16x32_bf16 a[236:239], a[108:111], v[164:167], a[236:239]
    v_mul_f32 v225, v225, v85
    v_mul_f32 v226, v226, v86
    v_mul_f32 v227, v227, v87
    v_mfma_f32_16x16x32_bf16 a[240:243], a[112:115], v[152:155], a[240:243]
    s_add_u32 s54, s33, 53248
    buffer_load_dwordx4 a[56:59], v6, s[28:31], s54 offen sc1
    v_mfma_f32_16x16x32_bf16 a[244:247], a[112:115], v[156:159], a[244:247]
    v_cvt_pk_bf16_f32 v234, v224, v225
    v_cvt_pk_bf16_f32 v235, v226, v227
    v_mfma_f32_16x16x32_bf16 a[248:251], a[112:115], v[160:163], a[248:251]
    ds_write_b128 v1, v[232:235] offset:27648
    v_mfma_f32_16x16x32_bf16 a[252:255], a[112:115], v[164:167], a[252:255]
    s_waitcnt vmcnt(23) lgkmcnt(0)
    v_mul_f32 v228, v100, v100
    v_mul_f32 v229, v101, v101
    v_mfma_f32_16x16x32_bf16 v[8:11], a[116:119], v[168:171], v[8:11]
    s_add_u32 s54, s33, 54272
    buffer_load_dwordx4 a[60:63], v6, s[28:31], s54 offen sc1
    v_mfma_f32_16x16x32_bf16 v[12:15], a[116:119], v[172:175], v[12:15]
    v_mul_f32 v230, v102, v102
    v_mul_f32 v231, v103, v103
    v_mfma_f32_16x16x32_bf16 v[16:19], a[116:119], v[176:179], v[16:19]
    s_add_u32 s54, s33, 55296
    buffer_load_dwordx4 a[64:67], v6, s[28:31], s54 offen sc1
    v_fma_f32 v228, v228, v199, v198
    v_mfma_f32_16x16x32_bf16 v[20:23], a[116:119], v[180:183], v[20:23]
    v_fma_f32 v229, v229, v199, v198
    v_fma_f32 v230, v230, v199, v198
    v_fma_f32 v231, v231, v199, v198
    v_mfma_f32_16x16x32_bf16 v[24:27], a[120:123], v[168:171], v[24:27]
    s_add_u32 s54, s33, 56320
    buffer_load_dwordx4 a[68:71], v6, s[28:31], s54 offen sc1
    v_mfma_f32_16x16x32_bf16 v[28:31], a[120:123], v[172:175], v[28:31]
    v_mul_f32 v228, v228, v100
    v_mul_f32 v229, v229, v101
    v_mul_f32 v230, v230, v102
    v_mfma_f32_16x16x32_bf16 v[32:35], a[120:123], v[176:179], v[32:35]
    v_mul_f32 v231, v231, v103
    v_exp_f32 v228, v228
    v_mfma_f32_16x16x32_bf16 v[36:39], a[120:123], v[180:183], v[36:39]
    ds_read_b128 v[152:155], v238 offset:16384
    v_exp_f32 v229, v229
    v_mfma_f32_16x16x32_bf16 v[40:43], a[124:127], v[168:171], v[40:43]
    s_add_u32 s54, s33, 57344
    buffer_load_dwordx4 a[72:75], v6, s[28:31], s54 offen sc1
    v_mfma_f32_16x16x32_bf16 v[44:47], a[124:127], v[172:175], v[44:47]
    v_exp_f32 v230, v230
    v_mfma_f32_16x16x32_bf16 v[48:51], a[124:127], v[176:179], v[48:51]
    v_exp_f32 v231, v231
    v_mfma_f32_16x16x32_bf16 v[52:55], a[124:127], v[180:183], v[52:55]
    s_waitcnt vmcnt(24)
    v_fma_f32 v228, v228, v197, v197
    v_fma_f32 v229, v229, v197, v197
    v_fma_f32 v230, v230, v197, v197
    v_mfma_f32_16x16x32_bf16 a[160:163], a[128:131], v[168:171], a[160:163]
    s_add_u32 s54, s33, 58368
    buffer_load_dwordx4 a[76:79], v6, s[28:31], s54 offen sc1
    v_fma_f32 v231, v231, v197, v197
    v_mfma_f32_16x16x32_bf16 a[164:167], a[128:131], v[172:175], a[164:167]
    ds_read_b128 v[156:159], v238 offset:17408
    v_rcp_f32 v228, v228
    v_mfma_f32_16x16x32_bf16 a[168:171], a[128:131], v[176:179], a[168:171]
    v_rcp_f32 v229, v229
    v_mfma_f32_16x16x32_bf16 a[172:175], a[128:131], v[180:183], a[172:175]
    v_rcp_f32 v230, v230
    v_mfma_f32_16x16x32_bf16 a[176:179], a[132:135], v[168:171], a[176:179]
    s_add_u32 s54, s33, 59392
    buffer_load_dwordx4 a[80:83], v6, s[28:31], s54 offen sc1
    v_mfma_f32_16x16x32_bf16 a[180:183], a[132:135], v[172:175], a[180:183]
    v_rcp_f32 v231, v231
    v_mul_f32 v228, v228, v100
    v_mul_f32 v229, v229, v101
    v_mfma_f32_16x16x32_bf16 a[184:187], a[132:135], v[176:179], a[184:187]
    v_mul_f32 v230, v230, v102
    v_mul_f32 v231, v231, v103
    v_mfma_f32_16x16x32_bf16 a[188:191], a[132:135], v[180:183], a[188:191]
    ds_read_b128 v[160:163], v238 offset:18432
    v_cvt_pk_bf16_f32 v236, v228, v229
    v_cvt_pk_bf16_f32 v237, v230, v231
    v_mfma_f32_16x16x32_bf16 a[192:195], a[136:139], v[168:171], a[192:195]
    s_add_u32 s54, s33, 60416
    buffer_load_dwordx4 a[84:87], v6, s[28:31], s54 offen sc1
    v_mfma_f32_16x16x32_bf16 a[196:199], a[136:139], v[172:175], a[196:199]
    ds_write_b64 v2, v[236:237] offset:27648
    v_mfma_f32_16x16x32_bf16 a[200:203], a[136:139], v[176:179], a[200:203]
    v_mfma_f32_16x16x32_bf16 a[204:207], a[136:139], v[180:183], a[204:207]
    s_waitcnt vmcnt(24)
    v_mfma_f32_16x16x32_bf16 a[208:211], a[140:143], v[168:171], a[208:211]
    s_add_u32 s54, s33, 61440
    buffer_load_dwordx4 a[88:91], v6, s[28:31], s54 offen sc1
    v_mfma_f32_16x16x32_bf16 a[212:215], a[140:143], v[172:175], a[212:215]
    ds_read_b128 v[164:167], v238 offset:19456
    v_accvgpr_read_b32 v56, a160
    v_mul_f32 v224, v104, v104
    v_mfma_f32_16x16x32_bf16 a[216:219], a[140:143], v[176:179], a[216:219]
    v_accvgpr_read_b32 v57, a161
    v_mul_f32 v225, v105, v105
    v_mul_f32 v226, v106, v106
    v_mfma_f32_16x16x32_bf16 a[220:223], a[140:143], v[180:183], a[220:223]
    v_accvgpr_read_b32 v58, a162
    v_mul_f32 v227, v107, v107
    v_mfma_f32_16x16x32_bf16 a[224:227], a[144:147], v[168:171], a[224:227]
    s_add_u32 s54, s33, 62464
    buffer_load_dwordx4 a[92:95], v6, s[28:31], s54 offen sc1
    v_fma_f32 v224, v224, v187, v186
    v_mfma_f32_16x16x32_bf16 a[228:231], a[144:147], v[172:175], a[228:231]
    v_accvgpr_read_b32 v59, a163
    v_fma_f32 v225, v225, v187, v186
    v_fma_f32 v226, v226, v187, v186
    v_mfma_f32_16x16x32_bf16 a[232:235], a[144:147], v[176:179], a[232:235]
    s_add_u32 s54, s33, 63488
    buffer_load_dwordx4 a[96:99], v6, s[28:31], s54 offen sc1
    v_accvgpr_read_b32 v60, a164
    v_fma_f32 v227, v227, v187, v186
    v_mfma_f32_16x16x32_bf16 a[236:239], a[144:147], v[180:183], a[236:239]
    v_accvgpr_read_b32 v61, a165
    v_mul_f32 v224, v224, v104
    v_mfma_f32_16x16x32_bf16 a[240:243], a[148:151], v[168:171], a[240:243]
    s_add_u32 s54, s33, 64512
    buffer_load_dwordx4 a[100:103], v6, s[28:31], s54 offen sc1
    v_mul_f32 v225, v225, v105
    v_mfma_f32_16x16x32_bf16 a[244:247], a[148:151], v[172:175], a[244:247]
    v_accvgpr_read_b32 v62, a166
    v_mul_f32 v226, v226, v106
    v_mul_f32 v227, v227, v107
    v_mfma_f32_16x16x32_bf16 a[248:251], a[148:151], v[176:179], a[248:251]
    v_accvgpr_read_b32 v63, a167
    v_exp_f32 v224, v224
    v_mfma_f32_16x16x32_bf16 a[252:255], a[148:151], v[180:183], a[252:255]
    s_waitcnt vmcnt(25) lgkmcnt(0)
    v_accvgpr_read_b32 v64, a168
    v_exp_f32 v225, v225
    v_mfma_f32_16x16x32_bf16 v[8:11], a[152:155], v[152:155], v[8:11]
    s_add_u32 s54, s33, 65536
    buffer_load_dwordx4 a[104:107], v6, s[28:31], s54 offen sc1
    v_mfma_f32_16x16x32_bf16 v[12:15], a[152:155], v[156:159], v[12:15]
    v_accvgpr_read_b32 v65, a169
    v_exp_f32 v226, v226
    v_mfma_f32_16x16x32_bf16 v[16:19], a[152:155], v[160:163], v[16:19]
    v_accvgpr_read_b32 v66, a170
    v_exp_f32 v227, v227
    v_mfma_f32_16x16x32_bf16 v[20:23], a[152:155], v[164:167], v[20:23]
    v_accvgpr_read_b32 v67, a171
    v_fma_f32 v224, v224, v185, v185
    v_mfma_f32_16x16x32_bf16 v[24:27], a[156:159], v[152:155], v[24:27]
    s_add_u32 s54, s33, 66560
    buffer_load_dwordx4 a[108:111], v6, s[28:31], s54 offen sc1
    v_fma_f32 v225, v225, v185, v185
    v_mfma_f32_16x16x32_bf16 v[28:31], a[156:159], v[156:159], v[28:31]
    v_accvgpr_read_b32 v68, a172
    v_fma_f32 v226, v226, v185, v185
    v_fma_f32 v227, v227, v185, v185
    v_mfma_f32_16x16x32_bf16 v[32:35], a[156:159], v[160:163], v[32:35]
    v_accvgpr_read_b32 v69, a173
    v_rcp_f32 v224, v224
    v_mfma_f32_16x16x32_bf16 v[36:39], a[156:159], v[164:167], v[36:39]
    ds_read_b128 v[168:171], v238 offset:20480
    v_accvgpr_read_b32 v70, a174
    v_mfma_f32_16x16x32_bf16 v[40:43], a[0:3], v[152:155], v[40:43]
    s_add_u32 s54, s33, 67584
    buffer_load_dwordx4 a[112:115], v6, s[28:31], s54 offen sc1
    v_mfma_f32_16x16x32_bf16 v[44:47], a[0:3], v[156:159], v[44:47]
    v_accvgpr_read_b32 v71, a175
    v_rcp_f32 v225, v225
    v_mfma_f32_16x16x32_bf16 v[48:51], a[0:3], v[160:163], v[48:51]
    v_rcp_f32 v226, v226
    v_mfma_f32_16x16x32_bf16 v[52:55], a[0:3], v[164:167], v[52:55]
    s_waitcnt vmcnt(25)
    v_rcp_f32 v227, v227
    v_mul_f32 v224, v224, v104
    v_mul_f32 v225, v225, v105
    v_mfma_f32_16x16x32_bf16 v[56:59], a[4:7], v[152:155], v[56:59]
    s_add_u32 s54, s33, 68608
    buffer_load_dwordx4 a[116:119], v6, s[28:31], s54 offen sc1
    v_mul_f32 v226, v226, v106
    v_mfma_f32_16x16x32_bf16 v[60:63], a[4:7], v[156:159], v[60:63]
    ds_read_b128 v[172:175], v238 offset:21504
    v_mul_f32 v227, v227, v107
    v_mfma_f32_16x16x32_bf16 v[64:67], a[4:7], v[160:163], v[64:67]
    v_cvt_pk_bf16_f32 v232, v224, v225
    v_cvt_pk_bf16_f32 v233, v226, v227
    v_mul_f32 v228, v120, v120
    v_mfma_f32_16x16x32_bf16 v[68:71], a[4:7], v[164:167], v[68:71]
    v_mul_f32 v229, v121, v121
    v_mul_f32 v230, v122, v122
    v_mul_f32 v231, v123, v123
    v_mfma_f32_16x16x32_bf16 a[176:179], a[8:11], v[152:155], a[176:179]
    s_add_u32 s54, s33, 69632
    buffer_load_dwordx4 a[120:123], v6, s[28:31], s54 offen sc1
    v_fma_f32 v228, v228, v187, v186
    v_mfma_f32_16x16x32_bf16 a[180:183], a[8:11], v[156:159], a[180:183]
    v_fma_f32 v229, v229, v187, v186
    v_fma_f32 v230, v230, v187, v186
    v_mfma_f32_16x16x32_bf16 a[184:187], a[8:11], v[160:163], a[184:187]
    v_fma_f32 v231, v231, v187, v186
    v_mul_f32 v228, v228, v120
    v_mul_f32 v229, v229, v121
    v_mfma_f32_16x16x32_bf16 a[188:191], a[8:11], v[164:167], a[188:191]
    ds_read_b128 v[176:179], v238 offset:22528
    v_mul_f32 v230, v230, v122
    v_mul_f32 v231, v231, v123
    v_mfma_f32_16x16x32_bf16 a[192:195], a[12:15], v[152:155], a[192:195]
    s_add_u32 s54, s33, 70656
    buffer_load_dwordx4 a[124:127], v6, s[28:31], s54 offen sc1
    v_mfma_f32_16x16x32_bf16 a[196:199], a[12:15], v[156:159], a[196:199]
    v_exp_f32 v228, v228
    v_mfma_f32_16x16x32_bf16 a[200:203], a[12:15], v[160:163], a[200:203]
    v_exp_f32 v229, v229
    v_exp_f32 v230, v230
    v_mfma_f32_16x16x32_bf16 a[204:207], a[12:15], v[164:167], a[204:207]
    s_waitcnt vmcnt(25)
    v_exp_f32 v231, v231
    v_fma_f32 v228, v228, v185, v185
    v_mfma_f32_16x16x32_bf16 a[208:211], a[16:19], v[152:155], a[208:211]
    s_add_u32 s54, s33, 71680
    buffer_load_dwordx4 a[128:131], v6, s[28:31], s54 offen sc1
    v_mfma_f32_16x16x32_bf16 a[212:215], a[16:19], v[156:159], a[212:215]
    ds_read_b128 v[180:183], v238 offset:23552
    v_fma_f32 v229, v229, v185, v185
    v_fma_f32 v230, v230, v185, v185
    v_mfma_f32_16x16x32_bf16 a[216:219], a[16:19], v[160:163], a[216:219]
    s_add_u32 s54, s33, 72704
    buffer_load_dwordx4 a[132:135], v6, s[28:31], s54 offen sc1
    v_fma_f32 v231, v231, v185, v185
    v_mfma_f32_16x16x32_bf16 a[220:223], a[16:19], v[164:167], a[220:223]
    v_rcp_f32 v228, v228
    v_mfma_f32_16x16x32_bf16 a[224:227], a[20:23], v[152:155], a[224:227]
    s_add_u32 s54, s33, 73728
    buffer_load_dwordx4 a[136:139], v6, s[28:31], s54 offen sc1
    v_mfma_f32_16x16x32_bf16 a[228:231], a[20:23], v[156:159], a[228:231]
    v_accvgpr_read_b32 v72, a176
    v_rcp_f32 v229, v229
    v_mfma_f32_16x16x32_bf16 a[232:235], a[20:23], v[160:163], a[232:235]
    v_accvgpr_read_b32 v73, a177
    v_rcp_f32 v230, v230
    v_mfma_f32_16x16x32_bf16 a[236:239], a[20:23], v[164:167], a[236:239]
    v_accvgpr_read_b32 v74, a178
    v_rcp_f32 v231, v231
    v_mul_f32 v228, v228, v120
    v_mfma_f32_16x16x32_bf16 a[240:243], a[24:27], v[152:155], a[240:243]
    s_add_u32 s54, s33, 74752
    buffer_load_dwordx4 a[140:143], v6, s[28:31], s54 offen sc1
    v_mfma_f32_16x16x32_bf16 a[244:247], a[24:27], v[156:159], a[244:247]
    v_accvgpr_read_b32 v75, a179
    v_mul_f32 v229, v229, v121
    v_mul_f32 v230, v230, v122
    v_mfma_f32_16x16x32_bf16 a[248:251], a[24:27], v[160:163], a[248:251]
    v_accvgpr_read_b32 v76, a180
    v_mul_f32 v231, v231, v123
    v_cvt_pk_bf16_f32 v234, v228, v229
    v_mfma_f32_16x16x32_bf16 a[252:255], a[24:27], v[164:167], a[252:255]
    s_waitcnt vmcnt(26) lgkmcnt(0)
    s_barrier
    v_accvgpr_read_b32 v77, a181
    v_mfma_f32_16x16x32_bf16 v[8:11], a[28:31], v[168:171], v[8:11]
    s_add_u32 s54, s33, 75776
    buffer_load_dwordx4 a[144:147], v6, s[28:31], s54 offen sc1
    v_cvt_pk_bf16_f32 v235, v230, v231
    v_mfma_f32_16x16x32_bf16 v[12:15], a[28:31], v[172:175], v[12:15]
    v_accvgpr_read_b32 v78, a182
    ds_write_b128 v1, v[232:235] offset:49152
    v_mfma_f32_16x16x32_bf16 v[16:19], a[28:31], v[176:179], v[16:19]
    v_accvgpr_read_b32 v79, a183
    v_mul_f32 v224, v136, v136
    v_mfma_f32_16x16x32_bf16 v[20:23], a[28:31], v[180:183], v[20:23]
    v_accvgpr_read_b32 v80, a184
    v_mul_f32 v225, v137, v137
    v_mfma_f32_16x16x32_bf16 v[24:27], a[32:35], v[168:171], v[24:27]
    s_add_u32 s54, s33, 76800
    buffer_load_dwordx4 a[148:151], v6, s[28:31], s54 offen sc1
    v_mfma_f32_16x16x32_bf16 v[28:31], a[32:35], v[172:175], v[28:31]
    v_accvgpr_read_b32 v81, a185
    v_mul_f32 v226, v138, v138
    v_mfma_f32_16x16x32_bf16 v[32:35], a[32:35], v[176:179], v[32:35]
    v_accvgpr_read_b32 v82, a186
    v_mul_f32 v227, v139, v139
    v_mfma_f32_16x16x32_bf16 v[36:39], a[32:35], v[180:183], v[36:39]
    ds_read_b128 v[152:155], v238 offset:24576
    v_accvgpr_read_b32 v83, a187
    v_fma_f32 v224, v224, v187, v186
    v_mfma_f32_16x16x32_bf16 v[40:43], a[36:39], v[168:171], v[40:43]
    s_add_u32 s54, s33, 77824
    buffer_load_dwordx4 a[152:155], v6, s[28:31], s54 offen sc1
    v_fma_f32 v225, v225, v187, v186
    v_mfma_f32_16x16x32_bf16 v[44:47], a[36:39], v[172:175], v[44:47]
    v_accvgpr_read_b32 v84, a188
    v_fma_f32 v226, v226, v187, v186
    v_fma_f32 v227, v227, v187, v186
    v_mfma_f32_16x16x32_bf16 v[48:51], a[36:39], v[176:179], v[48:51]
    v_accvgpr_read_b32 v85, a189
    v_mul_f32 v224, v224, v136
    v_mfma_f32_16x16x32_bf16 v[52:55], a[36:39], v[180:183], v[52:55]
    s_waitcnt vmcnt(26)
    v_accvgpr_read_b32 v86, a190
    v_mul_f32 v225, v225, v137
    v_mul_f32 v226, v226, v138
    v_mfma_f32_16x16x32_bf16 v[56:59], a[40:43], v[168:171], v[56:59]
    s_add_u32 s54, s33, 78848
    buffer_load_dwordx4 a[156:159], v6, s[28:31], s54 offen sc1
    v_mul_f32 v227, v227, v139
    v_mfma_f32_16x16x32_bf16 v[60:63], a[40:43], v[172:175], v[60:63]
    ds_read_b128 v[156:159], v238 offset:25600
    v_accvgpr_read_b32 v87, a191
    v_mfma_f32_16x16x32_bf16 v[64:67], a[40:43], v[176:179], v[64:67]
    v_exp_f32 v224, v224
    v_mfma_f32_16x16x32_bf16 v[68:71], a[40:43], v[180:183], v[68:71]
    v_exp_f32 v225, v225
    v_exp_f32 v226, v226
    v_mfma_f32_16x16x32_bf16 v[72:75], a[44:47], v[168:171], v[72:75]
    s_add_u32 s54, s33, 79872
    buffer_load_dwordx4 a[0:3], v6, s[28:31], s54 offen sc1
    v_mfma_f32_16x16x32_bf16 v[76:79], a[44:47], v[172:175], v[76:79]
    v_exp_f32 v227, v227
    v_fma_f32 v224, v224, v185, v185
    v_mfma_f32_16x16x32_bf16 v[80:83], a[44:47], v[176:179], v[80:83]
    v_fma_f32 v225, v225, v185, v185
    v_fma_f32 v226, v226, v185, v185
    v_fma_f32 v227, v227, v185, v185
    v_mfma_f32_16x16x32_bf16 v[84:87], a[44:47], v[180:183], v[84:87]
    ds_read_b128 v[160:163], v238 offset:26624
    v_rcp_f32 v224, v224
    v_mfma_f32_16x16x32_bf16 a[192:195], a[48:51], v[168:171], a[192:195]
    s_add_u32 s54, s33, 80896
    buffer_load_dwordx4 a[4:7], v6, s[28:31], s54 offen sc1
    v_mfma_f32_16x16x32_bf16 a[196:199], a[48:51], v[172:175], a[196:199]
    v_rcp_f32 v225, v225
    v_mfma_f32_16x16x32_bf16 a[200:203], a[48:51], v[176:179], a[200:203]
    s_add_u32 s54, s33, 81920
    buffer_load_dwordx4 a[8:11], v6, s[28:31], s54 offen sc1
    v_rcp_f32 v226, v226
    v_mfma_f32_16x16x32_bf16 a[204:207], a[48:51], v[180:183], a[204:207]
    s_waitcnt vmcnt(27)
    v_rcp_f32 v227, v227
    v_mul_f32 v224, v224, v136
    v_mfma_f32_16x16x32_bf16 a[208:211], a[52:55], v[168:171], a[208:211]
    s_add_u32 s54, s33, 82944
    buffer_load_dwordx4 a[12:15], v6, s[28:31], s54 offen sc1
    v_mul_f32 v225, v225, v137
    v_mfma_f32_16x16x32_bf16 a[212:215], a[52:55], v[172:175], a[212:215]
    ds_read_b128 v[164:167], v238 offset:27648
    v_mul_f32 v226, v226, v138
    v_mfma_f32_16x16x32_bf16 a[216:219], a[52:55], v[176:179], a[216:219]
    v_mul_f32 v227, v227, v139
    v_cvt_pk_bf16_f32 v236, v224, v225
    v_cvt_pk_bf16_f32 v237, v226, v227
    v_mfma_f32_16x16x32_bf16 a[220:223], a[52:55], v[180:183], a[220:223]
    ds_write_b64 v2, v[236:237] offset:49152
    v_mfma_f32_16x16x32_bf16 a[224:227], a[56:59], v[168:171], a[224:227]
    s_add_u32 s54, s33, 83968
    buffer_load_dwordx4 a[16:19], v6, s[28:31], s54 offen sc1
    v_mfma_f32_16x16x32_bf16 a[228:231], a[56:59], v[172:175], a[228:231]
    v_mul_f32 v228, v108, v108
    v_mul_f32 v229, v109, v109
    v_mul_f32 v230, v110, v110
    v_mfma_f32_16x16x32_bf16 a[232:235], a[56:59], v[176:179], a[232:235]
    v_mul_f32 v231, v111, v111
    v_fma_f32 v228, v228, v191, v190
    v_fma_f32 v229, v229, v191, v190
    v_mfma_f32_16x16x32_bf16 a[236:239], a[56:59], v[180:183], a[236:239]
    v_fma_f32 v230, v230, v191, v190
    v_fma_f32 v231, v231, v191, v190
    v_mul_f32 v228, v228, v108
    v_mfma_f32_16x16x32_bf16 a[240:243], a[60:63], v[168:171], a[240:243]
    s_add_u32 s54, s33, 84992
    buffer_load_dwordx4 a[20:23], v6, s[28:31], s54 offen sc1
    v_mfma_f32_16x16x32_bf16 a[244:247], a[60:63], v[172:175], a[244:247]
    v_accvgpr_read_b32 v88, a192
    v_mul_f32 v229, v229, v109
    v_mul_f32 v230, v230, v110
    v_mfma_f32_16x16x32_bf16 a[248:251], a[60:63], v[176:179], a[248:251]
    v_accvgpr_read_b32 v89, a193
    v_mul_f32 v231, v231, v111
    v_mfma_f32_16x16x32_bf16 a[252:255], a[60:63], v[180:183], a[252:255]
    s_waitcnt vmcnt(27) lgkmcnt(0)
    v_accvgpr_read_b32 v90, a194
    v_exp_f32 v228, v228
    v_mfma_f32_16x16x32_bf16 v[8:11], a[64:67], v[152:155], v[8:11]
    s_add_u32 s54, s33, 86016
    buffer_load_dwordx4 a[24:27], v6, s[28:31], s54 offen sc1
    v_mfma_f32_16x16x32_bf16 v[12:15], a[64:67], v[156:159], v[12:15]
    v_accvgpr_read_b32 v91, a195
    v_exp_f32 v229, v229
    v_mfma_f32_16x16x32_bf16 v[16:19], a[64:67], v[160:163], v[16:19]
    v_accvgpr_read_b32 v92, a196
    v_exp_f32 v230, v230
    v_mfma_f32_16x16x32_bf16 v[20:23], a[64:67], v[164:167], v[20:23]
    v_accvgpr_read_b32 v93, a197
    v_exp_f32 v231, v231
    v_fma_f32 v228, v228, v189, v189
    v_mfma_f32_16x16x32_bf16 v[24:27], a[68:71], v[152:155], v[24:27]
    s_add_u32 s54, s33, 87040
    buffer_load_dwordx4 a[28:31], v6, s[28:31], s54 offen sc1
    v_mfma_f32_16x16x32_bf16 v[28:31], a[68:71], v[156:159], v[28:31]
    v_accvgpr_read_b32 v94, a198
    v_fma_f32 v229, v229, v189, v189
    v_fma_f32 v230, v230, v189, v189
    v_mfma_f32_16x16x32_bf16 v[32:35], a[68:71], v[160:163], v[32:35]
    v_accvgpr_read_b32 v95, a199
    v_fma_f32 v231, v231, v189, v189
    v_mfma_f32_16x16x32_bf16 v[36:39], a[68:71], v[164:167], v[36:39]
    ds_read_b128 v[168:171], v238 offset:28672
    v_accvgpr_read_b32 v96, a200
    v_mfma_f32_16x16x32_bf16 v[40:43], a[72:75], v[152:155], v[40:43]
    s_add_u32 s54, s33, 88064
    buffer_load_dwordx4 a[32:35], v6, s[28:31], s54 offen sc1
    v_rcp_f32 v228, v228
    v_mfma_f32_16x16x32_bf16 v[44:47], a[72:75], v[156:159], v[44:47]
    v_accvgpr_read_b32 v97, a201
    v_rcp_f32 v229, v229
    v_mfma_f32_16x16x32_bf16 v[48:51], a[72:75], v[160:163], v[48:51]
    v_accvgpr_read_b32 v98, a202
    v_rcp_f32 v230, v230
    v_mfma_f32_16x16x32_bf16 v[52:55], a[72:75], v[164:167], v[52:55]
    s_waitcnt vmcnt(27)
    v_accvgpr_read_b32 v99, a203
    v_rcp_f32 v231, v231
    v_mfma_f32_16x16x32_bf16 v[56:59], a[76:79], v[152:155], v[56:59]
    s_add_u32 s54, s33, 89088
    buffer_load_dwordx4 a[36:39], v6, s[28:31], s54 offen sc1
    v_mfma_f32_16x16x32_bf16 v[60:63], a[76:79], v[156:159], v[60:63]
    ds_read_b128 v[172:175], v238 offset:29696
    v_accvgpr_read_b32 v100, a204
    v_mul_f32 v228, v228, v108
    v_mfma_f32_16x16x32_bf16 v[64:67], a[76:79], v[160:163], v[64:67]
    s_add_u32 s54, s33, 90112
    buffer_load_dwordx4 a[40:43], v6, s[28:31], s54 offen sc1
    v_accvgpr_read_b32 v101, a205
    v_mul_f32 v229, v229, v109
    v_mfma_f32_16x16x32_bf16 v[68:71], a[76:79], v[164:167], v[68:71]
    v_accvgpr_read_b32 v102, a206
    v_mul_f32 v230, v230, v110
    v_mfma_f32_16x16x32_bf16 v[72:75], a[80:83], v[152:155], v[72:75]
    s_add_u32 s54, s33, 91136
    buffer_load_dwordx4 a[44:47], v6, s[28:31], s54 offen sc1
    v_mul_f32 v231, v231, v111
    v_mfma_f32_16x16x32_bf16 v[76:79], a[80:83], v[156:159], v[76:79]
    v_accvgpr_read_b32 v103, a207
    v_cvt_pk_bf16_f32 v232, v228, v229
    v_cvt_pk_bf16_f32 v233, v230, v231
    v_mfma_f32_16x16x32_bf16 v[80:83], a[80:83], v[160:163], v[80:83]
    v_mul_f32 v224, v124, v124
    v_mul_f32 v225, v125, v125
    v_mfma_f32_16x16x32_bf16 v[84:87], a[80:83], v[164:167], v[84:87]
    ds_read_b128 v[176:179], v238 offset:30720
    v_mul_f32 v226, v126, v126
    v_mul_f32 v227, v127, v127
    v_mfma_f32_16x16x32_bf16 v[88:91], a[84:87], v[152:155], v[88:91]
    s_add_u32 s54, s33, 92160
    buffer_load_dwordx4 a[48:51], v6, s[28:31], s54 offen sc1
    v_fma_f32 v224, v224, v191, v190
    v_mfma_f32_16x16x32_bf16 v[92:95], a[84:87], v[156:159], v[92:95]
    v_fma_f32 v225, v225, v191, v190
    v_fma_f32 v226, v226, v191, v190
    v_fma_f32 v227, v227, v191, v190
    v_mfma_f32_16x16x32_bf16 v[96:99], a[84:87], v[160:163], v[96:99]
    v_mul_f32 v224, v224, v124
    v_mul_f32 v225, v225, v125
    v_mfma_f32_16x16x32_bf16 v[100:103], a[84:87], v[164:167], v[100:103]
    s_waitcnt vmcnt(28)
    v_mul_f32 v226, v226, v126
    v_mul_f32 v227, v227, v127
    v_mfma_f32_16x16x32_bf16 a[208:211], a[88:91], v[152:155], a[208:211]
    s_add_u32 s54, s33, 93184
    buffer_load_dwordx4 a[52:55], v6, s[28:31], s54 offen sc1
    v_exp_f32 v224, v224
    v_mfma_f32_16x16x32_bf16 a[212:215], a[88:91], v[156:159], a[212:215]
    ds_read_b128 v[180:183], v238 offset:31744
    v_exp_f32 v225, v225
    v_mfma_f32_16x16x32_bf16 a[216:219], a[88:91], v[160:163], a[216:219]
    v_exp_f32 v226, v226
    v_mfma_f32_16x16x32_bf16 a[220:223], a[88:91], v[164:167], a[220:223]
    v_exp_f32 v227, v227
    v_fma_f32 v224, v224, v189, v189
    v_mfma_f32_16x16x32_bf16 a[224:227], a[92:95], v[152:155], a[224:227]
    s_add_u32 s54, s33, 94208
    buffer_load_dwordx4 a[56:59], v6, s[28:31], s54 offen sc1
    v_fma_f32 v225, v225, v189, v189
    v_mfma_f32_16x16x32_bf16 a[228:231], a[92:95], v[156:159], a[228:231]
    v_fma_f32 v226, v226, v189, v189
    v_fma_f32 v227, v227, v189, v189
    v_mfma_f32_16x16x32_bf16 a[232:235], a[92:95], v[160:163], a[232:235]
    v_rcp_f32 v224, v224
    v_mfma_f32_16x16x32_bf16 a[236:239], a[92:95], v[164:167], a[236:239]
    v_rcp_f32 v225, v225
    v_rcp_f32 v226, v226
    v_mfma_f32_16x16x32_bf16 a[240:243], a[96:99], v[152:155], a[240:243]
    s_add_u32 s54, s33, 95232
    buffer_load_dwordx4 a[60:63], v6, s[28:31], s54 offen sc1
    v_mfma_f32_16x16x32_bf16 a[244:247], a[96:99], v[156:159], a[244:247]
    v_rcp_f32 v227, v227
    v_mul_f32 v224, v224, v124
    v_mfma_f32_16x16x32_bf16 a[248:251], a[96:99], v[160:163], a[248:251]
    v_mul_f32 v225, v225, v125
    v_mul_f32 v226, v226, v126
    v_mul_f32 v227, v227, v127
    v_mfma_f32_16x16x32_bf16 a[252:255], a[96:99], v[164:167], a[252:255]
    s_waitcnt vmcnt(28) lgkmcnt(0)
    v_cvt_pk_bf16_f32 v234, v224, v225
    v_cvt_pk_bf16_f32 v235, v226, v227
    v_mfma_f32_16x16x32_bf16 v[8:11], a[100:103], v[168:171], v[8:11]
    s_add_u32 s54, s33, 96256
    buffer_load_dwordx4 a[64:67], v6, s[28:31], s54 offen sc1
    v_mfma_f32_16x16x32_bf16 v[12:15], a[100:103], v[172:175], v[12:15]
    ds_write_b128 v1, v[232:235] offset:50176
    v_mfma_f32_16x16x32_bf16 v[16:19], a[100:103], v[176:179], v[16:19]
    v_mul_f32 v228, v140, v140
    v_mul_f32 v229, v141, v141
    v_mfma_f32_16x16x32_bf16 v[20:23], a[100:103], v[180:183], v[20:23]
    v_mul_f32 v230, v142, v142
    v_mul_f32 v231, v143, v143
    v_fma_f32 v228, v228, v191, v190
    v_mfma_f32_16x16x32_bf16 v[24:27], a[104:107], v[168:171], v[24:27]
    s_add_u32 s54, s33, 97280
    buffer_load_dwordx4 a[68:71], v6, s[28:31], s54 offen sc1
    v_mfma_f32_16x16x32_bf16 v[28:31], a[104:107], v[172:175], v[28:31]
    v_fma_f32 v229, v229, v191, v190
    v_fma_f32 v230, v230, v191, v190
    v_fma_f32 v231, v231, v191, v190
    v_mfma_f32_16x16x32_bf16 v[32:35], a[104:107], v[176:179], v[32:35]
    v_mul_f32 v228, v228, v140
    v_mul_f32 v229, v229, v141
    v_mul_f32 v230, v230, v142
    v_mfma_f32_16x16x32_bf16 v[36:39], a[104:107], v[180:183], v[36:39]
    ds_read_b128 v[152:155], v238 offset:32768
    v_mul_f32 v231, v231, v143
    v_mfma_f32_16x16x32_bf16 v[40:43], a[108:111], v[168:171], v[40:43]
    s_add_u32 s54, s33, 98304
    buffer_load_dwordx4 a[72:75], v6, s[28:31], s54 offen sc1
    v_mfma_f32_16x16x32_bf16 v[44:47], a[108:111], v[172:175], v[44:47]
    v_exp_f32 v228, v228
    v_exp_f32 v229, v229
    v_mfma_f32_16x16x32_bf16 v[48:51], a[108:111], v[176:179], v[48:51]
    s_add_u32 s54, s33, 99328
    buffer_load_dwordx4 a[76:79], v6, s[28:31], s54 offen sc1
    v_mfma_f32_16x16x32_bf16 v[52:55], a[108:111], v[180:183], v[52:55]
    s_waitcnt vmcnt(29)
    v_exp_f32 v230, v230
    v_exp_f32 v231, v231
    v_mfma_f32_16x16x32_bf16 v[56:59], a[112:115], v[168:171], v[56:59]
    s_add_u32 s54, s33, 100352
    buffer_load_dwordx4 a[80:83], v6, s[28:31], s54 offen sc1
    v_mfma_f32_16x16x32_bf16 v[60:63], a[112:115], v[172:175], v[60:63]
    ds_read_b128 v[156:159], v238 offset:33792
    v_fma_f32 v228, v228, v189, v189
    v_fma_f32 v229, v229, v189, v189
    v_mfma_f32_16x16x32_bf16 v[64:67], a[112:115], v[176:179], v[64:67]
    v_fma_f32 v230, v230, v189, v189
    v_fma_f32 v231, v231, v189, v189
    v_mfma_f32_16x16x32_bf16 v[68:71], a[112:115], v[180:183], v[68:71]
    v_rcp_f32 v228, v228
    v_mfma_f32_16x16x32_bf16 v[72:75], a[116:119], v[168:171], v[72:75]
    s_add_u32 s54, s33, 101376
    buffer_load_dwordx4 a[84:87], v6, s[28:31], s54 offen sc1
    v_rcp_f32 v229, v229
    v_mfma_f32_16x16x32_bf16 v[76:79], a[116:119], v[172:175], v[76:79]
    v_rcp_f32 v230, v230
    v_mfma_f32_16x16x32_bf16 v[80:83], a[116:119], v[176:179], v[80:83]
    v_rcp_f32 v231, v231
    v_mul_f32 v228, v228, v140
    v_mul_f32 v229, v229, v141
    v_mfma_f32_16x16x32_bf16 v[84:87], a[116:119], v[180:183], v[84:87]
    ds_read_b128 v[160:163], v238 offset:34816
    v_mul_f32 v230, v230, v142
    v_mfma_f32_16x16x32_bf16 v[88:91], a[120:123], v[168:171], v[88:91]
    s_add_u32 s54, s33, 102400
    buffer_load_dwordx4 a[88:91], v6, s[28:31], s54 offen sc1
    v_mul_f32 v231, v231, v143
    v_mfma_f32_16x16x32_bf16 v[92:95], a[120:123], v[172:175], v[92:95]
    v_cvt_pk_bf16_f32 v236, v228, v229
    v_cvt_pk_bf16_f32 v237, v230, v231
    v_mfma_f32_16x16x32_bf16 v[96:99], a[120:123], v[176:179], v[96:99]
    ds_write_b64 v2, v[236:237] offset:50176
    v_mul_f32 v224, v112, v112
    v_mfma_f32_16x16x32_bf16 v[100:103], a[120:123], v[180:183], v[100:103]
    s_waitcnt vmcnt(29)
    v_mul_f32 v225, v113, v113
    v_mul_f32 v226, v114, v114
    v_mfma_f32_16x16x32_bf16 a[208:211], a[124:127], v[168:171], a[208:211]
    s_add_u32 s54, s33, 103424
    buffer_load_dwordx4 a[92:95], v6, s[28:31], s54 offen sc1
    v_mul_f32 v227, v115, v115
    v_mfma_f32_16x16x32_bf16 a[212:215], a[124:127], v[172:175], a[212:215]
    ds_read_b128 v[164:167], v238 offset:35840
    v_fma_f32 v224, v224, v195, v194
    v_fma_f32 v225, v225, v195, v194
    v_mfma_f32_16x16x32_bf16 a[216:219], a[124:127], v[176:179], a[216:219]
    v_fma_f32 v226, v226, v195, v194
    v_fma_f32 v227, v227, v195, v194
    v_mfma_f32_16x16x32_bf16 a[220:223], a[124:127], v[180:183], a[220:223]
    v_mul_f32 v224, v224, v112
    v_mul_f32 v225, v225, v113
    v_mul_f32 v226, v226, v114
    v_mfma_f32_16x16x32_bf16 a[224:227], a[128:131], v[168:171], a[224:227]
    s_add_u32 s54, s33, 104448
    buffer_load_dwordx4 a[96:99], v6, s[28:31], s54 offen sc1
    v_mul_f32 v227, v227, v115
    v_mfma_f32_16x16x32_bf16 a[228:231], a[128:131], v[172:175], a[228:231]
    v_exp_f32 v224, v224
    v_mfma_f32_16x16x32_bf16 a[232:235], a[128:131], v[176:179], a[232:235]
    v_exp_f32 v225, v225
    v_mfma_f32_16x16x32_bf16 a[236:239], a[128:131], v[180:183], a[236:239]
    v_exp_f32 v226, v226
    v_exp_f32 v227, v227
    v_mfma_f32_16x16x32_bf16 a[240:243], a[132:135], v[168:171], a[240:243]
    s_add_u32 s54, s33, 105472
    buffer_load_dwordx4 a[100:103], v6, s[28:31], s54 offen sc1
    v_fma_f32 v224, v224, v193, v193
    v_mfma_f32_16x16x32_bf16 a[244:247], a[132:135], v[172:175], a[244:247]
    v_fma_f32 v225, v225, v193, v193
    v_fma_f32 v226, v226, v193, v193
    v_fma_f32 v227, v227, v193, v193
    v_mfma_f32_16x16x32_bf16 a[248:251], a[132:135], v[176:179], a[248:251]
    v_rcp_f32 v224, v224
    v_mfma_f32_16x16x32_bf16 a[252:255], a[132:135], v[180:183], a[252:255]
    s_waitcnt vmcnt(29) lgkmcnt(0)
    v_rcp_f32 v225, v225
    v_mfma_f32_16x16x32_bf16 v[8:11], a[136:139], v[152:155], v[8:11]
    s_add_u32 s54, s33, 106496
    buffer_load_dwordx4 a[104:107], v6, s[28:31], s54 offen sc1
    v_rcp_f32 v226, v226
    v_mfma_f32_16x16x32_bf16 v[12:15], a[136:139], v[156:159], v[12:15]
    v_rcp_f32 v227, v227
    v_mul_f32 v224, v224, v112
    v_mfma_f32_16x16x32_bf16 v[16:19], a[136:139], v[160:163], v[16:19]
    v_mul_f32 v225, v225, v113
    v_mul_f32 v226, v226, v114
    v_mfma_f32_16x16x32_bf16 v[20:23], a[136:139], v[164:167], v[20:23]
    v_mul_f32 v227, v227, v115
    v_cvt_pk_bf16_f32 v232, v224, v225
    v_cvt_pk_bf16_f32 v233, v226, v227
    v_mfma_f32_16x16x32_bf16 v[24:27], a[140:143], v[152:155], v[24:27]
    s_add_u32 s54, s33, 107520
    buffer_load_dwordx4 a[108:111], v6, s[28:31], s54 offen sc1
    v_mul_f32 v228, v128, v128
    v_mfma_f32_16x16x32_bf16 v[28:31], a[140:143], v[156:159], v[28:31]
    v_mul_f32 v229, v129, v129
    v_mul_f32 v230, v130, v130
    v_mfma_f32_16x16x32_bf16 v[32:35], a[140:143], v[160:163], v[32:35]
    s_add_u32 s54, s33, 108544
    buffer_load_dwordx4 a[112:115], v6, s[28:31], s54 offen sc1
    v_mul_f32 v231, v131, v131
    v_mfma_f32_16x16x32_bf16 v[36:39], a[140:143], v[164:167], v[36:39]
    ds_read_b128 v[168:171], v239 offset:0
    v_fma_f32 v228, v228, v195, v194
    v_fma_f32 v229, v229, v195, v194
    v_mfma_f32_16x16x32_bf16 v[40:43], a[144:147], v[152:155], v[40:43]
    s_add_u32 s54, s33, 109568
    buffer_load_dwordx4 a[116:119], v6, s[28:31], s54 offen sc1
    v_fma_f32 v230, v230, v195, v194
    v_mfma_f32_16x16x32_bf16 v[44:47], a[144:147], v[156:159], v[44:47]
    v_fma_f32 v231, v231, v195, v194
    v_mul_f32 v228, v228, v128
    v_mfma_f32_16x16x32_bf16 v[48:51], a[144:147], v[160:163], v[48:51]
    v_mul_f32 v229, v229, v129
    v_mul_f32 v230, v230, v130
    v_mul_f32 v231, v231, v131
    v_mfma_f32_16x16x32_bf16 v[52:55], a[144:147], v[164:167], v[52:55]
    s_waitcnt vmcnt(30)
    v_exp_f32 v228, v228
    v_mfma_f32_16x16x32_bf16 v[56:59], a[148:151], v[152:155], v[56:59]
    s_add_u32 s54, s33, 110592
    buffer_load_dwordx4 a[120:123], v6, s[28:31], s54 offen sc1
    v_mfma_f32_16x16x32_bf16 v[60:63], a[148:151], v[156:159], v[60:63]
    ds_read_b128 v[172:175], v239 offset:1024
    v_exp_f32 v229, v229
    v_mfma_f32_16x16x32_bf16 v[64:67], a[148:151], v[160:163], v[64:67]
    v_exp_f32 v230, v230
    v_exp_f32 v231, v231
    v_mfma_f32_16x16x32_bf16 v[68:71], a[148:151], v[164:167], v[68:71]
    v_fma_f32 v228, v228, v193, v193
    v_fma_f32 v229, v229, v193, v193
    v_fma_f32 v230, v230, v193, v193
    v_mfma_f32_16x16x32_bf16 v[72:75], a[152:155], v[152:155], v[72:75]
    s_add_u32 s54, s33, 111616
    buffer_load_dwordx4 a[124:127], v6, s[28:31], s54 offen sc1
    v_mfma_f32_16x16x32_bf16 v[76:79], a[152:155], v[156:159], v[76:79]
    v_fma_f32 v231, v231, v193, v193
    v_rcp_f32 v228, v228
    v_mfma_f32_16x16x32_bf16 v[80:83], a[152:155], v[160:163], v[80:83]
    v_rcp_f32 v229, v229
    v_mfma_f32_16x16x32_bf16 v[84:87], a[152:155], v[164:167], v[84:87]
    ds_read_b128 v[176:179], v239 offset:2048
    v_rcp_f32 v230, v230
    v_mfma_f32_16x16x32_bf16 v[88:91], a[156:159], v[152:155], v[88:91]
    s_add_u32 s54, s33, 119808
    buffer_load_dwordx4 a[128:131], v6, s[28:31], s54 offen sc1
    v_mfma_f32_16x16x32_bf16 v[92:95], a[156:159], v[156:159], v[92:95]
    v_rcp_f32 v231, v231
    v_mul_f32 v228, v228, v128
    v_mul_f32 v229, v229, v129
    v_mfma_f32_16x16x32_bf16 v[96:99], a[156:159], v[160:163], v[96:99]
    v_mul_f32 v230, v230, v130
    v_mul_f32 v231, v231, v131
    v_cvt_pk_bf16_f32 v234, v228, v229
    v_mfma_f32_16x16x32_bf16 v[100:103], a[156:159], v[164:167], v[100:103]
    s_waitcnt vmcnt(30)
    v_cvt_pk_bf16_f32 v235, v230, v231
    ds_write_b128 v1, v[232:235] offset:51200
    v_mfma_f32_16x16x32_bf16 a[208:211], a[0:3], v[152:155], a[208:211]
    s_add_u32 s54, s33, 120832
    buffer_load_dwordx4 a[132:135], v6, s[28:31], s54 offen sc1
    v_mfma_f32_16x16x32_bf16 a[212:215], a[0:3], v[156:159], a[212:215]
    ds_read_b128 v[180:183], v239 offset:3072
    v_mul_f32 v224, v144, v144
    v_mfma_f32_16x16x32_bf16 a[216:219], a[0:3], v[160:163], a[216:219]
    v_mul_f32 v225, v145, v145
    v_mul_f32 v226, v146, v146
    v_mfma_f32_16x16x32_bf16 a[220:223], a[0:3], v[164:167], a[220:223]
    v_mul_f32 v227, v147, v147
    v_fma_f32 v224, v224, v195, v194
    v_mfma_f32_16x16x32_bf16 a[224:227], a[4:7], v[152:155], a[224:227]
    s_add_u32 s54, s33, 129024
    buffer_load_dwordx4 a[136:139], v6, s[28:31], s54 offen sc1
    v_mfma_f32_16x16x32_bf16 a[228:231], a[4:7], v[156:159], a[228:231]
    v_fma_f32 v225, v225, v195, v194
    v_fma_f32 v226, v226, v195, v194
    v_fma_f32 v227, v227, v195, v194
    v_mfma_f32_16x16x32_bf16 a[232:235], a[4:7], v[160:163], a[232:235]
    v_mul_f32 v224, v224, v144
    v_mul_f32 v225, v225, v145
    v_mfma_f32_16x16x32_bf16 a[236:239], a[4:7], v[164:167], a[236:239]
    v_mul_f32 v226, v226, v146
    v_mul_f32 v227, v227, v147
    v_mfma_f32_16x16x32_bf16 a[240:243], a[8:11], v[152:155], a[240:243]
    s_add_u32 s54, s33, 130048
    buffer_load_dwordx4 a[140:143], v6, s[28:31], s54 offen sc1
    v_exp_f32 v224, v224
    v_mfma_f32_16x16x32_bf16 a[244:247], a[8:11], v[156:159], a[244:247]
    v_exp_f32 v225, v225
    v_mfma_f32_16x16x32_bf16 a[248:251], a[8:11], v[160:163], a[248:251]
    s_add_u32 s54, s33, 138240
    buffer_load_dwordx4 a[144:147], v6, s[28:31], s54 offen sc1
    v_mfma_f32_16x16x32_bf16 a[252:255], a[8:11], v[164:167], a[252:255]
    s_waitcnt vmcnt(31) lgkmcnt(0)
    v_exp_f32 v226, v226
    v_exp_f32 v227, v227
    v_mfma_f32_16x16x32_bf16 v[8:11], a[12:15], v[168:171], v[8:11]
    s_add_u32 s54, s33, 139264
    buffer_load_dwordx4 a[148:151], v6, s[28:31], s54 offen sc1
    v_fma_f32 v224, v224, v193, v193
    v_mfma_f32_16x16x32_bf16 v[12:15], a[12:15], v[172:175], v[12:15]
    v_fma_f32 v225, v225, v193, v193
    v_fma_f32 v226, v226, v193, v193
    v_fma_f32 v227, v227, v193, v193
    v_mfma_f32_16x16x32_bf16 v[16:19], a[12:15], v[176:179], v[16:19]
    v_rcp_f32 v224, v224
    v_mfma_f32_16x16x32_bf16 v[20:23], a[12:15], v[180:183], v[20:23]
    v_rcp_f32 v225, v225
    v_mfma_f32_16x16x32_bf16 v[24:27], a[16:19], v[168:171], v[24:27]
    s_add_u32 s54, s33, 147456
    buffer_load_dwordx4 a[152:155], v6, s[28:31], s54 offen sc1
    v_rcp_f32 v226, v226
    v_mfma_f32_16x16x32_bf16 v[28:31], a[16:19], v[172:175], v[28:31]
    v_rcp_f32 v227, v227
    v_mul_f32 v224, v224, v144
    v_mfma_f32_16x16x32_bf16 v[32:35], a[16:19], v[176:179], v[32:35]
    v_mul_f32 v225, v225, v145
    v_mul_f32 v226, v226, v146
    v_mfma_f32_16x16x32_bf16 v[36:39], a[16:19], v[180:183], v[36:39]
    ds_read_b128 v[152:155], v239 offset:4096
    v_mul_f32 v227, v227, v147
    v_cvt_pk_bf16_f32 v236, v224, v225
    v_mfma_f32_16x16x32_bf16 v[40:43], a[20:23], v[168:171], v[40:43]
    s_add_u32 s54, s33, 148480
    buffer_load_dwordx4 a[156:159], v6, s[28:31], s54 offen sc1
    v_cvt_pk_bf16_f32 v237, v226, v227
    v_mfma_f32_16x16x32_bf16 v[44:47], a[20:23], v[172:175], v[44:47]
    ds_write_b64 v2, v[236:237] offset:51200
    v_mfma_f32_16x16x32_bf16 v[48:51], a[20:23], v[176:179], v[48:51]
    v_mul_f32 v228, v116, v116
    v_mul_f32 v229, v117, v117
    v_mfma_f32_16x16x32_bf16 v[52:55], a[20:23], v[180:183], v[52:55]
    s_waitcnt vmcnt(31)
    v_mul_f32 v230, v118, v118
    v_mul_f32 v231, v119, v119
    v_fma_f32 v228, v228, v199, v198
    v_mfma_f32_16x16x32_bf16 v[56:59], a[24:27], v[168:171], v[56:59]
    s_add_u32 s54, s33, 156672
    buffer_load_dwordx4 a[0:3], v6, s[28:31], s54 offen sc1
    v_fma_f32 v229, v229, v199, v198
    v_mfma_f32_16x16x32_bf16 v[60:63], a[24:27], v[172:175], v[60:63]
    ds_read_b128 v[156:159], v239 offset:5120
    v_fma_f32 v230, v230, v199, v198
    v_mfma_f32_16x16x32_bf16 v[64:67], a[24:27], v[176:179], v[64:67]
    v_fma_f32 v231, v231, v199, v198
    v_mul_f32 v228, v228, v116
    v_mul_f32 v229, v229, v117
    v_mfma_f32_16x16x32_bf16 v[68:71], a[24:27], v[180:183], v[68:71]
    v_mul_f32 v230, v230, v118
    v_mul_f32 v231, v231, v119
    v_mfma_f32_16x16x32_bf16 v[72:75], a[28:31], v[168:171], v[72:75]
    s_add_u32 s54, s33, 157696
    buffer_load_dwordx4 a[4:7], v6, s[28:31], s54 offen sc1
    v_exp_f32 v228, v228
    v_mfma_f32_16x16x32_bf16 v[76:79], a[28:31], v[172:175], v[76:79]
    v_exp_f32 v229, v229
    v_mfma_f32_16x16x32_bf16 v[80:83], a[28:31], v[176:179], v[80:83]
    v_exp_f32 v230, v230
    v_mfma_f32_16x16x32_bf16 v[84:87], a[28:31], v[180:183], v[84:87]
    ds_read_b128 v[160:163], v239 offset:6144
    v_exp_f32 v231, v231
    v_fma_f32 v228, v228, v197, v197
    v_mfma_f32_16x16x32_bf16 v[88:91], a[32:35], v[168:171], v[88:91]
    s_add_u32 s54, s33, 112640
    buffer_load_dwordx4 a[8:11], v6, s[28:31], s54 offen sc1
    v_mfma_f32_16x16x32_bf16 v[92:95], a[32:35], v[172:175], v[92:95]
    v_fma_f32 v229, v229, v197, v197
    v_fma_f32 v230, v230, v197, v197
    v_fma_f32 v231, v231, v197, v197
    v_mfma_f32_16x16x32_bf16 v[96:99], a[32:35], v[176:179], v[96:99]
    v_rcp_f32 v228, v228
    v_mfma_f32_16x16x32_bf16 v[100:103], a[32:35], v[180:183], v[100:103]
    s_waitcnt vmcnt(31)
    v_rcp_f32 v229, v229
    v_rcp_f32 v230, v230
    v_mfma_f32_16x16x32_bf16 a[208:211], a[36:39], v[168:171], a[208:211]
    s_add_u32 s54, s33, 113664
    buffer_load_dwordx4 a[12:15], v6, s[28:31], s54 offen sc1
    v_mfma_f32_16x16x32_bf16 a[212:215], a[36:39], v[172:175], a[212:215]
    ds_read_b128 v[164:167], v239 offset:7168
    v_rcp_f32 v231, v231
    v_mfma_f32_16x16x32_bf16 a[216:219], a[36:39], v[176:179], a[216:219]
    v_mul_f32 v228, v228, v116
    v_mul_f32 v229, v229, v117
    v_mul_f32 v230, v230, v118
    v_mfma_f32_16x16x32_bf16 a[220:223], a[36:39], v[180:183], a[220:223]
    v_mul_f32 v231, v231, v119
    v_cvt_pk_bf16_f32 v232, v228, v229
    v_cvt_pk_bf16_f32 v233, v230, v231
    v_mfma_f32_16x16x32_bf16 a[224:227], a[40:43], v[168:171], a[224:227]
    s_add_u32 s54, s33, 121856
    buffer_load_dwordx4 a[16:19], v6, s[28:31], s54 offen sc1
    v_mfma_f32_16x16x32_bf16 a[228:231], a[40:43], v[172:175], a[228:231]
    v_mul_f32 v224, v132, v132
    v_mul_f32 v225, v133, v133
    v_mul_f32 v226, v134, v134
    v_mfma_f32_16x16x32_bf16 a[232:235], a[40:43], v[176:179], a[232:235]
    s_add_u32 s54, s33, 122880
    buffer_load_dwordx4 a[20:23], v6, s[28:31], s54 offen sc1
    v_mul_f32 v227, v135, v135
    v_mfma_f32_16x16x32_bf16 a[236:239], a[40:43], v[180:183], a[236:239]
    v_fma_f32 v224, v224, v199, v198
    v_fma_f32 v225, v225, v199, v198
    v_mfma_f32_16x16x32_bf16 a[240:243], a[44:47], v[168:171], a[240:243]
    s_add_u32 s54, s33, 131072
    buffer_load_dwordx4 a[24:27], v6, s[28:31], s54 offen sc1
    v_fma_f32 v226, v226, v199, v198
    v_mfma_f32_16x16x32_bf16 a[244:247], a[44:47], v[172:175], a[244:247]
    v_fma_f32 v227, v227, v199, v198
    v_mul_f32 v224, v224, v132
    v_mul_f32 v225, v225, v133
    v_mfma_f32_16x16x32_bf16 a[248:251], a[44:47], v[176:179], a[248:251]
    v_mul_f32 v226, v226, v134
    v_mul_f32 v227, v227, v135
    v_mfma_f32_16x16x32_bf16 a[252:255], a[44:47], v[180:183], a[252:255]
    s_waitcnt vmcnt(32) lgkmcnt(0)
    v_exp_f32 v224, v224
    v_mfma_f32_16x16x32_bf16 v[8:11], a[48:51], v[152:155], v[8:11]
    s_add_u32 s54, s33, 132096
    buffer_load_dwordx4 a[28:31], v6, s[28:31], s54 offen sc1
    v_exp_f32 v225, v225
    v_mfma_f32_16x16x32_bf16 v[12:15], a[48:51], v[156:159], v[12:15]
    v_exp_f32 v226, v226
    v_mfma_f32_16x16x32_bf16 v[16:19], a[48:51], v[160:163], v[16:19]
    v_exp_f32 v227, v227
    v_fma_f32 v224, v224, v197, v197
    v_fma_f32 v225, v225, v197, v197
    v_mfma_f32_16x16x32_bf16 v[20:23], a[48:51], v[164:167], v[20:23]
    v_fma_f32 v226, v226, v197, v197
    v_fma_f32 v227, v227, v197, v197
    v_mfma_f32_16x16x32_bf16 v[24:27], a[52:55], v[152:155], v[24:27]
    s_add_u32 s54, s33, 140288
    buffer_load_dwordx4 a[32:35], v6, s[28:31], s54 offen sc1
    v_mfma_f32_16x16x32_bf16 v[28:31], a[52:55], v[156:159], v[28:31]
    v_rcp_f32 v224, v224
    v_rcp_f32 v225, v225
    v_mfma_f32_16x16x32_bf16 v[32:35], a[52:55], v[160:163], v[32:35]
    v_rcp_f32 v226, v226
    v_mfma_f32_16x16x32_bf16 v[36:39], a[52:55], v[164:167], v[36:39]
    ds_read_b128 v[168:171], v239 offset:8192
    v_rcp_f32 v227, v227
    v_mfma_f32_16x16x32_bf16 v[40:43], a[56:59], v[152:155], v[40:43]
    s_add_u32 s54, s33, 141312
    buffer_load_dwordx4 a[36:39], v6, s[28:31], s54 offen sc1
    v_mul_f32 v224, v224, v132
    v_mfma_f32_16x16x32_bf16 v[44:47], a[56:59], v[156:159], v[44:47]
    v_mul_f32 v225, v225, v133
    v_mul_f32 v226, v226, v134
    v_mul_f32 v227, v227, v135
    v_mfma_f32_16x16x32_bf16 v[48:51], a[56:59], v[160:163], v[48:51]
    v_cvt_pk_bf16_f32 v234, v224, v225
    v_cvt_pk_bf16_f32 v235, v226, v227
    v_mfma_f32_16x16x32_bf16 v[52:55], a[56:59], v[164:167], v[52:55]
    s_waitcnt vmcnt(32)
    ds_write_b128 v1, v[232:235] offset:52224
    v_mfma_f32_16x16x32_bf16 v[56:59], a[60:63], v[152:155], v[56:59]
    s_add_u32 s54, s33, 149504
    buffer_load_dwordx4 a[40:43], v6, s[28:31], s54 offen sc1
    v_mfma_f32_16x16x32_bf16 v[60:63], a[60:63], v[156:159], v[60:63]
    ds_read_b128 v[172:175], v239 offset:9216
    v_mul_f32 v228, v148, v148
    v_mfma_f32_16x16x32_bf16 v[64:67], a[60:63], v[160:163], v[64:67]
    v_mul_f32 v229, v149, v149
    v_mul_f32 v230, v150, v150
    v_mfma_f32_16x16x32_bf16 v[68:71], a[60:63], v[164:167], v[68:71]
    v_mul_f32 v231, v151, v151
    v_fma_f32 v228, v228, v199, v198
    v_fma_f32 v229, v229, v199, v198
    v_mfma_f32_16x16x32_bf16 v[72:75], a[64:67], v[152:155], v[72:75]
    s_add_u32 s54, s33, 150528
    buffer_load_dwordx4 a[44:47], v6, s[28:31], s54 offen sc1
    v_fma_f32 v230, v230, v199, v198
    v_mfma_f32_16x16x32_bf16 v[76:79], a[64:67], v[156:159], v[76:79]
    v_fma_f32 v231, v231, v199, v198
    v_mul_f32 v228, v228, v148
    v_mfma_f32_16x16x32_bf16 v[80:83], a[64:67], v[160:163], v[80:83]
    v_mul_f32 v229, v229, v149
    v_mul_f32 v230, v230, v150
    v_mul_f32 v231, v231, v151
    v_mfma_f32_16x16x32_bf16 v[84:87], a[64:67], v[164:167], v[84:87]
    ds_read_b128 v[176:179], v239 offset:10240
    v_exp_f32 v228, v228
    v_mfma_f32_16x16x32_bf16 v[88:91], a[68:71], v[152:155], v[88:91]
    s_add_u32 s54, s33, 158720
    buffer_load_dwordx4 a[48:51], v6, s[28:31], s54 offen sc1
    v_mfma_f32_16x16x32_bf16 v[92:95], a[68:71], v[156:159], v[92:95]
    v_exp_f32 v229, v229
    v_mfma_f32_16x16x32_bf16 v[96:99], a[68:71], v[160:163], v[96:99]
    v_exp_f32 v230, v230
    v_exp_f32 v231, v231
    v_mfma_f32_16x16x32_bf16 v[100:103], a[68:71], v[164:167], v[100:103]
    s_waitcnt vmcnt(32)
    v_fma_f32 v228, v228, v197, v197
    v_fma_f32 v229, v229, v197, v197
    v_fma_f32 v230, v230, v197, v197
    v_mfma_f32_16x16x32_bf16 a[208:211], a[72:75], v[152:155], a[208:211]
    s_add_u32 s54, s33, 159744
    buffer_load_dwordx4 a[52:55], v6, s[28:31], s54 offen sc1
    v_fma_f32 v231, v231, v197, v197
    v_mfma_f32_16x16x32_bf16 a[212:215], a[72:75], v[156:159], a[212:215]
    ds_read_b128 v[180:183], v239 offset:11264
    v_rcp_f32 v228, v228
    v_mfma_f32_16x16x32_bf16 a[216:219], a[72:75], v[160:163], a[216:219]
    s_add_u32 s54, s33, 114688
    buffer_load_dwordx4 a[56:59], v6, s[28:31], s54 offen sc1
    v_mfma_f32_16x16x32_bf16 a[220:223], a[72:75], v[164:167], a[220:223]
    v_rcp_f32 v229, v229
    v_mfma_f32_16x16x32_bf16 a[224:227], a[76:79], v[152:155], a[224:227]
    s_add_u32 s54, s33, 115712
    buffer_load_dwordx4 a[60:63], v6, s[28:31], s54 offen sc1
    v_mfma_f32_16x16x32_bf16 a[228:231], a[76:79], v[156:159], a[228:231]
    v_rcp_f32 v230, v230
    v_rcp_f32 v231, v231
    v_mfma_f32_16x16x32_bf16 a[232:235], a[76:79], v[160:163], a[232:235]
    v_mul_f32 v228, v228, v148
    v_mul_f32 v229, v229, v149
    v_mul_f32 v230, v230, v150
    v_mfma_f32_16x16x32_bf16 a[236:239], a[76:79], v[164:167], a[236:239]
    v_mul_f32 v231, v231, v151
    v_cvt_pk_bf16_f32 v236, v228, v229
    v_cvt_pk_bf16_f32 v237, v230, v231
    v_mfma_f32_16x16x32_bf16 a[240:243], a[80:83], v[152:155], a[240:243]
    s_add_u32 s54, s33, 123904
    buffer_load_dwordx4 a[64:67], v6, s[28:31], s54 offen sc1
    v_mfma_f32_16x16x32_bf16 a[244:247], a[80:83], v[156:159], a[244:247]
    ds_write_b64 v2, v[236:237] offset:52224
    v_mfma_f32_16x16x32_bf16 a[248:251], a[80:83], v[160:163], a[248:251]
    v_mfma_f32_16x16x32_bf16 a[252:255], a[80:83], v[164:167], a[252:255]
    s_waitcnt vmcnt(33) lgkmcnt(0)
    s_barrier
    v_mfma_f32_16x16x32_bf16 v[8:11], a[84:87], v[168:171], v[8:11]
    s_add_u32 s54, s33, 124928
    buffer_load_dwordx4 a[68:71], v6, s[28:31], s54 offen sc1
    v_mfma_f32_16x16x32_bf16 v[12:15], a[84:87], v[172:175], v[12:15]
    ds_read_b128 v[184:187], v239 offset:12288
    v_mfma_f32_16x16x32_bf16 v[16:19], a[84:87], v[176:179], v[16:19]
    ds_read_b128 v[188:191], v239 offset:13312
    v_mfma_f32_16x16x32_bf16 v[20:23], a[84:87], v[180:183], v[20:23]
    ds_read_b128 v[192:195], v239 offset:14336
    v_mfma_f32_16x16x32_bf16 v[24:27], a[88:91], v[168:171], v[24:27]
    s_add_u32 s54, s33, 133120
    buffer_load_dwordx4 a[72:75], v6, s[28:31], s54 offen sc1
    v_mfma_f32_16x16x32_bf16 v[28:31], a[88:91], v[172:175], v[28:31]
    ds_read_b128 v[196:199], v239 offset:15360
    v_mfma_f32_16x16x32_bf16 v[32:35], a[88:91], v[176:179], v[32:35]
    ds_read_b128 v[200:203], v239 offset:16384
    v_mfma_f32_16x16x32_bf16 v[36:39], a[88:91], v[180:183], v[36:39]
    ds_read_b128 v[204:207], v239 offset:17408
    v_mfma_f32_16x16x32_bf16 v[40:43], a[92:95], v[168:171], v[40:43]
    s_add_u32 s54, s33, 134144
    buffer_load_dwordx4 a[76:79], v6, s[28:31], s54 offen sc1
    v_mfma_f32_16x16x32_bf16 v[44:47], a[92:95], v[172:175], v[44:47]
    ds_read_b128 v[208:211], v239 offset:18432
    v_mfma_f32_16x16x32_bf16 v[48:51], a[92:95], v[176:179], v[48:51]
    ds_read_b128 v[212:215], v239 offset:19456
    v_mfma_f32_16x16x32_bf16 v[52:55], a[92:95], v[180:183], v[52:55]
    s_waitcnt vmcnt(33)
    ds_read_b128 v[216:219], v239 offset:20480
    v_mfma_f32_16x16x32_bf16 v[56:59], a[96:99], v[168:171], v[56:59]
    s_add_u32 s54, s33, 142336
    buffer_load_dwordx4 a[80:83], v6, s[28:31], s54 offen sc1
    v_mfma_f32_16x16x32_bf16 v[60:63], a[96:99], v[172:175], v[60:63]
    ds_read_b128 v[220:223], v239 offset:21504
    v_mfma_f32_16x16x32_bf16 v[64:67], a[96:99], v[176:179], v[64:67]
    ds_read_b128 v[224:227], v239 offset:22528
    v_mfma_f32_16x16x32_bf16 v[68:71], a[96:99], v[180:183], v[68:71]
    ds_read_b128 v[228:231], v239 offset:23552
    v_mfma_f32_16x16x32_bf16 v[72:75], a[100:103], v[168:171], v[72:75]
    s_add_u32 s54, s33, 143360
    buffer_load_dwordx4 a[84:87], v6, s[28:31], s54 offen sc1
    v_mfma_f32_16x16x32_bf16 v[76:79], a[100:103], v[172:175], v[76:79]
    ds_read_b128 v[152:155], v239 offset:24576
    v_mfma_f32_16x16x32_bf16 v[80:83], a[100:103], v[176:179], v[80:83]
    s_add_u32 s54, s33, 151552
    buffer_load_dwordx4 a[88:91], v6, s[28:31], s54 offen sc1
    v_mfma_f32_16x16x32_bf16 v[84:87], a[100:103], v[180:183], v[84:87]
    ds_read_b128 v[156:159], v239 offset:25600
    v_mfma_f32_16x16x32_bf16 v[88:91], a[104:107], v[168:171], v[88:91]
    s_add_u32 s54, s33, 152576
    buffer_load_dwordx4 a[92:95], v6, s[28:31], s54 offen sc1
    v_mfma_f32_16x16x32_bf16 v[92:95], a[104:107], v[172:175], v[92:95]
    ds_read_b128 v[160:163], v239 offset:26624
    v_mfma_f32_16x16x32_bf16 v[96:99], a[104:107], v[176:179], v[96:99]
    ds_read_b128 v[164:167], v239 offset:27648
    v_mfma_f32_16x16x32_bf16 v[100:103], a[104:107], v[180:183], v[100:103]
    s_waitcnt vmcnt(34)
    ds_read_b128 a[160:163], v239 offset:28672
    v_mfma_f32_16x16x32_bf16 a[208:211], a[108:111], v[168:171], a[208:211]
    s_add_u32 s54, s33, 160768
    buffer_load_dwordx4 a[96:99], v6, s[28:31], s54 offen sc1
    v_mfma_f32_16x16x32_bf16 a[212:215], a[108:111], v[172:175], a[212:215]
    ds_read_b128 a[164:167], v239 offset:29696
    v_mfma_f32_16x16x32_bf16 a[216:219], a[108:111], v[176:179], a[216:219]
    ds_read_b128 a[168:171], v239 offset:30720
    v_mfma_f32_16x16x32_bf16 a[220:223], a[108:111], v[180:183], a[220:223]
    ds_read_b128 a[172:175], v239 offset:31744
    v_mfma_f32_16x16x32_bf16 a[224:227], a[112:115], v[168:171], a[224:227]
    s_add_u32 s54, s33, 161792
    buffer_load_dwordx4 a[100:103], v6, s[28:31], s54 offen sc1
    v_mfma_f32_16x16x32_bf16 a[228:231], a[112:115], v[172:175], a[228:231]
    ds_read_b128 a[176:179], v239 offset:32768
    v_mfma_f32_16x16x32_bf16 a[232:235], a[112:115], v[176:179], a[232:235]
    ds_read_b128 a[180:183], v239 offset:33792
    v_mfma_f32_16x16x32_bf16 a[236:239], a[112:115], v[180:183], a[236:239]
    ds_read_b128 a[184:187], v239 offset:34816
    v_mfma_f32_16x16x32_bf16 a[240:243], a[116:119], v[168:171], a[240:243]
    s_add_u32 s54, s33, 116736
    buffer_load_dwordx4 a[104:107], v6, s[28:31], s54 offen sc1
    v_mfma_f32_16x16x32_bf16 a[244:247], a[116:119], v[172:175], a[244:247]
    ds_read_b128 a[188:191], v239 offset:35840
    v_mfma_f32_16x16x32_bf16 a[248:251], a[116:119], v[176:179], a[248:251]
    v_mfma_f32_16x16x32_bf16 a[252:255], a[116:119], v[180:183], a[252:255]
    s_waitcnt vmcnt(34) lgkmcnt(0)
    v_mfma_f32_16x16x32_bf16 v[8:11], a[120:123], v[184:187], v[8:11]
    s_add_u32 s54, s33, 117760
    buffer_load_dwordx4 a[108:111], v6, s[28:31], s54 offen sc1
    v_mfma_f32_16x16x32_bf16 v[12:15], a[120:123], v[188:191], v[12:15]
    v_mfma_f32_16x16x32_bf16 v[16:19], a[120:123], v[192:195], v[16:19]
    v_mfma_f32_16x16x32_bf16 v[20:23], a[120:123], v[196:199], v[20:23]
    v_mfma_f32_16x16x32_bf16 v[24:27], a[124:127], v[184:187], v[24:27]
    s_add_u32 s54, s33, 125952
    buffer_load_dwordx4 a[112:115], v6, s[28:31], s54 offen sc1
    v_mfma_f32_16x16x32_bf16 v[28:31], a[124:127], v[188:191], v[28:31]
    v_mfma_f32_16x16x32_bf16 v[32:35], a[124:127], v[192:195], v[32:35]
    v_accvgpr_read_b32 v104, a208
    v_mfma_f32_16x16x32_bf16 v[36:39], a[124:127], v[196:199], v[36:39]
    v_mfma_f32_16x16x32_bf16 v[8:11], a[128:131], v[200:203], v[8:11]
    s_add_u32 s54, s33, 126976
    buffer_load_dwordx4 a[116:119], v6, s[28:31], s54 offen sc1
    v_mfma_f32_16x16x32_bf16 v[12:15], a[128:131], v[204:207], v[12:15]
    v_accvgpr_read_b32 v105, a209
    v_mfma_f32_16x16x32_bf16 v[16:19], a[128:131], v[208:211], v[16:19]
    v_mfma_f32_16x16x32_bf16 v[20:23], a[128:131], v[212:215], v[20:23]
    s_waitcnt vmcnt(34)
    v_mfma_f32_16x16x32_bf16 v[24:27], a[132:135], v[200:203], v[24:27]
    s_add_u32 s54, s33, 135168
    buffer_load_dwordx4 a[120:123], v6, s[28:31], s54 offen sc1
    v_mfma_f32_16x16x32_bf16 v[28:31], a[132:135], v[204:207], v[28:31]
    v_accvgpr_read_b32 v106, a210
    v_mfma_f32_16x16x32_bf16 v[32:35], a[132:135], v[208:211], v[32:35]
    s_add_u32 s54, s33, 136192
    buffer_load_dwordx4 a[124:127], v6, s[28:31], s54 offen sc1
    v_mfma_f32_16x16x32_bf16 v[36:39], a[132:135], v[212:215], v[36:39]
    v_mfma_f32_16x16x32_bf16 v[8:11], a[136:139], v[216:219], v[8:11]
    s_add_u32 s54, s33, 144384
    buffer_load_dwordx4 a[128:131], v6, s[28:31], s54 offen sc1
    v_mfma_f32_16x16x32_bf16 v[12:15], a[136:139], v[220:223], v[12:15]
    v_accvgpr_read_b32 v107, a211
    v_mfma_f32_16x16x32_bf16 v[16:19], a[136:139], v[224:227], v[16:19]
    v_mfma_f32_16x16x32_bf16 v[20:23], a[136:139], v[228:231], v[20:23]
    v_mfma_f32_16x16x32_bf16 v[24:27], a[140:143], v[216:219], v[24:27]
    s_add_u32 s54, s33, 145408
    buffer_load_dwordx4 a[132:135], v6, s[28:31], s54 offen sc1
    v_mfma_f32_16x16x32_bf16 v[28:31], a[140:143], v[220:223], v[28:31]
    v_accvgpr_read_b32 v108, a212
    v_mfma_f32_16x16x32_bf16 v[32:35], a[140:143], v[224:227], v[32:35]
    v_mfma_f32_16x16x32_bf16 v[36:39], a[140:143], v[228:231], v[36:39]
    s_waitcnt vmcnt(35)
    v_accvgpr_read_b32 v109, a213
    v_mfma_f32_16x16x32_bf16 v[8:11], a[144:147], v[152:155], v[8:11]
    s_add_u32 s54, s33, 153600
    buffer_load_dwordx4 a[136:139], v6, s[28:31], s54 offen sc1
    v_mfma_f32_16x16x32_bf16 v[12:15], a[144:147], v[156:159], v[12:15]
    v_mfma_f32_16x16x32_bf16 v[16:19], a[144:147], v[160:163], v[16:19]
    v_mfma_f32_16x16x32_bf16 v[20:23], a[144:147], v[164:167], v[20:23]
    v_accvgpr_read_b32 v110, a214
    v_mfma_f32_16x16x32_bf16 v[24:27], a[148:151], v[152:155], v[24:27]
    s_add_u32 s54, s33, 154624
    buffer_load_dwordx4 a[140:143], v6, s[28:31], s54 offen sc1
    v_mfma_f32_16x16x32_bf16 v[28:31], a[148:151], v[156:159], v[28:31]
    v_mfma_f32_16x16x32_bf16 v[32:35], a[148:151], v[160:163], v[32:35]
    v_accvgpr_read_b32 v111, a215
    v_mfma_f32_16x16x32_bf16 v[36:39], a[148:151], v[164:167], v[36:39]
    v_mfma_f32_16x16x32_bf16 v[8:11], a[152:155], a[160:163], v[8:11]
    s_add_u32 s54, s33, 162816
    buffer_load_dwordx4 a[144:147], v6, s[28:31], s54 offen sc1
    v_mfma_f32_16x16x32_bf16 v[12:15], a[152:155], a[164:167], v[12:15]
    v_mfma_f32_16x16x32_bf16 v[16:19], a[152:155], a[168:171], v[16:19]
    v_accvgpr_read_b32 v112, a216
    v_mfma_f32_16x16x32_bf16 v[20:23], a[152:155], a[172:175], v[20:23]
    s_waitcnt vmcnt(35)
    v_mfma_f32_16x16x32_bf16 v[24:27], a[156:159], a[160:163], v[24:27]
    s_add_u32 s54, s33, 163840
    buffer_load_dwordx4 a[148:151], v6, s[28:31], s54 offen sc1
    v_mfma_f32_16x16x32_bf16 v[28:31], a[156:159], a[164:167], v[28:31]
    v_accvgpr_read_b32 v113, a217
    v_mfma_f32_16x16x32_bf16 v[32:35], a[156:159], a[168:171], v[32:35]
    v_mfma_f32_16x16x32_bf16 v[36:39], a[156:159], a[172:175], v[36:39]
    v_mfma_f32_16x16x32_bf16 v[8:11], a[0:3], a[176:179], v[8:11]
    s_add_u32 s54, s33, 118784
    buffer_load_dwordx4 a[152:155], v6, s[28:31], s54 offen sc1
    v_mfma_f32_16x16x32_bf16 v[12:15], a[0:3], a[180:183], v[12:15]
    v_accvgpr_read_b32 v114, a218
    v_mfma_f32_16x16x32_bf16 v[16:19], a[0:3], a[184:187], v[16:19]
    v_mfma_f32_16x16x32_bf16 v[20:23], a[0:3], a[188:191], v[20:23]
    v_accvgpr_read_b32 v115, a219
    v_mfma_f32_16x16x32_bf16 v[24:27], a[4:7], a[176:179], v[24:27]
    s_add_u32 s54, s33, 128000
    buffer_load_dwordx4 a[156:159], v6, s[28:31], s54 offen sc1
    v_mfma_f32_16x16x32_bf16 v[28:31], a[4:7], a[180:183], v[28:31]
    v_mfma_f32_16x16x32_bf16 v[32:35], a[4:7], a[184:187], v[32:35]
    s_add_u32 s54, s33, 137216
    buffer_load_dwordx4 a[0:3], v6, s[28:31], s54 offen sc1
    v_mfma_f32_16x16x32_bf16 v[36:39], a[4:7], a[188:191], v[36:39]
    s_waitcnt vmcnt(36)
    v_mfma_f32_16x16x32_bf16 v[40:43], a[8:11], v[184:187], v[40:43]
    s_add_u32 s54, s33, 146432
    buffer_load_dwordx4 a[4:7], v6, s[28:31], s54 offen sc1
    v_mfma_f32_16x16x32_bf16 v[44:47], a[8:11], v[188:191], v[44:47]
    v_accvgpr_read_b32 v116, a220
    v_mfma_f32_16x16x32_bf16 v[48:51], a[8:11], v[192:195], v[48:51]
    v_mfma_f32_16x16x32_bf16 v[52:55], a[8:11], v[196:199], v[52:55]
    v_accvgpr_read_b32 v117, a221
    v_cvt_pk_bf16_f32 v8, v8, v9
    v_mfma_f32_16x16x32_bf16 v[56:59], a[12:15], v[184:187], v[56:59]
    s_add_u32 s54, s33, 155648
    buffer_load_dwordx4 a[8:11], v6, s[28:31], s54 offen sc1
    v_mfma_f32_16x16x32_bf16 v[60:63], a[12:15], v[188:191], v[60:63]
    v_cvt_pk_bf16_f32 v9, v10, v11
    v_mfma_f32_16x16x32_bf16 v[64:67], a[12:15], v[192:195], v[64:67]
    v_cvt_pk_bf16_f32 v10, v24, v25
    v_mfma_f32_16x16x32_bf16 v[68:71], a[12:15], v[196:199], v[68:71]
    v_accvgpr_read_b32 v118, a222
    v_mfma_f32_16x16x32_bf16 v[40:43], a[16:19], v[200:203], v[40:43]
    s_add_u32 s54, s33, 164864
    buffer_load_dwordx4 a[12:15], v6, s[28:31], s54 offen sc1
    v_mfma_f32_16x16x32_bf16 v[44:47], a[16:19], v[204:207], v[44:47]
    v_cvt_pk_bf16_f32 v11, v26, v27
    v_mfma_f32_16x16x32_bf16 v[48:51], a[16:19], v[208:211], v[48:51]
    v_accvgpr_read_b32 v119, a223
    v_mfma_f32_16x16x32_bf16 v[52:55], a[16:19], v[212:215], v[52:55]
    s_waitcnt vmcnt(36)
    buffer_store_dwordx4 v[8:11], v6, s[16:19], s42 offen offset:0 sc1
    v_mfma_f32_16x16x32_bf16 v[56:59], a[20:23], v[200:203], v[56:59]
    v_mfma_f32_16x16x32_bf16 v[60:63], a[20:23], v[204:207], v[60:63]
    v_accvgpr_read_b32 v120, a224
    v_mfma_f32_16x16x32_bf16 v[64:67], a[20:23], v[208:211], v[64:67]
    ds_write_b128 v252, v[8:11] offset:0
    v_mfma_f32_16x16x32_bf16 v[68:71], a[20:23], v[212:215], v[68:71]
    v_accvgpr_read_b32 v121, a225
    v_mfma_f32_16x16x32_bf16 v[40:43], a[24:27], v[216:219], v[40:43]
    v_mfma_f32_16x16x32_bf16 v[44:47], a[24:27], v[220:223], v[44:47]
    v_mfma_f32_16x16x32_bf16 v[48:51], a[24:27], v[224:227], v[48:51]
    v_accvgpr_read_b32 v122, a226
    v_mfma_f32_16x16x32_bf16 v[52:55], a[24:27], v[228:231], v[52:55]
    v_cvt_pk_bf16_f32 v12, v12, v13
    v_mfma_f32_16x16x32_bf16 v[56:59], a[28:31], v[216:219], v[56:59]
    v_accvgpr_read_b32 v123, a227
    v_cvt_pk_bf16_f32 v13, v14, v15
    v_mfma_f32_16x16x32_bf16 v[60:63], a[28:31], v[220:223], v[60:63]
    v_cvt_pk_bf16_f32 v14, v28, v29
    v_mfma_f32_16x16x32_bf16 v[64:67], a[28:31], v[224:227], v[64:67]
    v_cvt_pk_bf16_f32 v15, v30, v31
    v_mfma_f32_16x16x32_bf16 v[68:71], a[28:31], v[228:231], v[68:71]
    s_waitcnt vmcnt(34)
    v_accvgpr_read_b32 v124, a228
    v_mfma_f32_16x16x32_bf16 v[40:43], a[32:35], v[152:155], v[40:43]
    buffer_store_dwordx4 v[12:15], v6, s[28:31], s48 offen offset:0 sc1
    v_mfma_f32_16x16x32_bf16 v[44:47], a[32:35], v[156:159], v[44:47]
    v_accvgpr_read_b32 v125, a229
    v_mfma_f32_16x16x32_bf16 v[48:51], a[32:35], v[160:163], v[48:51]
    v_cvt_pk_bf16_f32 v16, v16, v17
    v_mfma_f32_16x16x32_bf16 v[52:55], a[32:35], v[164:167], v[52:55]
    v_cvt_pk_bf16_f32 v17, v18, v19
    v_mfma_f32_16x16x32_bf16 v[56:59], a[36:39], v[152:155], v[56:59]
    v_accvgpr_read_b32 v126, a230
    v_cvt_pk_bf16_f32 v18, v32, v33
    v_mfma_f32_16x16x32_bf16 v[60:63], a[36:39], v[156:159], v[60:63]
    v_cvt_pk_bf16_f32 v19, v34, v35
    v_mfma_f32_16x16x32_bf16 v[64:67], a[36:39], v[160:163], v[64:67]
    v_accvgpr_read_b32 v127, a231
    v_mfma_f32_16x16x32_bf16 v[68:71], a[36:39], v[164:167], v[68:71]
    buffer_store_dwordx4 v[16:19], v6, s[28:31], s49 offen offset:0 sc1
    v_mfma_f32_16x16x32_bf16 v[40:43], a[40:43], a[160:163], v[40:43]
    v_mfma_f32_16x16x32_bf16 v[44:47], a[40:43], a[164:167], v[44:47]
    v_accvgpr_read_b32 v128, a232
    v_cvt_pk_bf16_f32 v20, v20, v21
    v_mfma_f32_16x16x32_bf16 v[48:51], a[40:43], a[168:171], v[48:51]
    v_cvt_pk_bf16_f32 v21, v22, v23
    v_mfma_f32_16x16x32_bf16 v[52:55], a[40:43], a[172:175], v[52:55]
    s_waitcnt vmcnt(33)
    v_accvgpr_read_b32 v129, a233
    v_mfma_f32_16x16x32_bf16 v[56:59], a[44:47], a[160:163], v[56:59]
    v_cvt_pk_bf16_f32 v22, v36, v37
    v_mfma_f32_16x16x32_bf16 v[60:63], a[44:47], a[164:167], v[60:63]
    v_cvt_pk_bf16_f32 v23, v38, v39
    v_mfma_f32_16x16x32_bf16 v[64:67], a[44:47], a[168:171], v[64:67]
    v_accvgpr_read_b32 v130, a234
    v_mfma_f32_16x16x32_bf16 v[68:71], a[44:47], a[172:175], v[68:71]
    buffer_store_dwordx4 v[20:23], v6, s[28:31], s50 offen offset:0 sc1
    v_mfma_f32_16x16x32_bf16 v[40:43], a[48:51], a[176:179], v[40:43]
    v_accvgpr_read_b32 v131, a235
    v_mfma_f32_16x16x32_bf16 v[44:47], a[48:51], a[180:183], v[44:47]
    v_mfma_f32_16x16x32_bf16 v[48:51], a[48:51], a[184:187], v[48:51]
    v_mfma_f32_16x16x32_bf16 v[52:55], a[48:51], a[188:191], v[52:55]
    v_accvgpr_read_b32 v132, a236
    v_mfma_f32_16x16x32_bf16 v[56:59], a[52:55], a[176:179], v[56:59]
    v_mfma_f32_16x16x32_bf16 v[60:63], a[52:55], a[180:183], v[60:63]
    v_accvgpr_read_b32 v133, a237
    v_mfma_f32_16x16x32_bf16 v[64:67], a[52:55], a[184:187], v[64:67]
    v_mfma_f32_16x16x32_bf16 v[68:71], a[52:55], a[188:191], v[68:71]
    s_waitcnt vmcnt(31)
    v_mfma_f32_16x16x32_bf16 v[72:75], a[56:59], v[184:187], v[72:75]
    v_accvgpr_read_b32 v134, a238
    v_mfma_f32_16x16x32_bf16 v[76:79], a[56:59], v[188:191], v[76:79]
    v_mfma_f32_16x16x32_bf16 v[80:83], a[56:59], v[192:195], v[80:83]
    v_accvgpr_read_b32 v135, a239
    v_mfma_f32_16x16x32_bf16 v[84:87], a[56:59], v[196:199], v[84:87]
    v_cvt_pk_bf16_f32 v40, v40, v41
    v_mfma_f32_16x16x32_bf16 v[88:91], a[60:63], v[184:187], v[88:91]
    v_cvt_pk_bf16_f32 v41, v42, v43
    v_mfma_f32_16x16x32_bf16 v[92:95], a[60:63], v[188:191], v[92:95]
    v_accvgpr_read_b32 v136, a240
    v_mfma_f32_16x16x32_bf16 v[96:99], a[60:63], v[192:195], v[96:99]
    v_cvt_pk_bf16_f32 v42, v56, v57
    v_mfma_f32_16x16x32_bf16 v[100:103], a[60:63], v[196:199], v[100:103]
    v_accvgpr_read_b32 v137, a241
    v_cvt_pk_bf16_f32 v43, v58, v59
    v_mfma_f32_16x16x32_bf16 v[72:75], a[64:67], v[200:203], v[72:75]
    v_mfma_f32_16x16x32_bf16 v[76:79], a[64:67], v[204:207], v[76:79]
    buffer_store_dwordx4 v[40:43], v6, s[16:19], s42 offen offset:1024 sc1
    v_mfma_f32_16x16x32_bf16 v[80:83], a[64:67], v[208:211], v[80:83]
    v_accvgpr_read_b32 v138, a242
    v_mfma_f32_16x16x32_bf16 v[84:87], a[64:67], v[212:215], v[84:87]
    s_waitcnt vmcnt(29)
    ds_write_b128 v252, v[40:43] offset:1024
    v_mfma_f32_16x16x32_bf16 v[88:91], a[68:71], v[200:203], v[88:91]
    v_accvgpr_read_b32 v139, a243
    v_mfma_f32_16x16x32_bf16 v[92:95], a[68:71], v[204:207], v[92:95]
    v_mfma_f32_16x16x32_bf16 v[96:99], a[68:71], v[208:211], v[96:99]
    v_mfma_f32_16x16x32_bf16 v[100:103], a[68:71], v[212:215], v[100:103]
    v_accvgpr_read_b32 v140, a244
    v_mfma_f32_16x16x32_bf16 v[72:75], a[72:75], v[216:219], v[72:75]
    v_mfma_f32_16x16x32_bf16 v[76:79], a[72:75], v[220:223], v[76:79]
    v_accvgpr_read_b32 v141, a245
    v_mfma_f32_16x16x32_bf16 v[80:83], a[72:75], v[224:227], v[80:83]
    v_cvt_pk_bf16_f32 v44, v44, v45
    v_mfma_f32_16x16x32_bf16 v[84:87], a[72:75], v[228:231], v[84:87]
    v_cvt_pk_bf16_f32 v45, v46, v47
    v_mfma_f32_16x16x32_bf16 v[88:91], a[76:79], v[216:219], v[88:91]
    v_accvgpr_read_b32 v142, a246
    v_cvt_pk_bf16_f32 v46, v60, v61
    v_mfma_f32_16x16x32_bf16 v[92:95], a[76:79], v[220:223], v[92:95]
    v_cvt_pk_bf16_f32 v47, v62, v63
    v_mfma_f32_16x16x32_bf16 v[96:99], a[76:79], v[224:227], v[96:99]
    v_accvgpr_read_b32 v143, a247
    v_mfma_f32_16x16x32_bf16 v[100:103], a[76:79], v[228:231], v[100:103]
    s_waitcnt vmcnt(26)
    buffer_store_dwordx4 v[44:47], v6, s[28:31], s48 offen offset:1024 sc1
    v_mfma_f32_16x16x32_bf16 v[72:75], a[80:83], v[152:155], v[72:75]
    v_mfma_f32_16x16x32_bf16 v[76:79], a[80:83], v[156:159], v[76:79]
    v_accvgpr_read_b32 v144, a248
    v_cvt_pk_bf16_f32 v48, v48, v49
    v_mfma_f32_16x16x32_bf16 v[80:83], a[80:83], v[160:163], v[80:83]
    v_cvt_pk_bf16_f32 v49, v50, v51
    v_mfma_f32_16x16x32_bf16 v[84:87], a[80:83], v[164:167], v[84:87]
    v_accvgpr_read_b32 v145, a249
    v_mfma_f32_16x16x32_bf16 v[88:91], a[84:87], v[152:155], v[88:91]
    v_cvt_pk_bf16_f32 v50, v64, v65
    v_mfma_f32_16x16x32_bf16 v[92:95], a[84:87], v[156:159], v[92:95]
    v_cvt_pk_bf16_f32 v51, v66, v67
    v_mfma_f32_16x16x32_bf16 v[96:99], a[84:87], v[160:163], v[96:99]
    v_accvgpr_read_b32 v146, a250
    v_mfma_f32_16x16x32_bf16 v[100:103], a[84:87], v[164:167], v[100:103]
    buffer_store_dwordx4 v[48:51], v6, s[28:31], s49 offen offset:1024 sc1
    v_mfma_f32_16x16x32_bf16 v[72:75], a[88:91], a[160:163], v[72:75]
    v_accvgpr_read_b32 v147, a251
    v_mfma_f32_16x16x32_bf16 v[76:79], a[88:91], a[164:167], v[76:79]
    v_cvt_pk_bf16_f32 v52, v52, v53
    v_mfma_f32_16x16x32_bf16 v[80:83], a[88:91], a[168:171], v[80:83]
    v_cvt_pk_bf16_f32 v53, v54, v55
    v_mfma_f32_16x16x32_bf16 v[84:87], a[88:91], a[172:175], v[84:87]
    s_waitcnt vmcnt(25)
    v_accvgpr_read_b32 v148, a252
    v_cvt_pk_bf16_f32 v54, v68, v69
    v_mfma_f32_16x16x32_bf16 v[88:91], a[92:95], a[160:163], v[88:91]
    v_mfma_f32_16x16x32_bf16 v[92:95], a[92:95], a[164:167], v[92:95]
    v_accvgpr_read_b32 v149, a253
    v_cvt_pk_bf16_f32 v55, v70, v71
    v_mfma_f32_16x16x32_bf16 v[96:99], a[92:95], a[168:171], v[96:99]
    buffer_store_dwordx4 v[52:55], v6, s[28:31], s50 offen offset:1024 sc1
    v_mfma_f32_16x16x32_bf16 v[100:103], a[92:95], a[172:175], v[100:103]
    v_mfma_f32_16x16x32_bf16 v[72:75], a[96:99], a[176:179], v[72:75]
    v_accvgpr_read_b32 v150, a254
    v_mfma_f32_16x16x32_bf16 v[76:79], a[96:99], a[180:183], v[76:79]
    v_mfma_f32_16x16x32_bf16 v[80:83], a[96:99], a[184:187], v[80:83]
    v_accvgpr_read_b32 v151, a255
    v_mfma_f32_16x16x32_bf16 v[84:87], a[96:99], a[188:191], v[84:87]
    v_mfma_f32_16x16x32_bf16 v[88:91], a[100:103], a[176:179], v[88:91]
    v_mfma_f32_16x16x32_bf16 v[92:95], a[100:103], a[180:183], v[92:95]
    v_mfma_f32_16x16x32_bf16 v[96:99], a[100:103], a[184:187], v[96:99]
    v_mfma_f32_16x16x32_bf16 v[100:103], a[100:103], a[188:191], v[100:103]
    s_waitcnt vmcnt(23)
    v_mfma_f32_16x16x32_bf16 v[104:107], a[104:107], v[184:187], v[104:107]
    v_mfma_f32_16x16x32_bf16 v[108:111], a[104:107], v[188:191], v[108:111]
    v_mfma_f32_16x16x32_bf16 v[112:115], a[104:107], v[192:195], v[112:115]
    v_mfma_f32_16x16x32_bf16 v[116:119], a[104:107], v[196:199], v[116:119]
    v_cvt_pk_bf16_f32 v72, v72, v73
    v_mfma_f32_16x16x32_bf16 v[120:123], a[108:111], v[184:187], v[120:123]
    v_cvt_pk_bf16_f32 v73, v74, v75
    v_mfma_f32_16x16x32_bf16 v[124:127], a[108:111], v[188:191], v[124:127]
    v_mfma_f32_16x16x32_bf16 v[128:131], a[108:111], v[192:195], v[128:131]
    v_cvt_pk_bf16_f32 v74, v88, v89
    v_mfma_f32_16x16x32_bf16 v[132:135], a[108:111], v[196:199], v[132:135]
    v_cvt_pk_bf16_f32 v75, v90, v91
    v_mfma_f32_16x16x32_bf16 v[104:107], a[112:115], v[200:203], v[104:107]
    v_mfma_f32_16x16x32_bf16 v[108:111], a[112:115], v[204:207], v[108:111]
    buffer_store_dwordx4 v[72:75], v6, s[16:19], s42 offen offset:2048 sc1
    v_mfma_f32_16x16x32_bf16 v[112:115], a[112:115], v[208:211], v[112:115]
    v_mfma_f32_16x16x32_bf16 v[116:119], a[112:115], v[212:215], v[116:119]
    s_waitcnt vmcnt(21)
    ds_write_b128 v252, v[72:75] offset:2048
    v_mfma_f32_16x16x32_bf16 v[120:123], a[116:119], v[200:203], v[120:123]
    v_mfma_f32_16x16x32_bf16 v[124:127], a[116:119], v[204:207], v[124:127]
    v_mfma_f32_16x16x32_bf16 v[128:131], a[116:119], v[208:211], v[128:131]
    v_mfma_f32_16x16x32_bf16 v[132:135], a[116:119], v[212:215], v[132:135]
    v_mfma_f32_16x16x32_bf16 v[104:107], a[120:123], v[216:219], v[104:107]
    v_mfma_f32_16x16x32_bf16 v[108:111], a[120:123], v[220:223], v[108:111]
    v_mfma_f32_16x16x32_bf16 v[112:115], a[120:123], v[224:227], v[112:115]
    v_cvt_pk_bf16_f32 v76, v76, v77
    v_mfma_f32_16x16x32_bf16 v[116:119], a[120:123], v[228:231], v[116:119]
    v_cvt_pk_bf16_f32 v77, v78, v79
    v_mfma_f32_16x16x32_bf16 v[120:123], a[124:127], v[216:219], v[120:123]
    v_cvt_pk_bf16_f32 v78, v92, v93
    v_mfma_f32_16x16x32_bf16 v[124:127], a[124:127], v[220:223], v[124:127]
    v_cvt_pk_bf16_f32 v79, v94, v95
    v_mfma_f32_16x16x32_bf16 v[128:131], a[124:127], v[224:227], v[128:131]
    v_mfma_f32_16x16x32_bf16 v[132:135], a[124:127], v[228:231], v[132:135]
    s_waitcnt vmcnt(18)
    buffer_store_dwordx4 v[76:79], v6, s[28:31], s48 offen offset:2048 sc1
    v_mfma_f32_16x16x32_bf16 v[104:107], a[128:131], v[152:155], v[104:107]
    v_mfma_f32_16x16x32_bf16 v[108:111], a[128:131], v[156:159], v[108:111]
    v_cvt_pk_bf16_f32 v80, v80, v81
    v_mfma_f32_16x16x32_bf16 v[112:115], a[128:131], v[160:163], v[112:115]
    v_mfma_f32_16x16x32_bf16 v[116:119], a[128:131], v[164:167], v[116:119]
    v_cvt_pk_bf16_f32 v81, v82, v83
    v_mfma_f32_16x16x32_bf16 v[120:123], a[132:135], v[152:155], v[120:123]
    v_cvt_pk_bf16_f32 v82, v96, v97
    v_mfma_f32_16x16x32_bf16 v[124:127], a[132:135], v[156:159], v[124:127]
    v_cvt_pk_bf16_f32 v83, v98, v99
    v_mfma_f32_16x16x32_bf16 v[128:131], a[132:135], v[160:163], v[128:131]
    v_mfma_f32_16x16x32_bf16 v[132:135], a[132:135], v[164:167], v[132:135]
    buffer_store_dwordx4 v[80:83], v6, s[28:31], s49 offen offset:2048 sc1
    v_mfma_f32_16x16x32_bf16 v[104:107], a[136:139], a[160:163], v[104:107]
    v_mfma_f32_16x16x32_bf16 v[108:111], a[136:139], a[164:167], v[108:111]
    v_cvt_pk_bf16_f32 v84, v84, v85
    v_mfma_f32_16x16x32_bf16 v[112:115], a[136:139], a[168:171], v[112:115]
    v_cvt_pk_bf16_f32 v85, v86, v87
    v_mfma_f32_16x16x32_bf16 v[116:119], a[136:139], a[172:175], v[116:119]
    s_waitcnt vmcnt(17)
    v_cvt_pk_bf16_f32 v86, v100, v101
    v_mfma_f32_16x16x32_bf16 v[120:123], a[140:143], a[160:163], v[120:123]
    v_cvt_pk_bf16_f32 v87, v102, v103
    v_mfma_f32_16x16x32_bf16 v[124:127], a[140:143], a[164:167], v[124:127]
    v_mfma_f32_16x16x32_bf16 v[128:131], a[140:143], a[168:171], v[128:131]
    buffer_store_dwordx4 v[84:87], v6, s[28:31], s50 offen offset:2048 sc1
    v_mfma_f32_16x16x32_bf16 v[132:135], a[140:143], a[172:175], v[132:135]
    v_mfma_f32_16x16x32_bf16 v[104:107], a[144:147], a[176:179], v[104:107]
    v_mfma_f32_16x16x32_bf16 v[108:111], a[144:147], a[180:183], v[108:111]
    v_mfma_f32_16x16x32_bf16 v[112:115], a[144:147], a[184:187], v[112:115]
    v_mfma_f32_16x16x32_bf16 v[116:119], a[144:147], a[188:191], v[116:119]
    v_mfma_f32_16x16x32_bf16 v[120:123], a[148:151], a[176:179], v[120:123]
    v_mfma_f32_16x16x32_bf16 v[124:127], a[148:151], a[180:183], v[124:127]
    v_mfma_f32_16x16x32_bf16 v[128:131], a[148:151], a[184:187], v[128:131]
    v_mfma_f32_16x16x32_bf16 v[132:135], a[148:151], a[188:191], v[132:135]
    s_waitcnt vmcnt(15)
    v_mfma_f32_16x16x32_bf16 v[136:139], a[152:155], v[184:187], v[136:139]
    v_mfma_f32_16x16x32_bf16 v[140:143], a[152:155], v[188:191], v[140:143]
    v_mfma_f32_16x16x32_bf16 v[144:147], a[152:155], v[192:195], v[144:147]
    v_mfma_f32_16x16x32_bf16 v[148:151], a[152:155], v[196:199], v[148:151]
    v_cvt_pk_bf16_f32 v104, v104, v105
    v_mfma_f32_16x16x32_bf16 v[136:139], a[156:159], v[200:203], v[136:139]
    v_cvt_pk_bf16_f32 v105, v106, v107
    v_cvt_pk_bf16_f32 v106, v120, v121
    v_mfma_f32_16x16x32_bf16 v[140:143], a[156:159], v[204:207], v[140:143]
    v_cvt_pk_bf16_f32 v107, v122, v123
    v_mfma_f32_16x16x32_bf16 v[144:147], a[156:159], v[208:211], v[144:147]
    buffer_store_dwordx4 v[104:107], v6, s[16:19], s42 offen offset:3072 sc1
    v_mfma_f32_16x16x32_bf16 v[148:151], a[156:159], v[212:215], v[148:151]
    v_mfma_f32_16x16x32_bf16 v[136:139], a[0:3], v[216:219], v[136:139]
    ds_write_b128 v252, v[104:107] offset:3072
    v_mfma_f32_16x16x32_bf16 v[140:143], a[0:3], v[220:223], v[140:143]
    v_mfma_f32_16x16x32_bf16 v[144:147], a[0:3], v[224:227], v[144:147]
    v_mfma_f32_16x16x32_bf16 v[148:151], a[0:3], v[228:231], v[148:151]
    s_waitcnt vmcnt(13)
    v_cvt_pk_bf16_f32 v108, v108, v109
    v_mfma_f32_16x16x32_bf16 v[136:139], a[4:7], v[152:155], v[136:139]
    v_cvt_pk_bf16_f32 v109, v110, v111
    v_cvt_pk_bf16_f32 v110, v124, v125
    v_mfma_f32_16x16x32_bf16 v[140:143], a[4:7], v[156:159], v[140:143]
    v_cvt_pk_bf16_f32 v111, v126, v127
    v_mfma_f32_16x16x32_bf16 v[144:147], a[4:7], v[160:163], v[144:147]
    buffer_store_dwordx4 v[108:111], v6, s[28:31], s48 offen offset:3072 sc1
    v_mfma_f32_16x16x32_bf16 v[148:151], a[4:7], v[164:167], v[148:151]
    v_cvt_pk_bf16_f32 v112, v112, v113
    v_mfma_f32_16x16x32_bf16 v[136:139], a[8:11], a[160:163], v[136:139]
    v_cvt_pk_bf16_f32 v113, v114, v115
    v_mfma_f32_16x16x32_bf16 v[140:143], a[8:11], a[164:167], v[140:143]
    v_cvt_pk_bf16_f32 v114, v128, v129
    v_cvt_pk_bf16_f32 v115, v130, v131
    v_mfma_f32_16x16x32_bf16 v[144:147], a[8:11], a[168:171], v[144:147]
    v_mfma_f32_16x16x32_bf16 v[148:151], a[8:11], a[172:175], v[148:151]
    buffer_store_dwordx4 v[112:115], v6, s[28:31], s49 offen offset:3072 sc1
    v_mfma_f32_16x16x32_bf16 v[136:139], a[12:15], a[176:179], v[136:139]
    v_cvt_pk_bf16_f32 v116, v116, v117
    v_cvt_pk_bf16_f32 v117, v118, v119
    v_mfma_f32_16x16x32_bf16 v[140:143], a[12:15], a[180:183], v[140:143]
    v_cvt_pk_bf16_f32 v118, v132, v133
    v_mfma_f32_16x16x32_bf16 v[144:147], a[12:15], a[184:187], v[144:147]
    v_cvt_pk_bf16_f32 v119, v134, v135
    v_mfma_f32_16x16x32_bf16 v[148:151], a[12:15], a[188:191], v[148:151]
    buffer_store_dwordx4 v[116:119], v6, s[28:31], s50 offen offset:3072 sc1
    v_cvt_pk_bf16_f32 v136, v136, v137
    v_cvt_pk_bf16_f32 v137, v138, v139
    s_nop 0
    v_cvt_pk_bf16_f32 v138, v140, v141
    v_cvt_pk_bf16_f32 v139, v142, v143
    v_cvt_pk_bf16_f32 v144, v144, v145
    v_cvt_pk_bf16_f32 v145, v146, v147
    v_cvt_pk_bf16_f32 v146, v148, v149
    v_cvt_pk_bf16_f32 v147, v150, v151
    v_permlane16_swap_b32 v136, v138
    v_permlane16_swap_b32 v137, v139
    v_permlane16_swap_b32 v144, v146
    v_permlane16_swap_b32 v145, v147
    buffer_store_dwordx4 v[136:139], v253, s[28:31], s43 offen sc1
    buffer_store_dwordx4 v[144:147], v248, s[28:31], s51 offen sc1
    ds_write_b128 v254, v[136:139]
    s_and_b32 s34, s4, 1
    s_lshr_b32 s35, s4, 1
    s_lshl_b32 s36, s3, 1
    s_add_u32 s36, s36, s35
    s_lshl_b32 s37, s35, 3
    s_sub_u32 s37, 8, s37
    s_sub_u32 s37, s37, s36
    s_mul_i32 s35, s35, 9
    s_add_u32 s35, s35, s36
    s_lshl_b32 s36, s36, 10
    s_add_u32 s36, s36, 147456
    v_add_u32 v1, s36, v6
    s_lshl_b32 s36, s35, 7
    s_add_u32 s36, s36, 77056
    v_lshlrev_b32 v3, 5, v241
    s_lshl_b32 s39, s14, 1
    s_add_u32 s39, s39, s34
    s_mul_i32 s39, s39, 18
    s_add_u32 s39, s39, s35
    s_lshl_b32 s39, s39, 10
    s_lshl_b32 s38, s35, 10
    v_add_u32 v0, s38, v6
    s_mul_i32 s38, s12, 73728
    s_add_u32 s39, s39, s38
    s_add_u32 s39, s39, 31457280
    v_mul_u32_u24 v7, 1152, v242
    v_lshl_add_u32 v7, v241, 4, v7
    s_add_u32 s38, s5, s34
    s_mul_i32 s38, s38, 18432
    s_lshl_b32 s40, s35, 6
    s_add_u32 s38, s38, s40
    s_lshl_b32 s40, s37, 10
    v_add_u32 v2, s40, v0
    v_add_u32 v4, s40, v1
    s_add_u32 s41, s39, s40
    s_lshl_b32 s40, s37, 7
    s_add_u32 s42, s36, s40
    s_lshl_b32 s40, s37, 6
    s_add_u32 s43, s38, s40
    buffer_load_dwordx4 v[16:19], v3, s[28:31], s36 offen offset:0 sc1
    buffer_load_dwordx4 v[20:23], v3, s[28:31], s36 offen offset:16 sc1
    ds_read_b128 v[40:43], v0 offset:0
    ds_read_b128 v[52:55], v1 offset:0
    buffer_load_dwordx4 v[24:27], v3, s[28:31], s36 offen offset:128 sc1
    buffer_load_dwordx4 v[28:31], v3, s[28:31], s36 offen offset:144 sc1
    ds_read_b128 v[44:47], v0 offset:1024
    ds_read_b128 v[56:59], v1 offset:1024
    buffer_load_dwordx4 v[32:35], v3, s[28:31], s42 offen offset:0 sc1
    buffer_load_dwordx4 v[36:39], v3, s[28:31], s42 offen offset:16 sc1
    ds_read_b128 v[48:51], v2 offset:0
    ds_read_b128 v[60:63], v4 offset:0
    v_lshrrev_b32 v8, 2, v242
    v_and_b32 v9, 1, v242
    v_lshlrev_b32 v9, 4, v9
    v_mov_b32 v10, 0x3f80
    v_lshlrev_b32 v9, v9, v10
    v_cmp_eq_u32 vcc, v8, v241
    s_nop 1
    v_cndmask_b32 v9, 0, v9, vcc
    v_and_b32 v8, 2, v242
    v_cmp_eq_u32 vcc, 0, v8
    s_nop 1
    v_cndmask_b32 v160, 0, v9, vcc
    v_cndmask_b32 v161, v9, 0, vcc
    v_mov_b32 v162, 0
    v_mov_b32 v163, 0
    v_mov_b32 v164, 0
    v_mov_b32 v165, 0
    v_mov_b32 v166, v160
    v_mov_b32 v167, v161
    s_waitcnt lgkmcnt(5)
    v_mfma_f32_16x16x32_bf16 v[168:171], v[160:163], v[40:43], 0
    v_mfma_f32_16x16x32_bf16 v[172:175], v[164:167], v[40:43], 0
    s_waitcnt lgkmcnt(3)
    v_mfma_f32_16x16x32_bf16 v[176:179], v[160:163], v[44:47], 0
    v_mfma_f32_16x16x32_bf16 v[180:183], v[164:167], v[44:47], 0
    s_waitcnt lgkmcnt(1)
    v_mfma_f32_16x16x32_bf16 v[184:187], v[160:163], v[48:51], 0
    v_mfma_f32_16x16x32_bf16 v[188:191], v[164:167], v[48:51], 0
    v_lshlrev_b32 v192, 16, v52
    v_and_b32 v193, 0xffff0000, v52
    v_lshlrev_b32 v194, 16, v53
    v_and_b32 v195, 0xffff0000, v53
    v_lshlrev_b32 v196, 16, v54
    v_and_b32 v197, 0xffff0000, v54
    v_lshlrev_b32 v198, 16, v55
    v_and_b32 v199, 0xffff0000, v55
    v_lshlrev_b32 v200, 16, v56
    v_and_b32 v201, 0xffff0000, v56
    v_lshlrev_b32 v202, 16, v57
    v_and_b32 v203, 0xffff0000, v57
    v_lshlrev_b32 v204, 16, v58
    v_and_b32 v205, 0xffff0000, v58
    v_lshlrev_b32 v206, 16, v59
    v_and_b32 v207, 0xffff0000, v59
    s_waitcnt lgkmcnt(0)
    v_lshlrev_b32 v208, 16, v60
    v_and_b32 v209, 0xffff0000, v60
    v_lshlrev_b32 v210, 16, v61
    v_and_b32 v211, 0xffff0000, v61
    v_lshlrev_b32 v212, 16, v62
    v_and_b32 v213, 0xffff0000, v62
    v_lshlrev_b32 v214, 16, v63
    v_and_b32 v215, 0xffff0000, v63
    s_add_u32 s45, s13, 1
    s_and_b32 s45, s45, 7
    s_mul_i32 s45, s45, 2359296
    s_add_u32 s46, s13, 2
    s_and_b32 s46, s46, 7
    s_mul_i32 s46, s46, 2359296
    s_add_u32 s47, s13, 3
    s_and_b32 s47, s47, 7
    s_mul_i32 s47, s47, 2359296
    s_add_u32 s48, s13, 4
    s_and_b32 s48, s48, 7
    s_mul_i32 s48, s48, 2359296
    s_add_u32 s49, s13, 5
    s_and_b32 s49, s49, 7
    s_mul_i32 s49, s49, 2359296
    s_add_u32 s50, s13, 6
    s_and_b32 s50, s50, 7
    s_mul_i32 s50, s50, 2359296
    s_add_u32 s51, s13, 7
    s_and_b32 s51, s51, 7
    s_mul_i32 s51, s51, 2359296
    s_lshl_b32 s61, s12, 10
    s_lshl_b32 s58, s13, 2
    s_add_u32 s61, s61, s58
    s_add_u32 s61, s61, 80
    v_lshl_add_u32 v249, v250, 3, s61
    s_waitcnt vmcnt(0) lgkmcnt(0)
    s_barrier
    ds_read_b128 v[64:67], v0 offset:18432
    ds_read_b128 v[96:99], v0 offset:19456
    ds_read_b128 v[128:131], v2 offset:18432
    s_waitcnt lgkmcnt(2)
    v_mfma_f32_16x16x32_bf16 v[168:171], v[160:163], v[64:67], v[168:171]
    v_mfma_f32_16x16x32_bf16 v[172:175], v[164:167], v[64:67], v[172:175]
    s_waitcnt lgkmcnt(1)
    v_mfma_f32_16x16x32_bf16 v[176:179], v[160:163], v[96:99], v[176:179]
    v_mfma_f32_16x16x32_bf16 v[180:183], v[164:167], v[96:99], v[180:183]
    s_waitcnt lgkmcnt(0)
    v_mfma_f32_16x16x32_bf16 v[184:187], v[160:163], v[128:131], v[184:187]
    v_mfma_f32_16x16x32_bf16 v[188:191], v[164:167], v[128:131], v[188:191]
    s_cmp_lg_u32 s3, 3
    s_cbranch_scc1 p5_32_go
    s_mov_b32 s58, 163840
    s_mov_b64 exec, 0xff
    buffer_store_dword v244, v249, s[28:31], s58 offen sc1
    s_mov_b64 exec, -1
    v_lshrrev_b32 v247, 2, v250
    v_add_u32 v247, 80, v247
    s_mov_b64 exec, 0xff
    s_mov_b32 s58, 0
poll_33:
    buffer_load_dword v246, v247, s[28:31], s60 offen sc1
    s_add_u32 s58, s58, 1
    s_waitcnt vmcnt(0)
    v_cmp_gt_u32 vcc, 1, v246
    s_cmp_gt_u32 s58, 0x40000
    s_cbranch_scc1 poll_33_done
    s_nop 3
    s_cbranch_vccnz poll_33
poll_33_done:
    s_mov_b64 exec, -1
p5_32_go:
    s_barrier
    s_cmp_eq_u32 s3, 0
    s_cbranch_scc1 p5_32_three
    s_add_u32 s40, s39, s45
    buffer_load_dwordx4 v[68:71], v6, s[28:31], s40 offen offset:0 sc1
    s_add_u32 s40, s39, s46
    buffer_load_dwordx4 v[72:75], v6, s[28:31], s40 offen offset:0 sc1
    s_add_u32 s40, s39, s47
    buffer_load_dwordx4 v[76:79], v6, s[28:31], s40 offen offset:0 sc1
    s_add_u32 s40, s39, s48
    buffer_load_dwordx4 v[80:83], v6, s[28:31], s40 offen offset:0 sc1
    s_add_u32 s40, s39, s49
    buffer_load_dwordx4 v[84:87], v6, s[28:31], s40 offen offset:0 sc1
    s_add_u32 s40, s39, s50
    buffer_load_dwordx4 v[88:91], v6, s[28:31], s40 offen offset:0 sc1
    s_add_u32 s40, s39, s51
    buffer_load_dwordx4 v[92:95], v6, s[28:31], s40 offen offset:0 sc1
    s_add_u32 s40, s39, s45
    buffer_load_dwordx4 v[100:103], v6, s[28:31], s40 offen offset:1024 sc1
    s_add_u32 s40, s39, s46
    buffer_load_dwordx4 v[104:107], v6, s[28:31], s40 offen offset:1024 sc1
    s_add_u32 s40, s39, s47
    buffer_load_dwordx4 v[108:111], v6, s[28:31], s40 offen offset:1024 sc1
    s_add_u32 s40, s39, s48
    buffer_load_dwordx4 v[112:115], v6, s[28:31], s40 offen offset:1024 sc1
    s_add_u32 s40, s39, s49
    buffer_load_dwordx4 v[116:119], v6, s[28:31], s40 offen offset:1024 sc1
    s_add_u32 s40, s39, s50
    buffer_load_dwordx4 v[120:123], v6, s[28:31], s40 offen offset:1024 sc1
    s_add_u32 s40, s39, s51
    buffer_load_dwordx4 v[124:127], v6, s[28:31], s40 offen offset:1024 sc1
    s_waitcnt vmcnt(13)
    v_mfma_f32_16x16x32_bf16 v[168:171], v[160:163], v[68:71], v[168:171]
    v_mfma_f32_16x16x32_bf16 v[172:175], v[164:167], v[68:71], v[172:175]
    s_waitcnt vmcnt(12)
    v_mfma_f32_16x16x32_bf16 v[168:171], v[160:163], v[72:75], v[168:171]
    v_mfma_f32_16x16x32_bf16 v[172:175], v[164:167], v[72:75], v[172:175]
    s_waitcnt vmcnt(11)
    v_mfma_f32_16x16x32_bf16 v[168:171], v[160:163], v[76:79], v[168:171]
    v_mfma_f32_16x16x32_bf16 v[172:175], v[164:167], v[76:79], v[172:175]
    s_waitcnt vmcnt(10)
    v_mfma_f32_16x16x32_bf16 v[168:171], v[160:163], v[80:83], v[168:171]
    v_mfma_f32_16x16x32_bf16 v[172:175], v[164:167], v[80:83], v[172:175]
    s_waitcnt vmcnt(9)
    v_mfma_f32_16x16x32_bf16 v[168:171], v[160:163], v[84:87], v[168:171]
    v_mfma_f32_16x16x32_bf16 v[172:175], v[164:167], v[84:87], v[172:175]
    s_waitcnt vmcnt(8)
    v_mfma_f32_16x16x32_bf16 v[168:171], v[160:163], v[88:91], v[168:171]
    v_mfma_f32_16x16x32_bf16 v[172:175], v[164:167], v[88:91], v[172:175]
    s_waitcnt vmcnt(7)
    v_mfma_f32_16x16x32_bf16 v[168:171], v[160:163], v[92:95], v[168:171]
    v_mfma_f32_16x16x32_bf16 v[172:175], v[164:167], v[92:95], v[172:175]
    s_waitcnt vmcnt(6)
    v_mfma_f32_16x16x32_bf16 v[176:179], v[160:163], v[100:103], v[176:179]
    v_mfma_f32_16x16x32_bf16 v[180:183], v[164:167], v[100:103], v[180:183]
    s_waitcnt vmcnt(5)
    v_mfma_f32_16x16x32_bf16 v[176:179], v[160:163], v[104:107], v[176:179]
    v_mfma_f32_16x16x32_bf16 v[180:183], v[164:167], v[104:107], v[180:183]
    s_waitcnt vmcnt(4)
    v_mfma_f32_16x16x32_bf16 v[176:179], v[160:163], v[108:111], v[176:179]
    v_mfma_f32_16x16x32_bf16 v[180:183], v[164:167], v[108:111], v[180:183]
    s_waitcnt vmcnt(3)
    v_mfma_f32_16x16x32_bf16 v[176:179], v[160:163], v[112:115], v[176:179]
    v_mfma_f32_16x16x32_bf16 v[180:183], v[164:167], v[112:115], v[180:183]
    s_waitcnt vmcnt(2)
    v_mfma_f32_16x16x32_bf16 v[176:179], v[160:163], v[116:119], v[176:179]
    v_mfma_f32_16x16x32_bf16 v[180:183], v[164:167], v[116:119], v[180:183]
    s_waitcnt vmcnt(1)
    v_mfma_f32_16x16x32_bf16 v[176:179], v[160:163], v[120:123], v[176:179]
    v_mfma_f32_16x16x32_bf16 v[180:183], v[164:167], v[120:123], v[180:183]
    s_waitcnt vmcnt(0)
    v_mfma_f32_16x16x32_bf16 v[176:179], v[160:163], v[124:127], v[176:179]
    v_mfma_f32_16x16x32_bf16 v[180:183], v[164:167], v[124:127], v[180:183]
    v_fmac_f32 v192, v168, v16
    v_fmac_f32 v193, v169, v17
    v_fmac_f32 v194, v170, v18
    v_fmac_f32 v195, v171, v19
    v_fmac_f32 v196, v172, v20
    v_fmac_f32 v197, v173, v21
    v_fmac_f32 v198, v174, v22
    v_fmac_f32 v199, v175, v23
    v_cvt_pk_bf16_f32 v216, v192, v193
    v_cvt_pk_bf16_f32 v217, v194, v195
    v_cvt_pk_bf16_f32 v218, v196, v197
    v_cvt_pk_bf16_f32 v219, v198, v199
    buffer_store_dwordx4 v[216:219], v7, s[8:11], s38 offen offset:0
    v_fmac_f32 v200, v176, v24
    v_fmac_f32 v201, v177, v25
    v_fmac_f32 v202, v178, v26
    v_fmac_f32 v203, v179, v27
    v_fmac_f32 v204, v180, v28
    v_fmac_f32 v205, v181, v29
    v_fmac_f32 v206, v182, v30
    v_fmac_f32 v207, v183, v31
    v_cvt_pk_bf16_f32 v220, v200, v201
    v_cvt_pk_bf16_f32 v221, v202, v203
    v_cvt_pk_bf16_f32 v222, v204, v205
    v_cvt_pk_bf16_f32 v223, v206, v207
    buffer_store_dwordx4 v[220:223], v7, s[8:11], s38 offen offset:64
    s_endpgm
p5_32_three:
    s_add_u32 s40, s39, s45
    buffer_load_dwordx4 v[68:71], v6, s[28:31], s40 offen offset:0 sc1
    s_add_u32 s40, s39, s46
    buffer_load_dwordx4 v[72:75], v6, s[28:31], s40 offen offset:0 sc1
    s_add_u32 s40, s39, s47
    buffer_load_dwordx4 v[76:79], v6, s[28:31], s40 offen offset:0 sc1
    s_add_u32 s40, s39, s48
    buffer_load_dwordx4 v[80:83], v6, s[28:31], s40 offen offset:0 sc1
    s_add_u32 s40, s39, s49
    buffer_load_dwordx4 v[84:87], v6, s[28:31], s40 offen offset:0 sc1
    s_add_u32 s40, s39, s50
    buffer_load_dwordx4 v[88:91], v6, s[28:31], s40 offen offset:0 sc1
    s_add_u32 s40, s39, s51
    buffer_load_dwordx4 v[92:95], v6, s[28:31], s40 offen offset:0 sc1
    s_add_u32 s40, s39, s45
    buffer_load_dwordx4 v[100:103], v6, s[28:31], s40 offen offset:1024 sc1
    s_add_u32 s40, s39, s46
    buffer_load_dwordx4 v[104:107], v6, s[28:31], s40 offen offset:1024 sc1
    s_add_u32 s40, s39, s47
    buffer_load_dwordx4 v[108:111], v6, s[28:31], s40 offen offset:1024 sc1
    s_add_u32 s40, s39, s48
    buffer_load_dwordx4 v[112:115], v6, s[28:31], s40 offen offset:1024 sc1
    s_add_u32 s40, s39, s49
    buffer_load_dwordx4 v[116:119], v6, s[28:31], s40 offen offset:1024 sc1
    s_add_u32 s40, s39, s50
    buffer_load_dwordx4 v[120:123], v6, s[28:31], s40 offen offset:1024 sc1
    s_add_u32 s40, s39, s51
    buffer_load_dwordx4 v[124:127], v6, s[28:31], s40 offen offset:1024 sc1
    s_add_u32 s40, s41, s45
    buffer_load_dwordx4 v[132:135], v6, s[28:31], s40 offen offset:0 sc1
    s_add_u32 s40, s41, s46
    buffer_load_dwordx4 v[136:139], v6, s[28:31], s40 offen offset:0 sc1
    s_add_u32 s40, s41, s47
    buffer_load_dwordx4 v[140:143], v6, s[28:31], s40 offen offset:0 sc1
    s_add_u32 s40, s41, s48
    buffer_load_dwordx4 v[144:147], v6, s[28:31], s40 offen offset:0 sc1
    s_add_u32 s40, s41, s49
    buffer_load_dwordx4 v[148:151], v6, s[28:31], s40 offen offset:0 sc1
    s_add_u32 s40, s41, s50
    buffer_load_dwordx4 v[152:155], v6, s[28:31], s40 offen offset:0 sc1
    s_add_u32 s40, s41, s51
    buffer_load_dwordx4 v[156:159], v6, s[28:31], s40 offen offset:0 sc1
    s_waitcnt vmcnt(20)
    v_mfma_f32_16x16x32_bf16 v[168:171], v[160:163], v[68:71], v[168:171]
    v_mfma_f32_16x16x32_bf16 v[172:175], v[164:167], v[68:71], v[172:175]
    s_waitcnt vmcnt(19)
    v_mfma_f32_16x16x32_bf16 v[168:171], v[160:163], v[72:75], v[168:171]
    v_mfma_f32_16x16x32_bf16 v[172:175], v[164:167], v[72:75], v[172:175]
    s_waitcnt vmcnt(18)
    v_mfma_f32_16x16x32_bf16 v[168:171], v[160:163], v[76:79], v[168:171]
    v_mfma_f32_16x16x32_bf16 v[172:175], v[164:167], v[76:79], v[172:175]
    s_waitcnt vmcnt(17)
    v_mfma_f32_16x16x32_bf16 v[168:171], v[160:163], v[80:83], v[168:171]
    v_mfma_f32_16x16x32_bf16 v[172:175], v[164:167], v[80:83], v[172:175]
    s_waitcnt vmcnt(16)
    v_mfma_f32_16x16x32_bf16 v[168:171], v[160:163], v[84:87], v[168:171]
    v_mfma_f32_16x16x32_bf16 v[172:175], v[164:167], v[84:87], v[172:175]
    s_waitcnt vmcnt(15)
    v_mfma_f32_16x16x32_bf16 v[168:171], v[160:163], v[88:91], v[168:171]
    v_mfma_f32_16x16x32_bf16 v[172:175], v[164:167], v[88:91], v[172:175]
    s_waitcnt vmcnt(14)
    v_mfma_f32_16x16x32_bf16 v[168:171], v[160:163], v[92:95], v[168:171]
    v_mfma_f32_16x16x32_bf16 v[172:175], v[164:167], v[92:95], v[172:175]
    s_waitcnt vmcnt(13)
    v_mfma_f32_16x16x32_bf16 v[176:179], v[160:163], v[100:103], v[176:179]
    v_mfma_f32_16x16x32_bf16 v[180:183], v[164:167], v[100:103], v[180:183]
    s_waitcnt vmcnt(12)
    v_mfma_f32_16x16x32_bf16 v[176:179], v[160:163], v[104:107], v[176:179]
    v_mfma_f32_16x16x32_bf16 v[180:183], v[164:167], v[104:107], v[180:183]
    s_waitcnt vmcnt(11)
    v_mfma_f32_16x16x32_bf16 v[176:179], v[160:163], v[108:111], v[176:179]
    v_mfma_f32_16x16x32_bf16 v[180:183], v[164:167], v[108:111], v[180:183]
    s_waitcnt vmcnt(10)
    v_mfma_f32_16x16x32_bf16 v[176:179], v[160:163], v[112:115], v[176:179]
    v_mfma_f32_16x16x32_bf16 v[180:183], v[164:167], v[112:115], v[180:183]
    s_waitcnt vmcnt(9)
    v_mfma_f32_16x16x32_bf16 v[176:179], v[160:163], v[116:119], v[176:179]
    v_mfma_f32_16x16x32_bf16 v[180:183], v[164:167], v[116:119], v[180:183]
    s_waitcnt vmcnt(8)
    v_mfma_f32_16x16x32_bf16 v[176:179], v[160:163], v[120:123], v[176:179]
    v_mfma_f32_16x16x32_bf16 v[180:183], v[164:167], v[120:123], v[180:183]
    s_waitcnt vmcnt(7)
    v_mfma_f32_16x16x32_bf16 v[176:179], v[160:163], v[124:127], v[176:179]
    v_mfma_f32_16x16x32_bf16 v[180:183], v[164:167], v[124:127], v[180:183]
    v_fmac_f32 v192, v168, v16
    v_fmac_f32 v193, v169, v17
    v_fmac_f32 v194, v170, v18
    v_fmac_f32 v195, v171, v19
    v_fmac_f32 v196, v172, v20
    v_fmac_f32 v197, v173, v21
    v_fmac_f32 v198, v174, v22
    v_fmac_f32 v199, v175, v23
    v_cvt_pk_bf16_f32 v216, v192, v193
    v_cvt_pk_bf16_f32 v217, v194, v195
    v_cvt_pk_bf16_f32 v218, v196, v197
    v_cvt_pk_bf16_f32 v219, v198, v199
    buffer_store_dwordx4 v[216:219], v7, s[8:11], s38 offen offset:0
    s_waitcnt vmcnt(7)
    v_mfma_f32_16x16x32_bf16 v[184:187], v[160:163], v[132:135], v[184:187]
    v_mfma_f32_16x16x32_bf16 v[188:191], v[164:167], v[132:135], v[188:191]
    s_waitcnt vmcnt(6)
    v_mfma_f32_16x16x32_bf16 v[184:187], v[160:163], v[136:139], v[184:187]
    v_mfma_f32_16x16x32_bf16 v[188:191], v[164:167], v[136:139], v[188:191]
    s_waitcnt vmcnt(5)
    v_mfma_f32_16x16x32_bf16 v[184:187], v[160:163], v[140:143], v[184:187]
    v_mfma_f32_16x16x32_bf16 v[188:191], v[164:167], v[140:143], v[188:191]
    s_waitcnt vmcnt(4)
    v_mfma_f32_16x16x32_bf16 v[184:187], v[160:163], v[144:147], v[184:187]
    v_mfma_f32_16x16x32_bf16 v[188:191], v[164:167], v[144:147], v[188:191]
    s_waitcnt vmcnt(3)
    v_mfma_f32_16x16x32_bf16 v[184:187], v[160:163], v[148:151], v[184:187]
    v_mfma_f32_16x16x32_bf16 v[188:191], v[164:167], v[148:151], v[188:191]
    s_waitcnt vmcnt(2)
    v_mfma_f32_16x16x32_bf16 v[184:187], v[160:163], v[152:155], v[184:187]
    v_mfma_f32_16x16x32_bf16 v[188:191], v[164:167], v[152:155], v[188:191]
    s_waitcnt vmcnt(1)
    v_mfma_f32_16x16x32_bf16 v[184:187], v[160:163], v[156:159], v[184:187]
    v_mfma_f32_16x16x32_bf16 v[188:191], v[164:167], v[156:159], v[188:191]
    v_fmac_f32 v200, v176, v24
    v_fmac_f32 v201, v177, v25
    v_fmac_f32 v202, v178, v26
    v_fmac_f32 v203, v179, v27
    v_fmac_f32 v204, v180, v28
    v_fmac_f32 v205, v181, v29
    v_fmac_f32 v206, v182, v30
    v_fmac_f32 v207, v183, v31
    v_cvt_pk_bf16_f32 v220, v200, v201
    v_cvt_pk_bf16_f32 v221, v202, v203
    v_cvt_pk_bf16_f32 v222, v204, v205
    v_cvt_pk_bf16_f32 v223, v206, v207
    buffer_store_dwordx4 v[220:223], v7, s[8:11], s38 offen offset:64
    v_fmac_f32 v208, v184, v32
    v_fmac_f32 v209, v185, v33
    v_fmac_f32 v210, v186, v34
    v_fmac_f32 v211, v187, v35
    v_fmac_f32 v212, v188, v36
    v_fmac_f32 v213, v189, v37
    v_fmac_f32 v214, v190, v38
    v_fmac_f32 v215, v191, v39
    v_cvt_pk_bf16_f32 v224, v208, v209
    v_cvt_pk_bf16_f32 v225, v210, v211
    v_cvt_pk_bf16_f32 v226, v212, v213
    v_cvt_pk_bf16_f32 v227, v214, v215
    buffer_store_dwordx4 v[224:227], v7, s[8:11], s43 offen offset:0
    s_endpgm
km_exit:
    s_endpgm
code_end:
.section .rodata,"a"
.p2align 6
.amdhsa_kernel adaLN_cond__ssm_conv_s4d__mixer_s_mlp__prompt_kernel
  .amdhsa_next_free_vgpr 512
  .amdhsa_next_free_sgpr 102
  .amdhsa_accum_offset 256
  .amdhsa_group_segment_fixed_size 0
  .amdhsa_kernarg_size 136
  .amdhsa_user_sgpr_count 2
  .amdhsa_user_sgpr_kernarg_segment_ptr 1
  .amdhsa_system_sgpr_workgroup_id_x 1
  .amdhsa_float_denorm_mode_32 3
  .amdhsa_float_denorm_mode_16_64 3
  .amdhsa_ieee_mode 0
.end_amdhsa_kernel
```
